```python
import torch

def _softmax(x, axis=-1):
    return torch.softmax(x, dim=axis)
def _gelu(x):
    return torch.nn.functional.gelu(x, approximate="tanh")
def _silu(x):
    return torch.nn.functional.silu(x)
def _sigmoid(x):
    return torch.sigmoid(x)
def _layernorm(x, axis=-1, eps=1e-5):
    m = x.mean(dim=axis, keepdim=True)
    v = x.var(dim=axis, keepdim=True, unbiased=False)
    return (x - m) / torch.sqrt(v + eps)
def _scatter_add(tgt, idx, src, axis=0):
    return tgt.clone().index_add_(axis, idx, src)
def _segment_sum(src, seg, n):
    out = torch.zeros((n,) + src.shape[1:], dtype=src.dtype)
    return out.index_add_(0, seg, src)
def _pad(x, pw):
    flat = tuple(v for pair in reversed(pw) for v in pair)
    return torch.nn.functional.pad(x, flat)

kernel_name = 'gated_mix__softmax_full_mha__mixer_channel_mlp__prompt'

def setup_inputs():

    _w = (lambda a: (lambda t: t.to(torch.bfloat16) if t.is_floating_point() else t)(torch.as_tensor(a)))
    def _A_setup():
        B, S, D = 1, 2048, 640
        return {
            "x": _w((lambda *s: torch.randn(*s, dtype=torch.bfloat16) * 0.05)(B, S, D)),
            "wqkv": _w((lambda *s: torch.randn(*s, dtype=torch.bfloat16) * 0.8)(D, 3 * D)),
            "wo": _w((lambda *s: torch.randn(*s, dtype=torch.bfloat16) * 0.1)(D, D)),
        }
    _A_in = _A_setup()

    def _B_setup():
        B, S, D, F = 1, 2048, 640, 1536
        return {
            "x": _w((lambda *s: torch.randn(*s, dtype=torch.bfloat16) * 0.05)(B, S, D)),
            "w1": _w((lambda *s: torch.randn(*s, dtype=torch.bfloat16) * 1.6)(D, F) * (D ** -0.5)),
            "b1": _w((lambda *s: torch.randn(*s, dtype=torch.bfloat16) * 1.6)(F)),
            "w2": _w((lambda *s: torch.randn(*s, dtype=torch.bfloat16) * 0.05)(F, D) * (F ** -0.5)),
            "b2": _w((lambda *s: torch.randn(*s, dtype=torch.bfloat16) * 0.05)(D)),
        }
    _B_in = _B_setup()

    return {
        "A_x": _A_in["x"],
        "A_wqkv": _A_in["wqkv"],
        "A_wo": _A_in["wo"],
        "B_x": _B_in["x"],
        "B_w1": _B_in["w1"],
        "B_b1": _B_in["b1"],
        "B_w2": _B_in["w2"],
        "B_b2": _B_in["b2"],
        "gate_w": _w((lambda *s: torch.randn(*s, dtype=torch.bfloat16) * 0.05)(640) * 16.0),
    }

def reference(A_x, A_wqkv, A_wo, B_x, B_w1, B_b1, B_w2, B_b2, gate_w):
    def _A_ref(x, wqkv, wo):
        B, S, D = x.shape
        H = 32; Dh = D // H
        qkv = (lambda x, *d: x.permute(*d))((x @ wqkv).reshape(B, S, 3, H, Dh), 2, 0, 3, 1, 4)
        q, k, v = qkv[0], qkv[1], qkv[2]
        scale = Dh ** -0.5
        scores = torch.einsum("bhqd,bhkd->bhqk", q, k) * scale
        p = _softmax(scores, axis=-1)
        o = torch.einsum("bhqk,bhkd->bhqd", p, v)
        return (lambda x, *d: x.permute(*d))(o, 0, 2, 1, 3).reshape(B, S, D) @ wo

    def _B_ref(x, w1, b1, w2, b2):
        y = _layernorm(x, axis=-1)
        h = _gelu(torch.einsum("bsd,df->bsf", y, w1) + b1)
        return torch.einsum("bsf,fd->bsd", h, w2) + b2

    x = A_x
    g = _sigmoid((x * gate_w).sum(-1, keepdims=True))
    a = _A_ref(x, A_wqkv, A_wo)
    b = _B_ref(x, B_w1, B_b1, B_w2, B_b2)
    return g * a + (1 - g) * b
```

```asm
; @launch grid=(256,1,1) block=(256,1,1) lds=163840
.amdgcn_target "amdgcn-amd-amdhsa--gfx950"
.text
.globl gated_mix__softmax_full_mha__mixer_channel_mlp__prompt_kernel
.p2align 8
.type gated_mix__softmax_full_mha__mixer_channel_mlp__prompt_kernel,@function
gated_mix__softmax_full_mha__mixer_channel_mlp__prompt_kernel:
    s_getpc_b64 s[90:91]
L_pc_base:
    s_lshr_b32 s92, s2, 3
    s_and_b32 s92, s92, 31
    s_mul_i32 s92, s92, (L_code_end-L_pc_base+4095)/4096
    v_add_u32 v2, s92, v0
    v_lshlrev_b32 v2, 7, v2
    v_min_u32 v2, L_code_end-L_pc_base-4, v2
    v_cmp_gt_u32 vcc, (L_code_end-L_pc_base+4095)/4096, v0
    s_and_saveexec_b64 s[92:93], vcc
    s_cbranch_execz L_pf_skip
    global_load_dword v252, v2, s[90:91]
L_pf_skip:
    s_mov_b64 exec, s[92:93]
    s_cmp_ge_u32 s2, 256
    s_cbranch_scc1 L_exit_gated_mix__softmax_full_mha__mixer_channel_mlp__prompt_kernel
    s_load_dwordx2 s[4:5], s[0:1], 0
    s_load_dwordx2 s[8:9], s[0:1], 8
    s_load_dwordx2 s[12:13], s[0:1], 16
    s_load_dwordx2 s[16:17], s[0:1], 32
    s_load_dwordx2 s[32:33], s[0:1], 40
    s_load_dwordx2 s[20:21], s[0:1], 48
    s_load_dwordx2 s[34:35], s[0:1], 56
    s_load_dwordx2 s[36:37], s[0:1], 64
    s_load_dwordx2 s[28:29], s[0:1], 72
    s_load_dwordx2 s[38:39], s[0:1], 80
    s_load_dwordx2 s[24:25], s[0:1], 88
    v_lshrrev_b32 v1, 6, v0
    s_mov_b32 s41, s2
    s_mov_b32 s6, 2621440
    s_mov_b32 s7, 0x00020000
    s_mov_b32 s10, 2457600
    s_mov_b32 s11, 0x00020000
    s_mov_b32 s14, 819200
    s_mov_b32 s15, 0x00020000
    s_mov_b32 s18, 1966080
    s_mov_b32 s19, 0x00020000
    s_mov_b32 s22, 1966080
    s_mov_b32 s23, 0x00020000
    s_mov_b32 s26, 25165824
    s_mov_b32 s27, 0x00020000
    s_mov_b32 s30, 2621440
    s_mov_b32 s31, 0x00020000
    v_readfirstlane_b32 s40, v1
    s_and_b32 s55, s41, 7
    s_lshr_b32 s56, s41, 3
    s_lshr_b32 s46, s55, 2
    s_lshl_b32 s46, s46, 3
    s_and_b32 s57, s56, 7
    s_add_u32 s46, s46, s57
    s_and_b32 s47, s55, 3
    s_lshl_b32 s47, s47, 2
    s_lshr_b32 s58, s56, 3
    s_add_u32 s47, s47, s58
    s_mul_i32 s82, s58, 5
    s_lshr_b32 s82, s82, 1
    s_add_u32 s82, s82, s57
    s_cmp_ge_u32 s82, 10
    s_cselect_b32 s57, 10, 0
    s_sub_u32 s82, s82, s57
    s_and_b32 s48, s40, 1
    s_lshr_b32 s49, s40, 1
    s_lshl_b32 s50, s46, 7
    s_mul_i32 s55, s47, 160
    s_mul_i32 s56, s47, 192
    s_sub_u32 s56, s56, 1536
    s_lshl_b32 s57, s47, 6
    s_add_u32 s58, s56, 160
    s_movk_i32 s51, 3072
    s_cmp_lt_u32 s47, 12
    s_cselect_b32 s51, 3840, s51
    s_cselect_b32 s52, s55, s56
    s_cselect_b32 s68, s57, s58
    v_and_b32 v1, 63, v0
    v_and_b32 v2, 15, v0
    v_lshrrev_b32 v3, 4, v1
    s_lshl_b32 s55, s40, 5
    s_add_u32 s55, s55, s50
    v_lshrrev_b32 v21, 3, v1
    v_add_u32 v21, s55, v21
    v_mul_u32_u24 v21, 1280, v21
    v_and_b32 v22, 7, v1
    v_xor_b32 v22, v22, v3
    v_lshlrev_b32 v23, 4, v22
    v_xor_b32 v24, 64, v23
    v_add_u32 v4, v21, v23
    v_add_u32 v5, v21, v24
    v_add_u32 v5, 9216, v5
    v_add_u32 v6, v21, v23
    v_add_u32 v6, 18432, v6
    v_add_u32 v7, v21, v24
    v_add_u32 v7, 27648, v7
    s_mul_i32 s55, s40, 320
    v_add_u32 v21, s55, v1
    v_mul_u32_u24 v22, 3277, v21
    v_lshrrev_b32 v22, 16, v22
    v_mul_u32_u24 v23, 20, v22
    v_sub_u32 v23, v21, v23
    v_bfe_u32 v24, v22, 3, 1
    v_lshlrev_b32 v24, 1, v24
    v_xor_b32 v23, v23, v24
    v_lshlrev_b32 v23, 4, v23
    v_mul_u32_u24 v22, s51, v22
    v_add_u32 v8, v22, v23
    v_add_u32 v21, s55, v1
    v_add_u32 v21, 64, v21
    v_mul_u32_u24 v22, 3277, v21
    v_lshrrev_b32 v22, 16, v22
    v_mul_u32_u24 v23, 20, v22
    v_sub_u32 v23, v21, v23
    v_bfe_u32 v24, v22, 3, 1
    v_lshlrev_b32 v24, 1, v24
    v_xor_b32 v23, v23, v24
    v_lshlrev_b32 v23, 4, v23
    v_mul_u32_u24 v22, s51, v22
    v_add_u32 v9, v22, v23
    v_subrev_u32 v9, 1024, v9
    v_add_u32 v21, s55, v1
    v_add_u32 v21, 128, v21
    v_mul_u32_u24 v22, 3277, v21
    v_lshrrev_b32 v22, 16, v22
    v_mul_u32_u24 v23, 20, v22
    v_sub_u32 v23, v21, v23
    v_bfe_u32 v24, v22, 3, 1
    v_lshlrev_b32 v24, 1, v24
    v_xor_b32 v23, v23, v24
    v_lshlrev_b32 v23, 4, v23
    v_mul_u32_u24 v22, s51, v22
    v_add_u32 v10, v22, v23
    v_subrev_u32 v10, 2048, v10
    v_add_u32 v21, s55, v1
    v_add_u32 v21, 192, v21
    v_mul_u32_u24 v22, 3277, v21
    v_lshrrev_b32 v22, 16, v22
    v_mul_u32_u24 v23, 20, v22
    v_sub_u32 v23, v21, v23
    v_bfe_u32 v24, v22, 3, 1
    v_lshlrev_b32 v24, 1, v24
    v_xor_b32 v23, v23, v24
    v_lshlrev_b32 v23, 4, v23
    v_mul_u32_u24 v22, s51, v22
    v_add_u32 v11, v22, v23
    v_subrev_u32 v11, 3072, v11
    v_add_u32 v21, s55, v1
    v_add_u32 v21, 256, v21
    v_mul_u32_u24 v22, 3277, v21
    v_lshrrev_b32 v22, 16, v22
    v_mul_u32_u24 v23, 20, v22
    v_sub_u32 v23, v21, v23
    v_bfe_u32 v24, v22, 3, 1
    v_lshlrev_b32 v24, 1, v24
    v_xor_b32 v23, v23, v24
    v_lshlrev_b32 v23, 4, v23
    v_mul_u32_u24 v22, s51, v22
    v_add_u32 v12, v22, v23
    s_lshl_b32 s53, s82, 7
    s_lshl_b32 s73, s51, 6
    s_mul_i32 s54, s82, s73
    s_lshl_b32 s55, s52, 1
    s_add_u32 s54, s54, s55
    s_mul_i32 s76, s73, 10
    s_lshl_b32 s83, s40, 12
    s_mul_i32 s69, s40, 5120
    s_add_u32 s69, s69, 16384
    s_waitcnt lgkmcnt(0)
    s_cmp_lt_u32 s47, 12
    s_cselect_b32 s64, s8, s16
    s_cselect_b32 s65, s9, s17
    s_cselect_b32 s66, s10, s18
    s_mov_b32 s67, 0x00020000
    s_or_b32 s88, s41, s40
    s_cmp_lg_u32 s88, 0
    s_cbranch_scc1 L_nononce_1
    s_mov_b64 exec, 1
    v_mov_b32 v204, 196608
    buffer_load_dwordx2 v[200:201], v204, s[24:27], 0 offen sc1
    s_waitcnt vmcnt(0)
    v_add_co_u32 v200, vcc, 1, v200
    s_nop 1
    v_addc_co_u32 v201, vcc, 0, v201, vcc
    v_or_b32 v202, v200, v201
    v_cmp_eq_u32 vcc, 0, v202
    s_nop 1
    v_cndmask_b32 v200, v200, 1, vcc
    v_mov_b32 v202, 0
    v_mov_b32 v203, 0
    v_mov_b32 v205, 0
    buffer_store_dwordx2 v[200:201], v204, s[24:27], 0 offen sc1
    global_atomic_cmpswap_x2 v205, v[200:203], s[38:39]
    s_mov_b64 exec, -1
L_nononce_1:
    s_and_b32 s42, s41, 7
    s_lshl_b32 s42, s42, 8
    s_lshr_b32 s43, s41, 3
    s_lshl_b32 s43, s43, 3
    s_add_u32 s42, s42, s43
    s_lshl_b32 s43, s40, 1
    s_add_u32 s42, s42, s43
    v_and_b32 v182, 63, v0
    v_lshrrev_b32 v183, 5, v182
    v_and_b32 v182, 31, v182
    v_add_u32 v184, s42, v183
    s_movk_i32 s43, 1280
    v_mul_lo_u32 v180, v184, s43
    v_lshlrev_b32 v181, 3, v182
    v_add_u32 v180, v180, v181
    buffer_load_dwordx2 v[160:161], v180, s[4:7], 0 offen offset:0
    buffer_load_dwordx2 v[162:163], v180, s[4:7], 0 offen offset:256
    buffer_load_dwordx2 v[164:165], v180, s[4:7], 0 offen offset:512
    buffer_load_dwordx2 v[166:167], v180, s[4:7], 0 offen offset:768
    buffer_load_dwordx2 v[168:169], v180, s[4:7], 0 offen offset:1024
    global_load_dwordx2 v[170:171], v181, s[36:37] offset:0
    global_load_dwordx2 v[172:173], v181, s[36:37] offset:256
    global_load_dwordx2 v[174:175], v181, s[36:37] offset:512
    global_load_dwordx2 v[176:177], v181, s[36:37] offset:768
    global_load_dwordx2 v[178:179], v181, s[36:37] offset:1024
    s_add_u32 m0, s83, 0
    s_nop 0
    buffer_load_dwordx4 v4, s[4:7], s53 offen offset:0 lds
    buffer_load_dwordx4 v5, s[4:7], s53 offen offset:1024 lds
    buffer_load_dwordx4 v6, s[4:7], s53 offen offset:2048 lds
    buffer_load_dwordx4 v7, s[4:7], s53 offen offset:3072 lds
    s_lshl_b32 s55, s48, 6
    v_add_u32 v21, s55, v2
    v_lshlrev_b32 v21, 7, v21
    v_lshrrev_b32 v22, 1, v2
    v_xor_b32 v22, v22, v3
    v_lshl_add_u32 v13, v22, 4, v21
    v_xor_b32 v14, 64, v13
    v_lshrrev_b32 v21, 2, v2
    v_lshl_add_u32 v21, v3, 3, v21
    v_mul_u32_u24 v21, 320, v21
    v_and_b32 v22, 3, v2
    v_lshl_add_u32 v21, v22, 3, v21
    s_mul_i32 s55, s49, 160
    s_add_u32 s55, s55, 16384
    v_add_u32 v21, s55, v21
    v_and_b32 v22, 1, v3
    v_lshlrev_b32 v22, 5, v22
    v_add_u32 v23, v21, v22
    v_sub_u32 v24, v21, v22
    s_cmp_eq_u32 s49, 0
    s_cselect_b64 vcc, -1, 0
    v_cndmask_b32 v15, v24, v23, vcc
    v_cndmask_b32 v16, v23, v24, vcc
    s_mov_b32 s78, 0x3f803f80
    v_add_u32 v17, 73728, v13
    v_add_u32 v18, 73728, v14
    v_add_u32 v19, 73728, v15
    v_add_u32 v20, 73728, v16
    s_and_b32 s88, s41, 7
    s_lshr_b32 s89, s41, 3
    s_lshl_b32 s100, s88, 2
    s_lshr_b32 s98, s89, 3
    s_add_u32 s100, s100, s98
    s_and_b32 s98, s89, 7
    s_lshl_b32 s98, s98, 5
    s_add_u32 s100, s100, s98
    s_lshl_b32 s100, s100, 7
    s_add_u32 s100, s100, 131072
    s_lshl_b32 s101, s88, 5
    s_add_u32 s101, s101, s89
    s_lshl_b32 s101, s101, 7
    s_add_u32 s101, s101, 163840
    s_lshl_b32 s98, s47, 4
    s_add_u32 s98, s98, s46
    s_lshl_b32 s98, s98, 7
    s_add_u32 s98, s98, 65536
    s_lshl_b32 s99, s46, 4
    s_add_u32 s99, s99, s47
    s_lshl_b32 s99, s99, 7
    s_add_u32 s99, s99, 98304
    s_add_u32 m0, s69, 0
    s_nop 0
    buffer_load_dwordx4 v8, s[64:67], s54 offen offset:0 lds
    buffer_load_dwordx4 v9, s[64:67], s54 offen offset:1024 lds
    buffer_load_dwordx4 v10, s[64:67], s54 offen offset:2048 lds
    buffer_load_dwordx4 v11, s[64:67], s54 offen offset:3072 lds
    s_add_u32 m0, s69, 4096
    s_nop 0
    buffer_load_dwordx4 v12, s[64:67], s54 offen offset:0 lds
    s_add_u32 s53, s53, 128
    s_add_u32 s54, s54, s73
    s_cmp_ge_u32 s53, 1280
    s_cselect_b32 s55, 1280, 0
    s_cselect_b32 s56, s76, 0
    s_sub_u32 s53, s53, s55
    s_sub_u32 s54, s54, s56
    s_cmp_ge_u32 s47, 12
    s_cbranch_scc1 L_p1m2_6
    v_lshrrev_b32 v216, 3, v1
    v_bfe_u32 v217, v1, 4, 1
    v_lshlrev_b32 v217, 1, v217
    v_and_b32 v218, 7, v1
    v_xor_b32 v218, v218, v217
    v_lshlrev_b32 v218, 4, v218
    v_xor_b32 v219, 64, v218
    v_mul_u32_u24 v216, 3072, v216
    v_add_u32 v21, v216, v218
    v_add_u32 v22, v216, v219
    v_add_u32 v22, 23552, v22
    v_add_u32 v23, v216, v218
    v_add_u32 v23, 47104, v23
    v_add_u32 v24, v216, v219
    v_add_u32 v24, 70656, v24
    v_lshrrev_b32 v216, 2, v2
    v_lshl_add_u32 v216, v3, 3, v216
    v_lshlrev_b32 v216, 7, v216
    v_and_b32 v217, 3, v2
    v_lshl_add_u32 v216, v217, 3, v216
    v_bfe_u32 v217, v2, 3, 1
    v_and_b32 v218, 1, v3
    v_lshl_or_b32 v217, v218, 1, v217
    s_lshl_b32 s55, s49, 1
    s_add_u32 s56, s55, 0
    v_xor_b32 v218, s56, v217
    v_lshl_add_u32 v25, v218, 5, v216
    s_add_u32 s56, s55, 1
    v_xor_b32 v218, s56, v217
    v_lshl_add_u32 v26, v218, 5, v216
    s_branch L_p1go_7
L_p1m2_6:
    v_lshrrev_b32 v216, 2, v1
    v_lshrrev_b32 v217, 5, v1
    v_lshlrev_b32 v217, 1, v217
    v_and_b32 v218, 3, v1
    v_xor_b32 v218, v218, v217
    v_lshlrev_b32 v218, 4, v218
    v_mul_u32_u24 v216, 3072, v216
    v_add_u32 v21, v216, v218
    v_add_u32 v22, 48128, v21
    v_add_u32 v23, 96256, v21
    v_add_u32 v24, 144384, v21
    v_lshrrev_b32 v216, 2, v2
    v_lshl_add_u32 v216, v3, 3, v216
    v_lshlrev_b32 v216, 6, v216
    v_and_b32 v217, 3, v2
    v_lshl_add_u32 v216, v217, 3, v216
    v_and_b32 v218, 1, v3
    v_xor_b32 v218, s49, v218
    v_lshl_add_u32 v25, v218, 5, v216
L_p1go_7:
    s_mov_b32 s43, 0x3f803f80
    v_mov_b32 v185, 0
    v_mov_b32 v186, 0
    v_mov_b32 v187, 0
    s_waitcnt vmcnt(9)
    v_dot2_f32_bf16 v185, v160, s43, v185
    v_dot2_f32_bf16 v186, v160, v170, v186
    v_dot2_f32_bf16 v187, v160, v160, v187
    v_dot2_f32_bf16 v185, v161, s43, v185
    v_dot2_f32_bf16 v186, v161, v171, v186
    v_dot2_f32_bf16 v187, v161, v161, v187
    v_dot2_f32_bf16 v185, v162, s43, v185
    v_dot2_f32_bf16 v186, v162, v172, v186
    v_dot2_f32_bf16 v187, v162, v162, v187
    v_dot2_f32_bf16 v185, v163, s43, v185
    v_dot2_f32_bf16 v186, v163, v173, v186
    v_dot2_f32_bf16 v187, v163, v163, v187
    v_dot2_f32_bf16 v185, v164, s43, v185
    v_dot2_f32_bf16 v186, v164, v174, v186
    v_dot2_f32_bf16 v187, v164, v164, v187
    v_dot2_f32_bf16 v185, v165, s43, v185
    v_dot2_f32_bf16 v186, v165, v175, v186
    v_dot2_f32_bf16 v187, v165, v165, v187
    v_dot2_f32_bf16 v185, v166, s43, v185
    v_dot2_f32_bf16 v186, v166, v176, v186
    v_dot2_f32_bf16 v187, v166, v166, v187
    v_dot2_f32_bf16 v185, v167, s43, v185
    v_dot2_f32_bf16 v186, v167, v177, v186
    v_dot2_f32_bf16 v187, v167, v167, v187
    v_dot2_f32_bf16 v185, v168, s43, v185
    v_dot2_f32_bf16 v186, v168, v178, v186
    v_dot2_f32_bf16 v187, v168, v168, v187
    v_dot2_f32_bf16 v185, v169, s43, v185
    v_dot2_f32_bf16 v186, v169, v179, v186
    v_dot2_f32_bf16 v187, v169, v169, v187
    s_nop 2
    s_nop 1
    v_add_f32_dpp v185, v185, v185 quad_perm:[1,0,3,2] row_mask:0xf bank_mask:0xf
    v_add_f32_dpp v186, v186, v186 quad_perm:[1,0,3,2] row_mask:0xf bank_mask:0xf
    v_add_f32_dpp v187, v187, v187 quad_perm:[1,0,3,2] row_mask:0xf bank_mask:0xf
    s_nop 1
    v_add_f32_dpp v185, v185, v185 quad_perm:[2,3,0,1] row_mask:0xf bank_mask:0xf
    v_add_f32_dpp v186, v186, v186 quad_perm:[2,3,0,1] row_mask:0xf bank_mask:0xf
    v_add_f32_dpp v187, v187, v187 quad_perm:[2,3,0,1] row_mask:0xf bank_mask:0xf
    s_nop 1
    v_add_f32_dpp v185, v185, v185 row_half_mirror row_mask:0xf bank_mask:0xf
    v_add_f32_dpp v186, v186, v186 row_half_mirror row_mask:0xf bank_mask:0xf
    v_add_f32_dpp v187, v187, v187 row_half_mirror row_mask:0xf bank_mask:0xf
    s_nop 1
    v_add_f32_dpp v185, v185, v185 row_mirror row_mask:0xf bank_mask:0xf
    v_add_f32_dpp v186, v186, v186 row_mirror row_mask:0xf bank_mask:0xf
    v_add_f32_dpp v187, v187, v187 row_mirror row_mask:0xf bank_mask:0xf
    v_mov_b32 v188, v185
    v_mov_b32 v189, v186
    v_mov_b32 v190, v187
    s_nop 1
    v_permlane16_swap_b32 v188, v185
    v_permlane16_swap_b32 v189, v186
    v_permlane16_swap_b32 v190, v187
    v_add_f32 v185, v185, v188
    v_add_f32 v186, v186, v189
    v_add_f32 v187, v187, v190
    v_mul_f32 v160, 0x3acccccd, v185
    v_mul_f32 v190, 0xbfb8aa3b, v186
    v_mul_f32 v189, 0x3acccccd, v187
    v_exp_f32 v190, v190
    v_fma_f32 v189, -v160, v160, v189
    v_max_f32 v189, 0, v189
    v_add_f32 v189, 0x3727c5ac, v189
    v_add_f32 v190, 1.0, v190
    v_rsq_f32 v161, v189
    v_rcp_f32 v162, v190
    v_lshlrev_b32 v188, 4, v184
    v_cmp_eq_u32 vcc, 0, v182
    v_sub_f32 v163, 1.0, v162
    s_and_saveexec_b64 s[44:45], vcc
    buffer_store_dwordx4 v[160:163], v188, s[24:27], 0 offen offset:0 sc1
    s_mov_b64 exec, s[44:45]
    v_mov_b32 v253, 0
    s_mov_b32 exec_lo, 0x1
    s_mov_b32 exec_hi, 0x0
    global_load_dwordx2 v[254:255], v253, s[38:39] sc1
    s_mov_b64 exec, -1
    s_add_u32 m0, s83, 36864
    s_nop 0
    buffer_load_dwordx4 v4, s[4:7], s53 offen offset:0 lds
    buffer_load_dwordx4 v5, s[4:7], s53 offen offset:1024 lds
    buffer_load_dwordx4 v6, s[4:7], s53 offen offset:2048 lds
    buffer_load_dwordx4 v7, s[4:7], s53 offen offset:3072 lds
    s_add_u32 m0, s69, 36864
    s_nop 0
    buffer_load_dwordx4 v8, s[64:67], s54 offen offset:0 lds
    buffer_load_dwordx4 v9, s[64:67], s54 offen offset:1024 lds
    buffer_load_dwordx4 v10, s[64:67], s54 offen offset:2048 lds
    buffer_load_dwordx4 v11, s[64:67], s54 offen offset:3072 lds
    s_add_u32 m0, s69, 40960
    s_nop 0
    buffer_load_dwordx4 v12, s[64:67], s54 offen offset:0 lds
    s_add_u32 s53, s53, 128
    s_add_u32 s54, s54, s73
    s_cmp_ge_u32 s53, 1280
    s_cselect_b32 s55, 1280, 0
    s_cselect_b32 s56, s76, 0
    s_sub_u32 s53, s53, s55
    s_sub_u32 s54, s54, s56
    s_waitcnt vmcnt(11)
    s_barrier
    s_cmp_ge_u32 s47, 12
    s_cbranch_scc1 L_p1m_3
    s_lshl_b32 s79, s49, 5
    s_add_u32 s79, s79, s68
    s_cmp_ge_u32 s47, 8
    s_cbranch_scc1 L_p1v_2
    ds_read_b64_tr_b16 v[112:113], v15 offset:0
    ds_read_b64_tr_b16 v[114:115], v15 offset:1280
    ds_read_b128 a[0:3], v13 offset:0
    ds_read_b128 a[80:83], v13 offset:2048
    ds_read_b128 a[160:163], v13 offset:4096
    ds_read_b128 a[240:243], v13 offset:6144
    ds_read_b64_tr_b16 v[116:117], v16 offset:32
    ds_read_b64_tr_b16 v[118:119], v16 offset:1312
    ds_read_b64_tr_b16 v[120:121], v15 offset:64
    ds_read_b64_tr_b16 v[122:123], v15 offset:1344
    ds_read_b64_tr_b16 v[124:125], v16 offset:96
    ds_read_b64_tr_b16 v[126:127], v16 offset:1376
    ds_read_b64_tr_b16 v[128:129], v15 offset:128
    ds_read_b64_tr_b16 v[130:131], v15 offset:1408
    s_waitcnt lgkmcnt(0)
    v_mfma_f32_16x16x32_bf16 v[32:35], v[112:115], a[0:3], 0
    ds_read_b64_tr_b16 v[132:133], v15 offset:10240
    s_add_u32 m0, s83, 73728
    v_mfma_f32_16x16x32_bf16 v[36:39], v[112:115], a[80:83], 0
    ds_read_b64_tr_b16 v[134:135], v15 offset:11520
    buffer_load_dwordx4 v4, s[4:7], s53 offen offset:0 lds
    v_mfma_f32_16x16x32_bf16 v[40:43], v[112:115], a[160:163], 0
    ds_read_b128 a[4:7], v14 offset:0
    v_mfma_f32_16x16x32_bf16 v[44:47], v[112:115], a[240:243], 0
    ds_read_b128 a[84:87], v14 offset:2048
    v_mfma_f32_16x16x32_bf16 v[48:51], v[116:119], a[0:3], 0
    ds_read_b128 a[164:167], v14 offset:4096
    buffer_load_dwordx4 v5, s[4:7], s53 offen offset:1024 lds
    v_mfma_f32_16x16x32_bf16 v[52:55], v[116:119], a[80:83], 0
    ds_read_b128 a[244:247], v14 offset:6144
    v_mfma_f32_16x16x32_bf16 v[56:59], v[116:119], a[160:163], 0
    ds_read_b64_tr_b16 v[136:137], v16 offset:10272
    v_mfma_f32_16x16x32_bf16 v[60:63], v[116:119], a[240:243], 0
    ds_read_b64_tr_b16 v[138:139], v16 offset:11552
    v_mfma_f32_16x16x32_bf16 v[64:67], v[120:123], a[0:3], 0
    ds_read_b64_tr_b16 v[140:141], v15 offset:10304
    buffer_load_dwordx4 v6, s[4:7], s53 offen offset:2048 lds
    v_mfma_f32_16x16x32_bf16 v[68:71], v[120:123], a[80:83], 0
    ds_read_b64_tr_b16 v[142:143], v15 offset:11584
    v_mfma_f32_16x16x32_bf16 v[72:75], v[120:123], a[160:163], 0
    ds_read_b64_tr_b16 v[144:145], v16 offset:10336
    v_mfma_f32_16x16x32_bf16 v[76:79], v[120:123], a[240:243], 0
    ds_read_b64_tr_b16 v[146:147], v16 offset:11616
    v_mfma_f32_16x16x32_bf16 v[80:83], v[124:127], a[0:3], 0
    ds_read_b64_tr_b16 v[148:149], v15 offset:10368
    buffer_load_dwordx4 v7, s[4:7], s53 offen offset:3072 lds
    v_mfma_f32_16x16x32_bf16 v[84:87], v[124:127], a[80:83], 0
    ds_read_b64_tr_b16 v[150:151], v15 offset:11648
    v_mfma_f32_16x16x32_bf16 v[88:91], v[124:127], a[160:163], 0
    s_add_u32 m0, s69, 73728
    v_mfma_f32_16x16x32_bf16 v[92:95], v[124:127], a[240:243], 0
    v_mfma_f32_16x16x32_bf16 v[96:99], v[128:131], a[0:3], 0
    buffer_load_dwordx4 v8, s[64:67], s54 offen offset:0 lds
    v_mfma_f32_16x16x32_bf16 v[100:103], v[128:131], a[80:83], 0
    v_mfma_f32_16x16x32_bf16 v[104:107], v[128:131], a[160:163], 0
    v_mfma_f32_16x16x32_bf16 v[108:111], v[128:131], a[240:243], 0
    s_waitcnt lgkmcnt(0)
    s_waitcnt vmcnt(5)
    s_barrier
    v_mfma_f32_16x16x32_bf16 v[32:35], v[132:135], a[4:7], v[32:35]
    ds_read_b64_tr_b16 v[112:113], v15 offset:36864
    buffer_load_dwordx4 v9, s[64:67], s54 offen offset:1024 lds
    v_mfma_f32_16x16x32_bf16 v[36:39], v[132:135], a[84:87], v[36:39]
    ds_read_b64_tr_b16 v[114:115], v15 offset:38144
    v_mfma_f32_16x16x32_bf16 v[40:43], v[132:135], a[164:167], v[40:43]
    ds_read_b128 a[8:11], v13 offset:36864
    v_mfma_f32_16x16x32_bf16 v[44:47], v[132:135], a[244:247], v[44:47]
    ds_read_b128 a[88:91], v13 offset:38912
    v_mfma_f32_16x16x32_bf16 v[48:51], v[136:139], a[4:7], v[48:51]
    ds_read_b128 a[168:171], v13 offset:40960
    buffer_load_dwordx4 v10, s[64:67], s54 offen offset:2048 lds
    v_mfma_f32_16x16x32_bf16 v[52:55], v[136:139], a[84:87], v[52:55]
    ds_read_b128 a[248:251], v13 offset:43008
    v_mfma_f32_16x16x32_bf16 v[56:59], v[136:139], a[164:167], v[56:59]
    ds_read_b64_tr_b16 v[116:117], v16 offset:36896
    v_mfma_f32_16x16x32_bf16 v[60:63], v[136:139], a[244:247], v[60:63]
    ds_read_b64_tr_b16 v[118:119], v16 offset:38176
    v_mfma_f32_16x16x32_bf16 v[64:67], v[140:143], a[4:7], v[64:67]
    ds_read_b64_tr_b16 v[120:121], v15 offset:36928
    buffer_load_dwordx4 v11, s[64:67], s54 offen offset:3072 lds
    v_mfma_f32_16x16x32_bf16 v[68:71], v[140:143], a[84:87], v[68:71]
    ds_read_b64_tr_b16 v[122:123], v15 offset:38208
    v_mfma_f32_16x16x32_bf16 v[72:75], v[140:143], a[164:167], v[72:75]
    ds_read_b64_tr_b16 v[124:125], v16 offset:36960
    s_add_u32 m0, s69, 77824
    v_mfma_f32_16x16x32_bf16 v[76:79], v[140:143], a[244:247], v[76:79]
    ds_read_b64_tr_b16 v[126:127], v16 offset:38240
    v_mfma_f32_16x16x32_bf16 v[80:83], v[144:147], a[4:7], v[80:83]
    ds_read_b64_tr_b16 v[128:129], v15 offset:36992
    buffer_load_dwordx4 v12, s[64:67], s54 offen offset:0 lds
    v_mfma_f32_16x16x32_bf16 v[84:87], v[144:147], a[84:87], v[84:87]
    ds_read_b64_tr_b16 v[130:131], v15 offset:38272
    s_add_u32 s53, s53, 128
    v_mfma_f32_16x16x32_bf16 v[88:91], v[144:147], a[164:167], v[88:91]
    s_add_u32 s54, s54, s73
    v_mfma_f32_16x16x32_bf16 v[92:95], v[144:147], a[244:247], v[92:95]
    s_cmp_ge_u32 s53, 1280
    s_cselect_b32 s55, 1280, 0
    s_cselect_b32 s56, s76, 0
    v_mfma_f32_16x16x32_bf16 v[96:99], v[148:151], a[4:7], v[96:99]
    s_sub_u32 s53, s53, s55
    s_sub_u32 s54, s54, s56
    v_mfma_f32_16x16x32_bf16 v[100:103], v[148:151], a[84:87], v[100:103]
    s_add_u32 m0, s83, 110592
    s_nop 0
    buffer_load_dwordx4 v4, s[4:7], s53 offen offset:0 lds
    v_mfma_f32_16x16x32_bf16 v[104:107], v[148:151], a[164:167], v[104:107]
    v_mfma_f32_16x16x32_bf16 v[108:111], v[148:151], a[244:247], v[108:111]
    s_waitcnt lgkmcnt(0)
    v_mfma_f32_16x16x32_bf16 v[32:35], v[112:115], a[8:11], v[32:35]
    ds_read_b64_tr_b16 v[132:133], v15 offset:47104
    buffer_load_dwordx4 v5, s[4:7], s53 offen offset:1024 lds
    v_mfma_f32_16x16x32_bf16 v[36:39], v[112:115], a[88:91], v[36:39]
    ds_read_b64_tr_b16 v[134:135], v15 offset:48384
    v_mfma_f32_16x16x32_bf16 v[40:43], v[112:115], a[168:171], v[40:43]
    ds_read_b128 a[12:15], v14 offset:36864
    v_mfma_f32_16x16x32_bf16 v[44:47], v[112:115], a[248:251], v[44:47]
    ds_read_b128 a[92:95], v14 offset:38912
    v_mfma_f32_16x16x32_bf16 v[48:51], v[116:119], a[8:11], v[48:51]
    ds_read_b128 a[172:175], v14 offset:40960
    buffer_load_dwordx4 v6, s[4:7], s53 offen offset:2048 lds
    v_mfma_f32_16x16x32_bf16 v[52:55], v[116:119], a[88:91], v[52:55]
    ds_read_b128 a[252:255], v14 offset:43008
    v_mfma_f32_16x16x32_bf16 v[56:59], v[116:119], a[168:171], v[56:59]
    ds_read_b64_tr_b16 v[136:137], v16 offset:47136
    v_mfma_f32_16x16x32_bf16 v[60:63], v[116:119], a[248:251], v[60:63]
    ds_read_b64_tr_b16 v[138:139], v16 offset:48416
    v_mfma_f32_16x16x32_bf16 v[64:67], v[120:123], a[8:11], v[64:67]
    ds_read_b64_tr_b16 v[140:141], v15 offset:47168
    buffer_load_dwordx4 v7, s[4:7], s53 offen offset:3072 lds
    v_mfma_f32_16x16x32_bf16 v[68:71], v[120:123], a[88:91], v[68:71]
    ds_read_b64_tr_b16 v[142:143], v15 offset:48448
    v_mfma_f32_16x16x32_bf16 v[72:75], v[120:123], a[168:171], v[72:75]
    ds_read_b64_tr_b16 v[144:145], v16 offset:47200
    s_add_u32 m0, s69, 110592
    v_mfma_f32_16x16x32_bf16 v[76:79], v[120:123], a[248:251], v[76:79]
    ds_read_b64_tr_b16 v[146:147], v16 offset:48480
    v_mfma_f32_16x16x32_bf16 v[80:83], v[124:127], a[8:11], v[80:83]
    ds_read_b64_tr_b16 v[148:149], v15 offset:47232
    buffer_load_dwordx4 v8, s[64:67], s54 offen offset:0 lds
    v_mfma_f32_16x16x32_bf16 v[84:87], v[124:127], a[88:91], v[84:87]
    ds_read_b64_tr_b16 v[150:151], v15 offset:48512
    v_mfma_f32_16x16x32_bf16 v[88:91], v[124:127], a[168:171], v[88:91]
    v_mfma_f32_16x16x32_bf16 v[92:95], v[124:127], a[248:251], v[92:95]
    v_mfma_f32_16x16x32_bf16 v[96:99], v[128:131], a[8:11], v[96:99]
    buffer_load_dwordx4 v9, s[64:67], s54 offen offset:1024 lds
    v_mfma_f32_16x16x32_bf16 v[100:103], v[128:131], a[88:91], v[100:103]
    v_mfma_f32_16x16x32_bf16 v[104:107], v[128:131], a[168:171], v[104:107]
    v_mfma_f32_16x16x32_bf16 v[108:111], v[128:131], a[248:251], v[108:111]
    s_waitcnt lgkmcnt(0)
    s_waitcnt vmcnt(6)
    s_barrier
    v_mfma_f32_16x16x32_bf16 v[32:35], v[132:135], a[12:15], v[32:35]
    ds_read_b64_tr_b16 v[112:113], v19 offset:0
    buffer_load_dwordx4 v10, s[64:67], s54 offen offset:2048 lds
    v_mfma_f32_16x16x32_bf16 v[36:39], v[132:135], a[92:95], v[36:39]
    ds_read_b64_tr_b16 v[114:115], v19 offset:1280
    v_mfma_f32_16x16x32_bf16 v[40:43], v[132:135], a[172:175], v[40:43]
    ds_read_b128 a[16:19], v17 offset:0
    v_mfma_f32_16x16x32_bf16 v[44:47], v[132:135], a[252:255], v[44:47]
    ds_read_b128 a[96:99], v17 offset:2048
    v_mfma_f32_16x16x32_bf16 v[48:51], v[136:139], a[12:15], v[48:51]
    ds_read_b128 a[176:179], v17 offset:4096
    buffer_load_dwordx4 v11, s[64:67], s54 offen offset:3072 lds
    v_mfma_f32_16x16x32_bf16 v[52:55], v[136:139], a[92:95], v[52:55]
    ds_read_b128 v[152:155], v17 offset:6144
    v_mfma_f32_16x16x32_bf16 v[56:59], v[136:139], a[172:175], v[56:59]
    ds_read_b64_tr_b16 v[116:117], v20 offset:32
    s_add_u32 m0, s69, 114688
    v_mfma_f32_16x16x32_bf16 v[60:63], v[136:139], a[252:255], v[60:63]
    ds_read_b64_tr_b16 v[118:119], v20 offset:1312
    v_mfma_f32_16x16x32_bf16 v[64:67], v[140:143], a[12:15], v[64:67]
    ds_read_b64_tr_b16 v[120:121], v19 offset:64
    buffer_load_dwordx4 v12, s[64:67], s54 offen offset:0 lds
    v_mfma_f32_16x16x32_bf16 v[68:71], v[140:143], a[92:95], v[68:71]
    ds_read_b64_tr_b16 v[122:123], v19 offset:1344
    s_add_u32 s53, s53, 128
    v_mfma_f32_16x16x32_bf16 v[72:75], v[140:143], a[172:175], v[72:75]
    ds_read_b64_tr_b16 v[124:125], v20 offset:96
    s_add_u32 s54, s54, s73
    v_mfma_f32_16x16x32_bf16 v[76:79], v[140:143], a[252:255], v[76:79]
    ds_read_b64_tr_b16 v[126:127], v20 offset:1376
    v_mfma_f32_16x16x32_bf16 v[80:83], v[144:147], a[12:15], v[80:83]
    ds_read_b64_tr_b16 v[128:129], v19 offset:128
    v_mfma_f32_16x16x32_bf16 v[84:87], v[144:147], a[92:95], v[84:87]
    ds_read_b64_tr_b16 v[130:131], v19 offset:1408
    v_mfma_f32_16x16x32_bf16 v[88:91], v[144:147], a[172:175], v[88:91]
    s_cmp_ge_u32 s53, 1280
    s_cselect_b32 s55, 1280, 0
    s_cselect_b32 s56, s76, 0
    v_mfma_f32_16x16x32_bf16 v[92:95], v[144:147], a[252:255], v[92:95]
    s_sub_u32 s53, s53, s55
    s_sub_u32 s54, s54, s56
    v_mfma_f32_16x16x32_bf16 v[96:99], v[148:151], a[12:15], v[96:99]
    s_add_u32 m0, s83, 0
    s_nop 0
    buffer_load_dwordx4 v4, s[4:7], s53 offen offset:0 lds
    v_mfma_f32_16x16x32_bf16 v[100:103], v[148:151], a[92:95], v[100:103]
    buffer_load_dwordx4 v5, s[4:7], s53 offen offset:1024 lds
    v_mfma_f32_16x16x32_bf16 v[104:107], v[148:151], a[172:175], v[104:107]
    v_mfma_f32_16x16x32_bf16 v[108:111], v[148:151], a[252:255], v[108:111]
    s_waitcnt lgkmcnt(0)
    v_mfma_f32_16x16x32_bf16 v[32:35], v[112:115], a[16:19], v[32:35]
    ds_read_b64_tr_b16 v[132:133], v19 offset:10240
    buffer_load_dwordx4 v6, s[4:7], s53 offen offset:2048 lds
    v_mfma_f32_16x16x32_bf16 v[36:39], v[112:115], a[96:99], v[36:39]
    ds_read_b64_tr_b16 v[134:135], v19 offset:11520
    v_mfma_f32_16x16x32_bf16 v[40:43], v[112:115], a[176:179], v[40:43]
    ds_read_b128 a[20:23], v18 offset:0
    v_mfma_f32_16x16x32_bf16 v[44:47], v[112:115], v[152:155], v[44:47]
    ds_read_b128 a[100:103], v18 offset:2048
    v_mfma_f32_16x16x32_bf16 v[48:51], v[116:119], a[16:19], v[48:51]
    ds_read_b128 a[180:183], v18 offset:4096
    buffer_load_dwordx4 v7, s[4:7], s53 offen offset:3072 lds
    v_mfma_f32_16x16x32_bf16 v[52:55], v[116:119], a[96:99], v[52:55]
    ds_read_b128 v[156:159], v18 offset:6144
    v_mfma_f32_16x16x32_bf16 v[56:59], v[116:119], a[176:179], v[56:59]
    ds_read_b64_tr_b16 v[136:137], v20 offset:10272
    s_add_u32 m0, s69, 0
    v_mfma_f32_16x16x32_bf16 v[60:63], v[116:119], v[152:155], v[60:63]
    ds_read_b64_tr_b16 v[138:139], v20 offset:11552
    v_mfma_f32_16x16x32_bf16 v[64:67], v[120:123], a[16:19], v[64:67]
    ds_read_b64_tr_b16 v[140:141], v19 offset:10304
    buffer_load_dwordx4 v8, s[64:67], s54 offen offset:0 lds
    v_mfma_f32_16x16x32_bf16 v[68:71], v[120:123], a[96:99], v[68:71]
    ds_read_b64_tr_b16 v[142:143], v19 offset:11584
    v_mfma_f32_16x16x32_bf16 v[72:75], v[120:123], a[176:179], v[72:75]
    ds_read_b64_tr_b16 v[144:145], v20 offset:10336
    v_mfma_f32_16x16x32_bf16 v[76:79], v[120:123], v[152:155], v[76:79]
    ds_read_b64_tr_b16 v[146:147], v20 offset:11616
    v_mfma_f32_16x16x32_bf16 v[80:83], v[124:127], a[16:19], v[80:83]
    ds_read_b64_tr_b16 v[148:149], v19 offset:10368
    buffer_load_dwordx4 v9, s[64:67], s54 offen offset:1024 lds
    v_mfma_f32_16x16x32_bf16 v[84:87], v[124:127], a[96:99], v[84:87]
    ds_read_b64_tr_b16 v[150:151], v19 offset:11648
    v_mfma_f32_16x16x32_bf16 v[88:91], v[124:127], a[176:179], v[88:91]
    v_mfma_f32_16x16x32_bf16 v[92:95], v[124:127], v[152:155], v[92:95]
    v_mfma_f32_16x16x32_bf16 v[96:99], v[128:131], a[16:19], v[96:99]
    buffer_load_dwordx4 v10, s[64:67], s54 offen offset:2048 lds
    v_mfma_f32_16x16x32_bf16 v[100:103], v[128:131], a[96:99], v[100:103]
    v_mfma_f32_16x16x32_bf16 v[104:107], v[128:131], a[176:179], v[104:107]
    v_mfma_f32_16x16x32_bf16 v[108:111], v[128:131], v[152:155], v[108:111]
    s_waitcnt lgkmcnt(0)
    s_waitcnt vmcnt(7)
    s_barrier
    v_mfma_f32_16x16x32_bf16 v[32:35], v[132:135], a[20:23], v[32:35]
    ds_read_b64_tr_b16 v[112:113], v19 offset:36864
    buffer_load_dwordx4 v11, s[64:67], s54 offen offset:3072 lds
    v_mfma_f32_16x16x32_bf16 v[36:39], v[132:135], a[100:103], v[36:39]
    ds_read_b64_tr_b16 v[114:115], v19 offset:38144
    v_mfma_f32_16x16x32_bf16 v[40:43], v[132:135], a[180:183], v[40:43]
    ds_read_b128 a[24:27], v17 offset:36864
    s_add_u32 m0, s69, 4096
    v_mfma_f32_16x16x32_bf16 v[44:47], v[132:135], v[156:159], v[44:47]
    ds_read_b128 a[104:107], v17 offset:38912
    v_mfma_f32_16x16x32_bf16 v[48:51], v[136:139], a[20:23], v[48:51]
    ds_read_b128 a[184:187], v17 offset:40960
    buffer_load_dwordx4 v12, s[64:67], s54 offen offset:0 lds
    v_mfma_f32_16x16x32_bf16 v[52:55], v[136:139], a[100:103], v[52:55]
    ds_read_b128 v[160:163], v17 offset:43008
    s_add_u32 s53, s53, 128
    v_mfma_f32_16x16x32_bf16 v[56:59], v[136:139], a[180:183], v[56:59]
    ds_read_b64_tr_b16 v[116:117], v20 offset:36896
    s_add_u32 s54, s54, s73
    v_mfma_f32_16x16x32_bf16 v[60:63], v[136:139], v[156:159], v[60:63]
    ds_read_b64_tr_b16 v[118:119], v20 offset:38176
    v_mfma_f32_16x16x32_bf16 v[64:67], v[140:143], a[20:23], v[64:67]
    ds_read_b64_tr_b16 v[120:121], v19 offset:36928
    v_mfma_f32_16x16x32_bf16 v[68:71], v[140:143], a[100:103], v[68:71]
    ds_read_b64_tr_b16 v[122:123], v19 offset:38208
    v_mfma_f32_16x16x32_bf16 v[72:75], v[140:143], a[180:183], v[72:75]
    ds_read_b64_tr_b16 v[124:125], v20 offset:36960
    v_mfma_f32_16x16x32_bf16 v[76:79], v[140:143], v[156:159], v[76:79]
    ds_read_b64_tr_b16 v[126:127], v20 offset:38240
    v_mfma_f32_16x16x32_bf16 v[80:83], v[144:147], a[20:23], v[80:83]
    ds_read_b64_tr_b16 v[128:129], v19 offset:36992
    v_mfma_f32_16x16x32_bf16 v[84:87], v[144:147], a[100:103], v[84:87]
    ds_read_b64_tr_b16 v[130:131], v19 offset:38272
    v_mfma_f32_16x16x32_bf16 v[88:91], v[144:147], a[180:183], v[88:91]
    s_cmp_ge_u32 s53, 1280
    s_cselect_b32 s55, 1280, 0
    s_cselect_b32 s56, s76, 0
    v_mfma_f32_16x16x32_bf16 v[92:95], v[144:147], v[156:159], v[92:95]
    s_sub_u32 s53, s53, s55
    s_sub_u32 s54, s54, s56
    v_mfma_f32_16x16x32_bf16 v[96:99], v[148:151], a[20:23], v[96:99]
    s_add_u32 m0, s83, 36864
    s_nop 0
    buffer_load_dwordx4 v4, s[4:7], s53 offen offset:0 lds
    v_mfma_f32_16x16x32_bf16 v[100:103], v[148:151], a[100:103], v[100:103]
    buffer_load_dwordx4 v5, s[4:7], s53 offen offset:1024 lds
    buffer_load_dwordx4 v6, s[4:7], s53 offen offset:2048 lds
    v_mfma_f32_16x16x32_bf16 v[104:107], v[148:151], a[180:183], v[104:107]
    v_mfma_f32_16x16x32_bf16 v[108:111], v[148:151], v[156:159], v[108:111]
    s_waitcnt lgkmcnt(0)
    v_mfma_f32_16x16x32_bf16 v[32:35], v[112:115], a[24:27], v[32:35]
    ds_read_b64_tr_b16 v[132:133], v19 offset:47104
    buffer_load_dwordx4 v7, s[4:7], s53 offen offset:3072 lds
    v_mfma_f32_16x16x32_bf16 v[36:39], v[112:115], a[104:107], v[36:39]
    ds_read_b64_tr_b16 v[134:135], v19 offset:48384
    v_mfma_f32_16x16x32_bf16 v[40:43], v[112:115], a[184:187], v[40:43]
    ds_read_b128 a[28:31], v18 offset:36864
    s_add_u32 m0, s69, 36864
    v_mfma_f32_16x16x32_bf16 v[44:47], v[112:115], v[160:163], v[44:47]
    ds_read_b128 a[108:111], v18 offset:38912
    v_mfma_f32_16x16x32_bf16 v[48:51], v[116:119], a[24:27], v[48:51]
    ds_read_b128 a[188:191], v18 offset:40960
    buffer_load_dwordx4 v8, s[64:67], s54 offen offset:0 lds
    v_mfma_f32_16x16x32_bf16 v[52:55], v[116:119], a[104:107], v[52:55]
    ds_read_b128 v[164:167], v18 offset:43008
    v_mfma_f32_16x16x32_bf16 v[56:59], v[116:119], a[184:187], v[56:59]
    ds_read_b64_tr_b16 v[136:137], v20 offset:47136
    v_mfma_f32_16x16x32_bf16 v[60:63], v[116:119], v[160:163], v[60:63]
    ds_read_b64_tr_b16 v[138:139], v20 offset:48416
    v_mfma_f32_16x16x32_bf16 v[64:67], v[120:123], a[24:27], v[64:67]
    ds_read_b64_tr_b16 v[140:141], v19 offset:47168
    buffer_load_dwordx4 v9, s[64:67], s54 offen offset:1024 lds
    v_mfma_f32_16x16x32_bf16 v[68:71], v[120:123], a[104:107], v[68:71]
    ds_read_b64_tr_b16 v[142:143], v19 offset:48448
    v_mfma_f32_16x16x32_bf16 v[72:75], v[120:123], a[184:187], v[72:75]
    ds_read_b64_tr_b16 v[144:145], v20 offset:47200
    v_mfma_f32_16x16x32_bf16 v[76:79], v[120:123], v[160:163], v[76:79]
    ds_read_b64_tr_b16 v[146:147], v20 offset:48480
    v_mfma_f32_16x16x32_bf16 v[80:83], v[124:127], a[24:27], v[80:83]
    ds_read_b64_tr_b16 v[148:149], v19 offset:47232
    buffer_load_dwordx4 v10, s[64:67], s54 offen offset:2048 lds
    v_mfma_f32_16x16x32_bf16 v[84:87], v[124:127], a[104:107], v[84:87]
    ds_read_b64_tr_b16 v[150:151], v19 offset:48512
    v_mfma_f32_16x16x32_bf16 v[88:91], v[124:127], a[184:187], v[88:91]
    v_mfma_f32_16x16x32_bf16 v[92:95], v[124:127], v[160:163], v[92:95]
    v_mfma_f32_16x16x32_bf16 v[96:99], v[128:131], a[24:27], v[96:99]
    buffer_load_dwordx4 v11, s[64:67], s54 offen offset:3072 lds
    v_mfma_f32_16x16x32_bf16 v[100:103], v[128:131], a[104:107], v[100:103]
    v_mfma_f32_16x16x32_bf16 v[104:107], v[128:131], a[184:187], v[104:107]
    s_add_u32 m0, s69, 40960
    v_mfma_f32_16x16x32_bf16 v[108:111], v[128:131], v[160:163], v[108:111]
    s_waitcnt lgkmcnt(0)
    s_waitcnt vmcnt(8)
    s_barrier
    s_mov_b32 exec_lo, 0x1
    s_mov_b32 exec_hi, 0x0
    s_nop 0
    v_readfirstlane_b32 s2, v254
    v_readfirstlane_b32 s3, v255
    v_or_b32 v254, v254, v255
    v_cmp_eq_u32 vcc, 0, v254
    s_mov_b64 exec, -1
    s_cmp_eq_u64 vcc, 0
    s_cbranch_scc1 L_pollok_8
    s_mov_b32 exec_lo, 0x1
    s_mov_b32 exec_hi, 0x0
    s_mov_b32 s84, 1048576
L_poll_9:
    global_load_dwordx2 v[254:255], v253, s[38:39] sc1
    s_waitcnt vmcnt(0)
    s_nop 0
    v_readfirstlane_b32 s2, v254
    v_readfirstlane_b32 s3, v255
    v_or_b32 v254, v254, v255
    v_cmp_eq_u32 vcc, 0, v254
    s_cmp_eq_u64 vcc, 0
    s_cbranch_scc1 L_polled_10
    s_sub_u32 s84, s84, 1
    s_cmp_eq_u32 s84, 0
    s_cbranch_scc1 L_polltmo_11
    s_sleep 2
    s_branch L_poll_9
L_polltmo_11:
    v_mov_b32 v254, 224
    v_mov_b32 v255, 252
    global_store_dword v255, v254, s[38:39]
L_polled_10:
    s_mov_b64 exec, -1
L_pollok_8:
    s_cmp_lg_u32 s40, 0
    s_cbranch_scc1 L_noflag_12
    s_mov_b64 exec, 1
    v_mov_b32 v240, s2
    v_mov_b32 v241, s3
    v_mov_b32 v242, 0
    buffer_store_dwordx2 v[240:241], v242, s[24:27], s101 offen sc1
    s_mov_b64 exec, -1
L_noflag_12:
    v_mfma_f32_16x16x32_bf16 v[32:35], v[132:135], a[28:31], v[32:35]
    ds_read_b64_tr_b16 v[112:113], v15 offset:0
    buffer_load_dwordx4 v12, s[64:67], s54 offen offset:0 lds
    v_mfma_f32_16x16x32_bf16 v[36:39], v[132:135], a[108:111], v[36:39]
    ds_read_b64_tr_b16 v[114:115], v15 offset:1280
    s_add_u32 s53, s53, 128
    v_mfma_f32_16x16x32_bf16 v[40:43], v[132:135], a[188:191], v[40:43]
    ds_read_b128 a[32:35], v13 offset:0
    s_add_u32 s54, s54, s73
    v_mfma_f32_16x16x32_bf16 v[44:47], v[132:135], v[164:167], v[44:47]
    ds_read_b128 a[112:115], v13 offset:2048
    v_mfma_f32_16x16x32_bf16 v[48:51], v[136:139], a[28:31], v[48:51]
    ds_read_b128 a[192:195], v13 offset:4096
    v_mfma_f32_16x16x32_bf16 v[52:55], v[136:139], a[108:111], v[52:55]
    ds_read_b128 v[168:171], v13 offset:6144
    v_mfma_f32_16x16x32_bf16 v[56:59], v[136:139], a[188:191], v[56:59]
    ds_read_b64_tr_b16 v[116:117], v16 offset:32
    v_mfma_f32_16x16x32_bf16 v[60:63], v[136:139], v[164:167], v[60:63]
    ds_read_b64_tr_b16 v[118:119], v16 offset:1312
    v_mfma_f32_16x16x32_bf16 v[64:67], v[140:143], a[28:31], v[64:67]
    ds_read_b64_tr_b16 v[120:121], v15 offset:64
    v_mfma_f32_16x16x32_bf16 v[68:71], v[140:143], a[108:111], v[68:71]
    ds_read_b64_tr_b16 v[122:123], v15 offset:1344
    v_mfma_f32_16x16x32_bf16 v[72:75], v[140:143], a[188:191], v[72:75]
    ds_read_b64_tr_b16 v[124:125], v16 offset:96
    v_mfma_f32_16x16x32_bf16 v[76:79], v[140:143], v[164:167], v[76:79]
    ds_read_b64_tr_b16 v[126:127], v16 offset:1376
    v_mfma_f32_16x16x32_bf16 v[80:83], v[144:147], a[28:31], v[80:83]
    ds_read_b64_tr_b16 v[128:129], v15 offset:128
    v_mfma_f32_16x16x32_bf16 v[84:87], v[144:147], a[108:111], v[84:87]
    ds_read_b64_tr_b16 v[130:131], v15 offset:1408
    v_mfma_f32_16x16x32_bf16 v[88:91], v[144:147], a[188:191], v[88:91]
    s_cmp_ge_u32 s53, 1280
    s_cselect_b32 s55, 1280, 0
    s_cselect_b32 s56, s76, 0
    v_mfma_f32_16x16x32_bf16 v[92:95], v[144:147], v[164:167], v[92:95]
    s_sub_u32 s53, s53, s55
    s_sub_u32 s54, s54, s56
    v_mfma_f32_16x16x32_bf16 v[96:99], v[148:151], a[28:31], v[96:99]
    s_add_u32 m0, s83, 73728
    s_nop 0
    buffer_load_dwordx4 v4, s[4:7], s53 offen offset:0 lds
    v_mfma_f32_16x16x32_bf16 v[100:103], v[148:151], a[108:111], v[100:103]
    buffer_load_dwordx4 v5, s[4:7], s53 offen offset:1024 lds
    buffer_load_dwordx4 v6, s[4:7], s53 offen offset:2048 lds
    v_mfma_f32_16x16x32_bf16 v[104:107], v[148:151], a[188:191], v[104:107]
    buffer_load_dwordx4 v7, s[4:7], s53 offen offset:3072 lds
    s_add_u32 m0, s69, 73728
    v_mfma_f32_16x16x32_bf16 v[108:111], v[148:151], v[164:167], v[108:111]
    s_waitcnt lgkmcnt(0)
    v_mfma_f32_16x16x32_bf16 v[32:35], v[112:115], a[32:35], v[32:35]
    ds_read_b64_tr_b16 v[132:133], v15 offset:10240
    buffer_load_dwordx4 v8, s[64:67], s54 offen offset:0 lds
    v_mfma_f32_16x16x32_bf16 v[36:39], v[112:115], a[112:115], v[36:39]
    ds_read_b64_tr_b16 v[134:135], v15 offset:11520
    v_mfma_f32_16x16x32_bf16 v[40:43], v[112:115], a[192:195], v[40:43]
    ds_read_b128 a[36:39], v14 offset:0
    v_mfma_f32_16x16x32_bf16 v[44:47], v[112:115], v[168:171], v[44:47]
    ds_read_b128 a[116:119], v14 offset:2048
    v_mfma_f32_16x16x32_bf16 v[48:51], v[116:119], a[32:35], v[48:51]
    ds_read_b128 a[196:199], v14 offset:4096
    buffer_load_dwordx4 v9, s[64:67], s54 offen offset:1024 lds
    v_mfma_f32_16x16x32_bf16 v[52:55], v[116:119], a[112:115], v[52:55]
    ds_read_b128 v[172:175], v14 offset:6144
    v_mfma_f32_16x16x32_bf16 v[56:59], v[116:119], a[192:195], v[56:59]
    ds_read_b64_tr_b16 v[136:137], v16 offset:10272
    v_mfma_f32_16x16x32_bf16 v[60:63], v[116:119], v[168:171], v[60:63]
    ds_read_b64_tr_b16 v[138:139], v16 offset:11552
    v_mfma_f32_16x16x32_bf16 v[64:67], v[120:123], a[32:35], v[64:67]
    ds_read_b64_tr_b16 v[140:141], v15 offset:10304
    buffer_load_dwordx4 v10, s[64:67], s54 offen offset:2048 lds
    v_mfma_f32_16x16x32_bf16 v[68:71], v[120:123], a[112:115], v[68:71]
    ds_read_b64_tr_b16 v[142:143], v15 offset:11584
    v_mfma_f32_16x16x32_bf16 v[72:75], v[120:123], a[192:195], v[72:75]
    ds_read_b64_tr_b16 v[144:145], v16 offset:10336
    v_mfma_f32_16x16x32_bf16 v[76:79], v[120:123], v[168:171], v[76:79]
    ds_read_b64_tr_b16 v[146:147], v16 offset:11616
    v_mfma_f32_16x16x32_bf16 v[80:83], v[124:127], a[32:35], v[80:83]
    ds_read_b64_tr_b16 v[148:149], v15 offset:10368
    buffer_load_dwordx4 v11, s[64:67], s54 offen offset:3072 lds
    v_mfma_f32_16x16x32_bf16 v[84:87], v[124:127], a[112:115], v[84:87]
    ds_read_b64_tr_b16 v[150:151], v15 offset:11648
    v_mfma_f32_16x16x32_bf16 v[88:91], v[124:127], a[192:195], v[88:91]
    s_add_u32 m0, s69, 77824
    v_mfma_f32_16x16x32_bf16 v[92:95], v[124:127], v[168:171], v[92:95]
    v_mfma_f32_16x16x32_bf16 v[96:99], v[128:131], a[32:35], v[96:99]
    buffer_load_dwordx4 v12, s[64:67], s54 offen offset:0 lds
    v_mfma_f32_16x16x32_bf16 v[100:103], v[128:131], a[112:115], v[100:103]
    s_add_u32 s53, s53, 128
    s_add_u32 s54, s54, s73
    v_mfma_f32_16x16x32_bf16 v[104:107], v[128:131], a[192:195], v[104:107]
    s_cmp_ge_u32 s53, 1280
    s_cselect_b32 s55, 1280, 0
    s_cselect_b32 s56, s76, 0
    v_mfma_f32_16x16x32_bf16 v[108:111], v[128:131], v[168:171], v[108:111]
    s_sub_u32 s53, s53, s55
    s_sub_u32 s54, s54, s56
    s_waitcnt lgkmcnt(0)
    s_waitcnt vmcnt(9)
    s_barrier
    v_mfma_f32_16x16x32_bf16 v[32:35], v[132:135], a[36:39], v[32:35]
    ds_read_b64_tr_b16 v[112:113], v15 offset:36864
    s_add_u32 m0, s83, 110592
    v_mfma_f32_16x16x32_bf16 v[36:39], v[132:135], a[116:119], v[36:39]
    ds_read_b64_tr_b16 v[114:115], v15 offset:38144
    buffer_load_dwordx4 v4, s[4:7], s53 offen offset:0 lds
    v_mfma_f32_16x16x32_bf16 v[40:43], v[132:135], a[196:199], v[40:43]
    ds_read_b128 a[40:43], v13 offset:36864
    v_mfma_f32_16x16x32_bf16 v[44:47], v[132:135], v[172:175], v[44:47]
    ds_read_b128 a[120:123], v13 offset:38912
    v_mfma_f32_16x16x32_bf16 v[48:51], v[136:139], a[36:39], v[48:51]
    ds_read_b128 a[200:203], v13 offset:40960
    buffer_load_dwordx4 v5, s[4:7], s53 offen offset:1024 lds
    v_mfma_f32_16x16x32_bf16 v[52:55], v[136:139], a[116:119], v[52:55]
    ds_read_b128 v[176:179], v13 offset:43008
    v_mfma_f32_16x16x32_bf16 v[56:59], v[136:139], a[196:199], v[56:59]
    ds_read_b64_tr_b16 v[116:117], v16 offset:36896
    v_mfma_f32_16x16x32_bf16 v[60:63], v[136:139], v[172:175], v[60:63]
    ds_read_b64_tr_b16 v[118:119], v16 offset:38176
    v_mfma_f32_16x16x32_bf16 v[64:67], v[140:143], a[36:39], v[64:67]
    ds_read_b64_tr_b16 v[120:121], v15 offset:36928
    buffer_load_dwordx4 v6, s[4:7], s53 offen offset:2048 lds
    v_mfma_f32_16x16x32_bf16 v[68:71], v[140:143], a[116:119], v[68:71]
    ds_read_b64_tr_b16 v[122:123], v15 offset:38208
    v_mfma_f32_16x16x32_bf16 v[72:75], v[140:143], a[196:199], v[72:75]
    ds_read_b64_tr_b16 v[124:125], v16 offset:36960
    v_mfma_f32_16x16x32_bf16 v[76:79], v[140:143], v[172:175], v[76:79]
    ds_read_b64_tr_b16 v[126:127], v16 offset:38240
    v_mfma_f32_16x16x32_bf16 v[80:83], v[144:147], a[36:39], v[80:83]
    ds_read_b64_tr_b16 v[128:129], v15 offset:36992
    buffer_load_dwordx4 v7, s[4:7], s53 offen offset:3072 lds
    v_mfma_f32_16x16x32_bf16 v[84:87], v[144:147], a[116:119], v[84:87]
    ds_read_b64_tr_b16 v[130:131], v15 offset:38272
    v_mfma_f32_16x16x32_bf16 v[88:91], v[144:147], a[196:199], v[88:91]
    s_add_u32 m0, s69, 110592
    v_mfma_f32_16x16x32_bf16 v[92:95], v[144:147], v[172:175], v[92:95]
    v_mfma_f32_16x16x32_bf16 v[96:99], v[148:151], a[36:39], v[96:99]
    buffer_load_dwordx4 v8, s[64:67], s54 offen offset:0 lds
    v_mfma_f32_16x16x32_bf16 v[100:103], v[148:151], a[116:119], v[100:103]
    v_mfma_f32_16x16x32_bf16 v[104:107], v[148:151], a[196:199], v[104:107]
    v_mfma_f32_16x16x32_bf16 v[108:111], v[148:151], v[172:175], v[108:111]
    s_waitcnt lgkmcnt(0)
    v_mfma_f32_16x16x32_bf16 v[32:35], v[112:115], a[40:43], v[32:35]
    ds_read_b64_tr_b16 v[132:133], v15 offset:47104
    buffer_load_dwordx4 v9, s[64:67], s54 offen offset:1024 lds
    v_mfma_f32_16x16x32_bf16 v[36:39], v[112:115], a[120:123], v[36:39]
    ds_read_b64_tr_b16 v[134:135], v15 offset:48384
    v_mfma_f32_16x16x32_bf16 v[40:43], v[112:115], a[200:203], v[40:43]
    ds_read_b128 a[44:47], v14 offset:36864
    v_mfma_f32_16x16x32_bf16 v[44:47], v[112:115], v[176:179], v[44:47]
    ds_read_b128 a[124:127], v14 offset:38912
    v_mfma_f32_16x16x32_bf16 v[48:51], v[116:119], a[40:43], v[48:51]
    ds_read_b128 a[204:207], v14 offset:40960
    buffer_load_dwordx4 v10, s[64:67], s54 offen offset:2048 lds
    v_mfma_f32_16x16x32_bf16 v[52:55], v[116:119], a[120:123], v[52:55]
    ds_read_b128 v[180:183], v14 offset:43008
    v_mfma_f32_16x16x32_bf16 v[56:59], v[116:119], a[200:203], v[56:59]
    ds_read_b64_tr_b16 v[136:137], v16 offset:47136
    v_mfma_f32_16x16x32_bf16 v[60:63], v[116:119], v[176:179], v[60:63]
    ds_read_b64_tr_b16 v[138:139], v16 offset:48416
    v_mfma_f32_16x16x32_bf16 v[64:67], v[120:123], a[40:43], v[64:67]
    ds_read_b64_tr_b16 v[140:141], v15 offset:47168
    buffer_load_dwordx4 v11, s[64:67], s54 offen offset:3072 lds
    v_mfma_f32_16x16x32_bf16 v[68:71], v[120:123], a[120:123], v[68:71]
    ds_read_b64_tr_b16 v[142:143], v15 offset:48448
    v_mfma_f32_16x16x32_bf16 v[72:75], v[120:123], a[200:203], v[72:75]
    ds_read_b64_tr_b16 v[144:145], v16 offset:47200
    s_add_u32 m0, s69, 114688
    v_mfma_f32_16x16x32_bf16 v[76:79], v[120:123], v[176:179], v[76:79]
    ds_read_b64_tr_b16 v[146:147], v16 offset:48480
    v_mfma_f32_16x16x32_bf16 v[80:83], v[124:127], a[40:43], v[80:83]
    ds_read_b64_tr_b16 v[148:149], v15 offset:47232
    buffer_load_dwordx4 v12, s[64:67], s54 offen offset:0 lds
    v_mfma_f32_16x16x32_bf16 v[84:87], v[124:127], a[120:123], v[84:87]
    ds_read_b64_tr_b16 v[150:151], v15 offset:48512
    s_add_u32 s53, s53, 128
    v_mfma_f32_16x16x32_bf16 v[88:91], v[124:127], a[200:203], v[88:91]
    s_add_u32 s54, s54, s73
    v_mfma_f32_16x16x32_bf16 v[92:95], v[124:127], v[176:179], v[92:95]
    s_cmp_ge_u32 s53, 1280
    s_cselect_b32 s55, 1280, 0
    s_cselect_b32 s56, s76, 0
    v_mfma_f32_16x16x32_bf16 v[96:99], v[128:131], a[40:43], v[96:99]
    s_sub_u32 s53, s53, s55
    s_sub_u32 s54, s54, s56
    v_mfma_f32_16x16x32_bf16 v[100:103], v[128:131], a[120:123], v[100:103]
    s_add_u32 m0, s83, 0
    s_nop 0
    buffer_load_dwordx4 v4, s[4:7], s53 offen offset:0 lds
    v_mfma_f32_16x16x32_bf16 v[104:107], v[128:131], a[200:203], v[104:107]
    v_mfma_f32_16x16x32_bf16 v[108:111], v[128:131], v[176:179], v[108:111]
    s_waitcnt lgkmcnt(0)
    s_waitcnt vmcnt(10)
    s_barrier
    v_mfma_f32_16x16x32_bf16 v[32:35], v[132:135], a[44:47], v[32:35]
    ds_read_b64_tr_b16 v[112:113], v19 offset:0
    buffer_load_dwordx4 v5, s[4:7], s53 offen offset:1024 lds
    v_mfma_f32_16x16x32_bf16 v[36:39], v[132:135], a[124:127], v[36:39]
    ds_read_b64_tr_b16 v[114:115], v19 offset:1280
    v_mfma_f32_16x16x32_bf16 v[40:43], v[132:135], a[204:207], v[40:43]
    ds_read_b128 a[48:51], v17 offset:0
    v_mfma_f32_16x16x32_bf16 v[44:47], v[132:135], v[180:183], v[44:47]
    ds_read_b128 a[128:131], v17 offset:2048
    v_mfma_f32_16x16x32_bf16 v[48:51], v[136:139], a[44:47], v[48:51]
    ds_read_b128 a[208:211], v17 offset:4096
    buffer_load_dwordx4 v6, s[4:7], s53 offen offset:2048 lds
    v_mfma_f32_16x16x32_bf16 v[52:55], v[136:139], a[124:127], v[52:55]
    ds_read_b128 v[184:187], v17 offset:6144
    v_mfma_f32_16x16x32_bf16 v[56:59], v[136:139], a[204:207], v[56:59]
    ds_read_b64_tr_b16 v[116:117], v20 offset:32
    v_mfma_f32_16x16x32_bf16 v[60:63], v[136:139], v[180:183], v[60:63]
    ds_read_b64_tr_b16 v[118:119], v20 offset:1312
    v_mfma_f32_16x16x32_bf16 v[64:67], v[140:143], a[44:47], v[64:67]
    ds_read_b64_tr_b16 v[120:121], v19 offset:64
    buffer_load_dwordx4 v7, s[4:7], s53 offen offset:3072 lds
    v_mfma_f32_16x16x32_bf16 v[68:71], v[140:143], a[124:127], v[68:71]
    ds_read_b64_tr_b16 v[122:123], v19 offset:1344
    v_mfma_f32_16x16x32_bf16 v[72:75], v[140:143], a[204:207], v[72:75]
    ds_read_b64_tr_b16 v[124:125], v20 offset:96
    s_add_u32 m0, s69, 0
    v_mfma_f32_16x16x32_bf16 v[76:79], v[140:143], v[180:183], v[76:79]
    ds_read_b64_tr_b16 v[126:127], v20 offset:1376
    v_mfma_f32_16x16x32_bf16 v[80:83], v[144:147], a[44:47], v[80:83]
    ds_read_b64_tr_b16 v[128:129], v19 offset:128
    buffer_load_dwordx4 v8, s[64:67], s54 offen offset:0 lds
    v_mfma_f32_16x16x32_bf16 v[84:87], v[144:147], a[124:127], v[84:87]
    ds_read_b64_tr_b16 v[130:131], v19 offset:1408
    v_mfma_f32_16x16x32_bf16 v[88:91], v[144:147], a[204:207], v[88:91]
    v_mfma_f32_16x16x32_bf16 v[92:95], v[144:147], v[180:183], v[92:95]
    v_mfma_f32_16x16x32_bf16 v[96:99], v[148:151], a[44:47], v[96:99]
    buffer_load_dwordx4 v9, s[64:67], s54 offen offset:1024 lds
    v_mfma_f32_16x16x32_bf16 v[100:103], v[148:151], a[124:127], v[100:103]
    v_mfma_f32_16x16x32_bf16 v[104:107], v[148:151], a[204:207], v[104:107]
    v_mfma_f32_16x16x32_bf16 v[108:111], v[148:151], v[180:183], v[108:111]
    s_waitcnt lgkmcnt(0)
    v_mfma_f32_16x16x32_bf16 v[32:35], v[112:115], a[48:51], v[32:35]
    ds_read_b64_tr_b16 v[132:133], v19 offset:10240
    buffer_load_dwordx4 v10, s[64:67], s54 offen offset:2048 lds
    v_mfma_f32_16x16x32_bf16 v[36:39], v[112:115], a[128:131], v[36:39]
    ds_read_b64_tr_b16 v[134:135], v19 offset:11520
    v_mfma_f32_16x16x32_bf16 v[40:43], v[112:115], a[208:211], v[40:43]
    ds_read_b128 a[52:55], v18 offset:0
    v_mfma_f32_16x16x32_bf16 v[44:47], v[112:115], v[184:187], v[44:47]
    ds_read_b128 a[132:135], v18 offset:2048
    v_mfma_f32_16x16x32_bf16 v[48:51], v[116:119], a[48:51], v[48:51]
    ds_read_b128 a[212:215], v18 offset:4096
    buffer_load_dwordx4 v11, s[64:67], s54 offen offset:3072 lds
    v_mfma_f32_16x16x32_bf16 v[52:55], v[116:119], a[128:131], v[52:55]
    ds_read_b128 v[188:191], v18 offset:6144
    v_mfma_f32_16x16x32_bf16 v[56:59], v[116:119], a[208:211], v[56:59]
    ds_read_b64_tr_b16 v[136:137], v20 offset:10272
    s_add_u32 m0, s69, 4096
    v_mfma_f32_16x16x32_bf16 v[60:63], v[116:119], v[184:187], v[60:63]
    ds_read_b64_tr_b16 v[138:139], v20 offset:11552
    v_mfma_f32_16x16x32_bf16 v[64:67], v[120:123], a[48:51], v[64:67]
    ds_read_b64_tr_b16 v[140:141], v19 offset:10304
    buffer_load_dwordx4 v12, s[64:67], s54 offen offset:0 lds
    v_mfma_f32_16x16x32_bf16 v[68:71], v[120:123], a[128:131], v[68:71]
    ds_read_b64_tr_b16 v[142:143], v19 offset:11584
    s_add_u32 s53, s53, 128
    v_mfma_f32_16x16x32_bf16 v[72:75], v[120:123], a[208:211], v[72:75]
    ds_read_b64_tr_b16 v[144:145], v20 offset:10336
    s_add_u32 s54, s54, s73
    v_mfma_f32_16x16x32_bf16 v[76:79], v[120:123], v[184:187], v[76:79]
    ds_read_b64_tr_b16 v[146:147], v20 offset:11616
    v_mfma_f32_16x16x32_bf16 v[80:83], v[124:127], a[48:51], v[80:83]
    ds_read_b64_tr_b16 v[148:149], v19 offset:10368
    v_mfma_f32_16x16x32_bf16 v[84:87], v[124:127], a[128:131], v[84:87]
    ds_read_b64_tr_b16 v[150:151], v19 offset:11648
    v_mfma_f32_16x16x32_bf16 v[88:91], v[124:127], a[208:211], v[88:91]
    s_cmp_ge_u32 s53, 1280
    s_cselect_b32 s55, 1280, 0
    s_cselect_b32 s56, s76, 0
    v_mfma_f32_16x16x32_bf16 v[92:95], v[124:127], v[184:187], v[92:95]
    s_sub_u32 s53, s53, s55
    s_sub_u32 s54, s54, s56
    v_mfma_f32_16x16x32_bf16 v[96:99], v[128:131], a[48:51], v[96:99]
    s_add_u32 m0, s83, 36864
    s_nop 0
    buffer_load_dwordx4 v4, s[4:7], s53 offen offset:0 lds
    v_mfma_f32_16x16x32_bf16 v[100:103], v[128:131], a[128:131], v[100:103]
    buffer_load_dwordx4 v5, s[4:7], s53 offen offset:1024 lds
    v_mfma_f32_16x16x32_bf16 v[104:107], v[128:131], a[208:211], v[104:107]
    v_mfma_f32_16x16x32_bf16 v[108:111], v[128:131], v[184:187], v[108:111]
    s_waitcnt lgkmcnt(0)
    s_waitcnt vmcnt(11)
    s_barrier
    v_mfma_f32_16x16x32_bf16 v[32:35], v[132:135], a[52:55], v[32:35]
    ds_read_b64_tr_b16 v[112:113], v19 offset:36864
    buffer_load_dwordx4 v6, s[4:7], s53 offen offset:2048 lds
    v_mfma_f32_16x16x32_bf16 v[36:39], v[132:135], a[132:135], v[36:39]
    ds_read_b64_tr_b16 v[114:115], v19 offset:38144
    v_mfma_f32_16x16x32_bf16 v[40:43], v[132:135], a[212:215], v[40:43]
    ds_read_b128 a[56:59], v17 offset:36864
    v_mfma_f32_16x16x32_bf16 v[44:47], v[132:135], v[188:191], v[44:47]
    ds_read_b128 a[136:139], v17 offset:38912
    v_mfma_f32_16x16x32_bf16 v[48:51], v[136:139], a[52:55], v[48:51]
    ds_read_b128 a[216:219], v17 offset:40960
    buffer_load_dwordx4 v7, s[4:7], s53 offen offset:3072 lds
    v_mfma_f32_16x16x32_bf16 v[52:55], v[136:139], a[132:135], v[52:55]
    ds_read_b128 v[192:195], v17 offset:43008
    v_mfma_f32_16x16x32_bf16 v[56:59], v[136:139], a[212:215], v[56:59]
    ds_read_b64_tr_b16 v[116:117], v20 offset:36896
    s_add_u32 m0, s69, 36864
    v_mfma_f32_16x16x32_bf16 v[60:63], v[136:139], v[188:191], v[60:63]
    ds_read_b64_tr_b16 v[118:119], v20 offset:38176
    v_mfma_f32_16x16x32_bf16 v[64:67], v[140:143], a[52:55], v[64:67]
    ds_read_b64_tr_b16 v[120:121], v19 offset:36928
    buffer_load_dwordx4 v8, s[64:67], s54 offen offset:0 lds
    v_mfma_f32_16x16x32_bf16 v[68:71], v[140:143], a[132:135], v[68:71]
    ds_read_b64_tr_b16 v[122:123], v19 offset:38208
    v_mfma_f32_16x16x32_bf16 v[72:75], v[140:143], a[212:215], v[72:75]
    ds_read_b64_tr_b16 v[124:125], v20 offset:36960
    v_mfma_f32_16x16x32_bf16 v[76:79], v[140:143], v[188:191], v[76:79]
    ds_read_b64_tr_b16 v[126:127], v20 offset:38240
    v_mfma_f32_16x16x32_bf16 v[80:83], v[144:147], a[52:55], v[80:83]
    ds_read_b64_tr_b16 v[128:129], v19 offset:36992
    buffer_load_dwordx4 v9, s[64:67], s54 offen offset:1024 lds
    v_mfma_f32_16x16x32_bf16 v[84:87], v[144:147], a[132:135], v[84:87]
    ds_read_b64_tr_b16 v[130:131], v19 offset:38272
    v_mfma_f32_16x16x32_bf16 v[88:91], v[144:147], a[212:215], v[88:91]
    v_mfma_f32_16x16x32_bf16 v[92:95], v[144:147], v[188:191], v[92:95]
    v_mfma_f32_16x16x32_bf16 v[96:99], v[148:151], a[52:55], v[96:99]
    buffer_load_dwordx4 v10, s[64:67], s54 offen offset:2048 lds
    v_mfma_f32_16x16x32_bf16 v[100:103], v[148:151], a[132:135], v[100:103]
    v_mfma_f32_16x16x32_bf16 v[104:107], v[148:151], a[212:215], v[104:107]
    v_mfma_f32_16x16x32_bf16 v[108:111], v[148:151], v[188:191], v[108:111]
    s_waitcnt lgkmcnt(0)
    v_mfma_f32_16x16x32_bf16 v[32:35], v[112:115], a[56:59], v[32:35]
    ds_read_b64_tr_b16 v[132:133], v19 offset:47104
    buffer_load_dwordx4 v11, s[64:67], s54 offen offset:3072 lds
    v_mfma_f32_16x16x32_bf16 v[36:39], v[112:115], a[136:139], v[36:39]
    ds_read_b64_tr_b16 v[134:135], v19 offset:48384
    v_mfma_f32_16x16x32_bf16 v[40:43], v[112:115], a[216:219], v[40:43]
    ds_read_b128 a[60:63], v18 offset:36864
    s_add_u32 m0, s69, 40960
    v_mfma_f32_16x16x32_bf16 v[44:47], v[112:115], v[192:195], v[44:47]
    ds_read_b128 a[140:143], v18 offset:38912
    v_mfma_f32_16x16x32_bf16 v[48:51], v[116:119], a[56:59], v[48:51]
    ds_read_b128 a[220:223], v18 offset:40960
    buffer_load_dwordx4 v12, s[64:67], s54 offen offset:0 lds
    v_mfma_f32_16x16x32_bf16 v[52:55], v[116:119], a[136:139], v[52:55]
    ds_read_b128 v[196:199], v18 offset:43008
    s_mul_i32 s55, s40, 8192
    v_mfma_f32_16x16x32_bf16 v[56:59], v[116:119], a[216:219], v[56:59]
    ds_read_b64_tr_b16 v[136:137], v20 offset:47136
    s_add_u32 m0, s55, 73728
    v_mfma_f32_16x16x32_bf16 v[60:63], v[116:119], v[192:195], v[60:63]
    ds_read_b64_tr_b16 v[138:139], v20 offset:48416
    s_mul_i32 s56, s40, 64
    v_mfma_f32_16x16x32_bf16 v[64:67], v[120:123], a[56:59], v[64:67]
    ds_read_b64_tr_b16 v[140:141], v19 offset:47168
    s_add_u32 s56, s56, 0
    v_mfma_f32_16x16x32_bf16 v[68:71], v[120:123], a[136:139], v[68:71]
    ds_read_b64_tr_b16 v[142:143], v19 offset:48448
    s_lshr_b32 s57, s56, 6
    v_mfma_f32_16x16x32_bf16 v[72:75], v[120:123], a[216:219], v[72:75]
    ds_read_b64_tr_b16 v[144:145], v20 offset:47200
    s_and_b32 s56, s56, 63
    v_mfma_f32_16x16x32_bf16 v[76:79], v[120:123], v[192:195], v[76:79]
    ds_read_b64_tr_b16 v[146:147], v20 offset:48480
    s_add_u32 s57, s57, s82
    v_mfma_f32_16x16x32_bf16 v[80:83], v[124:127], a[56:59], v[80:83]
    ds_read_b64_tr_b16 v[148:149], v19 offset:47232
    v_mfma_f32_16x16x32_bf16 v[84:87], v[124:127], a[136:139], v[84:87]
    ds_read_b64_tr_b16 v[150:151], v19 offset:48512
    v_mfma_f32_16x16x32_bf16 v[88:91], v[124:127], a[216:219], v[88:91]
    s_cmp_ge_u32 s57, 10
    s_cselect_b32 s58, 10, 0
    v_mfma_f32_16x16x32_bf16 v[92:95], v[124:127], v[192:195], v[92:95]
    s_sub_u32 s57, s57, s58
    s_lshl_b32 s57, s57, 6
    v_mfma_f32_16x16x32_bf16 v[96:99], v[128:131], a[56:59], v[96:99]
    s_add_u32 s56, s56, s57
    s_mul_i32 s56, s56, 3072
    v_mfma_f32_16x16x32_bf16 v[100:103], v[128:131], a[136:139], v[100:103]
    s_lshl_b32 s57, s68, 1
    s_add_u32 s56, s56, s57
    v_mfma_f32_16x16x32_bf16 v[104:107], v[128:131], a[216:219], v[104:107]
    buffer_load_dwordx4 v21, s[16:19], s56 offen offset:0 lds
    buffer_load_dwordx4 v22, s[16:19], s56 offen offset:1024 lds
    v_mfma_f32_16x16x32_bf16 v[108:111], v[128:131], v[192:195], v[108:111]
    buffer_load_dwordx4 v23, s[16:19], s56 offen offset:2048 lds
    s_waitcnt lgkmcnt(0)
    s_waitcnt vmcnt(12)
    s_barrier
    v_mfma_f32_16x16x32_bf16 v[32:35], v[132:135], a[60:63], v[32:35]
    ds_read_b64_tr_b16 v[112:113], v15 offset:0
    buffer_load_dwordx4 v24, s[16:19], s56 offen offset:3072 lds
    v_mfma_f32_16x16x32_bf16 v[36:39], v[132:135], a[140:143], v[36:39]
    ds_read_b64_tr_b16 v[114:115], v15 offset:1280
    s_mul_i32 s55, s40, 8192
    v_mfma_f32_16x16x32_bf16 v[40:43], v[132:135], a[220:223], v[40:43]
    ds_read_b128 a[64:67], v13 offset:0
    s_add_u32 m0, s55, 77824
    v_mfma_f32_16x16x32_bf16 v[44:47], v[132:135], v[196:199], v[44:47]
    ds_read_b128 a[144:147], v13 offset:2048
    s_mul_i32 s56, s40, 64
    v_mfma_f32_16x16x32_bf16 v[48:51], v[136:139], a[60:63], v[48:51]
    ds_read_b128 a[224:227], v13 offset:4096
    s_add_u32 s56, s56, 32
    v_mfma_f32_16x16x32_bf16 v[52:55], v[136:139], a[140:143], v[52:55]
    ds_read_b128 v[200:203], v13 offset:6144
    s_lshr_b32 s57, s56, 6
    v_mfma_f32_16x16x32_bf16 v[56:59], v[136:139], a[220:223], v[56:59]
    ds_read_b64_tr_b16 v[116:117], v16 offset:32
    s_and_b32 s56, s56, 63
    v_mfma_f32_16x16x32_bf16 v[60:63], v[136:139], v[196:199], v[60:63]
    ds_read_b64_tr_b16 v[118:119], v16 offset:1312
    s_add_u32 s57, s57, s82
    v_mfma_f32_16x16x32_bf16 v[64:67], v[140:143], a[60:63], v[64:67]
    ds_read_b64_tr_b16 v[120:121], v15 offset:64
    v_mfma_f32_16x16x32_bf16 v[68:71], v[140:143], a[140:143], v[68:71]
    ds_read_b64_tr_b16 v[122:123], v15 offset:1344
    v_mfma_f32_16x16x32_bf16 v[72:75], v[140:143], a[220:223], v[72:75]
    ds_read_b64_tr_b16 v[124:125], v16 offset:96
    v_mfma_f32_16x16x32_bf16 v[76:79], v[140:143], v[196:199], v[76:79]
    ds_read_b64_tr_b16 v[126:127], v16 offset:1376
    v_mfma_f32_16x16x32_bf16 v[80:83], v[144:147], a[60:63], v[80:83]
    ds_read_b64_tr_b16 v[128:129], v15 offset:128
    v_mfma_f32_16x16x32_bf16 v[84:87], v[144:147], a[140:143], v[84:87]
    ds_read_b64_tr_b16 v[130:131], v15 offset:1408
    v_mfma_f32_16x16x32_bf16 v[88:91], v[144:147], a[220:223], v[88:91]
    s_cmp_ge_u32 s57, 10
    s_cselect_b32 s58, 10, 0
    v_mfma_f32_16x16x32_bf16 v[92:95], v[144:147], v[196:199], v[92:95]
    s_sub_u32 s57, s57, s58
    s_lshl_b32 s57, s57, 6
    v_mfma_f32_16x16x32_bf16 v[96:99], v[148:151], a[60:63], v[96:99]
    s_add_u32 s56, s56, s57
    s_mul_i32 s56, s56, 3072
    v_mfma_f32_16x16x32_bf16 v[100:103], v[148:151], a[140:143], v[100:103]
    s_lshl_b32 s57, s68, 1
    s_add_u32 s56, s56, s57
    v_mfma_f32_16x16x32_bf16 v[104:107], v[148:151], a[220:223], v[104:107]
    buffer_load_dwordx4 v21, s[16:19], s56 offen offset:0 lds
    buffer_load_dwordx4 v22, s[16:19], s56 offen offset:1024 lds
    v_mfma_f32_16x16x32_bf16 v[108:111], v[148:151], v[196:199], v[108:111]
    buffer_load_dwordx4 v23, s[16:19], s56 offen offset:2048 lds
    buffer_load_dwordx4 v24, s[16:19], s56 offen offset:3072 lds
    s_waitcnt lgkmcnt(0)
    v_mfma_f32_16x16x32_bf16 v[32:35], v[112:115], a[64:67], v[32:35]
    ds_read_b64_tr_b16 v[132:133], v15 offset:10240
    s_mul_i32 s55, s40, 8192
    v_mfma_f32_16x16x32_bf16 v[36:39], v[112:115], a[144:147], v[36:39]
    ds_read_b64_tr_b16 v[134:135], v15 offset:11520
    s_add_u32 m0, s55, 110592
    v_mfma_f32_16x16x32_bf16 v[40:43], v[112:115], a[224:227], v[40:43]
    ds_read_b128 a[68:71], v14 offset:0
    s_mul_i32 s56, s40, 64
    v_mfma_f32_16x16x32_bf16 v[44:47], v[112:115], v[200:203], v[44:47]
    ds_read_b128 a[148:151], v14 offset:2048
    s_add_u32 s56, s56, 256
    v_mfma_f32_16x16x32_bf16 v[48:51], v[116:119], a[64:67], v[48:51]
    ds_read_b128 a[228:231], v14 offset:4096
    s_lshr_b32 s57, s56, 6
    v_mfma_f32_16x16x32_bf16 v[52:55], v[116:119], a[144:147], v[52:55]
    ds_read_b128 v[204:207], v14 offset:6144
    s_and_b32 s56, s56, 63
    v_mfma_f32_16x16x32_bf16 v[56:59], v[116:119], a[224:227], v[56:59]
    ds_read_b64_tr_b16 v[136:137], v16 offset:10272
    s_add_u32 s57, s57, s82
    v_mfma_f32_16x16x32_bf16 v[60:63], v[116:119], v[200:203], v[60:63]
    ds_read_b64_tr_b16 v[138:139], v16 offset:11552
    v_mfma_f32_16x16x32_bf16 v[64:67], v[120:123], a[64:67], v[64:67]
    ds_read_b64_tr_b16 v[140:141], v15 offset:10304
    v_mfma_f32_16x16x32_bf16 v[68:71], v[120:123], a[144:147], v[68:71]
    ds_read_b64_tr_b16 v[142:143], v15 offset:11584
    v_mfma_f32_16x16x32_bf16 v[72:75], v[120:123], a[224:227], v[72:75]
    ds_read_b64_tr_b16 v[144:145], v16 offset:10336
    v_mfma_f32_16x16x32_bf16 v[76:79], v[120:123], v[200:203], v[76:79]
    ds_read_b64_tr_b16 v[146:147], v16 offset:11616
    v_mfma_f32_16x16x32_bf16 v[80:83], v[124:127], a[64:67], v[80:83]
    ds_read_b64_tr_b16 v[148:149], v15 offset:10368
    v_mfma_f32_16x16x32_bf16 v[84:87], v[124:127], a[144:147], v[84:87]
    ds_read_b64_tr_b16 v[150:151], v15 offset:11648
    v_mfma_f32_16x16x32_bf16 v[88:91], v[124:127], a[224:227], v[88:91]
    s_cmp_ge_u32 s57, 10
    s_cselect_b32 s58, 10, 0
    v_mfma_f32_16x16x32_bf16 v[92:95], v[124:127], v[200:203], v[92:95]
    s_sub_u32 s57, s57, s58
    s_lshl_b32 s57, s57, 6
    v_mfma_f32_16x16x32_bf16 v[96:99], v[128:131], a[64:67], v[96:99]
    s_add_u32 s56, s56, s57
    s_mul_i32 s56, s56, 3072
    v_mfma_f32_16x16x32_bf16 v[100:103], v[128:131], a[144:147], v[100:103]
    s_lshl_b32 s57, s68, 1
    s_add_u32 s56, s56, s57
    v_mfma_f32_16x16x32_bf16 v[104:107], v[128:131], a[224:227], v[104:107]
    buffer_load_dwordx4 v21, s[16:19], s56 offen offset:0 lds
    buffer_load_dwordx4 v22, s[16:19], s56 offen offset:1024 lds
    v_mfma_f32_16x16x32_bf16 v[108:111], v[128:131], v[200:203], v[108:111]
    buffer_load_dwordx4 v23, s[16:19], s56 offen offset:2048 lds
    buffer_load_dwordx4 v24, s[16:19], s56 offen offset:3072 lds
    s_waitcnt lgkmcnt(0)
    s_waitcnt vmcnt(12)
    s_barrier
    v_mfma_f32_16x16x32_bf16 v[32:35], v[132:135], a[68:71], v[32:35]
    ds_read_b64_tr_b16 v[112:113], v15 offset:36864
    s_mul_i32 s55, s40, 8192
    v_mfma_f32_16x16x32_bf16 v[36:39], v[132:135], a[148:151], v[36:39]
    ds_read_b64_tr_b16 v[114:115], v15 offset:38144
    s_add_u32 m0, s55, 114688
    v_mfma_f32_16x16x32_bf16 v[40:43], v[132:135], a[228:231], v[40:43]
    ds_read_b128 a[72:75], v13 offset:36864
    s_mul_i32 s56, s40, 64
    v_mfma_f32_16x16x32_bf16 v[44:47], v[132:135], v[204:207], v[44:47]
    ds_read_b128 a[152:155], v13 offset:38912
    s_add_u32 s56, s56, 288
    v_mfma_f32_16x16x32_bf16 v[48:51], v[136:139], a[68:71], v[48:51]
    ds_read_b128 a[232:235], v13 offset:40960
    s_lshr_b32 s57, s56, 6
    v_mfma_f32_16x16x32_bf16 v[52:55], v[136:139], a[148:151], v[52:55]
    ds_read_b128 v[208:211], v13 offset:43008
    s_and_b32 s56, s56, 63
    v_mfma_f32_16x16x32_bf16 v[56:59], v[136:139], a[228:231], v[56:59]
    ds_read_b64_tr_b16 v[116:117], v16 offset:36896
    s_add_u32 s57, s57, s82
    v_mfma_f32_16x16x32_bf16 v[60:63], v[136:139], v[204:207], v[60:63]
    ds_read_b64_tr_b16 v[118:119], v16 offset:38176
    v_mfma_f32_16x16x32_bf16 v[64:67], v[140:143], a[68:71], v[64:67]
    ds_read_b64_tr_b16 v[120:121], v15 offset:36928
    v_mfma_f32_16x16x32_bf16 v[68:71], v[140:143], a[148:151], v[68:71]
    ds_read_b64_tr_b16 v[122:123], v15 offset:38208
    v_mfma_f32_16x16x32_bf16 v[72:75], v[140:143], a[228:231], v[72:75]
    ds_read_b64_tr_b16 v[124:125], v16 offset:36960
    v_mfma_f32_16x16x32_bf16 v[76:79], v[140:143], v[204:207], v[76:79]
    ds_read_b64_tr_b16 v[126:127], v16 offset:38240
    v_mfma_f32_16x16x32_bf16 v[80:83], v[144:147], a[68:71], v[80:83]
    ds_read_b64_tr_b16 v[128:129], v15 offset:36992
    v_mfma_f32_16x16x32_bf16 v[84:87], v[144:147], a[148:151], v[84:87]
    ds_read_b64_tr_b16 v[130:131], v15 offset:38272
    v_mfma_f32_16x16x32_bf16 v[88:91], v[144:147], a[228:231], v[88:91]
    s_cmp_ge_u32 s57, 10
    s_cselect_b32 s58, 10, 0
    v_mfma_f32_16x16x32_bf16 v[92:95], v[144:147], v[204:207], v[92:95]
    s_sub_u32 s57, s57, s58
    s_lshl_b32 s57, s57, 6
    v_mfma_f32_16x16x32_bf16 v[96:99], v[148:151], a[68:71], v[96:99]
    s_add_u32 s56, s56, s57
    s_mul_i32 s56, s56, 3072
    v_mfma_f32_16x16x32_bf16 v[100:103], v[148:151], a[148:151], v[100:103]
    s_lshl_b32 s57, s68, 1
    s_add_u32 s56, s56, s57
    v_mfma_f32_16x16x32_bf16 v[104:107], v[148:151], a[228:231], v[104:107]
    buffer_load_dwordx4 v21, s[16:19], s56 offen offset:0 lds
    buffer_load_dwordx4 v22, s[16:19], s56 offen offset:1024 lds
    v_mfma_f32_16x16x32_bf16 v[108:111], v[148:151], v[204:207], v[108:111]
    buffer_load_dwordx4 v23, s[16:19], s56 offen offset:2048 lds
    buffer_load_dwordx4 v24, s[16:19], s56 offen offset:3072 lds
    s_waitcnt lgkmcnt(0)
    v_mfma_f32_16x16x32_bf16 v[32:35], v[112:115], a[72:75], v[32:35]
    ds_read_b64_tr_b16 v[132:133], v15 offset:47104
    s_mul_i32 s55, s40, 4096
    v_mfma_f32_16x16x32_bf16 v[36:39], v[112:115], a[152:155], v[36:39]
    ds_read_b64_tr_b16 v[134:135], v15 offset:48384
    s_add_u32 m0, s55, 0
    v_mfma_f32_16x16x32_bf16 v[40:43], v[112:115], a[232:235], v[40:43]
    ds_read_b128 a[76:79], v14 offset:36864
    s_mul_i32 s56, s40, 32
    v_mfma_f32_16x16x32_bf16 v[44:47], v[112:115], v[208:211], v[44:47]
    ds_read_b128 a[156:159], v14 offset:38912
    s_add_u32 s56, s56, 512
    v_mfma_f32_16x16x32_bf16 v[48:51], v[116:119], a[72:75], v[48:51]
    ds_read_b128 a[236:239], v14 offset:40960
    s_lshr_b32 s57, s56, 6
    v_mfma_f32_16x16x32_bf16 v[52:55], v[116:119], a[152:155], v[52:55]
    ds_read_b128 v[212:215], v14 offset:43008
    s_and_b32 s56, s56, 63
    v_mfma_f32_16x16x32_bf16 v[56:59], v[116:119], a[232:235], v[56:59]
    ds_read_b64_tr_b16 v[136:137], v16 offset:47136
    s_add_u32 s57, s57, s82
    v_mfma_f32_16x16x32_bf16 v[60:63], v[116:119], v[208:211], v[60:63]
    ds_read_b64_tr_b16 v[138:139], v16 offset:48416
    v_mfma_f32_16x16x32_bf16 v[64:67], v[120:123], a[72:75], v[64:67]
    ds_read_b64_tr_b16 v[140:141], v15 offset:47168
    v_mfma_f32_16x16x32_bf16 v[68:71], v[120:123], a[152:155], v[68:71]
    ds_read_b64_tr_b16 v[142:143], v15 offset:48448
    v_mfma_f32_16x16x32_bf16 v[72:75], v[120:123], a[232:235], v[72:75]
    ds_read_b64_tr_b16 v[144:145], v16 offset:47200
    v_mfma_f32_16x16x32_bf16 v[76:79], v[120:123], v[208:211], v[76:79]
    ds_read_b64_tr_b16 v[146:147], v16 offset:48480
    v_mfma_f32_16x16x32_bf16 v[80:83], v[124:127], a[72:75], v[80:83]
    ds_read_b64_tr_b16 v[148:149], v15 offset:47232
    v_mfma_f32_16x16x32_bf16 v[84:87], v[124:127], a[152:155], v[84:87]
    ds_read_b64_tr_b16 v[150:151], v15 offset:48512
    v_mfma_f32_16x16x32_bf16 v[88:91], v[124:127], a[232:235], v[88:91]
    s_cmp_ge_u32 s57, 10
    s_cselect_b32 s58, 10, 0
    v_mfma_f32_16x16x32_bf16 v[92:95], v[124:127], v[208:211], v[92:95]
    s_sub_u32 s57, s57, s58
    s_lshl_b32 s57, s57, 6
    v_mfma_f32_16x16x32_bf16 v[96:99], v[128:131], a[72:75], v[96:99]
    s_add_u32 s56, s56, s57
    s_mul_i32 s56, s56, 3072
    v_mfma_f32_16x16x32_bf16 v[100:103], v[128:131], a[152:155], v[100:103]
    s_lshl_b32 s57, s68, 1
    s_add_u32 s56, s56, s57
    v_mfma_f32_16x16x32_bf16 v[104:107], v[128:131], a[232:235], v[104:107]
    buffer_load_dwordx4 v21, s[16:19], s56 offen offset:0 lds
    buffer_load_dwordx4 v22, s[16:19], s56 offen offset:1024 lds
    v_mfma_f32_16x16x32_bf16 v[108:111], v[128:131], v[208:211], v[108:111]
    buffer_load_dwordx4 v23, s[16:19], s56 offen offset:2048 lds
    buffer_load_dwordx4 v24, s[16:19], s56 offen offset:3072 lds
    s_waitcnt lgkmcnt(0)
    v_mfma_f32_16x16x32_bf16 v[32:35], v[132:135], a[76:79], v[32:35]
    v_mfma_f32_16x16x32_bf16 v[36:39], v[132:135], a[156:159], v[36:39]
    v_mfma_f32_16x16x32_bf16 v[40:43], v[132:135], a[236:239], v[40:43]
    v_mfma_f32_16x16x32_bf16 v[44:47], v[132:135], v[212:215], v[44:47]
    v_mfma_f32_16x16x32_bf16 v[48:51], v[136:139], a[76:79], v[48:51]
    v_mfma_f32_16x16x32_bf16 v[52:55], v[136:139], a[156:159], v[52:55]
    v_mfma_f32_16x16x32_bf16 v[56:59], v[136:139], a[236:239], v[56:59]
    v_mfma_f32_16x16x32_bf16 v[60:63], v[136:139], v[212:215], v[60:63]
    v_mfma_f32_16x16x32_bf16 v[64:67], v[140:143], a[76:79], v[64:67]
    v_mfma_f32_16x16x32_bf16 v[68:71], v[140:143], a[156:159], v[68:71]
    v_mfma_f32_16x16x32_bf16 v[72:75], v[140:143], a[236:239], v[72:75]
    v_mfma_f32_16x16x32_bf16 v[76:79], v[140:143], v[212:215], v[76:79]
    v_mfma_f32_16x16x32_bf16 v[80:83], v[144:147], a[76:79], v[80:83]
    v_mfma_f32_16x16x32_bf16 v[84:87], v[144:147], a[156:159], v[84:87]
    v_mfma_f32_16x16x32_bf16 v[88:91], v[144:147], a[236:239], v[88:91]
    v_mfma_f32_16x16x32_bf16 v[92:95], v[144:147], v[212:215], v[92:95]
    v_mfma_f32_16x16x32_bf16 v[96:99], v[148:151], a[76:79], v[96:99]
    v_mfma_f32_16x16x32_bf16 v[100:103], v[148:151], a[156:159], v[100:103]
    v_mfma_f32_16x16x32_bf16 v[104:107], v[148:151], a[236:239], v[104:107]
    v_mfma_f32_16x16x32_bf16 v[108:111], v[148:151], v[212:215], v[108:111]
    s_nop 7
    v_mov_b32 v136, 0x3f803f80
    v_mov_b32 v137, 0x3f803f80
    v_mov_b32 v138, 0x3f803f80
    v_mov_b32 v139, 0x3f803f80
    s_waitcnt vmcnt(0)
    s_barrier
    v_add_u32 v27, 73728, v25
    v_add_u32 v28, 73728, v26
    ds_read_b64_tr_b16 v[112:113], v27 offset:0
    ds_read_b64_tr_b16 v[114:115], v27 offset:512
    ds_read_b64_tr_b16 v[116:117], v28 offset:0
    ds_read_b64_tr_b16 v[118:119], v28 offset:512
    ds_read_b64_tr_b16 v[120:121], v27 offset:4096
    ds_read_b64_tr_b16 v[122:123], v27 offset:4608
    ds_read_b64_tr_b16 v[124:125], v28 offset:4096
    ds_read_b64_tr_b16 v[126:127], v28 offset:4608
    s_waitcnt lgkmcnt(4)
    v_mfma_f32_16x16x32_bf16 v[216:219], v[112:115], a[0:3], 0
    ds_read_b64_tr_b16 v[128:129], v27 offset:8192
    v_mfma_f32_16x16x32_bf16 v[220:223], v[112:115], a[80:83], 0
    ds_read_b64_tr_b16 v[130:131], v27 offset:8704
    v_mfma_f32_16x16x32_bf16 v[224:227], v[112:115], a[160:163], 0
    ds_read_b64_tr_b16 v[132:133], v28 offset:8192
    v_mfma_f32_16x16x32_bf16 v[228:231], v[112:115], a[240:243], 0
    ds_read_b64_tr_b16 v[134:135], v28 offset:8704
    v_mfma_f32_16x16x32_bf16 v[248:251], v[112:115], v[136:139], 0
    s_cmp_lt_u32 s47, 4
    s_cselect_b32 s70, 0x3ea52b5c, 1.0
    s_cselect_b32 s72, 0, 3145728
    v_mfma_f32_16x16x32_bf16 v[232:235], v[116:119], a[0:3], 0
    s_mov_b32 s71, s70
    s_add_u32 s72, s72, 1048576
    v_mfma_f32_16x16x32_bf16 v[236:239], v[116:119], a[80:83], 0
    s_and_b32 s55, s47, 3
    s_lshl_b32 s55, s55, 2
    v_mfma_f32_16x16x32_bf16 v[240:243], v[116:119], a[160:163], 0
    s_lshl_b32 s56, s49, 1
    s_add_u32 s55, s55, s56
    v_mfma_f32_16x16x32_bf16 v[244:247], v[116:119], a[240:243], 0
    s_lshl_b32 s56, s46, 2
    s_lshl_b32 s57, s48, 1
    v_mfma_f32_16x16x32_bf16 v[252:255], v[116:119], v[136:139], 0
    s_add_u32 s56, s56, s57
    s_lshl_b32 s57, s55, 17
    s_waitcnt lgkmcnt(4)
    v_mfma_f32_16x16x32_bf16 v[216:219], v[120:123], a[4:7], v[216:219]
    ds_read_b64_tr_b16 v[112:113], v27 offset:12288
    s_lshl_b32 s58, s56, 10
    v_mfma_f32_16x16x32_bf16 v[220:223], v[120:123], a[84:87], v[220:223]
    ds_read_b64_tr_b16 v[114:115], v27 offset:12800
    s_add_u32 s57, s57, s58
    v_mfma_f32_16x16x32_bf16 v[224:227], v[120:123], a[164:167], v[224:227]
    ds_read_b64_tr_b16 v[116:117], v28 offset:12288
    s_lshl_b32 s58, s55, 15
    v_mfma_f32_16x16x32_bf16 v[228:231], v[120:123], a[244:247], v[228:231]
    ds_read_b64_tr_b16 v[118:119], v28 offset:12800
    s_lshl_b32 s59, s56, 9
    v_mfma_f32_16x16x32_bf16 v[248:251], v[120:123], v[136:139], v[248:251]
    s_add_u32 s58, s58, s59
    v_mfma_f32_16x16x32_bf16 v[232:235], v[124:127], a[4:7], v[232:235]
    s_add_u32 s58, s58, 0x200000
    v_mfma_f32_16x16x32_bf16 v[236:239], v[124:127], a[84:87], v[236:239]
    v_and_b32 v13, 1, v3
    v_mfma_f32_16x16x32_bf16 v[240:243], v[124:127], a[164:167], v[240:243]
    v_lshl_add_u32 v13, v13, 4, v2
    v_lshlrev_b32 v13, 4, v13
    v_mfma_f32_16x16x32_bf16 v[244:247], v[124:127], a[244:247], v[244:247]
    v_add_u32 v14, s57, v13
    v_mfma_f32_16x16x32_bf16 v[252:255], v[124:127], v[136:139], v[252:255]
    v_add_u32 v15, s58, v13
    s_waitcnt lgkmcnt(4)
    v_mfma_f32_16x16x32_bf16 v[216:219], v[128:131], a[8:11], v[216:219]
    ds_read_b64_tr_b16 v[120:121], v27 offset:16384
    v_cmp_le_u32 vcc, 2, v3
    v_mfma_f32_16x16x32_bf16 v[220:223], v[128:131], a[88:91], v[220:223]
    ds_read_b64_tr_b16 v[122:123], v27 offset:16896
    v_add_u32 v4, 0, v14
    v_mfma_f32_16x16x32_bf16 v[224:227], v[128:131], a[168:171], v[224:227]
    ds_read_b64_tr_b16 v[124:125], v28 offset:16384
    v_add_u32 v16, 512, v14
    v_mfma_f32_16x16x32_bf16 v[228:231], v[128:131], a[248:251], v[228:231]
    ds_read_b64_tr_b16 v[126:127], v28 offset:16896
    v_cndmask_b32 v4, v4, v16, vcc
    v_mfma_f32_16x16x32_bf16 v[248:251], v[128:131], v[136:139], v[248:251]
    v_add_u32 v5, 0, v15
    v_mfma_f32_16x16x32_bf16 v[232:235], v[132:135], a[8:11], v[232:235]
    v_add_u32 v16, 65536, v14
    v_mfma_f32_16x16x32_bf16 v[236:239], v[132:135], a[88:91], v[236:239]
    v_cndmask_b32 v5, v5, v16, vcc
    v_add_u32 v6, 512, v15
    v_mfma_f32_16x16x32_bf16 v[240:243], v[132:135], a[168:171], v[240:243]
    v_add_u32 v16, 66560, v14
    v_mfma_f32_16x16x32_bf16 v[244:247], v[132:135], a[248:251], v[244:247]
    v_cndmask_b32 v6, v6, v16, vcc
    v_mfma_f32_16x16x32_bf16 v[252:255], v[132:135], v[136:139], v[252:255]
    v_add_u32 v7, 66048, v14
    s_waitcnt lgkmcnt(4)
    v_mfma_f32_16x16x32_bf16 v[216:219], v[112:115], a[12:15], v[216:219]
    ds_read_b64_tr_b16 v[128:129], v27 offset:20480
    v_add_u32 v16, 131072, v14
    v_mfma_f32_16x16x32_bf16 v[220:223], v[112:115], a[92:95], v[220:223]
    ds_read_b64_tr_b16 v[130:131], v27 offset:20992
    v_cndmask_b32 v7, v7, v16, vcc
    v_mfma_f32_16x16x32_bf16 v[224:227], v[112:115], a[172:175], v[224:227]
    ds_read_b64_tr_b16 v[132:133], v28 offset:20480
    v_add_u32 v8, 131584, v14
    v_mfma_f32_16x16x32_bf16 v[228:231], v[112:115], a[252:255], v[228:231]
    ds_read_b64_tr_b16 v[134:135], v28 offset:20992
    v_add_u32 v16, 32768, v15
    v_mfma_f32_16x16x32_bf16 v[248:251], v[112:115], v[136:139], v[248:251]
    v_cndmask_b32 v8, v8, v16, vcc
    v_add_u32 v9, 132608, v14
    v_mfma_f32_16x16x32_bf16 v[232:235], v[116:119], a[12:15], v[232:235]
    v_add_u32 v16, 33280, v15
    v_mfma_f32_16x16x32_bf16 v[236:239], v[116:119], a[92:95], v[236:239]
    v_cndmask_b32 v9, v9, v16, vcc
    v_mfma_f32_16x16x32_bf16 v[240:243], v[116:119], a[172:175], v[240:243]
    v_add_u32 v10, 196608, v14
    v_mfma_f32_16x16x32_bf16 v[244:247], v[116:119], a[252:255], v[244:247]
    v_add_u32 v16, 197120, v14
    v_mfma_f32_16x16x32_bf16 v[252:255], v[116:119], v[136:139], v[252:255]
    v_cndmask_b32 v10, v10, v16, vcc
    s_waitcnt lgkmcnt(4)
    v_mfma_f32_16x16x32_bf16 v[216:219], v[120:123], a[16:19], v[216:219]
    ds_read_b64_tr_b16 v[112:113], v27 offset:24576
    v_pk_mul_f32 v[32:33], v[32:33], s[70:71]
    v_mfma_f32_16x16x32_bf16 v[220:223], v[120:123], a[96:99], v[220:223]
    ds_read_b64_tr_b16 v[114:115], v27 offset:25088
    v_pk_mul_f32 v[34:35], v[34:35], s[70:71]
    v_mfma_f32_16x16x32_bf16 v[224:227], v[120:123], a[176:179], v[224:227]
    ds_read_b64_tr_b16 v[116:117], v28 offset:24576
    v_cvt_pk_bf16_f32 v140, v32, v33
    v_mfma_f32_16x16x32_bf16 v[228:231], v[120:123], v[152:155], v[228:231]
    ds_read_b64_tr_b16 v[118:119], v28 offset:25088
    v_cvt_pk_bf16_f32 v141, v34, v35
    v_mfma_f32_16x16x32_bf16 v[248:251], v[120:123], v[136:139], v[248:251]
    v_pk_mul_f32 v[36:37], v[36:37], s[70:71]
    v_pk_mul_f32 v[38:39], v[38:39], s[70:71]
    v_mfma_f32_16x16x32_bf16 v[232:235], v[124:127], a[16:19], v[232:235]
    v_cvt_pk_bf16_f32 v142, v36, v37
    v_mfma_f32_16x16x32_bf16 v[236:239], v[124:127], a[96:99], v[236:239]
    v_cvt_pk_bf16_f32 v143, v38, v39
    v_mfma_f32_16x16x32_bf16 v[240:243], v[124:127], a[176:179], v[240:243]
    s_nop 1
    v_mfma_f32_16x16x32_bf16 v[244:247], v[124:127], v[152:155], v[244:247]
    v_permlane16_swap_b32 v140, v142
    v_mfma_f32_16x16x32_bf16 v[252:255], v[124:127], v[136:139], v[252:255]
    v_permlane16_swap_b32 v141, v143
    s_waitcnt lgkmcnt(4)
    v_mfma_f32_16x16x32_bf16 v[216:219], v[128:131], a[20:23], v[216:219]
    ds_read_b64_tr_b16 v[120:121], v27 offset:28672
    buffer_store_dwordx4 v[140:143], v4, s[24:27], s72 offen offset:0 sc1
    v_mfma_f32_16x16x32_bf16 v[220:223], v[128:131], a[100:103], v[220:223]
    ds_read_b64_tr_b16 v[122:123], v27 offset:29184
    v_pk_mul_f32 v[40:41], v[40:41], s[70:71]
    v_mfma_f32_16x16x32_bf16 v[224:227], v[128:131], a[180:183], v[224:227]
    ds_read_b64_tr_b16 v[124:125], v28 offset:28672
    v_pk_mul_f32 v[42:43], v[42:43], s[70:71]
    v_mfma_f32_16x16x32_bf16 v[228:231], v[128:131], v[156:159], v[228:231]
    ds_read_b64_tr_b16 v[126:127], v28 offset:29184
    v_cvt_pk_bf16_f32 v144, v40, v41
    v_mfma_f32_16x16x32_bf16 v[248:251], v[128:131], v[136:139], v[248:251]
    v_cvt_pk_bf16_f32 v145, v42, v43
    v_pk_mul_f32 v[44:45], v[44:45], s[70:71]
    v_mfma_f32_16x16x32_bf16 v[232:235], v[132:135], a[20:23], v[232:235]
    v_pk_mul_f32 v[46:47], v[46:47], s[70:71]
    v_mfma_f32_16x16x32_bf16 v[236:239], v[132:135], a[100:103], v[236:239]
    v_cvt_pk_bf16_f32 v146, v44, v45
    v_mfma_f32_16x16x32_bf16 v[240:243], v[132:135], a[180:183], v[240:243]
    v_cvt_pk_bf16_f32 v147, v46, v47
    v_mfma_f32_16x16x32_bf16 v[244:247], v[132:135], v[156:159], v[244:247]
    s_nop 1
    v_mfma_f32_16x16x32_bf16 v[252:255], v[132:135], v[136:139], v[252:255]
    s_lshl_b32 s88, s46, 11
    s_add_u32 s88, s88, 163840
    v_and_b32 v24, 15, v0
    v_lshlrev_b32 v24, 7, v24
    v_add_u32 v24, s88, v24
    s_mov_b32 exec_lo, 0xffff
    s_mov_b32 exec_hi, 0x0
    buffer_load_dwordx2 v[22:23], v24, s[24:27], 0 offen sc1
    s_mov_b64 exec, -1
    v_permlane16_swap_b32 v144, v146
    s_waitcnt lgkmcnt(4)
    v_mfma_f32_16x16x32_bf16 v[216:219], v[112:115], a[24:27], v[216:219]
    v_add_u32 v27, 110592, v25
    v_permlane16_swap_b32 v145, v147
    v_mfma_f32_16x16x32_bf16 v[220:223], v[112:115], a[104:107], v[220:223]
    v_add_u32 v28, 110592, v26
    buffer_store_dwordx4 v[144:147], v4, s[24:27], s72 offen offset:1024 sc1
    v_mfma_f32_16x16x32_bf16 v[224:227], v[112:115], a[184:187], v[224:227]
    ds_read_b64_tr_b16 v[128:129], v27 offset:0
    v_pk_mul_f32 v[48:49], v[48:49], s[70:71]
    v_mfma_f32_16x16x32_bf16 v[228:231], v[112:115], v[160:163], v[228:231]
    ds_read_b64_tr_b16 v[130:131], v27 offset:512
    v_pk_mul_f32 v[50:51], v[50:51], s[70:71]
    v_mfma_f32_16x16x32_bf16 v[248:251], v[112:115], v[136:139], v[248:251]
    ds_read_b64_tr_b16 v[132:133], v28 offset:0
    v_cvt_pk_bf16_f32 v148, v48, v49
    v_mfma_f32_16x16x32_bf16 v[232:235], v[116:119], a[24:27], v[232:235]
    ds_read_b64_tr_b16 v[134:135], v28 offset:512
    v_cvt_pk_bf16_f32 v149, v50, v51
    v_mfma_f32_16x16x32_bf16 v[236:239], v[116:119], a[104:107], v[236:239]
    v_pk_mul_f32 v[52:53], v[52:53], s[70:71]
    v_mfma_f32_16x16x32_bf16 v[240:243], v[116:119], a[184:187], v[240:243]
    v_pk_mul_f32 v[54:55], v[54:55], s[70:71]
    v_mfma_f32_16x16x32_bf16 v[244:247], v[116:119], v[160:163], v[244:247]
    v_cvt_pk_bf16_f32 v150, v52, v53
    v_cvt_pk_bf16_f32 v151, v54, v55
    v_mfma_f32_16x16x32_bf16 v[252:255], v[116:119], v[136:139], v[252:255]
    s_nop 1
    s_waitcnt lgkmcnt(4)
    v_mfma_f32_16x16x32_bf16 v[216:219], v[120:123], a[28:31], v[216:219]
    ds_read_b64_tr_b16 v[112:113], v27 offset:4096
    v_permlane16_swap_b32 v148, v150
    v_mfma_f32_16x16x32_bf16 v[220:223], v[120:123], a[108:111], v[220:223]
    ds_read_b64_tr_b16 v[114:115], v27 offset:4608
    v_permlane16_swap_b32 v149, v151
    v_mfma_f32_16x16x32_bf16 v[224:227], v[120:123], a[188:191], v[224:227]
    ds_read_b64_tr_b16 v[116:117], v28 offset:4096
    buffer_store_dwordx4 v[148:151], v5, s[24:27], s72 offen offset:0 sc1
    v_mfma_f32_16x16x32_bf16 v[228:231], v[120:123], v[164:167], v[228:231]
    ds_read_b64_tr_b16 v[118:119], v28 offset:4608
    v_pk_mul_f32 v[56:57], v[56:57], s[70:71]
    v_mfma_f32_16x16x32_bf16 v[248:251], v[120:123], v[136:139], v[248:251]
    v_pk_mul_f32 v[58:59], v[58:59], s[70:71]
    v_mfma_f32_16x16x32_bf16 v[232:235], v[124:127], a[28:31], v[232:235]
    v_cvt_pk_bf16_f32 v140, v56, v57
    v_mfma_f32_16x16x32_bf16 v[236:239], v[124:127], a[108:111], v[236:239]
    v_cvt_pk_bf16_f32 v141, v58, v59
    v_pk_mul_f32 v[60:61], v[60:61], s[70:71]
    v_mfma_f32_16x16x32_bf16 v[240:243], v[124:127], a[188:191], v[240:243]
    v_pk_mul_f32 v[62:63], v[62:63], s[70:71]
    v_mfma_f32_16x16x32_bf16 v[244:247], v[124:127], v[164:167], v[244:247]
    v_cvt_pk_bf16_f32 v142, v60, v61
    v_mfma_f32_16x16x32_bf16 v[252:255], v[124:127], v[136:139], v[252:255]
    v_cvt_pk_bf16_f32 v143, v62, v63
    s_waitcnt lgkmcnt(4)
    v_mfma_f32_16x16x32_bf16 v[216:219], v[128:131], a[32:35], v[216:219]
    ds_read_b64_tr_b16 v[120:121], v27 offset:8192
    s_nop 1
    v_mfma_f32_16x16x32_bf16 v[220:223], v[128:131], a[112:115], v[220:223]
    ds_read_b64_tr_b16 v[122:123], v27 offset:8704
    v_permlane16_swap_b32 v140, v142
    v_mfma_f32_16x16x32_bf16 v[224:227], v[128:131], a[192:195], v[224:227]
    ds_read_b64_tr_b16 v[124:125], v28 offset:8192
    v_permlane16_swap_b32 v141, v143
    v_mfma_f32_16x16x32_bf16 v[228:231], v[128:131], v[168:171], v[228:231]
    ds_read_b64_tr_b16 v[126:127], v28 offset:8704
    buffer_store_dwordx4 v[140:143], v6, s[24:27], s72 offen offset:0 sc1
    v_mfma_f32_16x16x32_bf16 v[248:251], v[128:131], v[136:139], v[248:251]
    v_pk_mul_f32 v[64:65], v[64:65], s[70:71]
    v_mfma_f32_16x16x32_bf16 v[232:235], v[132:135], a[32:35], v[232:235]
    v_pk_mul_f32 v[66:67], v[66:67], s[70:71]
    v_cvt_pk_bf16_f32 v144, v64, v65
    v_mfma_f32_16x16x32_bf16 v[236:239], v[132:135], a[112:115], v[236:239]
    v_cvt_pk_bf16_f32 v145, v66, v67
    v_mfma_f32_16x16x32_bf16 v[240:243], v[132:135], a[192:195], v[240:243]
    v_pk_mul_f32 v[68:69], v[68:69], s[70:71]
    v_mfma_f32_16x16x32_bf16 v[244:247], v[132:135], v[168:171], v[244:247]
    v_pk_mul_f32 v[70:71], v[70:71], s[70:71]
    v_mfma_f32_16x16x32_bf16 v[252:255], v[132:135], v[136:139], v[252:255]
    v_cvt_pk_bf16_f32 v146, v68, v69
    s_waitcnt lgkmcnt(4)
    v_mfma_f32_16x16x32_bf16 v[216:219], v[112:115], a[36:39], v[216:219]
    ds_read_b64_tr_b16 v[128:129], v27 offset:12288
    v_cvt_pk_bf16_f32 v147, v70, v71
    v_mfma_f32_16x16x32_bf16 v[220:223], v[112:115], a[116:119], v[220:223]
    ds_read_b64_tr_b16 v[130:131], v27 offset:12800
    s_nop 1
    v_mfma_f32_16x16x32_bf16 v[224:227], v[112:115], a[196:199], v[224:227]
    ds_read_b64_tr_b16 v[132:133], v28 offset:12288
    v_permlane16_swap_b32 v144, v146
    v_mfma_f32_16x16x32_bf16 v[228:231], v[112:115], v[172:175], v[228:231]
    ds_read_b64_tr_b16 v[134:135], v28 offset:12800
    v_permlane16_swap_b32 v145, v147
    v_mfma_f32_16x16x32_bf16 v[248:251], v[112:115], v[136:139], v[248:251]
    buffer_store_dwordx4 v[144:147], v7, s[24:27], s72 offen offset:0 sc1
    v_pk_mul_f32 v[72:73], v[72:73], s[70:71]
    v_mfma_f32_16x16x32_bf16 v[232:235], v[116:119], a[36:39], v[232:235]
    v_pk_mul_f32 v[74:75], v[74:75], s[70:71]
    v_mfma_f32_16x16x32_bf16 v[236:239], v[116:119], a[116:119], v[236:239]
    v_cvt_pk_bf16_f32 v148, v72, v73
    v_mfma_f32_16x16x32_bf16 v[240:243], v[116:119], a[196:199], v[240:243]
    v_cvt_pk_bf16_f32 v149, v74, v75
    v_mfma_f32_16x16x32_bf16 v[244:247], v[116:119], v[172:175], v[244:247]
    v_pk_mul_f32 v[76:77], v[76:77], s[70:71]
    v_mfma_f32_16x16x32_bf16 v[252:255], v[116:119], v[136:139], v[252:255]
    v_pk_mul_f32 v[78:79], v[78:79], s[70:71]
    s_waitcnt lgkmcnt(4)
    v_mfma_f32_16x16x32_bf16 v[216:219], v[120:123], a[40:43], v[216:219]
    ds_read_b64_tr_b16 v[112:113], v27 offset:16384
    v_cvt_pk_bf16_f32 v150, v76, v77
    v_mfma_f32_16x16x32_bf16 v[220:223], v[120:123], a[120:123], v[220:223]
    ds_read_b64_tr_b16 v[114:115], v27 offset:16896
    v_cvt_pk_bf16_f32 v151, v78, v79
    v_mfma_f32_16x16x32_bf16 v[224:227], v[120:123], a[200:203], v[224:227]
    ds_read_b64_tr_b16 v[116:117], v28 offset:16384
    s_nop 1
    v_mfma_f32_16x16x32_bf16 v[228:231], v[120:123], v[176:179], v[228:231]
    ds_read_b64_tr_b16 v[118:119], v28 offset:16896
    v_permlane16_swap_b32 v148, v150
    v_mfma_f32_16x16x32_bf16 v[248:251], v[120:123], v[136:139], v[248:251]
    v_permlane16_swap_b32 v149, v151
    buffer_store_dwordx4 v[148:151], v7, s[24:27], s72 offen offset:1024 sc1
    v_mfma_f32_16x16x32_bf16 v[232:235], v[124:127], a[40:43], v[232:235]
    v_pk_mul_f32 v[80:81], v[80:81], s[70:71]
    v_mfma_f32_16x16x32_bf16 v[236:239], v[124:127], a[120:123], v[236:239]
    v_pk_mul_f32 v[82:83], v[82:83], s[70:71]
    v_mfma_f32_16x16x32_bf16 v[240:243], v[124:127], a[200:203], v[240:243]
    v_cvt_pk_bf16_f32 v140, v80, v81
    v_mfma_f32_16x16x32_bf16 v[244:247], v[124:127], v[176:179], v[244:247]
    v_cvt_pk_bf16_f32 v141, v82, v83
    v_mfma_f32_16x16x32_bf16 v[252:255], v[124:127], v[136:139], v[252:255]
    v_pk_mul_f32 v[84:85], v[84:85], s[70:71]
    s_waitcnt lgkmcnt(4)
    v_mfma_f32_16x16x32_bf16 v[216:219], v[128:131], a[44:47], v[216:219]
    ds_read_b64_tr_b16 v[120:121], v27 offset:20480
    v_pk_mul_f32 v[86:87], v[86:87], s[70:71]
    v_mfma_f32_16x16x32_bf16 v[220:223], v[128:131], a[124:127], v[220:223]
    ds_read_b64_tr_b16 v[122:123], v27 offset:20992
    v_cvt_pk_bf16_f32 v142, v84, v85
    v_mfma_f32_16x16x32_bf16 v[224:227], v[128:131], a[204:207], v[224:227]
    ds_read_b64_tr_b16 v[124:125], v28 offset:20480
    v_cvt_pk_bf16_f32 v143, v86, v87
    v_mfma_f32_16x16x32_bf16 v[228:231], v[128:131], v[180:183], v[228:231]
    ds_read_b64_tr_b16 v[126:127], v28 offset:20992
    s_nop 1
    v_mfma_f32_16x16x32_bf16 v[248:251], v[128:131], v[136:139], v[248:251]
    v_permlane16_swap_b32 v140, v142
    v_permlane16_swap_b32 v141, v143
    v_mfma_f32_16x16x32_bf16 v[232:235], v[132:135], a[44:47], v[232:235]
    buffer_store_dwordx4 v[140:143], v8, s[24:27], s72 offen offset:0 sc1
    v_mfma_f32_16x16x32_bf16 v[236:239], v[132:135], a[124:127], v[236:239]
    v_pk_mul_f32 v[88:89], v[88:89], s[70:71]
    v_mfma_f32_16x16x32_bf16 v[240:243], v[132:135], a[204:207], v[240:243]
    v_pk_mul_f32 v[90:91], v[90:91], s[70:71]
    v_mfma_f32_16x16x32_bf16 v[244:247], v[132:135], v[180:183], v[244:247]
    v_cvt_pk_bf16_f32 v144, v88, v89
    v_cvt_pk_bf16_f32 v145, v90, v91
    v_mfma_f32_16x16x32_bf16 v[252:255], v[132:135], v[136:139], v[252:255]
    v_pk_mul_f32 v[92:93], v[92:93], s[70:71]
    s_waitcnt lgkmcnt(4)
    v_mfma_f32_16x16x32_bf16 v[216:219], v[112:115], a[48:51], v[216:219]
    ds_read_b64_tr_b16 v[128:129], v27 offset:24576
    v_pk_mul_f32 v[94:95], v[94:95], s[70:71]
    v_mfma_f32_16x16x32_bf16 v[220:223], v[112:115], a[128:131], v[220:223]
    ds_read_b64_tr_b16 v[130:131], v27 offset:25088
    v_cvt_pk_bf16_f32 v146, v92, v93
    v_mfma_f32_16x16x32_bf16 v[224:227], v[112:115], a[208:211], v[224:227]
    ds_read_b64_tr_b16 v[132:133], v28 offset:24576
    v_cvt_pk_bf16_f32 v147, v94, v95
    v_mfma_f32_16x16x32_bf16 v[228:231], v[112:115], v[184:187], v[228:231]
    ds_read_b64_tr_b16 v[134:135], v28 offset:25088
    s_nop 1
    v_mfma_f32_16x16x32_bf16 v[248:251], v[112:115], v[136:139], v[248:251]
    v_permlane16_swap_b32 v144, v146
    v_mfma_f32_16x16x32_bf16 v[232:235], v[116:119], a[48:51], v[232:235]
    v_permlane16_swap_b32 v145, v147
    v_mfma_f32_16x16x32_bf16 v[236:239], v[116:119], a[128:131], v[236:239]
    buffer_store_dwordx4 v[144:147], v9, s[24:27], s72 offen offset:0 sc1
    v_mfma_f32_16x16x32_bf16 v[240:243], v[116:119], a[208:211], v[240:243]
    v_pk_mul_f32 v[96:97], v[96:97], s[70:71]
    v_pk_mul_f32 v[98:99], v[98:99], s[70:71]
    v_mfma_f32_16x16x32_bf16 v[244:247], v[116:119], v[184:187], v[244:247]
    v_cvt_pk_bf16_f32 v148, v96, v97
    v_mfma_f32_16x16x32_bf16 v[252:255], v[116:119], v[136:139], v[252:255]
    v_cvt_pk_bf16_f32 v149, v98, v99
    s_waitcnt lgkmcnt(4)
    v_mfma_f32_16x16x32_bf16 v[216:219], v[120:123], a[52:55], v[216:219]
    ds_read_b64_tr_b16 v[112:113], v27 offset:28672
    v_pk_mul_f32 v[100:101], v[100:101], s[70:71]
    v_mfma_f32_16x16x32_bf16 v[220:223], v[120:123], a[132:135], v[220:223]
    ds_read_b64_tr_b16 v[114:115], v27 offset:29184
    v_pk_mul_f32 v[102:103], v[102:103], s[70:71]
    v_mfma_f32_16x16x32_bf16 v[224:227], v[120:123], a[212:215], v[224:227]
    ds_read_b64_tr_b16 v[116:117], v28 offset:28672
    v_cvt_pk_bf16_f32 v150, v100, v101
    v_mfma_f32_16x16x32_bf16 v[228:231], v[120:123], v[188:191], v[228:231]
    ds_read_b64_tr_b16 v[118:119], v28 offset:29184
    v_cvt_pk_bf16_f32 v151, v102, v103
    v_mfma_f32_16x16x32_bf16 v[248:251], v[120:123], v[136:139], v[248:251]
    s_nop 1
    v_mfma_f32_16x16x32_bf16 v[232:235], v[124:127], a[52:55], v[232:235]
    v_permlane16_swap_b32 v148, v150
    v_permlane16_swap_b32 v149, v151
    v_mfma_f32_16x16x32_bf16 v[236:239], v[124:127], a[132:135], v[236:239]
    buffer_store_dwordx4 v[148:151], v10, s[24:27], s72 offen offset:0 sc1
    v_mfma_f32_16x16x32_bf16 v[240:243], v[124:127], a[212:215], v[240:243]
    v_pk_mul_f32 v[104:105], v[104:105], s[70:71]
    v_mfma_f32_16x16x32_bf16 v[244:247], v[124:127], v[188:191], v[244:247]
    v_pk_mul_f32 v[106:107], v[106:107], s[70:71]
    v_mfma_f32_16x16x32_bf16 v[252:255], v[124:127], v[136:139], v[252:255]
    v_cvt_pk_bf16_f32 v140, v104, v105
    s_waitcnt lgkmcnt(4)
    v_mfma_f32_16x16x32_bf16 v[216:219], v[128:131], a[56:59], v[216:219]
    v_add_u32 v27, 0, v25
    v_cvt_pk_bf16_f32 v141, v106, v107
    v_mfma_f32_16x16x32_bf16 v[220:223], v[128:131], a[136:139], v[220:223]
    v_add_u32 v28, 0, v26
    v_pk_mul_f32 v[108:109], v[108:109], s[70:71]
    v_mfma_f32_16x16x32_bf16 v[224:227], v[128:131], a[216:219], v[224:227]
    ds_read_b64_tr_b16 v[120:121], v27 offset:0
    v_pk_mul_f32 v[110:111], v[110:111], s[70:71]
    v_mfma_f32_16x16x32_bf16 v[228:231], v[128:131], v[192:195], v[228:231]
    ds_read_b64_tr_b16 v[122:123], v27 offset:512
    v_cvt_pk_bf16_f32 v142, v108, v109
    v_mfma_f32_16x16x32_bf16 v[248:251], v[128:131], v[136:139], v[248:251]
    ds_read_b64_tr_b16 v[124:125], v28 offset:0
    v_cvt_pk_bf16_f32 v143, v110, v111
    v_mfma_f32_16x16x32_bf16 v[232:235], v[132:135], a[56:59], v[232:235]
    ds_read_b64_tr_b16 v[126:127], v28 offset:512
    s_nop 1
    v_mfma_f32_16x16x32_bf16 v[236:239], v[132:135], a[136:139], v[236:239]
    v_permlane16_swap_b32 v140, v142
    v_permlane16_swap_b32 v141, v143
    v_mfma_f32_16x16x32_bf16 v[240:243], v[132:135], a[216:219], v[240:243]
    buffer_store_dwordx4 v[140:143], v10, s[24:27], s72 offen offset:1024 sc1
    v_mfma_f32_16x16x32_bf16 v[244:247], v[132:135], v[192:195], v[244:247]
    s_waitcnt vmcnt(9)
    s_mov_b32 exec_lo, 0xffff
    s_mov_b32 exec_hi, 0x0
    v_xor_b32 v22, s2, v22
    v_xor_b32 v23, s3, v23
    v_or_b32 v22, v22, v23
    v_cmp_ne_u32 vcc, 0, v22
    s_mov_b64 exec, -1
    s_cmp_eq_u64 vcc, 0
    s_cbranch_scc1 L_pollok_13
    s_mov_b32 exec_lo, 0xffff
    s_mov_b32 exec_hi, 0x0
    s_mov_b32 s84, 1048576
L_poll_14:
    buffer_load_dwordx2 v[22:23], v24, s[24:27], 0 offen sc1
    s_waitcnt vmcnt(0)
    v_xor_b32 v22, s2, v22
    v_xor_b32 v23, s3, v23
    v_or_b32 v22, v22, v23
    v_cmp_ne_u32 vcc, 0, v22
    s_cmp_eq_u64 vcc, 0
    s_cbranch_scc1 L_polled_15
    s_sub_u32 s84, s84, 1
    s_cmp_eq_u32 s84, 0
    s_cbranch_scc1 L_polltmo_16
    s_sleep 2
    s_branch L_poll_14
L_polltmo_16:
    v_mov_b32 v22, 225
    v_mov_b32 v23, 252
    global_store_dword v23, v22, s[38:39]
L_polled_15:
    s_mov_b64 exec, -1
L_pollok_13:
    v_mfma_f32_16x16x32_bf16 v[252:255], v[132:135], v[136:139], v[252:255]
    s_lshl_b32 s55, s48, 6
    s_waitcnt lgkmcnt(4)
    v_mfma_f32_16x16x32_bf16 v[216:219], v[112:115], a[60:63], v[216:219]
    ds_read_b64_tr_b16 v[128:129], v27 offset:4096
    s_add_u32 s55, s55, s50
    v_mfma_f32_16x16x32_bf16 v[220:223], v[112:115], a[140:143], v[220:223]
    ds_read_b64_tr_b16 v[130:131], v27 offset:4608
    v_add_u32 v17, s55, v2
    v_mfma_f32_16x16x32_bf16 v[224:227], v[112:115], a[220:223], v[224:227]
    ds_read_b64_tr_b16 v[132:133], v28 offset:4096
    v_lshlrev_b32 v17, 4, v17
    v_mfma_f32_16x16x32_bf16 v[228:231], v[112:115], v[196:199], v[228:231]
    ds_read_b64_tr_b16 v[134:135], v28 offset:4608
    buffer_load_dwordx4 v[32:35], v17, s[24:27], 0 offen offset:0 sc1
    v_mfma_f32_16x16x32_bf16 v[248:251], v[112:115], v[136:139], v[248:251]
    buffer_load_dwordx4 v[36:39], v17, s[24:27], 0 offen offset:256 sc1
    buffer_load_dwordx4 v[40:43], v17, s[24:27], 0 offen offset:512 sc1
    v_mfma_f32_16x16x32_bf16 v[232:235], v[116:119], a[60:63], v[232:235]
    buffer_load_dwordx4 v[44:47], v17, s[24:27], 0 offen offset:768 sc1
    v_mfma_f32_16x16x32_bf16 v[236:239], v[116:119], a[140:143], v[236:239]
    v_lshlrev_b32 v18, 3, v3
    v_mfma_f32_16x16x32_bf16 v[240:243], v[116:119], a[220:223], v[240:243]
    s_lshl_b32 s56, s79, 1
    v_mfma_f32_16x16x32_bf16 v[244:247], v[116:119], v[196:199], v[244:247]
    v_add_u32 v18, s56, v18
    v_mfma_f32_16x16x32_bf16 v[252:255], v[116:119], v[136:139], v[252:255]
    global_load_dwordx2 v[48:49], v18, s[32:33] offset:0
    s_waitcnt lgkmcnt(4)
    v_mfma_f32_16x16x32_bf16 v[216:219], v[120:123], a[64:67], v[216:219]
    ds_read_b64_tr_b16 v[112:113], v27 offset:8192
    global_load_dwordx2 v[50:51], v18, s[32:33] offset:32
    v_mfma_f32_16x16x32_bf16 v[220:223], v[120:123], a[144:147], v[220:223]
    ds_read_b64_tr_b16 v[114:115], v27 offset:8704
    v_mfma_f32_16x16x32_bf16 v[224:227], v[120:123], a[224:227], v[224:227]
    ds_read_b64_tr_b16 v[116:117], v28 offset:8192
    v_mfma_f32_16x16x32_bf16 v[228:231], v[120:123], v[200:203], v[228:231]
    ds_read_b64_tr_b16 v[118:119], v28 offset:8704
    v_mfma_f32_16x16x32_bf16 v[248:251], v[120:123], v[136:139], v[248:251]
    v_mfma_f32_16x16x32_bf16 v[232:235], v[124:127], a[64:67], v[232:235]
    v_mfma_f32_16x16x32_bf16 v[236:239], v[124:127], a[144:147], v[236:239]
    v_mfma_f32_16x16x32_bf16 v[240:243], v[124:127], a[224:227], v[240:243]
    v_mfma_f32_16x16x32_bf16 v[244:247], v[124:127], v[200:203], v[244:247]
    v_mfma_f32_16x16x32_bf16 v[252:255], v[124:127], v[136:139], v[252:255]
    s_waitcnt lgkmcnt(4)
    v_mfma_f32_16x16x32_bf16 v[216:219], v[128:131], a[68:71], v[216:219]
    ds_read_b64_tr_b16 v[120:121], v27 offset:12288
    v_mfma_f32_16x16x32_bf16 v[220:223], v[128:131], a[148:151], v[220:223]
    ds_read_b64_tr_b16 v[122:123], v27 offset:12800
    v_mfma_f32_16x16x32_bf16 v[224:227], v[128:131], a[228:231], v[224:227]
    ds_read_b64_tr_b16 v[124:125], v28 offset:12288
    v_mfma_f32_16x16x32_bf16 v[228:231], v[128:131], v[204:207], v[228:231]
    ds_read_b64_tr_b16 v[126:127], v28 offset:12800
    v_mfma_f32_16x16x32_bf16 v[248:251], v[128:131], v[136:139], v[248:251]
    v_mfma_f32_16x16x32_bf16 v[232:235], v[132:135], a[68:71], v[232:235]
    v_mfma_f32_16x16x32_bf16 v[236:239], v[132:135], a[148:151], v[236:239]
    v_mfma_f32_16x16x32_bf16 v[240:243], v[132:135], a[228:231], v[240:243]
    v_mfma_f32_16x16x32_bf16 v[244:247], v[132:135], v[204:207], v[244:247]
    v_mfma_f32_16x16x32_bf16 v[252:255], v[132:135], v[136:139], v[252:255]
    s_waitcnt lgkmcnt(4)
    v_mfma_f32_16x16x32_bf16 v[216:219], v[112:115], a[72:75], v[216:219]
    v_mfma_f32_16x16x32_bf16 v[220:223], v[112:115], a[152:155], v[220:223]
    v_mfma_f32_16x16x32_bf16 v[224:227], v[112:115], a[232:235], v[224:227]
    v_mfma_f32_16x16x32_bf16 v[228:231], v[112:115], v[208:211], v[228:231]
    v_mfma_f32_16x16x32_bf16 v[248:251], v[112:115], v[136:139], v[248:251]
    v_mfma_f32_16x16x32_bf16 v[232:235], v[116:119], a[72:75], v[232:235]
    v_mfma_f32_16x16x32_bf16 v[236:239], v[116:119], a[152:155], v[236:239]
    v_mfma_f32_16x16x32_bf16 v[240:243], v[116:119], a[232:235], v[240:243]
    v_mfma_f32_16x16x32_bf16 v[244:247], v[116:119], v[208:211], v[244:247]
    v_mfma_f32_16x16x32_bf16 v[252:255], v[116:119], v[136:139], v[252:255]
    s_waitcnt lgkmcnt(0)
    v_mfma_f32_16x16x32_bf16 v[216:219], v[120:123], a[76:79], v[216:219]
    v_mfma_f32_16x16x32_bf16 v[220:223], v[120:123], a[156:159], v[220:223]
    v_mfma_f32_16x16x32_bf16 v[224:227], v[120:123], a[236:239], v[224:227]
    v_mfma_f32_16x16x32_bf16 v[228:231], v[120:123], v[212:215], v[228:231]
    v_mfma_f32_16x16x32_bf16 v[248:251], v[120:123], v[136:139], v[248:251]
    v_mfma_f32_16x16x32_bf16 v[232:235], v[124:127], a[76:79], v[232:235]
    v_mfma_f32_16x16x32_bf16 v[236:239], v[124:127], a[156:159], v[236:239]
    v_mfma_f32_16x16x32_bf16 v[240:243], v[124:127], a[236:239], v[240:243]
    v_mfma_f32_16x16x32_bf16 v[244:247], v[124:127], v[212:215], v[244:247]
    v_mfma_f32_16x16x32_bf16 v[252:255], v[124:127], v[136:139], v[252:255]
    s_branch L_p1join_4
L_p1v_2:
    ds_read_b64_tr_b16 v[112:113], v15 offset:0
    ds_read_b64_tr_b16 v[114:115], v15 offset:1280
    ds_read_b128 a[0:3], v13 offset:0
    ds_read_b128 a[80:83], v13 offset:2048
    ds_read_b128 a[160:163], v13 offset:4096
    ds_read_b128 a[240:243], v13 offset:6144
    ds_read_b64_tr_b16 v[116:117], v16 offset:32
    ds_read_b64_tr_b16 v[118:119], v16 offset:1312
    ds_read_b64_tr_b16 v[120:121], v15 offset:64
    ds_read_b64_tr_b16 v[122:123], v15 offset:1344
    ds_read_b64_tr_b16 v[124:125], v16 offset:96
    ds_read_b64_tr_b16 v[126:127], v16 offset:1376
    ds_read_b64_tr_b16 v[128:129], v15 offset:128
    ds_read_b64_tr_b16 v[130:131], v15 offset:1408
    s_waitcnt lgkmcnt(0)
    v_mfma_f32_16x16x32_bf16 v[32:35], a[0:3], v[112:115], 0
    ds_read_b64_tr_b16 v[132:133], v15 offset:10240
    s_add_u32 m0, s83, 73728
    v_mfma_f32_16x16x32_bf16 v[36:39], a[80:83], v[112:115], 0
    ds_read_b64_tr_b16 v[134:135], v15 offset:11520
    buffer_load_dwordx4 v4, s[4:7], s53 offen offset:0 lds
    v_mfma_f32_16x16x32_bf16 v[40:43], a[160:163], v[112:115], 0
    ds_read_b128 a[4:7], v14 offset:0
    v_mfma_f32_16x16x32_bf16 v[44:47], a[240:243], v[112:115], 0
    ds_read_b128 a[84:87], v14 offset:2048
    v_mfma_f32_16x16x32_bf16 v[48:51], a[0:3], v[116:119], 0
    ds_read_b128 a[164:167], v14 offset:4096
    buffer_load_dwordx4 v5, s[4:7], s53 offen offset:1024 lds
    v_mfma_f32_16x16x32_bf16 v[52:55], a[80:83], v[116:119], 0
    ds_read_b128 a[244:247], v14 offset:6144
    v_mfma_f32_16x16x32_bf16 v[56:59], a[160:163], v[116:119], 0
    ds_read_b64_tr_b16 v[136:137], v16 offset:10272
    v_mfma_f32_16x16x32_bf16 v[60:63], a[240:243], v[116:119], 0
    ds_read_b64_tr_b16 v[138:139], v16 offset:11552
    v_mfma_f32_16x16x32_bf16 v[64:67], a[0:3], v[120:123], 0
    ds_read_b64_tr_b16 v[140:141], v15 offset:10304
    buffer_load_dwordx4 v6, s[4:7], s53 offen offset:2048 lds
    v_mfma_f32_16x16x32_bf16 v[68:71], a[80:83], v[120:123], 0
    ds_read_b64_tr_b16 v[142:143], v15 offset:11584
    v_mfma_f32_16x16x32_bf16 v[72:75], a[160:163], v[120:123], 0
    ds_read_b64_tr_b16 v[144:145], v16 offset:10336
    v_mfma_f32_16x16x32_bf16 v[76:79], a[240:243], v[120:123], 0
    ds_read_b64_tr_b16 v[146:147], v16 offset:11616
    v_mfma_f32_16x16x32_bf16 v[80:83], a[0:3], v[124:127], 0
    ds_read_b64_tr_b16 v[148:149], v15 offset:10368
    buffer_load_dwordx4 v7, s[4:7], s53 offen offset:3072 lds
    v_mfma_f32_16x16x32_bf16 v[84:87], a[80:83], v[124:127], 0
    ds_read_b64_tr_b16 v[150:151], v15 offset:11648
    v_mfma_f32_16x16x32_bf16 v[88:91], a[160:163], v[124:127], 0
    s_add_u32 m0, s69, 73728
    v_mfma_f32_16x16x32_bf16 v[92:95], a[240:243], v[124:127], 0
    v_mfma_f32_16x16x32_bf16 v[96:99], a[0:3], v[128:131], 0
    buffer_load_dwordx4 v8, s[64:67], s54 offen offset:0 lds
    v_mfma_f32_16x16x32_bf16 v[100:103], a[80:83], v[128:131], 0
    v_mfma_f32_16x16x32_bf16 v[104:107], a[160:163], v[128:131], 0
    v_mfma_f32_16x16x32_bf16 v[108:111], a[240:243], v[128:131], 0
    s_waitcnt lgkmcnt(0)
    s_waitcnt vmcnt(5)
    s_barrier
    v_mfma_f32_16x16x32_bf16 v[32:35], a[4:7], v[132:135], v[32:35]
    ds_read_b64_tr_b16 v[112:113], v15 offset:36864
    buffer_load_dwordx4 v9, s[64:67], s54 offen offset:1024 lds
    v_mfma_f32_16x16x32_bf16 v[36:39], a[84:87], v[132:135], v[36:39]
    ds_read_b64_tr_b16 v[114:115], v15 offset:38144
    v_mfma_f32_16x16x32_bf16 v[40:43], a[164:167], v[132:135], v[40:43]
    ds_read_b128 a[8:11], v13 offset:36864
    v_mfma_f32_16x16x32_bf16 v[44:47], a[244:247], v[132:135], v[44:47]
    ds_read_b128 a[88:91], v13 offset:38912
    v_mfma_f32_16x16x32_bf16 v[48:51], a[4:7], v[136:139], v[48:51]
    ds_read_b128 a[168:171], v13 offset:40960
    buffer_load_dwordx4 v10, s[64:67], s54 offen offset:2048 lds
    v_mfma_f32_16x16x32_bf16 v[52:55], a[84:87], v[136:139], v[52:55]
    ds_read_b128 a[248:251], v13 offset:43008
    v_mfma_f32_16x16x32_bf16 v[56:59], a[164:167], v[136:139], v[56:59]
    ds_read_b64_tr_b16 v[116:117], v16 offset:36896
    v_mfma_f32_16x16x32_bf16 v[60:63], a[244:247], v[136:139], v[60:63]
    ds_read_b64_tr_b16 v[118:119], v16 offset:38176
    v_mfma_f32_16x16x32_bf16 v[64:67], a[4:7], v[140:143], v[64:67]
    ds_read_b64_tr_b16 v[120:121], v15 offset:36928
    buffer_load_dwordx4 v11, s[64:67], s54 offen offset:3072 lds
    v_mfma_f32_16x16x32_bf16 v[68:71], a[84:87], v[140:143], v[68:71]
    ds_read_b64_tr_b16 v[122:123], v15 offset:38208
    v_mfma_f32_16x16x32_bf16 v[72:75], a[164:167], v[140:143], v[72:75]
    ds_read_b64_tr_b16 v[124:125], v16 offset:36960
    s_add_u32 m0, s69, 77824
    v_mfma_f32_16x16x32_bf16 v[76:79], a[244:247], v[140:143], v[76:79]
    ds_read_b64_tr_b16 v[126:127], v16 offset:38240
    v_mfma_f32_16x16x32_bf16 v[80:83], a[4:7], v[144:147], v[80:83]
    ds_read_b64_tr_b16 v[128:129], v15 offset:36992
    buffer_load_dwordx4 v12, s[64:67], s54 offen offset:0 lds
    v_mfma_f32_16x16x32_bf16 v[84:87], a[84:87], v[144:147], v[84:87]
    ds_read_b64_tr_b16 v[130:131], v15 offset:38272
    s_add_u32 s53, s53, 128
    v_mfma_f32_16x16x32_bf16 v[88:91], a[164:167], v[144:147], v[88:91]
    s_add_u32 s54, s54, s73
    v_mfma_f32_16x16x32_bf16 v[92:95], a[244:247], v[144:147], v[92:95]
    s_cmp_ge_u32 s53, 1280
    s_cselect_b32 s55, 1280, 0
    s_cselect_b32 s56, s76, 0
    v_mfma_f32_16x16x32_bf16 v[96:99], a[4:7], v[148:151], v[96:99]
    s_sub_u32 s53, s53, s55
    s_sub_u32 s54, s54, s56
    v_mfma_f32_16x16x32_bf16 v[100:103], a[84:87], v[148:151], v[100:103]
    s_add_u32 m0, s83, 110592
    s_nop 0
    buffer_load_dwordx4 v4, s[4:7], s53 offen offset:0 lds
    v_mfma_f32_16x16x32_bf16 v[104:107], a[164:167], v[148:151], v[104:107]
    v_mfma_f32_16x16x32_bf16 v[108:111], a[244:247], v[148:151], v[108:111]
    s_waitcnt lgkmcnt(0)
    v_mfma_f32_16x16x32_bf16 v[32:35], a[8:11], v[112:115], v[32:35]
    ds_read_b64_tr_b16 v[132:133], v15 offset:47104
    buffer_load_dwordx4 v5, s[4:7], s53 offen offset:1024 lds
    v_mfma_f32_16x16x32_bf16 v[36:39], a[88:91], v[112:115], v[36:39]
    ds_read_b64_tr_b16 v[134:135], v15 offset:48384
    v_mfma_f32_16x16x32_bf16 v[40:43], a[168:171], v[112:115], v[40:43]
    ds_read_b128 a[12:15], v14 offset:36864
    v_mfma_f32_16x16x32_bf16 v[44:47], a[248:251], v[112:115], v[44:47]
    ds_read_b128 a[92:95], v14 offset:38912
    v_mfma_f32_16x16x32_bf16 v[48:51], a[8:11], v[116:119], v[48:51]
    ds_read_b128 a[172:175], v14 offset:40960
    buffer_load_dwordx4 v6, s[4:7], s53 offen offset:2048 lds
    v_mfma_f32_16x16x32_bf16 v[52:55], a[88:91], v[116:119], v[52:55]
    ds_read_b128 a[252:255], v14 offset:43008
    v_mfma_f32_16x16x32_bf16 v[56:59], a[168:171], v[116:119], v[56:59]
    ds_read_b64_tr_b16 v[136:137], v16 offset:47136
    v_mfma_f32_16x16x32_bf16 v[60:63], a[248:251], v[116:119], v[60:63]
    ds_read_b64_tr_b16 v[138:139], v16 offset:48416
    v_mfma_f32_16x16x32_bf16 v[64:67], a[8:11], v[120:123], v[64:67]
    ds_read_b64_tr_b16 v[140:141], v15 offset:47168
    buffer_load_dwordx4 v7, s[4:7], s53 offen offset:3072 lds
    v_mfma_f32_16x16x32_bf16 v[68:71], a[88:91], v[120:123], v[68:71]
    ds_read_b64_tr_b16 v[142:143], v15 offset:48448
    v_mfma_f32_16x16x32_bf16 v[72:75], a[168:171], v[120:123], v[72:75]
    ds_read_b64_tr_b16 v[144:145], v16 offset:47200
    s_add_u32 m0, s69, 110592
    v_mfma_f32_16x16x32_bf16 v[76:79], a[248:251], v[120:123], v[76:79]
    ds_read_b64_tr_b16 v[146:147], v16 offset:48480
    v_mfma_f32_16x16x32_bf16 v[80:83], a[8:11], v[124:127], v[80:83]
    ds_read_b64_tr_b16 v[148:149], v15 offset:47232
    buffer_load_dwordx4 v8, s[64:67], s54 offen offset:0 lds
    v_mfma_f32_16x16x32_bf16 v[84:87], a[88:91], v[124:127], v[84:87]
    ds_read_b64_tr_b16 v[150:151], v15 offset:48512
    v_mfma_f32_16x16x32_bf16 v[88:91], a[168:171], v[124:127], v[88:91]
    v_mfma_f32_16x16x32_bf16 v[92:95], a[248:251], v[124:127], v[92:95]
    v_mfma_f32_16x16x32_bf16 v[96:99], a[8:11], v[128:131], v[96:99]
    buffer_load_dwordx4 v9, s[64:67], s54 offen offset:1024 lds
    v_mfma_f32_16x16x32_bf16 v[100:103], a[88:91], v[128:131], v[100:103]
    v_mfma_f32_16x16x32_bf16 v[104:107], a[168:171], v[128:131], v[104:107]
    v_mfma_f32_16x16x32_bf16 v[108:111], a[248:251], v[128:131], v[108:111]
    s_waitcnt lgkmcnt(0)
    s_waitcnt vmcnt(6)
    s_barrier
    v_mfma_f32_16x16x32_bf16 v[32:35], a[12:15], v[132:135], v[32:35]
    ds_read_b64_tr_b16 v[112:113], v19 offset:0
    buffer_load_dwordx4 v10, s[64:67], s54 offen offset:2048 lds
    v_mfma_f32_16x16x32_bf16 v[36:39], a[92:95], v[132:135], v[36:39]
    ds_read_b64_tr_b16 v[114:115], v19 offset:1280
    v_mfma_f32_16x16x32_bf16 v[40:43], a[172:175], v[132:135], v[40:43]
    ds_read_b128 a[16:19], v17 offset:0
    v_mfma_f32_16x16x32_bf16 v[44:47], a[252:255], v[132:135], v[44:47]
    ds_read_b128 a[96:99], v17 offset:2048
    v_mfma_f32_16x16x32_bf16 v[48:51], a[12:15], v[136:139], v[48:51]
    ds_read_b128 a[176:179], v17 offset:4096
    buffer_load_dwordx4 v11, s[64:67], s54 offen offset:3072 lds
    v_mfma_f32_16x16x32_bf16 v[52:55], a[92:95], v[136:139], v[52:55]
    ds_read_b128 v[152:155], v17 offset:6144
    v_mfma_f32_16x16x32_bf16 v[56:59], a[172:175], v[136:139], v[56:59]
    ds_read_b64_tr_b16 v[116:117], v20 offset:32
    s_add_u32 m0, s69, 114688
    v_mfma_f32_16x16x32_bf16 v[60:63], a[252:255], v[136:139], v[60:63]
    ds_read_b64_tr_b16 v[118:119], v20 offset:1312
    v_mfma_f32_16x16x32_bf16 v[64:67], a[12:15], v[140:143], v[64:67]
    ds_read_b64_tr_b16 v[120:121], v19 offset:64
    buffer_load_dwordx4 v12, s[64:67], s54 offen offset:0 lds
    v_mfma_f32_16x16x32_bf16 v[68:71], a[92:95], v[140:143], v[68:71]
    ds_read_b64_tr_b16 v[122:123], v19 offset:1344
    s_add_u32 s53, s53, 128
    v_mfma_f32_16x16x32_bf16 v[72:75], a[172:175], v[140:143], v[72:75]
    ds_read_b64_tr_b16 v[124:125], v20 offset:96
    s_add_u32 s54, s54, s73
    v_mfma_f32_16x16x32_bf16 v[76:79], a[252:255], v[140:143], v[76:79]
    ds_read_b64_tr_b16 v[126:127], v20 offset:1376
    v_mfma_f32_16x16x32_bf16 v[80:83], a[12:15], v[144:147], v[80:83]
    ds_read_b64_tr_b16 v[128:129], v19 offset:128
    v_mfma_f32_16x16x32_bf16 v[84:87], a[92:95], v[144:147], v[84:87]
    ds_read_b64_tr_b16 v[130:131], v19 offset:1408
    v_mfma_f32_16x16x32_bf16 v[88:91], a[172:175], v[144:147], v[88:91]
    s_cmp_ge_u32 s53, 1280
    s_cselect_b32 s55, 1280, 0
    s_cselect_b32 s56, s76, 0
    v_mfma_f32_16x16x32_bf16 v[92:95], a[252:255], v[144:147], v[92:95]
    s_sub_u32 s53, s53, s55
    s_sub_u32 s54, s54, s56
    v_mfma_f32_16x16x32_bf16 v[96:99], a[12:15], v[148:151], v[96:99]
    s_add_u32 m0, s83, 0
    s_nop 0
    buffer_load_dwordx4 v4, s[4:7], s53 offen offset:0 lds
    v_mfma_f32_16x16x32_bf16 v[100:103], a[92:95], v[148:151], v[100:103]
    buffer_load_dwordx4 v5, s[4:7], s53 offen offset:1024 lds
    v_mfma_f32_16x16x32_bf16 v[104:107], a[172:175], v[148:151], v[104:107]
    v_mfma_f32_16x16x32_bf16 v[108:111], a[252:255], v[148:151], v[108:111]
    s_waitcnt lgkmcnt(0)
    v_mfma_f32_16x16x32_bf16 v[32:35], a[16:19], v[112:115], v[32:35]
    ds_read_b64_tr_b16 v[132:133], v19 offset:10240
    buffer_load_dwordx4 v6, s[4:7], s53 offen offset:2048 lds
    v_mfma_f32_16x16x32_bf16 v[36:39], a[96:99], v[112:115], v[36:39]
    ds_read_b64_tr_b16 v[134:135], v19 offset:11520
    v_mfma_f32_16x16x32_bf16 v[40:43], a[176:179], v[112:115], v[40:43]
    ds_read_b128 a[20:23], v18 offset:0
    v_mfma_f32_16x16x32_bf16 v[44:47], v[152:155], v[112:115], v[44:47]
    ds_read_b128 a[100:103], v18 offset:2048
    v_mfma_f32_16x16x32_bf16 v[48:51], a[16:19], v[116:119], v[48:51]
    ds_read_b128 a[180:183], v18 offset:4096
    buffer_load_dwordx4 v7, s[4:7], s53 offen offset:3072 lds
    v_mfma_f32_16x16x32_bf16 v[52:55], a[96:99], v[116:119], v[52:55]
    ds_read_b128 v[156:159], v18 offset:6144
    v_mfma_f32_16x16x32_bf16 v[56:59], a[176:179], v[116:119], v[56:59]
    ds_read_b64_tr_b16 v[136:137], v20 offset:10272
    s_add_u32 m0, s69, 0
    v_mfma_f32_16x16x32_bf16 v[60:63], v[152:155], v[116:119], v[60:63]
    ds_read_b64_tr_b16 v[138:139], v20 offset:11552
    v_mfma_f32_16x16x32_bf16 v[64:67], a[16:19], v[120:123], v[64:67]
    ds_read_b64_tr_b16 v[140:141], v19 offset:10304
    buffer_load_dwordx4 v8, s[64:67], s54 offen offset:0 lds
    v_mfma_f32_16x16x32_bf16 v[68:71], a[96:99], v[120:123], v[68:71]
    ds_read_b64_tr_b16 v[142:143], v19 offset:11584
    v_mfma_f32_16x16x32_bf16 v[72:75], a[176:179], v[120:123], v[72:75]
    ds_read_b64_tr_b16 v[144:145], v20 offset:10336
    v_mfma_f32_16x16x32_bf16 v[76:79], v[152:155], v[120:123], v[76:79]
    ds_read_b64_tr_b16 v[146:147], v20 offset:11616
    v_mfma_f32_16x16x32_bf16 v[80:83], a[16:19], v[124:127], v[80:83]
    ds_read_b64_tr_b16 v[148:149], v19 offset:10368
    buffer_load_dwordx4 v9, s[64:67], s54 offen offset:1024 lds
    v_mfma_f32_16x16x32_bf16 v[84:87], a[96:99], v[124:127], v[84:87]
    ds_read_b64_tr_b16 v[150:151], v19 offset:11648
    v_mfma_f32_16x16x32_bf16 v[88:91], a[176:179], v[124:127], v[88:91]
    v_mfma_f32_16x16x32_bf16 v[92:95], v[152:155], v[124:127], v[92:95]
    v_mfma_f32_16x16x32_bf16 v[96:99], a[16:19], v[128:131], v[96:99]
    buffer_load_dwordx4 v10, s[64:67], s54 offen offset:2048 lds
    v_mfma_f32_16x16x32_bf16 v[100:103], a[96:99], v[128:131], v[100:103]
    v_mfma_f32_16x16x32_bf16 v[104:107], a[176:179], v[128:131], v[104:107]
    v_mfma_f32_16x16x32_bf16 v[108:111], v[152:155], v[128:131], v[108:111]
    s_waitcnt lgkmcnt(0)
    s_waitcnt vmcnt(7)
    s_barrier
    v_mfma_f32_16x16x32_bf16 v[32:35], a[20:23], v[132:135], v[32:35]
    ds_read_b64_tr_b16 v[112:113], v19 offset:36864
    buffer_load_dwordx4 v11, s[64:67], s54 offen offset:3072 lds
    v_mfma_f32_16x16x32_bf16 v[36:39], a[100:103], v[132:135], v[36:39]
    ds_read_b64_tr_b16 v[114:115], v19 offset:38144
    v_mfma_f32_16x16x32_bf16 v[40:43], a[180:183], v[132:135], v[40:43]
    ds_read_b128 a[24:27], v17 offset:36864
    s_add_u32 m0, s69, 4096
    v_mfma_f32_16x16x32_bf16 v[44:47], v[156:159], v[132:135], v[44:47]
    ds_read_b128 a[104:107], v17 offset:38912
    v_mfma_f32_16x16x32_bf16 v[48:51], a[20:23], v[136:139], v[48:51]
    ds_read_b128 a[184:187], v17 offset:40960
    buffer_load_dwordx4 v12, s[64:67], s54 offen offset:0 lds
    v_mfma_f32_16x16x32_bf16 v[52:55], a[100:103], v[136:139], v[52:55]
    ds_read_b128 v[160:163], v17 offset:43008
    s_add_u32 s53, s53, 128
    v_mfma_f32_16x16x32_bf16 v[56:59], a[180:183], v[136:139], v[56:59]
    ds_read_b64_tr_b16 v[116:117], v20 offset:36896
    s_add_u32 s54, s54, s73
    v_mfma_f32_16x16x32_bf16 v[60:63], v[156:159], v[136:139], v[60:63]
    ds_read_b64_tr_b16 v[118:119], v20 offset:38176
    v_mfma_f32_16x16x32_bf16 v[64:67], a[20:23], v[140:143], v[64:67]
    ds_read_b64_tr_b16 v[120:121], v19 offset:36928
    v_mfma_f32_16x16x32_bf16 v[68:71], a[100:103], v[140:143], v[68:71]
    ds_read_b64_tr_b16 v[122:123], v19 offset:38208
    v_mfma_f32_16x16x32_bf16 v[72:75], a[180:183], v[140:143], v[72:75]
    ds_read_b64_tr_b16 v[124:125], v20 offset:36960
    v_mfma_f32_16x16x32_bf16 v[76:79], v[156:159], v[140:143], v[76:79]
    ds_read_b64_tr_b16 v[126:127], v20 offset:38240
    v_mfma_f32_16x16x32_bf16 v[80:83], a[20:23], v[144:147], v[80:83]
    ds_read_b64_tr_b16 v[128:129], v19 offset:36992
    v_mfma_f32_16x16x32_bf16 v[84:87], a[100:103], v[144:147], v[84:87]
    ds_read_b64_tr_b16 v[130:131], v19 offset:38272
    v_mfma_f32_16x16x32_bf16 v[88:91], a[180:183], v[144:147], v[88:91]
    s_cmp_ge_u32 s53, 1280
    s_cselect_b32 s55, 1280, 0
    s_cselect_b32 s56, s76, 0
    v_mfma_f32_16x16x32_bf16 v[92:95], v[156:159], v[144:147], v[92:95]
    s_sub_u32 s53, s53, s55
    s_sub_u32 s54, s54, s56
    v_mfma_f32_16x16x32_bf16 v[96:99], a[20:23], v[148:151], v[96:99]
    s_add_u32 m0, s83, 36864
    s_nop 0
    buffer_load_dwordx4 v4, s[4:7], s53 offen offset:0 lds
    v_mfma_f32_16x16x32_bf16 v[100:103], a[100:103], v[148:151], v[100:103]
    buffer_load_dwordx4 v5, s[4:7], s53 offen offset:1024 lds
    buffer_load_dwordx4 v6, s[4:7], s53 offen offset:2048 lds
    v_mfma_f32_16x16x32_bf16 v[104:107], a[180:183], v[148:151], v[104:107]
    v_mfma_f32_16x16x32_bf16 v[108:111], v[156:159], v[148:151], v[108:111]
    s_waitcnt lgkmcnt(0)
    v_mfma_f32_16x16x32_bf16 v[32:35], a[24:27], v[112:115], v[32:35]
    ds_read_b64_tr_b16 v[132:133], v19 offset:47104
    buffer_load_dwordx4 v7, s[4:7], s53 offen offset:3072 lds
    v_mfma_f32_16x16x32_bf16 v[36:39], a[104:107], v[112:115], v[36:39]
    ds_read_b64_tr_b16 v[134:135], v19 offset:48384
    v_mfma_f32_16x16x32_bf16 v[40:43], a[184:187], v[112:115], v[40:43]
    ds_read_b128 a[28:31], v18 offset:36864
    s_add_u32 m0, s69, 36864
    v_mfma_f32_16x16x32_bf16 v[44:47], v[160:163], v[112:115], v[44:47]
    ds_read_b128 a[108:111], v18 offset:38912
    v_mfma_f32_16x16x32_bf16 v[48:51], a[24:27], v[116:119], v[48:51]
    ds_read_b128 a[188:191], v18 offset:40960
    buffer_load_dwordx4 v8, s[64:67], s54 offen offset:0 lds
    v_mfma_f32_16x16x32_bf16 v[52:55], a[104:107], v[116:119], v[52:55]
    ds_read_b128 v[164:167], v18 offset:43008
    v_mfma_f32_16x16x32_bf16 v[56:59], a[184:187], v[116:119], v[56:59]
    ds_read_b64_tr_b16 v[136:137], v20 offset:47136
    v_mfma_f32_16x16x32_bf16 v[60:63], v[160:163], v[116:119], v[60:63]
    ds_read_b64_tr_b16 v[138:139], v20 offset:48416
    v_mfma_f32_16x16x32_bf16 v[64:67], a[24:27], v[120:123], v[64:67]
    ds_read_b64_tr_b16 v[140:141], v19 offset:47168
    buffer_load_dwordx4 v9, s[64:67], s54 offen offset:1024 lds
    v_mfma_f32_16x16x32_bf16 v[68:71], a[104:107], v[120:123], v[68:71]
    ds_read_b64_tr_b16 v[142:143], v19 offset:48448
    v_mfma_f32_16x16x32_bf16 v[72:75], a[184:187], v[120:123], v[72:75]
    ds_read_b64_tr_b16 v[144:145], v20 offset:47200
    v_mfma_f32_16x16x32_bf16 v[76:79], v[160:163], v[120:123], v[76:79]
    ds_read_b64_tr_b16 v[146:147], v20 offset:48480
    v_mfma_f32_16x16x32_bf16 v[80:83], a[24:27], v[124:127], v[80:83]
    ds_read_b64_tr_b16 v[148:149], v19 offset:47232
    buffer_load_dwordx4 v10, s[64:67], s54 offen offset:2048 lds
    v_mfma_f32_16x16x32_bf16 v[84:87], a[104:107], v[124:127], v[84:87]
    ds_read_b64_tr_b16 v[150:151], v19 offset:48512
    v_mfma_f32_16x16x32_bf16 v[88:91], a[184:187], v[124:127], v[88:91]
    v_mfma_f32_16x16x32_bf16 v[92:95], v[160:163], v[124:127], v[92:95]
    v_mfma_f32_16x16x32_bf16 v[96:99], a[24:27], v[128:131], v[96:99]
    buffer_load_dwordx4 v11, s[64:67], s54 offen offset:3072 lds
    v_mfma_f32_16x16x32_bf16 v[100:103], a[104:107], v[128:131], v[100:103]
    v_mfma_f32_16x16x32_bf16 v[104:107], a[184:187], v[128:131], v[104:107]
    s_add_u32 m0, s69, 40960
    v_mfma_f32_16x16x32_bf16 v[108:111], v[160:163], v[128:131], v[108:111]
    s_waitcnt lgkmcnt(0)
    s_waitcnt vmcnt(8)
    s_barrier
    s_mov_b32 exec_lo, 0x1
    s_mov_b32 exec_hi, 0x0
    s_nop 0
    v_readfirstlane_b32 s2, v254
    v_readfirstlane_b32 s3, v255
    v_or_b32 v254, v254, v255
    v_cmp_eq_u32 vcc, 0, v254
    s_mov_b64 exec, -1
    s_cmp_eq_u64 vcc, 0
    s_cbranch_scc1 L_pollok_17
    s_mov_b32 exec_lo, 0x1
    s_mov_b32 exec_hi, 0x0
    s_mov_b32 s84, 1048576
L_poll_18:
    global_load_dwordx2 v[254:255], v253, s[38:39] sc1
    s_waitcnt vmcnt(0)
    s_nop 0
    v_readfirstlane_b32 s2, v254
    v_readfirstlane_b32 s3, v255
    v_or_b32 v254, v254, v255
    v_cmp_eq_u32 vcc, 0, v254
    s_cmp_eq_u64 vcc, 0
    s_cbranch_scc1 L_polled_19
    s_sub_u32 s84, s84, 1
    s_cmp_eq_u32 s84, 0
    s_cbranch_scc1 L_polltmo_20
    s_sleep 2
    s_branch L_poll_18
L_polltmo_20:
    v_mov_b32 v254, 224
    v_mov_b32 v255, 252
    global_store_dword v255, v254, s[38:39]
L_polled_19:
    s_mov_b64 exec, -1
L_pollok_17:
    s_cmp_lg_u32 s40, 0
    s_cbranch_scc1 L_noflag_21
    s_mov_b64 exec, 1
    v_mov_b32 v240, s2
    v_mov_b32 v241, s3
    v_mov_b32 v242, 0
    buffer_store_dwordx2 v[240:241], v242, s[24:27], s101 offen sc1
    s_mov_b64 exec, -1
L_noflag_21:
    v_mfma_f32_16x16x32_bf16 v[32:35], a[28:31], v[132:135], v[32:35]
    ds_read_b64_tr_b16 v[112:113], v15 offset:0
    buffer_load_dwordx4 v12, s[64:67], s54 offen offset:0 lds
    v_mfma_f32_16x16x32_bf16 v[36:39], a[108:111], v[132:135], v[36:39]
    ds_read_b64_tr_b16 v[114:115], v15 offset:1280
    s_add_u32 s53, s53, 128
    v_mfma_f32_16x16x32_bf16 v[40:43], a[188:191], v[132:135], v[40:43]
    ds_read_b128 a[32:35], v13 offset:0
    s_add_u32 s54, s54, s73
    v_mfma_f32_16x16x32_bf16 v[44:47], v[164:167], v[132:135], v[44:47]
    ds_read_b128 a[112:115], v13 offset:2048
    v_mfma_f32_16x16x32_bf16 v[48:51], a[28:31], v[136:139], v[48:51]
    ds_read_b128 a[192:195], v13 offset:4096
    v_mfma_f32_16x16x32_bf16 v[52:55], a[108:111], v[136:139], v[52:55]
    ds_read_b128 v[168:171], v13 offset:6144
    v_mfma_f32_16x16x32_bf16 v[56:59], a[188:191], v[136:139], v[56:59]
    ds_read_b64_tr_b16 v[116:117], v16 offset:32
    v_mfma_f32_16x16x32_bf16 v[60:63], v[164:167], v[136:139], v[60:63]
    ds_read_b64_tr_b16 v[118:119], v16 offset:1312
    v_mfma_f32_16x16x32_bf16 v[64:67], a[28:31], v[140:143], v[64:67]
    ds_read_b64_tr_b16 v[120:121], v15 offset:64
    v_mfma_f32_16x16x32_bf16 v[68:71], a[108:111], v[140:143], v[68:71]
    ds_read_b64_tr_b16 v[122:123], v15 offset:1344
    v_mfma_f32_16x16x32_bf16 v[72:75], a[188:191], v[140:143], v[72:75]
    ds_read_b64_tr_b16 v[124:125], v16 offset:96
    v_mfma_f32_16x16x32_bf16 v[76:79], v[164:167], v[140:143], v[76:79]
    ds_read_b64_tr_b16 v[126:127], v16 offset:1376
    v_mfma_f32_16x16x32_bf16 v[80:83], a[28:31], v[144:147], v[80:83]
    ds_read_b64_tr_b16 v[128:129], v15 offset:128
    v_mfma_f32_16x16x32_bf16 v[84:87], a[108:111], v[144:147], v[84:87]
    ds_read_b64_tr_b16 v[130:131], v15 offset:1408
    v_mfma_f32_16x16x32_bf16 v[88:91], a[188:191], v[144:147], v[88:91]
    s_cmp_ge_u32 s53, 1280
    s_cselect_b32 s55, 1280, 0
    s_cselect_b32 s56, s76, 0
    v_mfma_f32_16x16x32_bf16 v[92:95], v[164:167], v[144:147], v[92:95]
    s_sub_u32 s53, s53, s55
    s_sub_u32 s54, s54, s56
    v_mfma_f32_16x16x32_bf16 v[96:99], a[28:31], v[148:151], v[96:99]
    s_add_u32 m0, s83, 73728
    s_nop 0
    buffer_load_dwordx4 v4, s[4:7], s53 offen offset:0 lds
    v_mfma_f32_16x16x32_bf16 v[100:103], a[108:111], v[148:151], v[100:103]
    buffer_load_dwordx4 v5, s[4:7], s53 offen offset:1024 lds
    buffer_load_dwordx4 v6, s[4:7], s53 offen offset:2048 lds
    v_mfma_f32_16x16x32_bf16 v[104:107], a[188:191], v[148:151], v[104:107]
    buffer_load_dwordx4 v7, s[4:7], s53 offen offset:3072 lds
    s_add_u32 m0, s69, 73728
    v_mfma_f32_16x16x32_bf16 v[108:111], v[164:167], v[148:151], v[108:111]
    s_waitcnt lgkmcnt(0)
    v_mfma_f32_16x16x32_bf16 v[32:35], a[32:35], v[112:115], v[32:35]
    ds_read_b64_tr_b16 v[132:133], v15 offset:10240
    buffer_load_dwordx4 v8, s[64:67], s54 offen offset:0 lds
    v_mfma_f32_16x16x32_bf16 v[36:39], a[112:115], v[112:115], v[36:39]
    ds_read_b64_tr_b16 v[134:135], v15 offset:11520
    v_mfma_f32_16x16x32_bf16 v[40:43], a[192:195], v[112:115], v[40:43]
    ds_read_b128 a[36:39], v14 offset:0
    v_mfma_f32_16x16x32_bf16 v[44:47], v[168:171], v[112:115], v[44:47]
    ds_read_b128 a[116:119], v14 offset:2048
    v_mfma_f32_16x16x32_bf16 v[48:51], a[32:35], v[116:119], v[48:51]
    ds_read_b128 a[196:199], v14 offset:4096
    buffer_load_dwordx4 v9, s[64:67], s54 offen offset:1024 lds
    v_mfma_f32_16x16x32_bf16 v[52:55], a[112:115], v[116:119], v[52:55]
    ds_read_b128 v[172:175], v14 offset:6144
    v_mfma_f32_16x16x32_bf16 v[56:59], a[192:195], v[116:119], v[56:59]
    ds_read_b64_tr_b16 v[136:137], v16 offset:10272
    v_mfma_f32_16x16x32_bf16 v[60:63], v[168:171], v[116:119], v[60:63]
    ds_read_b64_tr_b16 v[138:139], v16 offset:11552
    v_mfma_f32_16x16x32_bf16 v[64:67], a[32:35], v[120:123], v[64:67]
    ds_read_b64_tr_b16 v[140:141], v15 offset:10304
    buffer_load_dwordx4 v10, s[64:67], s54 offen offset:2048 lds
    v_mfma_f32_16x16x32_bf16 v[68:71], a[112:115], v[120:123], v[68:71]
    ds_read_b64_tr_b16 v[142:143], v15 offset:11584
    v_mfma_f32_16x16x32_bf16 v[72:75], a[192:195], v[120:123], v[72:75]
    ds_read_b64_tr_b16 v[144:145], v16 offset:10336
    v_mfma_f32_16x16x32_bf16 v[76:79], v[168:171], v[120:123], v[76:79]
    ds_read_b64_tr_b16 v[146:147], v16 offset:11616
    v_mfma_f32_16x16x32_bf16 v[80:83], a[32:35], v[124:127], v[80:83]
    ds_read_b64_tr_b16 v[148:149], v15 offset:10368
    buffer_load_dwordx4 v11, s[64:67], s54 offen offset:3072 lds
    v_mfma_f32_16x16x32_bf16 v[84:87], a[112:115], v[124:127], v[84:87]
    ds_read_b64_tr_b16 v[150:151], v15 offset:11648
    v_mfma_f32_16x16x32_bf16 v[88:91], a[192:195], v[124:127], v[88:91]
    s_add_u32 m0, s69, 77824
    v_mfma_f32_16x16x32_bf16 v[92:95], v[168:171], v[124:127], v[92:95]
    v_mfma_f32_16x16x32_bf16 v[96:99], a[32:35], v[128:131], v[96:99]
    buffer_load_dwordx4 v12, s[64:67], s54 offen offset:0 lds
    v_mfma_f32_16x16x32_bf16 v[100:103], a[112:115], v[128:131], v[100:103]
    s_add_u32 s53, s53, 128
    s_add_u32 s54, s54, s73
    v_mfma_f32_16x16x32_bf16 v[104:107], a[192:195], v[128:131], v[104:107]
    s_cmp_ge_u32 s53, 1280
    s_cselect_b32 s55, 1280, 0
    s_cselect_b32 s56, s76, 0
    v_mfma_f32_16x16x32_bf16 v[108:111], v[168:171], v[128:131], v[108:111]
    s_sub_u32 s53, s53, s55
    s_sub_u32 s54, s54, s56
    s_waitcnt lgkmcnt(0)
    s_waitcnt vmcnt(9)
    s_barrier
    v_mfma_f32_16x16x32_bf16 v[32:35], a[36:39], v[132:135], v[32:35]
    ds_read_b64_tr_b16 v[112:113], v15 offset:36864
    s_add_u32 m0, s83, 110592
    v_mfma_f32_16x16x32_bf16 v[36:39], a[116:119], v[132:135], v[36:39]
    ds_read_b64_tr_b16 v[114:115], v15 offset:38144
    buffer_load_dwordx4 v4, s[4:7], s53 offen offset:0 lds
    v_mfma_f32_16x16x32_bf16 v[40:43], a[196:199], v[132:135], v[40:43]
    ds_read_b128 a[40:43], v13 offset:36864
    v_mfma_f32_16x16x32_bf16 v[44:47], v[172:175], v[132:135], v[44:47]
    ds_read_b128 a[120:123], v13 offset:38912
    v_mfma_f32_16x16x32_bf16 v[48:51], a[36:39], v[136:139], v[48:51]
    ds_read_b128 a[200:203], v13 offset:40960
    buffer_load_dwordx4 v5, s[4:7], s53 offen offset:1024 lds
    v_mfma_f32_16x16x32_bf16 v[52:55], a[116:119], v[136:139], v[52:55]
    ds_read_b128 v[176:179], v13 offset:43008
    v_mfma_f32_16x16x32_bf16 v[56:59], a[196:199], v[136:139], v[56:59]
    ds_read_b64_tr_b16 v[116:117], v16 offset:36896
    v_mfma_f32_16x16x32_bf16 v[60:63], v[172:175], v[136:139], v[60:63]
    ds_read_b64_tr_b16 v[118:119], v16 offset:38176
    v_mfma_f32_16x16x32_bf16 v[64:67], a[36:39], v[140:143], v[64:67]
    ds_read_b64_tr_b16 v[120:121], v15 offset:36928
    buffer_load_dwordx4 v6, s[4:7], s53 offen offset:2048 lds
    v_mfma_f32_16x16x32_bf16 v[68:71], a[116:119], v[140:143], v[68:71]
    ds_read_b64_tr_b16 v[122:123], v15 offset:38208
    v_mfma_f32_16x16x32_bf16 v[72:75], a[196:199], v[140:143], v[72:75]
    ds_read_b64_tr_b16 v[124:125], v16 offset:36960
    v_mfma_f32_16x16x32_bf16 v[76:79], v[172:175], v[140:143], v[76:79]
    ds_read_b64_tr_b16 v[126:127], v16 offset:38240
    v_mfma_f32_16x16x32_bf16 v[80:83], a[36:39], v[144:147], v[80:83]
    ds_read_b64_tr_b16 v[128:129], v15 offset:36992
    buffer_load_dwordx4 v7, s[4:7], s53 offen offset:3072 lds
    v_mfma_f32_16x16x32_bf16 v[84:87], a[116:119], v[144:147], v[84:87]
    ds_read_b64_tr_b16 v[130:131], v15 offset:38272
    v_mfma_f32_16x16x32_bf16 v[88:91], a[196:199], v[144:147], v[88:91]
    s_add_u32 m0, s69, 110592
    v_mfma_f32_16x16x32_bf16 v[92:95], v[172:175], v[144:147], v[92:95]
    v_mfma_f32_16x16x32_bf16 v[96:99], a[36:39], v[148:151], v[96:99]
    buffer_load_dwordx4 v8, s[64:67], s54 offen offset:0 lds
    v_mfma_f32_16x16x32_bf16 v[100:103], a[116:119], v[148:151], v[100:103]
    v_mfma_f32_16x16x32_bf16 v[104:107], a[196:199], v[148:151], v[104:107]
    v_mfma_f32_16x16x32_bf16 v[108:111], v[172:175], v[148:151], v[108:111]
    s_waitcnt lgkmcnt(0)
    v_mfma_f32_16x16x32_bf16 v[32:35], a[40:43], v[112:115], v[32:35]
    ds_read_b64_tr_b16 v[132:133], v15 offset:47104
    buffer_load_dwordx4 v9, s[64:67], s54 offen offset:1024 lds
    v_mfma_f32_16x16x32_bf16 v[36:39], a[120:123], v[112:115], v[36:39]
    ds_read_b64_tr_b16 v[134:135], v15 offset:48384
    v_mfma_f32_16x16x32_bf16 v[40:43], a[200:203], v[112:115], v[40:43]
    ds_read_b128 a[44:47], v14 offset:36864
    v_mfma_f32_16x16x32_bf16 v[44:47], v[176:179], v[112:115], v[44:47]
    ds_read_b128 a[124:127], v14 offset:38912
    v_mfma_f32_16x16x32_bf16 v[48:51], a[40:43], v[116:119], v[48:51]
    ds_read_b128 a[204:207], v14 offset:40960
    buffer_load_dwordx4 v10, s[64:67], s54 offen offset:2048 lds
    v_mfma_f32_16x16x32_bf16 v[52:55], a[120:123], v[116:119], v[52:55]
    ds_read_b128 v[180:183], v14 offset:43008
    v_mfma_f32_16x16x32_bf16 v[56:59], a[200:203], v[116:119], v[56:59]
    ds_read_b64_tr_b16 v[136:137], v16 offset:47136
    v_mfma_f32_16x16x32_bf16 v[60:63], v[176:179], v[116:119], v[60:63]
    ds_read_b64_tr_b16 v[138:139], v16 offset:48416
    v_mfma_f32_16x16x32_bf16 v[64:67], a[40:43], v[120:123], v[64:67]
    ds_read_b64_tr_b16 v[140:141], v15 offset:47168
    buffer_load_dwordx4 v11, s[64:67], s54 offen offset:3072 lds
    v_mfma_f32_16x16x32_bf16 v[68:71], a[120:123], v[120:123], v[68:71]
    ds_read_b64_tr_b16 v[142:143], v15 offset:48448
    v_mfma_f32_16x16x32_bf16 v[72:75], a[200:203], v[120:123], v[72:75]
    ds_read_b64_tr_b16 v[144:145], v16 offset:47200
    s_add_u32 m0, s69, 114688
    v_mfma_f32_16x16x32_bf16 v[76:79], v[176:179], v[120:123], v[76:79]
    ds_read_b64_tr_b16 v[146:147], v16 offset:48480
    v_mfma_f32_16x16x32_bf16 v[80:83], a[40:43], v[124:127], v[80:83]
    ds_read_b64_tr_b16 v[148:149], v15 offset:47232
    buffer_load_dwordx4 v12, s[64:67], s54 offen offset:0 lds
    v_mfma_f32_16x16x32_bf16 v[84:87], a[120:123], v[124:127], v[84:87]
    ds_read_b64_tr_b16 v[150:151], v15 offset:48512
    s_add_u32 s53, s53, 128
    v_mfma_f32_16x16x32_bf16 v[88:91], a[200:203], v[124:127], v[88:91]
    s_add_u32 s54, s54, s73
    v_mfma_f32_16x16x32_bf16 v[92:95], v[176:179], v[124:127], v[92:95]
    s_cmp_ge_u32 s53, 1280
    s_cselect_b32 s55, 1280, 0
    s_cselect_b32 s56, s76, 0
    v_mfma_f32_16x16x32_bf16 v[96:99], a[40:43], v[128:131], v[96:99]
    s_sub_u32 s53, s53, s55
    s_sub_u32 s54, s54, s56
    v_mfma_f32_16x16x32_bf16 v[100:103], a[120:123], v[128:131], v[100:103]
    s_add_u32 m0, s83, 0
    s_nop 0
    buffer_load_dwordx4 v4, s[4:7], s53 offen offset:0 lds
    v_mfma_f32_16x16x32_bf16 v[104:107], a[200:203], v[128:131], v[104:107]
    v_mfma_f32_16x16x32_bf16 v[108:111], v[176:179], v[128:131], v[108:111]
    s_waitcnt lgkmcnt(0)
    s_waitcnt vmcnt(10)
    s_barrier
    v_mfma_f32_16x16x32_bf16 v[32:35], a[44:47], v[132:135], v[32:35]
    ds_read_b64_tr_b16 v[112:113], v19 offset:0
    buffer_load_dwordx4 v5, s[4:7], s53 offen offset:1024 lds
    v_mfma_f32_16x16x32_bf16 v[36:39], a[124:127], v[132:135], v[36:39]
    ds_read_b64_tr_b16 v[114:115], v19 offset:1280
    v_mfma_f32_16x16x32_bf16 v[40:43], a[204:207], v[132:135], v[40:43]
    ds_read_b128 a[48:51], v17 offset:0
    v_mfma_f32_16x16x32_bf16 v[44:47], v[180:183], v[132:135], v[44:47]
    ds_read_b128 a[128:131], v17 offset:2048
    v_mfma_f32_16x16x32_bf16 v[48:51], a[44:47], v[136:139], v[48:51]
    ds_read_b128 a[208:211], v17 offset:4096
    buffer_load_dwordx4 v6, s[4:7], s53 offen offset:2048 lds
    v_mfma_f32_16x16x32_bf16 v[52:55], a[124:127], v[136:139], v[52:55]
    ds_read_b128 v[184:187], v17 offset:6144
    v_mfma_f32_16x16x32_bf16 v[56:59], a[204:207], v[136:139], v[56:59]
    ds_read_b64_tr_b16 v[116:117], v20 offset:32
    v_mfma_f32_16x16x32_bf16 v[60:63], v[180:183], v[136:139], v[60:63]
    ds_read_b64_tr_b16 v[118:119], v20 offset:1312
    v_mfma_f32_16x16x32_bf16 v[64:67], a[44:47], v[140:143], v[64:67]
    ds_read_b64_tr_b16 v[120:121], v19 offset:64
    buffer_load_dwordx4 v7, s[4:7], s53 offen offset:3072 lds
    v_mfma_f32_16x16x32_bf16 v[68:71], a[124:127], v[140:143], v[68:71]
    ds_read_b64_tr_b16 v[122:123], v19 offset:1344
    v_mfma_f32_16x16x32_bf16 v[72:75], a[204:207], v[140:143], v[72:75]
    ds_read_b64_tr_b16 v[124:125], v20 offset:96
    s_add_u32 m0, s69, 0
    v_mfma_f32_16x16x32_bf16 v[76:79], v[180:183], v[140:143], v[76:79]
    ds_read_b64_tr_b16 v[126:127], v20 offset:1376
    v_mfma_f32_16x16x32_bf16 v[80:83], a[44:47], v[144:147], v[80:83]
    ds_read_b64_tr_b16 v[128:129], v19 offset:128
    buffer_load_dwordx4 v8, s[64:67], s54 offen offset:0 lds
    v_mfma_f32_16x16x32_bf16 v[84:87], a[124:127], v[144:147], v[84:87]
    ds_read_b64_tr_b16 v[130:131], v19 offset:1408
    v_mfma_f32_16x16x32_bf16 v[88:91], a[204:207], v[144:147], v[88:91]
    v_mfma_f32_16x16x32_bf16 v[92:95], v[180:183], v[144:147], v[92:95]
    v_mfma_f32_16x16x32_bf16 v[96:99], a[44:47], v[148:151], v[96:99]
    buffer_load_dwordx4 v9, s[64:67], s54 offen offset:1024 lds
    v_mfma_f32_16x16x32_bf16 v[100:103], a[124:127], v[148:151], v[100:103]
    v_mfma_f32_16x16x32_bf16 v[104:107], a[204:207], v[148:151], v[104:107]
    v_mfma_f32_16x16x32_bf16 v[108:111], v[180:183], v[148:151], v[108:111]
    s_waitcnt lgkmcnt(0)
    v_mfma_f32_16x16x32_bf16 v[32:35], a[48:51], v[112:115], v[32:35]
    ds_read_b64_tr_b16 v[132:133], v19 offset:10240
    buffer_load_dwordx4 v10, s[64:67], s54 offen offset:2048 lds
    v_mfma_f32_16x16x32_bf16 v[36:39], a[128:131], v[112:115], v[36:39]
    ds_read_b64_tr_b16 v[134:135], v19 offset:11520
    v_mfma_f32_16x16x32_bf16 v[40:43], a[208:211], v[112:115], v[40:43]
    ds_read_b128 a[52:55], v18 offset:0
    v_mfma_f32_16x16x32_bf16 v[44:47], v[184:187], v[112:115], v[44:47]
    ds_read_b128 a[132:135], v18 offset:2048
    v_mfma_f32_16x16x32_bf16 v[48:51], a[48:51], v[116:119], v[48:51]
    ds_read_b128 a[212:215], v18 offset:4096
    buffer_load_dwordx4 v11, s[64:67], s54 offen offset:3072 lds
    v_mfma_f32_16x16x32_bf16 v[52:55], a[128:131], v[116:119], v[52:55]
    ds_read_b128 v[188:191], v18 offset:6144
    v_mfma_f32_16x16x32_bf16 v[56:59], a[208:211], v[116:119], v[56:59]
    ds_read_b64_tr_b16 v[136:137], v20 offset:10272
    s_add_u32 m0, s69, 4096
    v_mfma_f32_16x16x32_bf16 v[60:63], v[184:187], v[116:119], v[60:63]
    ds_read_b64_tr_b16 v[138:139], v20 offset:11552
    v_mfma_f32_16x16x32_bf16 v[64:67], a[48:51], v[120:123], v[64:67]
    ds_read_b64_tr_b16 v[140:141], v19 offset:10304
    buffer_load_dwordx4 v12, s[64:67], s54 offen offset:0 lds
    v_mfma_f32_16x16x32_bf16 v[68:71], a[128:131], v[120:123], v[68:71]
    ds_read_b64_tr_b16 v[142:143], v19 offset:11584
    s_add_u32 s53, s53, 128
    v_mfma_f32_16x16x32_bf16 v[72:75], a[208:211], v[120:123], v[72:75]
    ds_read_b64_tr_b16 v[144:145], v20 offset:10336
    s_add_u32 s54, s54, s73
    v_mfma_f32_16x16x32_bf16 v[76:79], v[184:187], v[120:123], v[76:79]
    ds_read_b64_tr_b16 v[146:147], v20 offset:11616
    v_mfma_f32_16x16x32_bf16 v[80:83], a[48:51], v[124:127], v[80:83]
    ds_read_b64_tr_b16 v[148:149], v19 offset:10368
    v_mfma_f32_16x16x32_bf16 v[84:87], a[128:131], v[124:127], v[84:87]
    ds_read_b64_tr_b16 v[150:151], v19 offset:11648
    v_mfma_f32_16x16x32_bf16 v[88:91], a[208:211], v[124:127], v[88:91]
    s_cmp_ge_u32 s53, 1280
    s_cselect_b32 s55, 1280, 0
    s_cselect_b32 s56, s76, 0
    v_mfma_f32_16x16x32_bf16 v[92:95], v[184:187], v[124:127], v[92:95]
    s_sub_u32 s53, s53, s55
    s_sub_u32 s54, s54, s56
    v_mfma_f32_16x16x32_bf16 v[96:99], a[48:51], v[128:131], v[96:99]
    s_add_u32 m0, s83, 36864
    s_nop 0
    buffer_load_dwordx4 v4, s[4:7], s53 offen offset:0 lds
    v_mfma_f32_16x16x32_bf16 v[100:103], a[128:131], v[128:131], v[100:103]
    buffer_load_dwordx4 v5, s[4:7], s53 offen offset:1024 lds
    v_mfma_f32_16x16x32_bf16 v[104:107], a[208:211], v[128:131], v[104:107]
    v_mfma_f32_16x16x32_bf16 v[108:111], v[184:187], v[128:131], v[108:111]
    s_waitcnt lgkmcnt(0)
    s_waitcnt vmcnt(11)
    s_barrier
    v_mfma_f32_16x16x32_bf16 v[32:35], a[52:55], v[132:135], v[32:35]
    ds_read_b64_tr_b16 v[112:113], v19 offset:36864
    buffer_load_dwordx4 v6, s[4:7], s53 offen offset:2048 lds
    v_mfma_f32_16x16x32_bf16 v[36:39], a[132:135], v[132:135], v[36:39]
    ds_read_b64_tr_b16 v[114:115], v19 offset:38144
    v_mfma_f32_16x16x32_bf16 v[40:43], a[212:215], v[132:135], v[40:43]
    ds_read_b128 a[56:59], v17 offset:36864
    v_mfma_f32_16x16x32_bf16 v[44:47], v[188:191], v[132:135], v[44:47]
    ds_read_b128 a[136:139], v17 offset:38912
    v_mfma_f32_16x16x32_bf16 v[48:51], a[52:55], v[136:139], v[48:51]
    ds_read_b128 a[216:219], v17 offset:40960
    buffer_load_dwordx4 v7, s[4:7], s53 offen offset:3072 lds
    v_mfma_f32_16x16x32_bf16 v[52:55], a[132:135], v[136:139], v[52:55]
    ds_read_b128 v[192:195], v17 offset:43008
    v_mfma_f32_16x16x32_bf16 v[56:59], a[212:215], v[136:139], v[56:59]
    ds_read_b64_tr_b16 v[116:117], v20 offset:36896
    s_add_u32 m0, s69, 36864
    v_mfma_f32_16x16x32_bf16 v[60:63], v[188:191], v[136:139], v[60:63]
    ds_read_b64_tr_b16 v[118:119], v20 offset:38176
    v_mfma_f32_16x16x32_bf16 v[64:67], a[52:55], v[140:143], v[64:67]
    ds_read_b64_tr_b16 v[120:121], v19 offset:36928
    buffer_load_dwordx4 v8, s[64:67], s54 offen offset:0 lds
    v_mfma_f32_16x16x32_bf16 v[68:71], a[132:135], v[140:143], v[68:71]
    ds_read_b64_tr_b16 v[122:123], v19 offset:38208
    v_mfma_f32_16x16x32_bf16 v[72:75], a[212:215], v[140:143], v[72:75]
    ds_read_b64_tr_b16 v[124:125], v20 offset:36960
    v_mfma_f32_16x16x32_bf16 v[76:79], v[188:191], v[140:143], v[76:79]
    ds_read_b64_tr_b16 v[126:127], v20 offset:38240
    v_mfma_f32_16x16x32_bf16 v[80:83], a[52:55], v[144:147], v[80:83]
    ds_read_b64_tr_b16 v[128:129], v19 offset:36992
    buffer_load_dwordx4 v9, s[64:67], s54 offen offset:1024 lds
    v_mfma_f32_16x16x32_bf16 v[84:87], a[132:135], v[144:147], v[84:87]
    ds_read_b64_tr_b16 v[130:131], v19 offset:38272
    v_mfma_f32_16x16x32_bf16 v[88:91], a[212:215], v[144:147], v[88:91]
    v_mfma_f32_16x16x32_bf16 v[92:95], v[188:191], v[144:147], v[92:95]
    v_mfma_f32_16x16x32_bf16 v[96:99], a[52:55], v[148:151], v[96:99]
    buffer_load_dwordx4 v10, s[64:67], s54 offen offset:2048 lds
    v_mfma_f32_16x16x32_bf16 v[100:103], a[132:135], v[148:151], v[100:103]
    v_mfma_f32_16x16x32_bf16 v[104:107], a[212:215], v[148:151], v[104:107]
    v_mfma_f32_16x16x32_bf16 v[108:111], v[188:191], v[148:151], v[108:111]
    s_waitcnt lgkmcnt(0)
    v_mfma_f32_16x16x32_bf16 v[32:35], a[56:59], v[112:115], v[32:35]
    ds_read_b64_tr_b16 v[132:133], v19 offset:47104
    buffer_load_dwordx4 v11, s[64:67], s54 offen offset:3072 lds
    v_mfma_f32_16x16x32_bf16 v[36:39], a[136:139], v[112:115], v[36:39]
    ds_read_b64_tr_b16 v[134:135], v19 offset:48384
    v_mfma_f32_16x16x32_bf16 v[40:43], a[216:219], v[112:115], v[40:43]
    ds_read_b128 a[60:63], v18 offset:36864
    s_add_u32 m0, s69, 40960
    v_mfma_f32_16x16x32_bf16 v[44:47], v[192:195], v[112:115], v[44:47]
    ds_read_b128 a[140:143], v18 offset:38912
    v_mfma_f32_16x16x32_bf16 v[48:51], a[56:59], v[116:119], v[48:51]
    ds_read_b128 a[220:223], v18 offset:40960
    buffer_load_dwordx4 v12, s[64:67], s54 offen offset:0 lds
    v_mfma_f32_16x16x32_bf16 v[52:55], a[136:139], v[116:119], v[52:55]
    ds_read_b128 v[196:199], v18 offset:43008
    s_mul_i32 s55, s40, 8192
    v_mfma_f32_16x16x32_bf16 v[56:59], a[216:219], v[116:119], v[56:59]
    ds_read_b64_tr_b16 v[136:137], v20 offset:47136
    s_add_u32 m0, s55, 73728
    v_mfma_f32_16x16x32_bf16 v[60:63], v[192:195], v[116:119], v[60:63]
    ds_read_b64_tr_b16 v[138:139], v20 offset:48416
    s_mul_i32 s56, s40, 64
    v_mfma_f32_16x16x32_bf16 v[64:67], a[56:59], v[120:123], v[64:67]
    ds_read_b64_tr_b16 v[140:141], v19 offset:47168
    s_add_u32 s56, s56, 0
    v_mfma_f32_16x16x32_bf16 v[68:71], a[136:139], v[120:123], v[68:71]
    ds_read_b64_tr_b16 v[142:143], v19 offset:48448
    s_lshr_b32 s57, s56, 6
    v_mfma_f32_16x16x32_bf16 v[72:75], a[216:219], v[120:123], v[72:75]
    ds_read_b64_tr_b16 v[144:145], v20 offset:47200
    s_and_b32 s56, s56, 63
    v_mfma_f32_16x16x32_bf16 v[76:79], v[192:195], v[120:123], v[76:79]
    ds_read_b64_tr_b16 v[146:147], v20 offset:48480
    s_add_u32 s57, s57, s82
    v_mfma_f32_16x16x32_bf16 v[80:83], a[56:59], v[124:127], v[80:83]
    ds_read_b64_tr_b16 v[148:149], v19 offset:47232
    v_mfma_f32_16x16x32_bf16 v[84:87], a[136:139], v[124:127], v[84:87]
    ds_read_b64_tr_b16 v[150:151], v19 offset:48512
    v_mfma_f32_16x16x32_bf16 v[88:91], a[216:219], v[124:127], v[88:91]
    s_cmp_ge_u32 s57, 10
    s_cselect_b32 s58, 10, 0
    v_mfma_f32_16x16x32_bf16 v[92:95], v[192:195], v[124:127], v[92:95]
    s_sub_u32 s57, s57, s58
    s_lshl_b32 s57, s57, 6
    v_mfma_f32_16x16x32_bf16 v[96:99], a[56:59], v[128:131], v[96:99]
    s_add_u32 s56, s56, s57
    s_mul_i32 s56, s56, 3072
    v_mfma_f32_16x16x32_bf16 v[100:103], a[136:139], v[128:131], v[100:103]
    s_lshl_b32 s57, s68, 1
    s_add_u32 s56, s56, s57
    v_mfma_f32_16x16x32_bf16 v[104:107], a[216:219], v[128:131], v[104:107]
    buffer_load_dwordx4 v21, s[16:19], s56 offen offset:0 lds
    buffer_load_dwordx4 v22, s[16:19], s56 offen offset:1024 lds
    v_mfma_f32_16x16x32_bf16 v[108:111], v[192:195], v[128:131], v[108:111]
    buffer_load_dwordx4 v23, s[16:19], s56 offen offset:2048 lds
    s_waitcnt lgkmcnt(0)
    s_waitcnt vmcnt(12)
    s_barrier
    v_mfma_f32_16x16x32_bf16 v[32:35], a[60:63], v[132:135], v[32:35]
    ds_read_b64_tr_b16 v[112:113], v15 offset:0
    buffer_load_dwordx4 v24, s[16:19], s56 offen offset:3072 lds
    v_mfma_f32_16x16x32_bf16 v[36:39], a[140:143], v[132:135], v[36:39]
    ds_read_b64_tr_b16 v[114:115], v15 offset:1280
    s_mul_i32 s55, s40, 8192
    v_mfma_f32_16x16x32_bf16 v[40:43], a[220:223], v[132:135], v[40:43]
    ds_read_b128 a[64:67], v13 offset:0
    s_add_u32 m0, s55, 77824
    v_mfma_f32_16x16x32_bf16 v[44:47], v[196:199], v[132:135], v[44:47]
    ds_read_b128 a[144:147], v13 offset:2048
    s_mul_i32 s56, s40, 64
    v_mfma_f32_16x16x32_bf16 v[48:51], a[60:63], v[136:139], v[48:51]
    ds_read_b128 a[224:227], v13 offset:4096
    s_add_u32 s56, s56, 32
    v_mfma_f32_16x16x32_bf16 v[52:55], a[140:143], v[136:139], v[52:55]
    ds_read_b128 v[200:203], v13 offset:6144
    s_lshr_b32 s57, s56, 6
    v_mfma_f32_16x16x32_bf16 v[56:59], a[220:223], v[136:139], v[56:59]
    ds_read_b64_tr_b16 v[116:117], v16 offset:32
    s_and_b32 s56, s56, 63
    v_mfma_f32_16x16x32_bf16 v[60:63], v[196:199], v[136:139], v[60:63]
    ds_read_b64_tr_b16 v[118:119], v16 offset:1312
    s_add_u32 s57, s57, s82
    v_mfma_f32_16x16x32_bf16 v[64:67], a[60:63], v[140:143], v[64:67]
    ds_read_b64_tr_b16 v[120:121], v15 offset:64
    v_mfma_f32_16x16x32_bf16 v[68:71], a[140:143], v[140:143], v[68:71]
    ds_read_b64_tr_b16 v[122:123], v15 offset:1344
    v_mfma_f32_16x16x32_bf16 v[72:75], a[220:223], v[140:143], v[72:75]
    ds_read_b64_tr_b16 v[124:125], v16 offset:96
    v_mfma_f32_16x16x32_bf16 v[76:79], v[196:199], v[140:143], v[76:79]
    ds_read_b64_tr_b16 v[126:127], v16 offset:1376
    v_mfma_f32_16x16x32_bf16 v[80:83], a[60:63], v[144:147], v[80:83]
    ds_read_b64_tr_b16 v[128:129], v15 offset:128
    v_mfma_f32_16x16x32_bf16 v[84:87], a[140:143], v[144:147], v[84:87]
    ds_read_b64_tr_b16 v[130:131], v15 offset:1408
    v_mfma_f32_16x16x32_bf16 v[88:91], a[220:223], v[144:147], v[88:91]
    s_cmp_ge_u32 s57, 10
    s_cselect_b32 s58, 10, 0
    v_mfma_f32_16x16x32_bf16 v[92:95], v[196:199], v[144:147], v[92:95]
    s_sub_u32 s57, s57, s58
    s_lshl_b32 s57, s57, 6
    v_mfma_f32_16x16x32_bf16 v[96:99], a[60:63], v[148:151], v[96:99]
    s_add_u32 s56, s56, s57
    s_mul_i32 s56, s56, 3072
    v_mfma_f32_16x16x32_bf16 v[100:103], a[140:143], v[148:151], v[100:103]
    s_lshl_b32 s57, s68, 1
    s_add_u32 s56, s56, s57
    v_mfma_f32_16x16x32_bf16 v[104:107], a[220:223], v[148:151], v[104:107]
    buffer_load_dwordx4 v21, s[16:19], s56 offen offset:0 lds
    buffer_load_dwordx4 v22, s[16:19], s56 offen offset:1024 lds
    v_mfma_f32_16x16x32_bf16 v[108:111], v[196:199], v[148:151], v[108:111]
    buffer_load_dwordx4 v23, s[16:19], s56 offen offset:2048 lds
    buffer_load_dwordx4 v24, s[16:19], s56 offen offset:3072 lds
    s_waitcnt lgkmcnt(0)
    v_mfma_f32_16x16x32_bf16 v[32:35], a[64:67], v[112:115], v[32:35]
    ds_read_b64_tr_b16 v[132:133], v15 offset:10240
    s_mul_i32 s55, s40, 8192
    v_mfma_f32_16x16x32_bf16 v[36:39], a[144:147], v[112:115], v[36:39]
    ds_read_b64_tr_b16 v[134:135], v15 offset:11520
    s_add_u32 m0, s55, 110592
    v_mfma_f32_16x16x32_bf16 v[40:43], a[224:227], v[112:115], v[40:43]
    ds_read_b128 a[68:71], v14 offset:0
    s_mul_i32 s56, s40, 64
    v_mfma_f32_16x16x32_bf16 v[44:47], v[200:203], v[112:115], v[44:47]
    ds_read_b128 a[148:151], v14 offset:2048
    s_add_u32 s56, s56, 256
    v_mfma_f32_16x16x32_bf16 v[48:51], a[64:67], v[116:119], v[48:51]
    ds_read_b128 a[228:231], v14 offset:4096
    s_lshr_b32 s57, s56, 6
    v_mfma_f32_16x16x32_bf16 v[52:55], a[144:147], v[116:119], v[52:55]
    ds_read_b128 v[204:207], v14 offset:6144
    s_and_b32 s56, s56, 63
    v_mfma_f32_16x16x32_bf16 v[56:59], a[224:227], v[116:119], v[56:59]
    ds_read_b64_tr_b16 v[136:137], v16 offset:10272
    s_add_u32 s57, s57, s82
    v_mfma_f32_16x16x32_bf16 v[60:63], v[200:203], v[116:119], v[60:63]
    ds_read_b64_tr_b16 v[138:139], v16 offset:11552
    v_mfma_f32_16x16x32_bf16 v[64:67], a[64:67], v[120:123], v[64:67]
    ds_read_b64_tr_b16 v[140:141], v15 offset:10304
    v_mfma_f32_16x16x32_bf16 v[68:71], a[144:147], v[120:123], v[68:71]
    ds_read_b64_tr_b16 v[142:143], v15 offset:11584
    v_mfma_f32_16x16x32_bf16 v[72:75], a[224:227], v[120:123], v[72:75]
    ds_read_b64_tr_b16 v[144:145], v16 offset:10336
    v_mfma_f32_16x16x32_bf16 v[76:79], v[200:203], v[120:123], v[76:79]
    ds_read_b64_tr_b16 v[146:147], v16 offset:11616
    v_mfma_f32_16x16x32_bf16 v[80:83], a[64:67], v[124:127], v[80:83]
    ds_read_b64_tr_b16 v[148:149], v15 offset:10368
    v_mfma_f32_16x16x32_bf16 v[84:87], a[144:147], v[124:127], v[84:87]
    ds_read_b64_tr_b16 v[150:151], v15 offset:11648
    v_mfma_f32_16x16x32_bf16 v[88:91], a[224:227], v[124:127], v[88:91]
    s_cmp_ge_u32 s57, 10
    s_cselect_b32 s58, 10, 0
    v_mfma_f32_16x16x32_bf16 v[92:95], v[200:203], v[124:127], v[92:95]
    s_sub_u32 s57, s57, s58
    s_lshl_b32 s57, s57, 6
    v_mfma_f32_16x16x32_bf16 v[96:99], a[64:67], v[128:131], v[96:99]
    s_add_u32 s56, s56, s57
    s_mul_i32 s56, s56, 3072
    v_mfma_f32_16x16x32_bf16 v[100:103], a[144:147], v[128:131], v[100:103]
    s_lshl_b32 s57, s68, 1
    s_add_u32 s56, s56, s57
    v_mfma_f32_16x16x32_bf16 v[104:107], a[224:227], v[128:131], v[104:107]
    buffer_load_dwordx4 v21, s[16:19], s56 offen offset:0 lds
    buffer_load_dwordx4 v22, s[16:19], s56 offen offset:1024 lds
    v_mfma_f32_16x16x32_bf16 v[108:111], v[200:203], v[128:131], v[108:111]
    buffer_load_dwordx4 v23, s[16:19], s56 offen offset:2048 lds
    buffer_load_dwordx4 v24, s[16:19], s56 offen offset:3072 lds
    s_waitcnt lgkmcnt(0)
    s_waitcnt vmcnt(12)
    s_barrier
    v_mfma_f32_16x16x32_bf16 v[32:35], a[68:71], v[132:135], v[32:35]
    ds_read_b64_tr_b16 v[112:113], v15 offset:36864
    s_mul_i32 s55, s40, 8192
    v_mfma_f32_16x16x32_bf16 v[36:39], a[148:151], v[132:135], v[36:39]
    ds_read_b64_tr_b16 v[114:115], v15 offset:38144
    s_add_u32 m0, s55, 114688
    v_mfma_f32_16x16x32_bf16 v[40:43], a[228:231], v[132:135], v[40:43]
    ds_read_b128 a[72:75], v13 offset:36864
    s_mul_i32 s56, s40, 64
    v_mfma_f32_16x16x32_bf16 v[44:47], v[204:207], v[132:135], v[44:47]
    ds_read_b128 a[152:155], v13 offset:38912
    s_add_u32 s56, s56, 288
    v_mfma_f32_16x16x32_bf16 v[48:51], a[68:71], v[136:139], v[48:51]
    ds_read_b128 a[232:235], v13 offset:40960
    s_lshr_b32 s57, s56, 6
    v_mfma_f32_16x16x32_bf16 v[52:55], a[148:151], v[136:139], v[52:55]
    ds_read_b128 v[208:211], v13 offset:43008
    s_and_b32 s56, s56, 63
    v_mfma_f32_16x16x32_bf16 v[56:59], a[228:231], v[136:139], v[56:59]
    ds_read_b64_tr_b16 v[116:117], v16 offset:36896
    s_add_u32 s57, s57, s82
    v_mfma_f32_16x16x32_bf16 v[60:63], v[204:207], v[136:139], v[60:63]
    ds_read_b64_tr_b16 v[118:119], v16 offset:38176
    v_mfma_f32_16x16x32_bf16 v[64:67], a[68:71], v[140:143], v[64:67]
    ds_read_b64_tr_b16 v[120:121], v15 offset:36928
    v_mfma_f32_16x16x32_bf16 v[68:71], a[148:151], v[140:143], v[68:71]
    ds_read_b64_tr_b16 v[122:123], v15 offset:38208
    v_mfma_f32_16x16x32_bf16 v[72:75], a[228:231], v[140:143], v[72:75]
    ds_read_b64_tr_b16 v[124:125], v16 offset:36960
    v_mfma_f32_16x16x32_bf16 v[76:79], v[204:207], v[140:143], v[76:79]
    ds_read_b64_tr_b16 v[126:127], v16 offset:38240
    v_mfma_f32_16x16x32_bf16 v[80:83], a[68:71], v[144:147], v[80:83]
    ds_read_b64_tr_b16 v[128:129], v15 offset:36992
    v_mfma_f32_16x16x32_bf16 v[84:87], a[148:151], v[144:147], v[84:87]
    ds_read_b64_tr_b16 v[130:131], v15 offset:38272
    v_mfma_f32_16x16x32_bf16 v[88:91], a[228:231], v[144:147], v[88:91]
    s_cmp_ge_u32 s57, 10
    s_cselect_b32 s58, 10, 0
    v_mfma_f32_16x16x32_bf16 v[92:95], v[204:207], v[144:147], v[92:95]
    s_sub_u32 s57, s57, s58
    s_lshl_b32 s57, s57, 6
    v_mfma_f32_16x16x32_bf16 v[96:99], a[68:71], v[148:151], v[96:99]
    s_add_u32 s56, s56, s57
    s_mul_i32 s56, s56, 3072
    v_mfma_f32_16x16x32_bf16 v[100:103], a[148:151], v[148:151], v[100:103]
    s_lshl_b32 s57, s68, 1
    s_add_u32 s56, s56, s57
    v_mfma_f32_16x16x32_bf16 v[104:107], a[228:231], v[148:151], v[104:107]
    buffer_load_dwordx4 v21, s[16:19], s56 offen offset:0 lds
    buffer_load_dwordx4 v22, s[16:19], s56 offen offset:1024 lds
    v_mfma_f32_16x16x32_bf16 v[108:111], v[204:207], v[148:151], v[108:111]
    buffer_load_dwordx4 v23, s[16:19], s56 offen offset:2048 lds
    buffer_load_dwordx4 v24, s[16:19], s56 offen offset:3072 lds
    s_waitcnt lgkmcnt(0)
    v_mfma_f32_16x16x32_bf16 v[32:35], a[72:75], v[112:115], v[32:35]
    ds_read_b64_tr_b16 v[132:133], v15 offset:47104
    s_mul_i32 s55, s40, 4096
    v_mfma_f32_16x16x32_bf16 v[36:39], a[152:155], v[112:115], v[36:39]
    ds_read_b64_tr_b16 v[134:135], v15 offset:48384
    s_add_u32 m0, s55, 0
    v_mfma_f32_16x16x32_bf16 v[40:43], a[232:235], v[112:115], v[40:43]
    ds_read_b128 a[76:79], v14 offset:36864
    s_mul_i32 s56, s40, 32
    v_mfma_f32_16x16x32_bf16 v[44:47], v[208:211], v[112:115], v[44:47]
    ds_read_b128 a[156:159], v14 offset:38912
    s_add_u32 s56, s56, 512
    v_mfma_f32_16x16x32_bf16 v[48:51], a[72:75], v[116:119], v[48:51]
    ds_read_b128 a[236:239], v14 offset:40960
    s_lshr_b32 s57, s56, 6
    v_mfma_f32_16x16x32_bf16 v[52:55], a[152:155], v[116:119], v[52:55]
    ds_read_b128 v[212:215], v14 offset:43008
    s_and_b32 s56, s56, 63
    v_mfma_f32_16x16x32_bf16 v[56:59], a[232:235], v[116:119], v[56:59]
    ds_read_b64_tr_b16 v[136:137], v16 offset:47136
    s_add_u32 s57, s57, s82
    v_mfma_f32_16x16x32_bf16 v[60:63], v[208:211], v[116:119], v[60:63]
    ds_read_b64_tr_b16 v[138:139], v16 offset:48416
    v_mfma_f32_16x16x32_bf16 v[64:67], a[72:75], v[120:123], v[64:67]
    ds_read_b64_tr_b16 v[140:141], v15 offset:47168
    v_mfma_f32_16x16x32_bf16 v[68:71], a[152:155], v[120:123], v[68:71]
    ds_read_b64_tr_b16 v[142:143], v15 offset:48448
    v_mfma_f32_16x16x32_bf16 v[72:75], a[232:235], v[120:123], v[72:75]
    ds_read_b64_tr_b16 v[144:145], v16 offset:47200
    v_mfma_f32_16x16x32_bf16 v[76:79], v[208:211], v[120:123], v[76:79]
    ds_read_b64_tr_b16 v[146:147], v16 offset:48480
    v_mfma_f32_16x16x32_bf16 v[80:83], a[72:75], v[124:127], v[80:83]
    ds_read_b64_tr_b16 v[148:149], v15 offset:47232
    v_mfma_f32_16x16x32_bf16 v[84:87], a[152:155], v[124:127], v[84:87]
    ds_read_b64_tr_b16 v[150:151], v15 offset:48512
    v_mfma_f32_16x16x32_bf16 v[88:91], a[232:235], v[124:127], v[88:91]
    s_cmp_ge_u32 s57, 10
    s_cselect_b32 s58, 10, 0
    v_mfma_f32_16x16x32_bf16 v[92:95], v[208:211], v[124:127], v[92:95]
    s_sub_u32 s57, s57, s58
    s_lshl_b32 s57, s57, 6
    v_mfma_f32_16x16x32_bf16 v[96:99], a[72:75], v[128:131], v[96:99]
    s_add_u32 s56, s56, s57
    s_mul_i32 s56, s56, 3072
    v_mfma_f32_16x16x32_bf16 v[100:103], a[152:155], v[128:131], v[100:103]
    s_lshl_b32 s57, s68, 1
    s_add_u32 s56, s56, s57
    v_mfma_f32_16x16x32_bf16 v[104:107], a[232:235], v[128:131], v[104:107]
    buffer_load_dwordx4 v21, s[16:19], s56 offen offset:0 lds
    buffer_load_dwordx4 v22, s[16:19], s56 offen offset:1024 lds
    v_mfma_f32_16x16x32_bf16 v[108:111], v[208:211], v[128:131], v[108:111]
    buffer_load_dwordx4 v23, s[16:19], s56 offen offset:2048 lds
    buffer_load_dwordx4 v24, s[16:19], s56 offen offset:3072 lds
    s_waitcnt lgkmcnt(0)
    v_mfma_f32_16x16x32_bf16 v[32:35], a[76:79], v[132:135], v[32:35]
    v_mfma_f32_16x16x32_bf16 v[36:39], a[156:159], v[132:135], v[36:39]
    v_mfma_f32_16x16x32_bf16 v[40:43], a[236:239], v[132:135], v[40:43]
    v_mfma_f32_16x16x32_bf16 v[44:47], v[212:215], v[132:135], v[44:47]
    v_mfma_f32_16x16x32_bf16 v[48:51], a[76:79], v[136:139], v[48:51]
    v_mfma_f32_16x16x32_bf16 v[52:55], a[156:159], v[136:139], v[52:55]
    v_mfma_f32_16x16x32_bf16 v[56:59], a[236:239], v[136:139], v[56:59]
    v_mfma_f32_16x16x32_bf16 v[60:63], v[212:215], v[136:139], v[60:63]
    v_mfma_f32_16x16x32_bf16 v[64:67], a[76:79], v[140:143], v[64:67]
    v_mfma_f32_16x16x32_bf16 v[68:71], a[156:159], v[140:143], v[68:71]
    v_mfma_f32_16x16x32_bf16 v[72:75], a[236:239], v[140:143], v[72:75]
    v_mfma_f32_16x16x32_bf16 v[76:79], v[212:215], v[140:143], v[76:79]
    v_mfma_f32_16x16x32_bf16 v[80:83], a[76:79], v[144:147], v[80:83]
    v_mfma_f32_16x16x32_bf16 v[84:87], a[156:159], v[144:147], v[84:87]
    v_mfma_f32_16x16x32_bf16 v[88:91], a[236:239], v[144:147], v[88:91]
    v_mfma_f32_16x16x32_bf16 v[92:95], v[212:215], v[144:147], v[92:95]
    v_mfma_f32_16x16x32_bf16 v[96:99], a[76:79], v[148:151], v[96:99]
    v_mfma_f32_16x16x32_bf16 v[100:103], a[156:159], v[148:151], v[100:103]
    v_mfma_f32_16x16x32_bf16 v[104:107], a[236:239], v[148:151], v[104:107]
    v_mfma_f32_16x16x32_bf16 v[108:111], v[212:215], v[148:151], v[108:111]
    s_nop 7
    v_mov_b32 v136, 0x3f803f80
    v_mov_b32 v137, 0x3f803f80
    v_mov_b32 v138, 0x3f803f80
    v_mov_b32 v139, 0x3f803f80
    s_waitcnt vmcnt(0)
    s_barrier
    v_add_u32 v27, 73728, v25
    v_add_u32 v28, 73728, v26
    ds_read_b64_tr_b16 v[112:113], v27 offset:0
    ds_read_b64_tr_b16 v[114:115], v27 offset:512
    ds_read_b64_tr_b16 v[116:117], v28 offset:0
    ds_read_b64_tr_b16 v[118:119], v28 offset:512
    ds_read_b64_tr_b16 v[120:121], v27 offset:4096
    ds_read_b64_tr_b16 v[122:123], v27 offset:4608
    ds_read_b64_tr_b16 v[124:125], v28 offset:4096
    ds_read_b64_tr_b16 v[126:127], v28 offset:4608
    s_waitcnt lgkmcnt(4)
    v_mfma_f32_16x16x32_bf16 v[216:219], v[112:115], a[0:3], 0
    ds_read_b64_tr_b16 v[128:129], v27 offset:8192
    v_mfma_f32_16x16x32_bf16 v[220:223], v[112:115], a[80:83], 0
    ds_read_b64_tr_b16 v[130:131], v27 offset:8704
    s_sub_u32 s55, s47, 8
    v_mfma_f32_16x16x32_bf16 v[224:227], v[112:115], a[160:163], 0
    ds_read_b64_tr_b16 v[132:133], v28 offset:8192
    s_lshl_b32 s55, s55, 3
    v_mfma_f32_16x16x32_bf16 v[228:231], v[112:115], a[240:243], 0
    ds_read_b64_tr_b16 v[134:135], v28 offset:8704
    s_mul_i32 s55, s55, 81920
    v_mfma_f32_16x16x32_bf16 v[248:251], v[112:115], v[136:139], 0
    s_lshl_b32 s56, s46, 2
    v_mfma_f32_16x16x32_bf16 v[232:235], v[116:119], a[0:3], 0
    s_lshl_b32 s57, s48, 1
    v_mfma_f32_16x16x32_bf16 v[236:239], v[116:119], a[80:83], 0
    s_add_u32 s56, s56, s57
    v_mfma_f32_16x16x32_bf16 v[240:243], v[116:119], a[160:163], 0
    s_mul_i32 s56, s56, 1280
    v_mfma_f32_16x16x32_bf16 v[244:247], v[116:119], a[240:243], 0
    s_add_u32 s55, s55, s56
    v_mfma_f32_16x16x32_bf16 v[252:255], v[116:119], v[136:139], 0
    s_add_u32 s72, s55, 7340032
    s_waitcnt lgkmcnt(4)
    v_mfma_f32_16x16x32_bf16 v[216:219], v[120:123], a[4:7], v[216:219]
    ds_read_b64_tr_b16 v[112:113], v27 offset:12288
    v_lshrrev_b32 v13, 1, v3
    v_mfma_f32_16x16x32_bf16 v[220:223], v[120:123], a[84:87], v[220:223]
    ds_read_b64_tr_b16 v[114:115], v27 offset:12800
    v_mul_u32_u24 v13, 640, v13
    v_mfma_f32_16x16x32_bf16 v[224:227], v[120:123], a[164:167], v[224:227]
    ds_read_b64_tr_b16 v[116:117], v28 offset:12288
    v_and_b32 v14, 1, v3
    v_mfma_f32_16x16x32_bf16 v[228:231], v[120:123], a[244:247], v[228:231]
    ds_read_b64_tr_b16 v[118:119], v28 offset:12800
    v_mul_u32_u24 v14, 320, v14
    v_mfma_f32_16x16x32_bf16 v[248:251], v[120:123], v[136:139], v[248:251]
    v_add_u32 v13, v13, v14
    v_mfma_f32_16x16x32_bf16 v[232:235], v[124:127], a[4:7], v[232:235]
    s_mul_i32 s57, s49, 80
    v_mfma_f32_16x16x32_bf16 v[236:239], v[124:127], a[84:87], v[236:239]
    s_mov_b32 s58, 81920
    v_mfma_f32_16x16x32_bf16 v[240:243], v[124:127], a[164:167], v[240:243]
    v_add_u32 v15, s57, v2
    v_mfma_f32_16x16x32_bf16 v[244:247], v[124:127], a[244:247], v[244:247]
    v_mul_u32_u24 v16, 3277, v15
    v_mfma_f32_16x16x32_bf16 v[252:255], v[124:127], v[136:139], v[252:255]
    v_lshrrev_b32 v16, 16, v16
    s_waitcnt lgkmcnt(4)
    v_mfma_f32_16x16x32_bf16 v[216:219], v[128:131], a[8:11], v[216:219]
    ds_read_b64_tr_b16 v[120:121], v27 offset:16384
    v_mul_u32_u24 v17, 20, v16
    v_mfma_f32_16x16x32_bf16 v[220:223], v[128:131], a[88:91], v[220:223]
    ds_read_b64_tr_b16 v[122:123], v27 offset:16896
    v_sub_u32 v15, v15, v17
    v_mfma_f32_16x16x32_bf16 v[224:227], v[128:131], a[168:171], v[224:227]
    ds_read_b64_tr_b16 v[124:125], v28 offset:16384
    v_lshlrev_b32 v15, 4, v15
    v_mfma_f32_16x16x32_bf16 v[228:231], v[128:131], a[248:251], v[228:231]
    ds_read_b64_tr_b16 v[126:127], v28 offset:16896
    v_mul_lo_u32 v16, v16, s58
    v_mfma_f32_16x16x32_bf16 v[248:251], v[128:131], v[136:139], v[248:251]
    v_add3_u32 v4, v15, v16, v13
    v_mfma_f32_16x16x32_bf16 v[232:235], v[132:135], a[8:11], v[232:235]
    v_add_u32 v15, s57, v2
    v_mfma_f32_16x16x32_bf16 v[236:239], v[132:135], a[88:91], v[236:239]
    v_add_u32 v15, 16, v15
    v_mfma_f32_16x16x32_bf16 v[240:243], v[132:135], a[168:171], v[240:243]
    v_mul_u32_u24 v16, 3277, v15
    v_mfma_f32_16x16x32_bf16 v[244:247], v[132:135], a[248:251], v[244:247]
    v_lshrrev_b32 v16, 16, v16
    v_mfma_f32_16x16x32_bf16 v[252:255], v[132:135], v[136:139], v[252:255]
    v_mul_u32_u24 v17, 20, v16
    s_waitcnt lgkmcnt(4)
    v_mfma_f32_16x16x32_bf16 v[216:219], v[112:115], a[12:15], v[216:219]
    ds_read_b64_tr_b16 v[128:129], v27 offset:20480
    v_sub_u32 v15, v15, v17
    v_mfma_f32_16x16x32_bf16 v[220:223], v[112:115], a[92:95], v[220:223]
    ds_read_b64_tr_b16 v[130:131], v27 offset:20992
    v_lshlrev_b32 v15, 4, v15
    v_mfma_f32_16x16x32_bf16 v[224:227], v[112:115], a[172:175], v[224:227]
    ds_read_b64_tr_b16 v[132:133], v28 offset:20480
    v_mfma_f32_16x16x32_bf16 v[228:231], v[112:115], a[252:255], v[228:231]
    ds_read_b64_tr_b16 v[134:135], v28 offset:20992
    v_mul_lo_u32 v16, v16, s58
    v_mfma_f32_16x16x32_bf16 v[248:251], v[112:115], v[136:139], v[248:251]
    v_add3_u32 v5, v15, v16, v13
    v_mfma_f32_16x16x32_bf16 v[232:235], v[116:119], a[12:15], v[232:235]
    v_add_u32 v15, s57, v2
    v_mfma_f32_16x16x32_bf16 v[236:239], v[116:119], a[92:95], v[236:239]
    v_add_u32 v15, 32, v15
    v_mfma_f32_16x16x32_bf16 v[240:243], v[116:119], a[172:175], v[240:243]
    v_mul_u32_u24 v16, 3277, v15
    v_mfma_f32_16x16x32_bf16 v[244:247], v[116:119], a[252:255], v[244:247]
    v_lshrrev_b32 v16, 16, v16
    v_mfma_f32_16x16x32_bf16 v[252:255], v[116:119], v[136:139], v[252:255]
    v_mul_u32_u24 v17, 20, v16
    s_waitcnt lgkmcnt(4)
    v_mfma_f32_16x16x32_bf16 v[216:219], v[120:123], a[16:19], v[216:219]
    ds_read_b64_tr_b16 v[112:113], v27 offset:24576
    v_sub_u32 v15, v15, v17
    v_mfma_f32_16x16x32_bf16 v[220:223], v[120:123], a[96:99], v[220:223]
    ds_read_b64_tr_b16 v[114:115], v27 offset:25088
    v_lshlrev_b32 v15, 4, v15
    v_mfma_f32_16x16x32_bf16 v[224:227], v[120:123], a[176:179], v[224:227]
    ds_read_b64_tr_b16 v[116:117], v28 offset:24576
    v_mul_lo_u32 v16, v16, s58
    v_mfma_f32_16x16x32_bf16 v[228:231], v[120:123], v[152:155], v[228:231]
    ds_read_b64_tr_b16 v[118:119], v28 offset:25088
    v_add3_u32 v6, v15, v16, v13
    v_mfma_f32_16x16x32_bf16 v[248:251], v[120:123], v[136:139], v[248:251]
    v_add_u32 v15, s57, v2
    v_mfma_f32_16x16x32_bf16 v[232:235], v[124:127], a[16:19], v[232:235]
    v_add_u32 v15, 48, v15
    v_mfma_f32_16x16x32_bf16 v[236:239], v[124:127], a[96:99], v[236:239]
    v_mul_u32_u24 v16, 3277, v15
    v_mfma_f32_16x16x32_bf16 v[240:243], v[124:127], a[176:179], v[240:243]
    v_lshrrev_b32 v16, 16, v16
    v_mfma_f32_16x16x32_bf16 v[244:247], v[124:127], v[152:155], v[244:247]
    v_mul_u32_u24 v17, 20, v16
    v_mfma_f32_16x16x32_bf16 v[252:255], v[124:127], v[136:139], v[252:255]
    v_sub_u32 v15, v15, v17
    s_waitcnt lgkmcnt(4)
    v_mfma_f32_16x16x32_bf16 v[216:219], v[128:131], a[20:23], v[216:219]
    ds_read_b64_tr_b16 v[120:121], v27 offset:28672
    v_lshlrev_b32 v15, 4, v15
    v_mfma_f32_16x16x32_bf16 v[220:223], v[128:131], a[100:103], v[220:223]
    ds_read_b64_tr_b16 v[122:123], v27 offset:29184
    v_mul_lo_u32 v16, v16, s58
    v_mfma_f32_16x16x32_bf16 v[224:227], v[128:131], a[180:183], v[224:227]
    ds_read_b64_tr_b16 v[124:125], v28 offset:28672
    v_add3_u32 v7, v15, v16, v13
    v_mfma_f32_16x16x32_bf16 v[228:231], v[128:131], v[156:159], v[228:231]
    ds_read_b64_tr_b16 v[126:127], v28 offset:29184
    v_add_u32 v15, s57, v2
    v_mfma_f32_16x16x32_bf16 v[248:251], v[128:131], v[136:139], v[248:251]
    v_add_u32 v15, 64, v15
    v_mfma_f32_16x16x32_bf16 v[232:235], v[132:135], a[20:23], v[232:235]
    v_mul_u32_u24 v16, 3277, v15
    v_mfma_f32_16x16x32_bf16 v[236:239], v[132:135], a[100:103], v[236:239]
    v_lshrrev_b32 v16, 16, v16
    v_mfma_f32_16x16x32_bf16 v[240:243], v[132:135], a[180:183], v[240:243]
    v_mul_u32_u24 v17, 20, v16
    v_mfma_f32_16x16x32_bf16 v[244:247], v[132:135], v[156:159], v[244:247]
    s_lshl_b32 s88, s46, 11
    s_add_u32 s88, s88, 163840
    v_and_b32 v24, 15, v0
    v_lshlrev_b32 v24, 7, v24
    v_add_u32 v24, s88, v24
    s_mov_b32 exec_lo, 0xffff
    s_mov_b32 exec_hi, 0x0
    buffer_load_dwordx2 v[22:23], v24, s[24:27], 0 offen sc1
    s_mov_b64 exec, -1
    v_mfma_f32_16x16x32_bf16 v[252:255], v[132:135], v[136:139], v[252:255]
    v_sub_u32 v15, v15, v17
    s_waitcnt lgkmcnt(4)
    v_mfma_f32_16x16x32_bf16 v[216:219], v[112:115], a[24:27], v[216:219]
    v_add_u32 v27, 110592, v25
    v_lshlrev_b32 v15, 4, v15
    v_mfma_f32_16x16x32_bf16 v[220:223], v[112:115], a[104:107], v[220:223]
    v_add_u32 v28, 110592, v26
    v_mul_lo_u32 v16, v16, s58
    v_mfma_f32_16x16x32_bf16 v[224:227], v[112:115], a[184:187], v[224:227]
    ds_read_b64_tr_b16 v[128:129], v27 offset:0
    v_add3_u32 v8, v15, v16, v13
    v_mfma_f32_16x16x32_bf16 v[228:231], v[112:115], v[160:163], v[228:231]
    ds_read_b64_tr_b16 v[130:131], v27 offset:512
    v_cvt_pk_bf16_f32 v140, v32, v33
    v_mfma_f32_16x16x32_bf16 v[248:251], v[112:115], v[136:139], v[248:251]
    ds_read_b64_tr_b16 v[132:133], v28 offset:0
    ds_read_b64_tr_b16 v[134:135], v28 offset:512
    v_mfma_f32_16x16x32_bf16 v[232:235], v[116:119], a[24:27], v[232:235]
    v_cvt_pk_bf16_f32 v141, v34, v35
    v_mfma_f32_16x16x32_bf16 v[236:239], v[116:119], a[104:107], v[236:239]
    v_cvt_pk_bf16_f32 v142, v36, v37
    v_mfma_f32_16x16x32_bf16 v[240:243], v[116:119], a[184:187], v[240:243]
    v_cvt_pk_bf16_f32 v143, v38, v39
    v_mfma_f32_16x16x32_bf16 v[244:247], v[116:119], v[160:163], v[244:247]
    s_nop 1
    v_mfma_f32_16x16x32_bf16 v[252:255], v[116:119], v[136:139], v[252:255]
    v_permlane32_swap_b32 v140, v142
    s_waitcnt lgkmcnt(4)
    v_mfma_f32_16x16x32_bf16 v[216:219], v[120:123], a[28:31], v[216:219]
    ds_read_b64_tr_b16 v[112:113], v27 offset:4096
    v_permlane32_swap_b32 v141, v143
    v_mfma_f32_16x16x32_bf16 v[220:223], v[120:123], a[108:111], v[220:223]
    ds_read_b64_tr_b16 v[114:115], v27 offset:4608
    buffer_store_dwordx4 v[140:143], v4, s[24:27], s72 offen offset:0 sc1
    v_mfma_f32_16x16x32_bf16 v[224:227], v[120:123], a[188:191], v[224:227]
    ds_read_b64_tr_b16 v[116:117], v28 offset:4096
    v_cvt_pk_bf16_f32 v144, v40, v41
    v_mfma_f32_16x16x32_bf16 v[228:231], v[120:123], v[164:167], v[228:231]
    ds_read_b64_tr_b16 v[118:119], v28 offset:4608
    v_cvt_pk_bf16_f32 v145, v42, v43
    v_mfma_f32_16x16x32_bf16 v[248:251], v[120:123], v[136:139], v[248:251]
    v_cvt_pk_bf16_f32 v146, v44, v45
    v_mfma_f32_16x16x32_bf16 v[232:235], v[124:127], a[28:31], v[232:235]
    v_cvt_pk_bf16_f32 v147, v46, v47
    v_mfma_f32_16x16x32_bf16 v[236:239], v[124:127], a[108:111], v[236:239]
    s_nop 1
    v_mfma_f32_16x16x32_bf16 v[240:243], v[124:127], a[188:191], v[240:243]
    v_permlane32_swap_b32 v144, v146
    v_mfma_f32_16x16x32_bf16 v[244:247], v[124:127], v[164:167], v[244:247]
    v_permlane32_swap_b32 v145, v147
    v_mfma_f32_16x16x32_bf16 v[252:255], v[124:127], v[136:139], v[252:255]
    buffer_store_dwordx4 v[144:147], v4, s[24:27], s72 offen offset:1280 sc1
    s_waitcnt lgkmcnt(4)
    v_mfma_f32_16x16x32_bf16 v[216:219], v[128:131], a[32:35], v[216:219]
    ds_read_b64_tr_b16 v[120:121], v27 offset:8192
    v_cvt_pk_bf16_f32 v148, v48, v49
    v_mfma_f32_16x16x32_bf16 v[220:223], v[128:131], a[112:115], v[220:223]
    ds_read_b64_tr_b16 v[122:123], v27 offset:8704
    v_cvt_pk_bf16_f32 v149, v50, v51
    v_mfma_f32_16x16x32_bf16 v[224:227], v[128:131], a[192:195], v[224:227]
    ds_read_b64_tr_b16 v[124:125], v28 offset:8192
    v_cvt_pk_bf16_f32 v150, v52, v53
    v_mfma_f32_16x16x32_bf16 v[228:231], v[128:131], v[168:171], v[228:231]
    ds_read_b64_tr_b16 v[126:127], v28 offset:8704
    v_cvt_pk_bf16_f32 v151, v54, v55
    v_mfma_f32_16x16x32_bf16 v[248:251], v[128:131], v[136:139], v[248:251]
    s_nop 1
    v_mfma_f32_16x16x32_bf16 v[232:235], v[132:135], a[32:35], v[232:235]
    v_permlane32_swap_b32 v148, v150
    v_mfma_f32_16x16x32_bf16 v[236:239], v[132:135], a[112:115], v[236:239]
    v_permlane32_swap_b32 v149, v151
    v_mfma_f32_16x16x32_bf16 v[240:243], v[132:135], a[192:195], v[240:243]
    buffer_store_dwordx4 v[148:151], v5, s[24:27], s72 offen offset:0 sc1
    v_mfma_f32_16x16x32_bf16 v[244:247], v[132:135], v[168:171], v[244:247]
    v_cvt_pk_bf16_f32 v140, v56, v57
    v_mfma_f32_16x16x32_bf16 v[252:255], v[132:135], v[136:139], v[252:255]
    v_cvt_pk_bf16_f32 v141, v58, v59
    s_waitcnt lgkmcnt(4)
    v_mfma_f32_16x16x32_bf16 v[216:219], v[112:115], a[36:39], v[216:219]
    ds_read_b64_tr_b16 v[128:129], v27 offset:12288
    v_cvt_pk_bf16_f32 v142, v60, v61
    v_mfma_f32_16x16x32_bf16 v[220:223], v[112:115], a[116:119], v[220:223]
    ds_read_b64_tr_b16 v[130:131], v27 offset:12800
    v_cvt_pk_bf16_f32 v143, v62, v63
    v_mfma_f32_16x16x32_bf16 v[224:227], v[112:115], a[196:199], v[224:227]
    ds_read_b64_tr_b16 v[132:133], v28 offset:12288
    s_nop 1
    v_mfma_f32_16x16x32_bf16 v[228:231], v[112:115], v[172:175], v[228:231]
    ds_read_b64_tr_b16 v[134:135], v28 offset:12800
    v_permlane32_swap_b32 v140, v142
    v_mfma_f32_16x16x32_bf16 v[248:251], v[112:115], v[136:139], v[248:251]
    v_permlane32_swap_b32 v141, v143
    v_mfma_f32_16x16x32_bf16 v[232:235], v[116:119], a[36:39], v[232:235]
    buffer_store_dwordx4 v[140:143], v5, s[24:27], s72 offen offset:1280 sc1
    v_mfma_f32_16x16x32_bf16 v[236:239], v[116:119], a[116:119], v[236:239]
    v_mfma_f32_16x16x32_bf16 v[240:243], v[116:119], a[196:199], v[240:243]
    v_cvt_pk_bf16_f32 v144, v64, v65
    v_mfma_f32_16x16x32_bf16 v[244:247], v[116:119], v[172:175], v[244:247]
    v_cvt_pk_bf16_f32 v145, v66, v67
    v_mfma_f32_16x16x32_bf16 v[252:255], v[116:119], v[136:139], v[252:255]
    v_cvt_pk_bf16_f32 v146, v68, v69
    s_waitcnt lgkmcnt(4)
    v_mfma_f32_16x16x32_bf16 v[216:219], v[120:123], a[40:43], v[216:219]
    ds_read_b64_tr_b16 v[112:113], v27 offset:16384
    v_cvt_pk_bf16_f32 v147, v70, v71
    v_mfma_f32_16x16x32_bf16 v[220:223], v[120:123], a[120:123], v[220:223]
    ds_read_b64_tr_b16 v[114:115], v27 offset:16896
    s_nop 1
    v_mfma_f32_16x16x32_bf16 v[224:227], v[120:123], a[200:203], v[224:227]
    ds_read_b64_tr_b16 v[116:117], v28 offset:16384
    v_permlane32_swap_b32 v144, v146
    v_mfma_f32_16x16x32_bf16 v[228:231], v[120:123], v[176:179], v[228:231]
    ds_read_b64_tr_b16 v[118:119], v28 offset:16896
    v_permlane32_swap_b32 v145, v147
    v_mfma_f32_16x16x32_bf16 v[248:251], v[120:123], v[136:139], v[248:251]
    buffer_store_dwordx4 v[144:147], v6, s[24:27], s72 offen offset:0 sc1
    v_mfma_f32_16x16x32_bf16 v[232:235], v[124:127], a[40:43], v[232:235]
    v_cvt_pk_bf16_f32 v148, v72, v73
    v_mfma_f32_16x16x32_bf16 v[236:239], v[124:127], a[120:123], v[236:239]
    v_cvt_pk_bf16_f32 v149, v74, v75
    v_mfma_f32_16x16x32_bf16 v[240:243], v[124:127], a[200:203], v[240:243]
    v_cvt_pk_bf16_f32 v150, v76, v77
    v_mfma_f32_16x16x32_bf16 v[244:247], v[124:127], v[176:179], v[244:247]
    v_cvt_pk_bf16_f32 v151, v78, v79
    v_mfma_f32_16x16x32_bf16 v[252:255], v[124:127], v[136:139], v[252:255]
    s_nop 1
    s_waitcnt lgkmcnt(4)
    v_mfma_f32_16x16x32_bf16 v[216:219], v[128:131], a[44:47], v[216:219]
    ds_read_b64_tr_b16 v[120:121], v27 offset:20480
    v_permlane32_swap_b32 v148, v150
    v_mfma_f32_16x16x32_bf16 v[220:223], v[128:131], a[124:127], v[220:223]
    ds_read_b64_tr_b16 v[122:123], v27 offset:20992
    v_permlane32_swap_b32 v149, v151
    v_mfma_f32_16x16x32_bf16 v[224:227], v[128:131], a[204:207], v[224:227]
    ds_read_b64_tr_b16 v[124:125], v28 offset:20480
    buffer_store_dwordx4 v[148:151], v6, s[24:27], s72 offen offset:1280 sc1
    v_mfma_f32_16x16x32_bf16 v[228:231], v[128:131], v[180:183], v[228:231]
    ds_read_b64_tr_b16 v[126:127], v28 offset:20992
    v_cvt_pk_bf16_f32 v140, v80, v81
    v_mfma_f32_16x16x32_bf16 v[248:251], v[128:131], v[136:139], v[248:251]
    v_cvt_pk_bf16_f32 v141, v82, v83
    v_mfma_f32_16x16x32_bf16 v[232:235], v[132:135], a[44:47], v[232:235]
    v_cvt_pk_bf16_f32 v142, v84, v85
    v_mfma_f32_16x16x32_bf16 v[236:239], v[132:135], a[124:127], v[236:239]
    v_cvt_pk_bf16_f32 v143, v86, v87
    v_mfma_f32_16x16x32_bf16 v[240:243], v[132:135], a[204:207], v[240:243]
    s_nop 1
    v_mfma_f32_16x16x32_bf16 v[244:247], v[132:135], v[180:183], v[244:247]
    v_permlane32_swap_b32 v140, v142
    v_mfma_f32_16x16x32_bf16 v[252:255], v[132:135], v[136:139], v[252:255]
    v_permlane32_swap_b32 v141, v143
    s_waitcnt lgkmcnt(4)
    v_mfma_f32_16x16x32_bf16 v[216:219], v[112:115], a[48:51], v[216:219]
    ds_read_b64_tr_b16 v[128:129], v27 offset:24576
    buffer_store_dwordx4 v[140:143], v7, s[24:27], s72 offen offset:0 sc1
    v_mfma_f32_16x16x32_bf16 v[220:223], v[112:115], a[128:131], v[220:223]
    ds_read_b64_tr_b16 v[130:131], v27 offset:25088
    v_cvt_pk_bf16_f32 v144, v88, v89
    v_mfma_f32_16x16x32_bf16 v[224:227], v[112:115], a[208:211], v[224:227]
    ds_read_b64_tr_b16 v[132:133], v28 offset:24576
    v_cvt_pk_bf16_f32 v145, v90, v91
    v_mfma_f32_16x16x32_bf16 v[228:231], v[112:115], v[184:187], v[228:231]
    ds_read_b64_tr_b16 v[134:135], v28 offset:25088
    v_cvt_pk_bf16_f32 v146, v92, v93
    v_mfma_f32_16x16x32_bf16 v[248:251], v[112:115], v[136:139], v[248:251]
    v_cvt_pk_bf16_f32 v147, v94, v95
    v_mfma_f32_16x16x32_bf16 v[232:235], v[116:119], a[48:51], v[232:235]
    s_nop 1
    v_mfma_f32_16x16x32_bf16 v[236:239], v[116:119], a[128:131], v[236:239]
    v_permlane32_swap_b32 v144, v146
    v_mfma_f32_16x16x32_bf16 v[240:243], v[116:119], a[208:211], v[240:243]
    v_permlane32_swap_b32 v145, v147
    v_mfma_f32_16x16x32_bf16 v[244:247], v[116:119], v[184:187], v[244:247]
    v_mfma_f32_16x16x32_bf16 v[252:255], v[116:119], v[136:139], v[252:255]
    buffer_store_dwordx4 v[144:147], v7, s[24:27], s72 offen offset:1280 sc1
    s_waitcnt lgkmcnt(4)
    v_mfma_f32_16x16x32_bf16 v[216:219], v[120:123], a[52:55], v[216:219]
    ds_read_b64_tr_b16 v[112:113], v27 offset:28672
    v_cvt_pk_bf16_f32 v148, v96, v97
    v_mfma_f32_16x16x32_bf16 v[220:223], v[120:123], a[132:135], v[220:223]
    ds_read_b64_tr_b16 v[114:115], v27 offset:29184
    v_cvt_pk_bf16_f32 v149, v98, v99
    v_mfma_f32_16x16x32_bf16 v[224:227], v[120:123], a[212:215], v[224:227]
    ds_read_b64_tr_b16 v[116:117], v28 offset:28672
    v_cvt_pk_bf16_f32 v150, v100, v101
    v_mfma_f32_16x16x32_bf16 v[228:231], v[120:123], v[188:191], v[228:231]
    ds_read_b64_tr_b16 v[118:119], v28 offset:29184
    v_cvt_pk_bf16_f32 v151, v102, v103
    v_mfma_f32_16x16x32_bf16 v[248:251], v[120:123], v[136:139], v[248:251]
    s_nop 1
    v_mfma_f32_16x16x32_bf16 v[232:235], v[124:127], a[52:55], v[232:235]
    v_permlane32_swap_b32 v148, v150
    v_mfma_f32_16x16x32_bf16 v[236:239], v[124:127], a[132:135], v[236:239]
    v_permlane32_swap_b32 v149, v151
    v_mfma_f32_16x16x32_bf16 v[240:243], v[124:127], a[212:215], v[240:243]
    buffer_store_dwordx4 v[148:151], v8, s[24:27], s72 offen offset:0 sc1
    v_mfma_f32_16x16x32_bf16 v[244:247], v[124:127], v[188:191], v[244:247]
    v_cvt_pk_bf16_f32 v140, v104, v105
    v_mfma_f32_16x16x32_bf16 v[252:255], v[124:127], v[136:139], v[252:255]
    v_cvt_pk_bf16_f32 v141, v106, v107
    s_waitcnt lgkmcnt(4)
    v_mfma_f32_16x16x32_bf16 v[216:219], v[128:131], a[56:59], v[216:219]
    v_add_u32 v27, 0, v25
    v_cvt_pk_bf16_f32 v142, v108, v109
    v_mfma_f32_16x16x32_bf16 v[220:223], v[128:131], a[136:139], v[220:223]
    v_add_u32 v28, 0, v26
    v_cvt_pk_bf16_f32 v143, v110, v111
    v_mfma_f32_16x16x32_bf16 v[224:227], v[128:131], a[216:219], v[224:227]
    ds_read_b64_tr_b16 v[120:121], v27 offset:0
    s_nop 1
    v_mfma_f32_16x16x32_bf16 v[228:231], v[128:131], v[192:195], v[228:231]
    ds_read_b64_tr_b16 v[122:123], v27 offset:512
    v_permlane32_swap_b32 v140, v142
    v_mfma_f32_16x16x32_bf16 v[248:251], v[128:131], v[136:139], v[248:251]
    ds_read_b64_tr_b16 v[124:125], v28 offset:0
    v_permlane32_swap_b32 v141, v143
    v_mfma_f32_16x16x32_bf16 v[232:235], v[132:135], a[56:59], v[232:235]
    ds_read_b64_tr_b16 v[126:127], v28 offset:512
    buffer_store_dwordx4 v[140:143], v8, s[24:27], s72 offen offset:1280 sc1
    v_mfma_f32_16x16x32_bf16 v[236:239], v[132:135], a[136:139], v[236:239]
    s_waitcnt vmcnt(10)
    s_mov_b32 exec_lo, 0xffff
    s_mov_b32 exec_hi, 0x0
    v_xor_b32 v22, s2, v22
    v_xor_b32 v23, s3, v23
    v_or_b32 v22, v22, v23
    v_cmp_ne_u32 vcc, 0, v22
    s_mov_b64 exec, -1
    s_cmp_eq_u64 vcc, 0
    s_cbranch_scc1 L_pollok_22
    s_mov_b32 exec_lo, 0xffff
    s_mov_b32 exec_hi, 0x0
    s_mov_b32 s84, 1048576
L_poll_23:
    buffer_load_dwordx2 v[22:23], v24, s[24:27], 0 offen sc1
    s_waitcnt vmcnt(0)
    v_xor_b32 v22, s2, v22
    v_xor_b32 v23, s3, v23
    v_or_b32 v22, v22, v23
    v_cmp_ne_u32 vcc, 0, v22
    s_cmp_eq_u64 vcc, 0
    s_cbranch_scc1 L_polled_24
    s_sub_u32 s84, s84, 1
    s_cmp_eq_u32 s84, 0
    s_cbranch_scc1 L_polltmo_25
    s_sleep 2
    s_branch L_poll_23
L_polltmo_25:
    v_mov_b32 v22, 225
    v_mov_b32 v23, 252
    global_store_dword v23, v22, s[38:39]
L_polled_24:
    s_mov_b64 exec, -1
L_pollok_22:
    v_mfma_f32_16x16x32_bf16 v[240:243], v[132:135], a[216:219], v[240:243]
    s_lshl_b32 s55, s48, 6
    v_mfma_f32_16x16x32_bf16 v[244:247], v[132:135], v[192:195], v[244:247]
    s_add_u32 s55, s55, s50
    v_mfma_f32_16x16x32_bf16 v[252:255], v[132:135], v[136:139], v[252:255]
    v_add_u32 v17, s55, v2
    s_waitcnt lgkmcnt(4)
    v_mfma_f32_16x16x32_bf16 v[216:219], v[112:115], a[60:63], v[216:219]
    ds_read_b64_tr_b16 v[128:129], v27 offset:4096
    v_lshlrev_b32 v17, 4, v17
    v_mfma_f32_16x16x32_bf16 v[220:223], v[112:115], a[140:143], v[220:223]
    ds_read_b64_tr_b16 v[130:131], v27 offset:4608
    buffer_load_dwordx4 v[32:35], v17, s[24:27], 0 offen offset:0 sc1
    v_mfma_f32_16x16x32_bf16 v[224:227], v[112:115], a[220:223], v[224:227]
    ds_read_b64_tr_b16 v[132:133], v28 offset:4096
    buffer_load_dwordx4 v[36:39], v17, s[24:27], 0 offen offset:256 sc1
    v_mfma_f32_16x16x32_bf16 v[228:231], v[112:115], v[196:199], v[228:231]
    ds_read_b64_tr_b16 v[134:135], v28 offset:4608
    buffer_load_dwordx4 v[40:43], v17, s[24:27], 0 offen offset:512 sc1
    v_mfma_f32_16x16x32_bf16 v[248:251], v[112:115], v[136:139], v[248:251]
    buffer_load_dwordx4 v[44:47], v17, s[24:27], 0 offen offset:768 sc1
    v_mfma_f32_16x16x32_bf16 v[232:235], v[116:119], a[60:63], v[232:235]
    v_lshlrev_b32 v18, 3, v3
    v_mfma_f32_16x16x32_bf16 v[236:239], v[116:119], a[140:143], v[236:239]
    s_lshl_b32 s56, s79, 1
    v_mfma_f32_16x16x32_bf16 v[240:243], v[116:119], a[220:223], v[240:243]
    v_add_u32 v18, s56, v18
    v_mfma_f32_16x16x32_bf16 v[244:247], v[116:119], v[196:199], v[244:247]
    global_load_dwordx2 v[48:49], v18, s[32:33] offset:0
    v_mfma_f32_16x16x32_bf16 v[252:255], v[116:119], v[136:139], v[252:255]
    global_load_dwordx2 v[50:51], v18, s[32:33] offset:32
    s_waitcnt lgkmcnt(4)
    v_mfma_f32_16x16x32_bf16 v[216:219], v[120:123], a[64:67], v[216:219]
    ds_read_b64_tr_b16 v[112:113], v27 offset:8192
    v_mfma_f32_16x16x32_bf16 v[220:223], v[120:123], a[144:147], v[220:223]
    ds_read_b64_tr_b16 v[114:115], v27 offset:8704
    v_mfma_f32_16x16x32_bf16 v[224:227], v[120:123], a[224:227], v[224:227]
    ds_read_b64_tr_b16 v[116:117], v28 offset:8192
    v_mfma_f32_16x16x32_bf16 v[228:231], v[120:123], v[200:203], v[228:231]
    ds_read_b64_tr_b16 v[118:119], v28 offset:8704
    v_mfma_f32_16x16x32_bf16 v[248:251], v[120:123], v[136:139], v[248:251]
    v_mfma_f32_16x16x32_bf16 v[232:235], v[124:127], a[64:67], v[232:235]
    v_mfma_f32_16x16x32_bf16 v[236:239], v[124:127], a[144:147], v[236:239]
    v_mfma_f32_16x16x32_bf16 v[240:243], v[124:127], a[224:227], v[240:243]
    v_mfma_f32_16x16x32_bf16 v[244:247], v[124:127], v[200:203], v[244:247]
    v_mfma_f32_16x16x32_bf16 v[252:255], v[124:127], v[136:139], v[252:255]
    s_waitcnt lgkmcnt(4)
    v_mfma_f32_16x16x32_bf16 v[216:219], v[128:131], a[68:71], v[216:219]
    ds_read_b64_tr_b16 v[120:121], v27 offset:12288
    v_mfma_f32_16x16x32_bf16 v[220:223], v[128:131], a[148:151], v[220:223]
    ds_read_b64_tr_b16 v[122:123], v27 offset:12800
    v_mfma_f32_16x16x32_bf16 v[224:227], v[128:131], a[228:231], v[224:227]
    ds_read_b64_tr_b16 v[124:125], v28 offset:12288
    v_mfma_f32_16x16x32_bf16 v[228:231], v[128:131], v[204:207], v[228:231]
    ds_read_b64_tr_b16 v[126:127], v28 offset:12800
    v_mfma_f32_16x16x32_bf16 v[248:251], v[128:131], v[136:139], v[248:251]
    v_mfma_f32_16x16x32_bf16 v[232:235], v[132:135], a[68:71], v[232:235]
    v_mfma_f32_16x16x32_bf16 v[236:239], v[132:135], a[148:151], v[236:239]
    v_mfma_f32_16x16x32_bf16 v[240:243], v[132:135], a[228:231], v[240:243]
    v_mfma_f32_16x16x32_bf16 v[244:247], v[132:135], v[204:207], v[244:247]
    v_mfma_f32_16x16x32_bf16 v[252:255], v[132:135], v[136:139], v[252:255]
    s_waitcnt lgkmcnt(4)
    v_mfma_f32_16x16x32_bf16 v[216:219], v[112:115], a[72:75], v[216:219]
    v_mfma_f32_16x16x32_bf16 v[220:223], v[112:115], a[152:155], v[220:223]
    v_mfma_f32_16x16x32_bf16 v[224:227], v[112:115], a[232:235], v[224:227]
    v_mfma_f32_16x16x32_bf16 v[228:231], v[112:115], v[208:211], v[228:231]
    v_mfma_f32_16x16x32_bf16 v[248:251], v[112:115], v[136:139], v[248:251]
    v_mfma_f32_16x16x32_bf16 v[232:235], v[116:119], a[72:75], v[232:235]
    v_mfma_f32_16x16x32_bf16 v[236:239], v[116:119], a[152:155], v[236:239]
    v_mfma_f32_16x16x32_bf16 v[240:243], v[116:119], a[232:235], v[240:243]
    v_mfma_f32_16x16x32_bf16 v[244:247], v[116:119], v[208:211], v[244:247]
    v_mfma_f32_16x16x32_bf16 v[252:255], v[116:119], v[136:139], v[252:255]
    s_waitcnt lgkmcnt(0)
    v_mfma_f32_16x16x32_bf16 v[216:219], v[120:123], a[76:79], v[216:219]
    v_mfma_f32_16x16x32_bf16 v[220:223], v[120:123], a[156:159], v[220:223]
    v_mfma_f32_16x16x32_bf16 v[224:227], v[120:123], a[236:239], v[224:227]
    v_mfma_f32_16x16x32_bf16 v[228:231], v[120:123], v[212:215], v[228:231]
    v_mfma_f32_16x16x32_bf16 v[248:251], v[120:123], v[136:139], v[248:251]
    v_mfma_f32_16x16x32_bf16 v[232:235], v[124:127], a[76:79], v[232:235]
    v_mfma_f32_16x16x32_bf16 v[236:239], v[124:127], a[156:159], v[236:239]
    v_mfma_f32_16x16x32_bf16 v[240:243], v[124:127], a[236:239], v[240:243]
    v_mfma_f32_16x16x32_bf16 v[244:247], v[124:127], v[212:215], v[244:247]
    v_mfma_f32_16x16x32_bf16 v[252:255], v[124:127], v[136:139], v[252:255]
L_p1join_4:
    s_waitcnt vmcnt(0)
    s_barrier
    s_cmp_lg_u32 s40, 0
    s_cbranch_scc1 L_noflag_26
    s_mov_b64 exec, 1
    v_mov_b32 v22, s2
    v_mov_b32 v23, s3
    v_mov_b32 v24, 0
    buffer_store_dwordx2 v[22:23], v24, s[24:27], s98 offen sc1
    s_mov_b64 exec, -1
L_noflag_26:
    v_mov_b32 v80, 0xc0135761
    v_mov_b32 v81, 0xc0135761
    v_mov_b32 v82, 0xbdd2d3e8
    v_mov_b32 v83, 0xbdd2d3e8
    s_mov_b32 s74, 1.0
    s_mov_b32 s75, 1.0
    s_lshr_b32 s56, s50, 4
    s_lshl_b32 s57, s48, 2
    s_add_u32 s56, s56, s57
    s_mul_i32 s56, s56, 49152
    s_add_u32 s72, s56, 10485760
    v_lshlrev_b32 v84, 4, v1
    v_lshlrev_b32 v56, 16, v48
    v_and_b32 v57, 0xffff0000, v48
    v_lshlrev_b32 v58, 16, v49
    v_and_b32 v59, 0xffff0000, v49
    v_pk_fma_f32 v[216:217], v[248:249], v[32:33], v[216:217] op_sel_hi:[1,0,1] neg_lo:[1,0,0] neg_hi:[1,0,0]
    v_pk_fma_f32 v[216:217], v[216:217], v[32:33], v[56:57] op_sel:[0,1,0] op_sel_hi:[1,1,1]
    v_pk_mul_f32 v[60:61], v[216:217], v[216:217]
    v_pk_fma_f32 v[60:61], v[60:61], v[82:83], v[80:81]
    v_pk_mul_f32 v[60:61], v[60:61], v[216:217]
    v_pk_fma_f32 v[218:219], v[250:251], v[32:33], v[218:219] op_sel_hi:[1,0,1] neg_lo:[1,0,0] neg_hi:[1,0,0]
    v_pk_fma_f32 v[218:219], v[218:219], v[32:33], v[58:59] op_sel:[0,1,0] op_sel_hi:[1,1,1]
    v_pk_mul_f32 v[62:63], v[218:219], v[218:219]
    v_pk_fma_f32 v[62:63], v[62:63], v[82:83], v[80:81]
    v_pk_mul_f32 v[62:63], v[62:63], v[218:219]
    v_exp_f32 v60, v60
    v_exp_f32 v61, v61
    v_exp_f32 v62, v62
    v_exp_f32 v63, v63
    v_pk_add_f32 v[60:61], v[60:61], s[74:75]
    v_pk_mul_f32 v[216:217], v[216:217], v[34:35] op_sel:[0,1] op_sel_hi:[1,1]
    v_pk_add_f32 v[62:63], v[62:63], s[74:75]
    v_pk_mul_f32 v[218:219], v[218:219], v[34:35] op_sel:[0,1] op_sel_hi:[1,1]
    v_rcp_f32 v60, v60
    v_rcp_f32 v61, v61
    v_rcp_f32 v62, v62
    v_rcp_f32 v63, v63
    s_nop 0
    v_pk_mul_f32 v[216:217], v[216:217], v[60:61]
    v_pk_mul_f32 v[218:219], v[218:219], v[62:63]
    v_cvt_pk_bf16_f32 v64, v216, v217
    v_cvt_pk_bf16_f32 v65, v218, v219
    v_pk_fma_f32 v[220:221], v[248:249], v[36:37], v[220:221] op_sel_hi:[1,0,1] neg_lo:[1,0,0] neg_hi:[1,0,0]
    v_pk_fma_f32 v[220:221], v[220:221], v[36:37], v[56:57] op_sel:[0,1,0] op_sel_hi:[1,1,1]
    v_pk_mul_f32 v[60:61], v[220:221], v[220:221]
    v_pk_fma_f32 v[60:61], v[60:61], v[82:83], v[80:81]
    v_pk_mul_f32 v[60:61], v[60:61], v[220:221]
    v_pk_fma_f32 v[222:223], v[250:251], v[36:37], v[222:223] op_sel_hi:[1,0,1] neg_lo:[1,0,0] neg_hi:[1,0,0]
    v_pk_fma_f32 v[222:223], v[222:223], v[36:37], v[58:59] op_sel:[0,1,0] op_sel_hi:[1,1,1]
    v_pk_mul_f32 v[62:63], v[222:223], v[222:223]
    v_pk_fma_f32 v[62:63], v[62:63], v[82:83], v[80:81]
    v_pk_mul_f32 v[62:63], v[62:63], v[222:223]
    v_exp_f32 v60, v60
    v_exp_f32 v61, v61
    v_exp_f32 v62, v62
    v_exp_f32 v63, v63
    v_pk_add_f32 v[60:61], v[60:61], s[74:75]
    v_pk_mul_f32 v[220:221], v[220:221], v[38:39] op_sel:[0,1] op_sel_hi:[1,1]
    v_pk_add_f32 v[62:63], v[62:63], s[74:75]
    v_pk_mul_f32 v[222:223], v[222:223], v[38:39] op_sel:[0,1] op_sel_hi:[1,1]
    v_rcp_f32 v60, v60
    v_rcp_f32 v61, v61
    v_rcp_f32 v62, v62
    v_rcp_f32 v63, v63
    s_nop 0
    v_pk_mul_f32 v[220:221], v[220:221], v[60:61]
    v_pk_mul_f32 v[222:223], v[222:223], v[62:63]
    v_cvt_pk_bf16_f32 v68, v220, v221
    v_cvt_pk_bf16_f32 v69, v222, v223
    v_pk_fma_f32 v[224:225], v[248:249], v[40:41], v[224:225] op_sel_hi:[1,0,1] neg_lo:[1,0,0] neg_hi:[1,0,0]
    v_pk_fma_f32 v[224:225], v[224:225], v[40:41], v[56:57] op_sel:[0,1,0] op_sel_hi:[1,1,1]
    v_pk_mul_f32 v[60:61], v[224:225], v[224:225]
    v_pk_fma_f32 v[60:61], v[60:61], v[82:83], v[80:81]
    v_pk_mul_f32 v[60:61], v[60:61], v[224:225]
    v_pk_fma_f32 v[226:227], v[250:251], v[40:41], v[226:227] op_sel_hi:[1,0,1] neg_lo:[1,0,0] neg_hi:[1,0,0]
    v_pk_fma_f32 v[226:227], v[226:227], v[40:41], v[58:59] op_sel:[0,1,0] op_sel_hi:[1,1,1]
    v_pk_mul_f32 v[62:63], v[226:227], v[226:227]
    v_pk_fma_f32 v[62:63], v[62:63], v[82:83], v[80:81]
    v_pk_mul_f32 v[62:63], v[62:63], v[226:227]
    v_exp_f32 v60, v60
    v_exp_f32 v61, v61
    v_exp_f32 v62, v62
    v_exp_f32 v63, v63
    v_pk_add_f32 v[60:61], v[60:61], s[74:75]
    v_pk_mul_f32 v[224:225], v[224:225], v[42:43] op_sel:[0,1] op_sel_hi:[1,1]
    v_pk_add_f32 v[62:63], v[62:63], s[74:75]
    v_pk_mul_f32 v[226:227], v[226:227], v[42:43] op_sel:[0,1] op_sel_hi:[1,1]
    v_rcp_f32 v60, v60
    v_rcp_f32 v61, v61
    v_rcp_f32 v62, v62
    v_rcp_f32 v63, v63
    s_nop 0
    v_pk_mul_f32 v[224:225], v[224:225], v[60:61]
    v_pk_mul_f32 v[226:227], v[226:227], v[62:63]
    v_cvt_pk_bf16_f32 v72, v224, v225
    v_cvt_pk_bf16_f32 v73, v226, v227
    v_pk_fma_f32 v[228:229], v[248:249], v[44:45], v[228:229] op_sel_hi:[1,0,1] neg_lo:[1,0,0] neg_hi:[1,0,0]
    v_pk_fma_f32 v[228:229], v[228:229], v[44:45], v[56:57] op_sel:[0,1,0] op_sel_hi:[1,1,1]
    v_pk_mul_f32 v[60:61], v[228:229], v[228:229]
    v_pk_fma_f32 v[60:61], v[60:61], v[82:83], v[80:81]
    v_pk_mul_f32 v[60:61], v[60:61], v[228:229]
    v_pk_fma_f32 v[230:231], v[250:251], v[44:45], v[230:231] op_sel_hi:[1,0,1] neg_lo:[1,0,0] neg_hi:[1,0,0]
    v_pk_fma_f32 v[230:231], v[230:231], v[44:45], v[58:59] op_sel:[0,1,0] op_sel_hi:[1,1,1]
    v_pk_mul_f32 v[62:63], v[230:231], v[230:231]
    v_pk_fma_f32 v[62:63], v[62:63], v[82:83], v[80:81]
    v_pk_mul_f32 v[62:63], v[62:63], v[230:231]
    v_exp_f32 v60, v60
    v_exp_f32 v61, v61
    v_exp_f32 v62, v62
    v_exp_f32 v63, v63
    v_pk_add_f32 v[60:61], v[60:61], s[74:75]
    v_pk_mul_f32 v[228:229], v[228:229], v[46:47] op_sel:[0,1] op_sel_hi:[1,1]
    v_pk_add_f32 v[62:63], v[62:63], s[74:75]
    v_pk_mul_f32 v[230:231], v[230:231], v[46:47] op_sel:[0,1] op_sel_hi:[1,1]
    v_rcp_f32 v60, v60
    v_rcp_f32 v61, v61
    v_rcp_f32 v62, v62
    v_rcp_f32 v63, v63
    s_nop 0
    v_pk_mul_f32 v[228:229], v[228:229], v[60:61]
    v_pk_mul_f32 v[230:231], v[230:231], v[62:63]
    v_cvt_pk_bf16_f32 v76, v228, v229
    v_cvt_pk_bf16_f32 v77, v230, v231
    v_lshlrev_b32 v56, 16, v50
    v_and_b32 v57, 0xffff0000, v50
    v_lshlrev_b32 v58, 16, v51
    v_and_b32 v59, 0xffff0000, v51
    v_pk_fma_f32 v[232:233], v[252:253], v[32:33], v[232:233] op_sel_hi:[1,0,1] neg_lo:[1,0,0] neg_hi:[1,0,0]
    v_pk_fma_f32 v[232:233], v[232:233], v[32:33], v[56:57] op_sel:[0,1,0] op_sel_hi:[1,1,1]
    v_pk_mul_f32 v[60:61], v[232:233], v[232:233]
    v_pk_fma_f32 v[60:61], v[60:61], v[82:83], v[80:81]
    v_pk_mul_f32 v[60:61], v[60:61], v[232:233]
    v_pk_fma_f32 v[234:235], v[254:255], v[32:33], v[234:235] op_sel_hi:[1,0,1] neg_lo:[1,0,0] neg_hi:[1,0,0]
    v_pk_fma_f32 v[234:235], v[234:235], v[32:33], v[58:59] op_sel:[0,1,0] op_sel_hi:[1,1,1]
    v_pk_mul_f32 v[62:63], v[234:235], v[234:235]
    v_pk_fma_f32 v[62:63], v[62:63], v[82:83], v[80:81]
    v_pk_mul_f32 v[62:63], v[62:63], v[234:235]
    v_exp_f32 v60, v60
    v_exp_f32 v61, v61
    v_exp_f32 v62, v62
    v_exp_f32 v63, v63
    v_pk_add_f32 v[60:61], v[60:61], s[74:75]
    v_pk_mul_f32 v[232:233], v[232:233], v[34:35] op_sel:[0,1] op_sel_hi:[1,1]
    v_pk_add_f32 v[62:63], v[62:63], s[74:75]
    v_pk_mul_f32 v[234:235], v[234:235], v[34:35] op_sel:[0,1] op_sel_hi:[1,1]
    v_rcp_f32 v60, v60
    v_rcp_f32 v61, v61
    v_rcp_f32 v62, v62
    v_rcp_f32 v63, v63
    s_nop 0
    v_pk_mul_f32 v[232:233], v[232:233], v[60:61]
    v_pk_mul_f32 v[234:235], v[234:235], v[62:63]
    v_cvt_pk_bf16_f32 v66, v232, v233
    v_cvt_pk_bf16_f32 v67, v234, v235
    s_lshr_b32 s56, s79, 4
    s_add_u32 s56, s56, 1
    s_lshr_b32 s56, s56, 1
    s_lshl_b32 s56, s56, 10
    s_add_u32 s56, s56, s72
    s_add_u32 s58, s56, 0
    buffer_store_dwordx4 v[64:67], v84, s[24:27], s58 offen sc1
    v_pk_fma_f32 v[236:237], v[252:253], v[36:37], v[236:237] op_sel_hi:[1,0,1] neg_lo:[1,0,0] neg_hi:[1,0,0]
    v_pk_fma_f32 v[236:237], v[236:237], v[36:37], v[56:57] op_sel:[0,1,0] op_sel_hi:[1,1,1]
    v_pk_mul_f32 v[60:61], v[236:237], v[236:237]
    v_pk_fma_f32 v[60:61], v[60:61], v[82:83], v[80:81]
    v_pk_mul_f32 v[60:61], v[60:61], v[236:237]
    v_pk_fma_f32 v[238:239], v[254:255], v[36:37], v[238:239] op_sel_hi:[1,0,1] neg_lo:[1,0,0] neg_hi:[1,0,0]
    v_pk_fma_f32 v[238:239], v[238:239], v[36:37], v[58:59] op_sel:[0,1,0] op_sel_hi:[1,1,1]
    v_pk_mul_f32 v[62:63], v[238:239], v[238:239]
    v_pk_fma_f32 v[62:63], v[62:63], v[82:83], v[80:81]
    v_pk_mul_f32 v[62:63], v[62:63], v[238:239]
    v_exp_f32 v60, v60
    v_exp_f32 v61, v61
    v_exp_f32 v62, v62
    v_exp_f32 v63, v63
    v_pk_add_f32 v[60:61], v[60:61], s[74:75]
    v_pk_mul_f32 v[236:237], v[236:237], v[38:39] op_sel:[0,1] op_sel_hi:[1,1]
    v_pk_add_f32 v[62:63], v[62:63], s[74:75]
    v_pk_mul_f32 v[238:239], v[238:239], v[38:39] op_sel:[0,1] op_sel_hi:[1,1]
    v_rcp_f32 v60, v60
    v_rcp_f32 v61, v61
    v_rcp_f32 v62, v62
    v_rcp_f32 v63, v63
    s_nop 0
    v_pk_mul_f32 v[236:237], v[236:237], v[60:61]
    v_pk_mul_f32 v[238:239], v[238:239], v[62:63]
    v_cvt_pk_bf16_f32 v70, v236, v237
    v_cvt_pk_bf16_f32 v71, v238, v239
    s_add_u32 s58, s56, 49152
    buffer_store_dwordx4 v[68:71], v84, s[24:27], s58 offen sc1
    v_pk_fma_f32 v[240:241], v[252:253], v[40:41], v[240:241] op_sel_hi:[1,0,1] neg_lo:[1,0,0] neg_hi:[1,0,0]
    v_pk_fma_f32 v[240:241], v[240:241], v[40:41], v[56:57] op_sel:[0,1,0] op_sel_hi:[1,1,1]
    v_pk_mul_f32 v[60:61], v[240:241], v[240:241]
    v_pk_fma_f32 v[60:61], v[60:61], v[82:83], v[80:81]
    v_pk_mul_f32 v[60:61], v[60:61], v[240:241]
    v_pk_fma_f32 v[242:243], v[254:255], v[40:41], v[242:243] op_sel_hi:[1,0,1] neg_lo:[1,0,0] neg_hi:[1,0,0]
    v_pk_fma_f32 v[242:243], v[242:243], v[40:41], v[58:59] op_sel:[0,1,0] op_sel_hi:[1,1,1]
    v_pk_mul_f32 v[62:63], v[242:243], v[242:243]
    v_pk_fma_f32 v[62:63], v[62:63], v[82:83], v[80:81]
    v_pk_mul_f32 v[62:63], v[62:63], v[242:243]
    v_exp_f32 v60, v60
    v_exp_f32 v61, v61
    v_exp_f32 v62, v62
    v_exp_f32 v63, v63
    v_pk_add_f32 v[60:61], v[60:61], s[74:75]
    v_pk_mul_f32 v[240:241], v[240:241], v[42:43] op_sel:[0,1] op_sel_hi:[1,1]
    v_pk_add_f32 v[62:63], v[62:63], s[74:75]
    v_pk_mul_f32 v[242:243], v[242:243], v[42:43] op_sel:[0,1] op_sel_hi:[1,1]
    v_rcp_f32 v60, v60
    v_rcp_f32 v61, v61
    v_rcp_f32 v62, v62
    v_rcp_f32 v63, v63
    s_nop 0
    v_pk_mul_f32 v[240:241], v[240:241], v[60:61]
    v_pk_mul_f32 v[242:243], v[242:243], v[62:63]
    v_cvt_pk_bf16_f32 v74, v240, v241
    v_cvt_pk_bf16_f32 v75, v242, v243
    s_add_u32 s58, s56, 98304
    buffer_store_dwordx4 v[72:75], v84, s[24:27], s58 offen sc1
    v_pk_fma_f32 v[244:245], v[252:253], v[44:45], v[244:245] op_sel_hi:[1,0,1] neg_lo:[1,0,0] neg_hi:[1,0,0]
    v_pk_fma_f32 v[244:245], v[244:245], v[44:45], v[56:57] op_sel:[0,1,0] op_sel_hi:[1,1,1]
    v_pk_mul_f32 v[60:61], v[244:245], v[244:245]
    v_pk_fma_f32 v[60:61], v[60:61], v[82:83], v[80:81]
    v_pk_mul_f32 v[60:61], v[60:61], v[244:245]
    v_pk_fma_f32 v[246:247], v[254:255], v[44:45], v[246:247] op_sel_hi:[1,0,1] neg_lo:[1,0,0] neg_hi:[1,0,0]
    v_pk_fma_f32 v[246:247], v[246:247], v[44:45], v[58:59] op_sel:[0,1,0] op_sel_hi:[1,1,1]
    v_pk_mul_f32 v[62:63], v[246:247], v[246:247]
    v_pk_fma_f32 v[62:63], v[62:63], v[82:83], v[80:81]
    v_pk_mul_f32 v[62:63], v[62:63], v[246:247]
    v_exp_f32 v60, v60
    v_exp_f32 v61, v61
    v_exp_f32 v62, v62
    v_exp_f32 v63, v63
    v_pk_add_f32 v[60:61], v[60:61], s[74:75]
    v_pk_mul_f32 v[244:245], v[244:245], v[46:47] op_sel:[0,1] op_sel_hi:[1,1]
    v_pk_add_f32 v[62:63], v[62:63], s[74:75]
    v_pk_mul_f32 v[246:247], v[246:247], v[46:47] op_sel:[0,1] op_sel_hi:[1,1]
    v_rcp_f32 v60, v60
    v_rcp_f32 v61, v61
    v_rcp_f32 v62, v62
    v_rcp_f32 v63, v63
    s_nop 0
    v_pk_mul_f32 v[244:245], v[244:245], v[60:61]
    v_pk_mul_f32 v[246:247], v[246:247], v[62:63]
    v_cvt_pk_bf16_f32 v78, v244, v245
    v_cvt_pk_bf16_f32 v79, v246, v247
    s_add_u32 s58, s56, 147456
    buffer_store_dwordx4 v[76:79], v84, s[24:27], s58 offen sc1
    s_branch L_p1end_5
L_p1m_3:
    v_mov_b32 v248, 0
    v_mov_b32 v249, 0
    v_mov_b32 v250, 0
    v_mov_b32 v251, 0
    v_mov_b32 v252, 0
    ds_read_b64_tr_b16 v[112:113], v15 offset:0
    ds_read_b64_tr_b16 v[114:115], v15 offset:1280
    ds_read_b128 a[0:3], v13 offset:0
    ds_read_b128 a[80:83], v13 offset:2048
    ds_read_b128 a[160:163], v13 offset:4096
    ds_read_b128 a[240:243], v13 offset:6144
    ds_read_b64_tr_b16 v[116:117], v16 offset:32
    ds_read_b64_tr_b16 v[118:119], v16 offset:1312
    ds_read_b64_tr_b16 v[120:121], v15 offset:64
    ds_read_b64_tr_b16 v[122:123], v15 offset:1344
    ds_read_b64_tr_b16 v[124:125], v16 offset:96
    ds_read_b64_tr_b16 v[126:127], v16 offset:1376
    ds_read_b64_tr_b16 v[128:129], v15 offset:128
    ds_read_b64_tr_b16 v[130:131], v15 offset:1408
    s_waitcnt lgkmcnt(0)
    v_mfma_f32_16x16x32_bf16 v[32:35], v[112:115], a[0:3], 0
    ds_read_b64_tr_b16 v[132:133], v15 offset:10240
    s_add_u32 m0, s83, 73728
    v_mfma_f32_16x16x32_bf16 v[36:39], v[112:115], a[80:83], 0
    ds_read_b64_tr_b16 v[134:135], v15 offset:11520
    buffer_load_dwordx4 v4, s[4:7], s53 offen offset:0 lds
    v_mfma_f32_16x16x32_bf16 v[40:43], v[112:115], a[160:163], 0
    ds_read_b128 a[4:7], v14 offset:0
    v_mfma_f32_16x16x32_bf16 v[44:47], v[112:115], a[240:243], 0
    ds_read_b128 a[84:87], v14 offset:2048
    v_mfma_f32_16x16x32_bf16 v[48:51], v[116:119], a[0:3], 0
    ds_read_b128 a[164:167], v14 offset:4096
    buffer_load_dwordx4 v5, s[4:7], s53 offen offset:1024 lds
    v_mfma_f32_16x16x32_bf16 v[52:55], v[116:119], a[80:83], 0
    ds_read_b128 a[244:247], v14 offset:6144
    v_mfma_f32_16x16x32_bf16 v[56:59], v[116:119], a[160:163], 0
    ds_read_b64_tr_b16 v[136:137], v16 offset:10272
    v_mfma_f32_16x16x32_bf16 v[60:63], v[116:119], a[240:243], 0
    ds_read_b64_tr_b16 v[138:139], v16 offset:11552
    v_mfma_f32_16x16x32_bf16 v[64:67], v[120:123], a[0:3], 0
    ds_read_b64_tr_b16 v[140:141], v15 offset:10304
    buffer_load_dwordx4 v6, s[4:7], s53 offen offset:2048 lds
    v_mfma_f32_16x16x32_bf16 v[68:71], v[120:123], a[80:83], 0
    ds_read_b64_tr_b16 v[142:143], v15 offset:11584
    v_mfma_f32_16x16x32_bf16 v[72:75], v[120:123], a[160:163], 0
    ds_read_b64_tr_b16 v[144:145], v16 offset:10336
    v_mfma_f32_16x16x32_bf16 v[76:79], v[120:123], a[240:243], 0
    ds_read_b64_tr_b16 v[146:147], v16 offset:11616
    v_mfma_f32_16x16x32_bf16 v[80:83], v[124:127], a[0:3], 0
    ds_read_b64_tr_b16 v[148:149], v15 offset:10368
    buffer_load_dwordx4 v7, s[4:7], s53 offen offset:3072 lds
    v_mfma_f32_16x16x32_bf16 v[84:87], v[124:127], a[80:83], 0
    ds_read_b64_tr_b16 v[150:151], v15 offset:11648
    v_mfma_f32_16x16x32_bf16 v[88:91], v[124:127], a[160:163], 0
    s_add_u32 m0, s69, 73728
    v_mfma_f32_16x16x32_bf16 v[92:95], v[124:127], a[240:243], 0
    v_mfma_f32_16x16x32_bf16 v[96:99], v[128:131], a[0:3], 0
    buffer_load_dwordx4 v8, s[64:67], s54 offen offset:0 lds
    v_mfma_f32_16x16x32_bf16 v[100:103], v[128:131], a[80:83], 0
    v_mfma_f32_16x16x32_bf16 v[104:107], v[128:131], a[160:163], 0
    v_mfma_f32_16x16x32_bf16 v[108:111], v[128:131], a[240:243], 0
    s_cmp_lg_u32 s48, 0
    s_cbranch_scc1 L_cs_27
    v_dot2_f32_bf16 v248, v112, s78, v248
    v_dot2_f32_bf16 v249, v116, s78, v249
    v_dot2_f32_bf16 v250, v120, s78, v250
    v_dot2_f32_bf16 v251, v124, s78, v251
    v_dot2_f32_bf16 v252, v128, s78, v252
    v_dot2_f32_bf16 v248, v113, s78, v248
    v_dot2_f32_bf16 v249, v117, s78, v249
    v_dot2_f32_bf16 v250, v121, s78, v250
    v_dot2_f32_bf16 v251, v125, s78, v251
    v_dot2_f32_bf16 v252, v129, s78, v252
    v_dot2_f32_bf16 v248, v114, s78, v248
    v_dot2_f32_bf16 v249, v118, s78, v249
    v_dot2_f32_bf16 v250, v122, s78, v250
    v_dot2_f32_bf16 v251, v126, s78, v251
    v_dot2_f32_bf16 v252, v130, s78, v252
    v_dot2_f32_bf16 v248, v115, s78, v248
    v_dot2_f32_bf16 v249, v119, s78, v249
    v_dot2_f32_bf16 v250, v123, s78, v250
    v_dot2_f32_bf16 v251, v127, s78, v251
    v_dot2_f32_bf16 v252, v131, s78, v252
L_cs_27:
    s_waitcnt lgkmcnt(0)
    s_waitcnt vmcnt(5)
    s_barrier
    v_mfma_f32_16x16x32_bf16 v[32:35], v[132:135], a[4:7], v[32:35]
    ds_read_b64_tr_b16 v[112:113], v15 offset:36864
    buffer_load_dwordx4 v9, s[64:67], s54 offen offset:1024 lds
    v_mfma_f32_16x16x32_bf16 v[36:39], v[132:135], a[84:87], v[36:39]
    ds_read_b64_tr_b16 v[114:115], v15 offset:38144
    v_mfma_f32_16x16x32_bf16 v[40:43], v[132:135], a[164:167], v[40:43]
    ds_read_b128 a[8:11], v13 offset:36864
    v_mfma_f32_16x16x32_bf16 v[44:47], v[132:135], a[244:247], v[44:47]
    ds_read_b128 a[88:91], v13 offset:38912
    v_mfma_f32_16x16x32_bf16 v[48:51], v[136:139], a[4:7], v[48:51]
    ds_read_b128 a[168:171], v13 offset:40960
    buffer_load_dwordx4 v10, s[64:67], s54 offen offset:2048 lds
    v_mfma_f32_16x16x32_bf16 v[52:55], v[136:139], a[84:87], v[52:55]
    ds_read_b128 a[248:251], v13 offset:43008
    v_mfma_f32_16x16x32_bf16 v[56:59], v[136:139], a[164:167], v[56:59]
    ds_read_b64_tr_b16 v[116:117], v16 offset:36896
    v_mfma_f32_16x16x32_bf16 v[60:63], v[136:139], a[244:247], v[60:63]
    ds_read_b64_tr_b16 v[118:119], v16 offset:38176
    v_mfma_f32_16x16x32_bf16 v[64:67], v[140:143], a[4:7], v[64:67]
    ds_read_b64_tr_b16 v[120:121], v15 offset:36928
    buffer_load_dwordx4 v11, s[64:67], s54 offen offset:3072 lds
    v_mfma_f32_16x16x32_bf16 v[68:71], v[140:143], a[84:87], v[68:71]
    ds_read_b64_tr_b16 v[122:123], v15 offset:38208
    v_mfma_f32_16x16x32_bf16 v[72:75], v[140:143], a[164:167], v[72:75]
    ds_read_b64_tr_b16 v[124:125], v16 offset:36960
    s_add_u32 m0, s69, 77824
    v_mfma_f32_16x16x32_bf16 v[76:79], v[140:143], a[244:247], v[76:79]
    ds_read_b64_tr_b16 v[126:127], v16 offset:38240
    v_mfma_f32_16x16x32_bf16 v[80:83], v[144:147], a[4:7], v[80:83]
    ds_read_b64_tr_b16 v[128:129], v15 offset:36992
    buffer_load_dwordx4 v12, s[64:67], s54 offen offset:0 lds
    v_mfma_f32_16x16x32_bf16 v[84:87], v[144:147], a[84:87], v[84:87]
    ds_read_b64_tr_b16 v[130:131], v15 offset:38272
    s_add_u32 s53, s53, 128
    v_mfma_f32_16x16x32_bf16 v[88:91], v[144:147], a[164:167], v[88:91]
    s_add_u32 s54, s54, s73
    v_mfma_f32_16x16x32_bf16 v[92:95], v[144:147], a[244:247], v[92:95]
    s_cmp_ge_u32 s53, 1280
    s_cselect_b32 s55, 1280, 0
    s_cselect_b32 s56, s76, 0
    v_mfma_f32_16x16x32_bf16 v[96:99], v[148:151], a[4:7], v[96:99]
    s_sub_u32 s53, s53, s55
    s_sub_u32 s54, s54, s56
    v_mfma_f32_16x16x32_bf16 v[100:103], v[148:151], a[84:87], v[100:103]
    s_add_u32 m0, s83, 110592
    s_nop 0
    buffer_load_dwordx4 v4, s[4:7], s53 offen offset:0 lds
    v_mfma_f32_16x16x32_bf16 v[104:107], v[148:151], a[164:167], v[104:107]
    v_mfma_f32_16x16x32_bf16 v[108:111], v[148:151], a[244:247], v[108:111]
    s_cmp_lg_u32 s48, 1
    s_cbranch_scc1 L_cs_28
    v_dot2_f32_bf16 v248, v132, s78, v248
    v_dot2_f32_bf16 v249, v136, s78, v249
    v_dot2_f32_bf16 v250, v140, s78, v250
    v_dot2_f32_bf16 v251, v144, s78, v251
    v_dot2_f32_bf16 v252, v148, s78, v252
    v_dot2_f32_bf16 v248, v133, s78, v248
    v_dot2_f32_bf16 v249, v137, s78, v249
    v_dot2_f32_bf16 v250, v141, s78, v250
    v_dot2_f32_bf16 v251, v145, s78, v251
    v_dot2_f32_bf16 v252, v149, s78, v252
    v_dot2_f32_bf16 v248, v134, s78, v248
    v_dot2_f32_bf16 v249, v138, s78, v249
    v_dot2_f32_bf16 v250, v142, s78, v250
    v_dot2_f32_bf16 v251, v146, s78, v251
    v_dot2_f32_bf16 v252, v150, s78, v252
    v_dot2_f32_bf16 v248, v135, s78, v248
    v_dot2_f32_bf16 v249, v139, s78, v249
    v_dot2_f32_bf16 v250, v143, s78, v250
    v_dot2_f32_bf16 v251, v147, s78, v251
    v_dot2_f32_bf16 v252, v151, s78, v252
L_cs_28:
    s_waitcnt lgkmcnt(0)
    v_mfma_f32_16x16x32_bf16 v[32:35], v[112:115], a[8:11], v[32:35]
    ds_read_b64_tr_b16 v[132:133], v15 offset:47104
    buffer_load_dwordx4 v5, s[4:7], s53 offen offset:1024 lds
    v_mfma_f32_16x16x32_bf16 v[36:39], v[112:115], a[88:91], v[36:39]
    ds_read_b64_tr_b16 v[134:135], v15 offset:48384
    v_mfma_f32_16x16x32_bf16 v[40:43], v[112:115], a[168:171], v[40:43]
    ds_read_b128 a[12:15], v14 offset:36864
    v_mfma_f32_16x16x32_bf16 v[44:47], v[112:115], a[248:251], v[44:47]
    ds_read_b128 a[92:95], v14 offset:38912
    v_mfma_f32_16x16x32_bf16 v[48:51], v[116:119], a[8:11], v[48:51]
    ds_read_b128 a[172:175], v14 offset:40960
    buffer_load_dwordx4 v6, s[4:7], s53 offen offset:2048 lds
    v_mfma_f32_16x16x32_bf16 v[52:55], v[116:119], a[88:91], v[52:55]
    ds_read_b128 a[252:255], v14 offset:43008
    v_mfma_f32_16x16x32_bf16 v[56:59], v[116:119], a[168:171], v[56:59]
    ds_read_b64_tr_b16 v[136:137], v16 offset:47136
    v_mfma_f32_16x16x32_bf16 v[60:63], v[116:119], a[248:251], v[60:63]
    ds_read_b64_tr_b16 v[138:139], v16 offset:48416
    v_mfma_f32_16x16x32_bf16 v[64:67], v[120:123], a[8:11], v[64:67]
    ds_read_b64_tr_b16 v[140:141], v15 offset:47168
    buffer_load_dwordx4 v7, s[4:7], s53 offen offset:3072 lds
    v_mfma_f32_16x16x32_bf16 v[68:71], v[120:123], a[88:91], v[68:71]
    ds_read_b64_tr_b16 v[142:143], v15 offset:48448
    v_mfma_f32_16x16x32_bf16 v[72:75], v[120:123], a[168:171], v[72:75]
    ds_read_b64_tr_b16 v[144:145], v16 offset:47200
    s_add_u32 m0, s69, 110592
    v_mfma_f32_16x16x32_bf16 v[76:79], v[120:123], a[248:251], v[76:79]
    ds_read_b64_tr_b16 v[146:147], v16 offset:48480
    v_mfma_f32_16x16x32_bf16 v[80:83], v[124:127], a[8:11], v[80:83]
    ds_read_b64_tr_b16 v[148:149], v15 offset:47232
    buffer_load_dwordx4 v8, s[64:67], s54 offen offset:0 lds
    v_mfma_f32_16x16x32_bf16 v[84:87], v[124:127], a[88:91], v[84:87]
    ds_read_b64_tr_b16 v[150:151], v15 offset:48512
    v_mfma_f32_16x16x32_bf16 v[88:91], v[124:127], a[168:171], v[88:91]
    v_mfma_f32_16x16x32_bf16 v[92:95], v[124:127], a[248:251], v[92:95]
    v_mfma_f32_16x16x32_bf16 v[96:99], v[128:131], a[8:11], v[96:99]
    buffer_load_dwordx4 v9, s[64:67], s54 offen offset:1024 lds
    v_mfma_f32_16x16x32_bf16 v[100:103], v[128:131], a[88:91], v[100:103]
    v_mfma_f32_16x16x32_bf16 v[104:107], v[128:131], a[168:171], v[104:107]
    v_mfma_f32_16x16x32_bf16 v[108:111], v[128:131], a[248:251], v[108:111]
    s_cmp_lg_u32 s48, 0
    s_cbranch_scc1 L_cs_29
    v_dot2_f32_bf16 v248, v112, s78, v248
    v_dot2_f32_bf16 v249, v116, s78, v249
    v_dot2_f32_bf16 v250, v120, s78, v250
    v_dot2_f32_bf16 v251, v124, s78, v251
    v_dot2_f32_bf16 v252, v128, s78, v252
    v_dot2_f32_bf16 v248, v113, s78, v248
    v_dot2_f32_bf16 v249, v117, s78, v249
    v_dot2_f32_bf16 v250, v121, s78, v250
    v_dot2_f32_bf16 v251, v125, s78, v251
    v_dot2_f32_bf16 v252, v129, s78, v252
    v_dot2_f32_bf16 v248, v114, s78, v248
    v_dot2_f32_bf16 v249, v118, s78, v249
    v_dot2_f32_bf16 v250, v122, s78, v250
    v_dot2_f32_bf16 v251, v126, s78, v251
    v_dot2_f32_bf16 v252, v130, s78, v252
    v_dot2_f32_bf16 v248, v115, s78, v248
    v_dot2_f32_bf16 v249, v119, s78, v249
    v_dot2_f32_bf16 v250, v123, s78, v250
    v_dot2_f32_bf16 v251, v127, s78, v251
    v_dot2_f32_bf16 v252, v131, s78, v252
L_cs_29:
    s_waitcnt lgkmcnt(0)
    s_waitcnt vmcnt(6)
    s_barrier
    v_mfma_f32_16x16x32_bf16 v[32:35], v[132:135], a[12:15], v[32:35]
    ds_read_b64_tr_b16 v[112:113], v19 offset:0
    buffer_load_dwordx4 v10, s[64:67], s54 offen offset:2048 lds
    v_mfma_f32_16x16x32_bf16 v[36:39], v[132:135], a[92:95], v[36:39]
    ds_read_b64_tr_b16 v[114:115], v19 offset:1280
    v_mfma_f32_16x16x32_bf16 v[40:43], v[132:135], a[172:175], v[40:43]
    ds_read_b128 a[16:19], v17 offset:0
    v_mfma_f32_16x16x32_bf16 v[44:47], v[132:135], a[252:255], v[44:47]
    ds_read_b128 a[96:99], v17 offset:2048
    v_mfma_f32_16x16x32_bf16 v[48:51], v[136:139], a[12:15], v[48:51]
    ds_read_b128 a[176:179], v17 offset:4096
    buffer_load_dwordx4 v11, s[64:67], s54 offen offset:3072 lds
    v_mfma_f32_16x16x32_bf16 v[52:55], v[136:139], a[92:95], v[52:55]
    ds_read_b128 v[152:155], v17 offset:6144
    v_mfma_f32_16x16x32_bf16 v[56:59], v[136:139], a[172:175], v[56:59]
    ds_read_b64_tr_b16 v[116:117], v20 offset:32
    s_add_u32 m0, s69, 114688
    v_mfma_f32_16x16x32_bf16 v[60:63], v[136:139], a[252:255], v[60:63]
    ds_read_b64_tr_b16 v[118:119], v20 offset:1312
    v_mfma_f32_16x16x32_bf16 v[64:67], v[140:143], a[12:15], v[64:67]
    ds_read_b64_tr_b16 v[120:121], v19 offset:64
    buffer_load_dwordx4 v12, s[64:67], s54 offen offset:0 lds
    v_mfma_f32_16x16x32_bf16 v[68:71], v[140:143], a[92:95], v[68:71]
    ds_read_b64_tr_b16 v[122:123], v19 offset:1344
    s_add_u32 s53, s53, 128
    v_mfma_f32_16x16x32_bf16 v[72:75], v[140:143], a[172:175], v[72:75]
    ds_read_b64_tr_b16 v[124:125], v20 offset:96
    s_add_u32 s54, s54, s73
    v_mfma_f32_16x16x32_bf16 v[76:79], v[140:143], a[252:255], v[76:79]
    ds_read_b64_tr_b16 v[126:127], v20 offset:1376
    v_mfma_f32_16x16x32_bf16 v[80:83], v[144:147], a[12:15], v[80:83]
    ds_read_b64_tr_b16 v[128:129], v19 offset:128
    v_mfma_f32_16x16x32_bf16 v[84:87], v[144:147], a[92:95], v[84:87]
    ds_read_b64_tr_b16 v[130:131], v19 offset:1408
    v_mfma_f32_16x16x32_bf16 v[88:91], v[144:147], a[172:175], v[88:91]
    s_cmp_ge_u32 s53, 1280
    s_cselect_b32 s55, 1280, 0
    s_cselect_b32 s56, s76, 0
    v_mfma_f32_16x16x32_bf16 v[92:95], v[144:147], a[252:255], v[92:95]
    s_sub_u32 s53, s53, s55
    s_sub_u32 s54, s54, s56
    v_mfma_f32_16x16x32_bf16 v[96:99], v[148:151], a[12:15], v[96:99]
    s_add_u32 m0, s83, 0
    s_nop 0
    buffer_load_dwordx4 v4, s[4:7], s53 offen offset:0 lds
    v_mfma_f32_16x16x32_bf16 v[100:103], v[148:151], a[92:95], v[100:103]
    buffer_load_dwordx4 v5, s[4:7], s53 offen offset:1024 lds
    v_mfma_f32_16x16x32_bf16 v[104:107], v[148:151], a[172:175], v[104:107]
    v_mfma_f32_16x16x32_bf16 v[108:111], v[148:151], a[252:255], v[108:111]
    s_cmp_lg_u32 s48, 1
    s_cbranch_scc1 L_cs_30
    v_dot2_f32_bf16 v248, v132, s78, v248
    v_dot2_f32_bf16 v249, v136, s78, v249
    v_dot2_f32_bf16 v250, v140, s78, v250
    v_dot2_f32_bf16 v251, v144, s78, v251
    v_dot2_f32_bf16 v252, v148, s78, v252
    v_dot2_f32_bf16 v248, v133, s78, v248
    v_dot2_f32_bf16 v249, v137, s78, v249
    v_dot2_f32_bf16 v250, v141, s78, v250
    v_dot2_f32_bf16 v251, v145, s78, v251
    v_dot2_f32_bf16 v252, v149, s78, v252
    v_dot2_f32_bf16 v248, v134, s78, v248
    v_dot2_f32_bf16 v249, v138, s78, v249
    v_dot2_f32_bf16 v250, v142, s78, v250
    v_dot2_f32_bf16 v251, v146, s78, v251
    v_dot2_f32_bf16 v252, v150, s78, v252
    v_dot2_f32_bf16 v248, v135, s78, v248
    v_dot2_f32_bf16 v249, v139, s78, v249
    v_dot2_f32_bf16 v250, v143, s78, v250
    v_dot2_f32_bf16 v251, v147, s78, v251
    v_dot2_f32_bf16 v252, v151, s78, v252
L_cs_30:
    s_waitcnt lgkmcnt(0)
    v_mfma_f32_16x16x32_bf16 v[32:35], v[112:115], a[16:19], v[32:35]
    ds_read_b64_tr_b16 v[132:133], v19 offset:10240
    buffer_load_dwordx4 v6, s[4:7], s53 offen offset:2048 lds
    v_mfma_f32_16x16x32_bf16 v[36:39], v[112:115], a[96:99], v[36:39]
    ds_read_b64_tr_b16 v[134:135], v19 offset:11520
    v_mfma_f32_16x16x32_bf16 v[40:43], v[112:115], a[176:179], v[40:43]
    ds_read_b128 a[20:23], v18 offset:0
    v_mfma_f32_16x16x32_bf16 v[44:47], v[112:115], v[152:155], v[44:47]
    ds_read_b128 a[100:103], v18 offset:2048
    v_mfma_f32_16x16x32_bf16 v[48:51], v[116:119], a[16:19], v[48:51]
    ds_read_b128 a[180:183], v18 offset:4096
    buffer_load_dwordx4 v7, s[4:7], s53 offen offset:3072 lds
    v_mfma_f32_16x16x32_bf16 v[52:55], v[116:119], a[96:99], v[52:55]
    ds_read_b128 v[156:159], v18 offset:6144
    v_mfma_f32_16x16x32_bf16 v[56:59], v[116:119], a[176:179], v[56:59]
    ds_read_b64_tr_b16 v[136:137], v20 offset:10272
    s_add_u32 m0, s69, 0
    v_mfma_f32_16x16x32_bf16 v[60:63], v[116:119], v[152:155], v[60:63]
    ds_read_b64_tr_b16 v[138:139], v20 offset:11552
    v_mfma_f32_16x16x32_bf16 v[64:67], v[120:123], a[16:19], v[64:67]
    ds_read_b64_tr_b16 v[140:141], v19 offset:10304
    buffer_load_dwordx4 v8, s[64:67], s54 offen offset:0 lds
    v_mfma_f32_16x16x32_bf16 v[68:71], v[120:123], a[96:99], v[68:71]
    ds_read_b64_tr_b16 v[142:143], v19 offset:11584
    v_mfma_f32_16x16x32_bf16 v[72:75], v[120:123], a[176:179], v[72:75]
    ds_read_b64_tr_b16 v[144:145], v20 offset:10336
    v_mfma_f32_16x16x32_bf16 v[76:79], v[120:123], v[152:155], v[76:79]
    ds_read_b64_tr_b16 v[146:147], v20 offset:11616
    v_mfma_f32_16x16x32_bf16 v[80:83], v[124:127], a[16:19], v[80:83]
    ds_read_b64_tr_b16 v[148:149], v19 offset:10368
    buffer_load_dwordx4 v9, s[64:67], s54 offen offset:1024 lds
    v_mfma_f32_16x16x32_bf16 v[84:87], v[124:127], a[96:99], v[84:87]
    ds_read_b64_tr_b16 v[150:151], v19 offset:11648
    v_mfma_f32_16x16x32_bf16 v[88:91], v[124:127], a[176:179], v[88:91]
    v_mfma_f32_16x16x32_bf16 v[92:95], v[124:127], v[152:155], v[92:95]
    v_mfma_f32_16x16x32_bf16 v[96:99], v[128:131], a[16:19], v[96:99]
    buffer_load_dwordx4 v10, s[64:67], s54 offen offset:2048 lds
    v_mfma_f32_16x16x32_bf16 v[100:103], v[128:131], a[96:99], v[100:103]
    v_mfma_f32_16x16x32_bf16 v[104:107], v[128:131], a[176:179], v[104:107]
    v_mfma_f32_16x16x32_bf16 v[108:111], v[128:131], v[152:155], v[108:111]
    s_cmp_lg_u32 s48, 0
    s_cbranch_scc1 L_cs_31
    v_dot2_f32_bf16 v248, v112, s78, v248
    v_dot2_f32_bf16 v249, v116, s78, v249
    v_dot2_f32_bf16 v250, v120, s78, v250
    v_dot2_f32_bf16 v251, v124, s78, v251
    v_dot2_f32_bf16 v252, v128, s78, v252
    v_dot2_f32_bf16 v248, v113, s78, v248
    v_dot2_f32_bf16 v249, v117, s78, v249
    v_dot2_f32_bf16 v250, v121, s78, v250
    v_dot2_f32_bf16 v251, v125, s78, v251
    v_dot2_f32_bf16 v252, v129, s78, v252
    v_dot2_f32_bf16 v248, v114, s78, v248
    v_dot2_f32_bf16 v249, v118, s78, v249
    v_dot2_f32_bf16 v250, v122, s78, v250
    v_dot2_f32_bf16 v251, v126, s78, v251
    v_dot2_f32_bf16 v252, v130, s78, v252
    v_dot2_f32_bf16 v248, v115, s78, v248
    v_dot2_f32_bf16 v249, v119, s78, v249
    v_dot2_f32_bf16 v250, v123, s78, v250
    v_dot2_f32_bf16 v251, v127, s78, v251
    v_dot2_f32_bf16 v252, v131, s78, v252
L_cs_31:
    s_waitcnt lgkmcnt(0)
    s_waitcnt vmcnt(7)
    s_barrier
    v_mfma_f32_16x16x32_bf16 v[32:35], v[132:135], a[20:23], v[32:35]
    ds_read_b64_tr_b16 v[112:113], v19 offset:36864
    buffer_load_dwordx4 v11, s[64:67], s54 offen offset:3072 lds
    v_mfma_f32_16x16x32_bf16 v[36:39], v[132:135], a[100:103], v[36:39]
    ds_read_b64_tr_b16 v[114:115], v19 offset:38144
    v_mfma_f32_16x16x32_bf16 v[40:43], v[132:135], a[180:183], v[40:43]
    ds_read_b128 a[24:27], v17 offset:36864
    s_add_u32 m0, s69, 4096
    v_mfma_f32_16x16x32_bf16 v[44:47], v[132:135], v[156:159], v[44:47]
    ds_read_b128 a[104:107], v17 offset:38912
    v_mfma_f32_16x16x32_bf16 v[48:51], v[136:139], a[20:23], v[48:51]
    ds_read_b128 a[184:187], v17 offset:40960
    buffer_load_dwordx4 v12, s[64:67], s54 offen offset:0 lds
    v_mfma_f32_16x16x32_bf16 v[52:55], v[136:139], a[100:103], v[52:55]
    ds_read_b128 v[160:163], v17 offset:43008
    s_add_u32 s53, s53, 128
    v_mfma_f32_16x16x32_bf16 v[56:59], v[136:139], a[180:183], v[56:59]
    ds_read_b64_tr_b16 v[116:117], v20 offset:36896
    s_add_u32 s54, s54, s73
    v_mfma_f32_16x16x32_bf16 v[60:63], v[136:139], v[156:159], v[60:63]
    ds_read_b64_tr_b16 v[118:119], v20 offset:38176
    v_mfma_f32_16x16x32_bf16 v[64:67], v[140:143], a[20:23], v[64:67]
    ds_read_b64_tr_b16 v[120:121], v19 offset:36928
    v_mfma_f32_16x16x32_bf16 v[68:71], v[140:143], a[100:103], v[68:71]
    ds_read_b64_tr_b16 v[122:123], v19 offset:38208
    v_mfma_f32_16x16x32_bf16 v[72:75], v[140:143], a[180:183], v[72:75]
    ds_read_b64_tr_b16 v[124:125], v20 offset:36960
    v_mfma_f32_16x16x32_bf16 v[76:79], v[140:143], v[156:159], v[76:79]
    ds_read_b64_tr_b16 v[126:127], v20 offset:38240
    v_mfma_f32_16x16x32_bf16 v[80:83], v[144:147], a[20:23], v[80:83]
    ds_read_b64_tr_b16 v[128:129], v19 offset:36992
    v_mfma_f32_16x16x32_bf16 v[84:87], v[144:147], a[100:103], v[84:87]
    ds_read_b64_tr_b16 v[130:131], v19 offset:38272
    v_mfma_f32_16x16x32_bf16 v[88:91], v[144:147], a[180:183], v[88:91]
    s_cmp_ge_u32 s53, 1280
    s_cselect_b32 s55, 1280, 0
    s_cselect_b32 s56, s76, 0
    v_mfma_f32_16x16x32_bf16 v[92:95], v[144:147], v[156:159], v[92:95]
    s_sub_u32 s53, s53, s55
    s_sub_u32 s54, s54, s56
    v_mfma_f32_16x16x32_bf16 v[96:99], v[148:151], a[20:23], v[96:99]
    s_add_u32 m0, s83, 36864
    s_nop 0
    buffer_load_dwordx4 v4, s[4:7], s53 offen offset:0 lds
    v_mfma_f32_16x16x32_bf16 v[100:103], v[148:151], a[100:103], v[100:103]
    buffer_load_dwordx4 v5, s[4:7], s53 offen offset:1024 lds
    buffer_load_dwordx4 v6, s[4:7], s53 offen offset:2048 lds
    v_mfma_f32_16x16x32_bf16 v[104:107], v[148:151], a[180:183], v[104:107]
    v_mfma_f32_16x16x32_bf16 v[108:111], v[148:151], v[156:159], v[108:111]
    s_cmp_lg_u32 s48, 1
    s_cbranch_scc1 L_cs_32
    v_dot2_f32_bf16 v248, v132, s78, v248
    v_dot2_f32_bf16 v249, v136, s78, v249
    v_dot2_f32_bf16 v250, v140, s78, v250
    v_dot2_f32_bf16 v251, v144, s78, v251
    v_dot2_f32_bf16 v252, v148, s78, v252
    v_dot2_f32_bf16 v248, v133, s78, v248
    v_dot2_f32_bf16 v249, v137, s78, v249
    v_dot2_f32_bf16 v250, v141, s78, v250
    v_dot2_f32_bf16 v251, v145, s78, v251
    v_dot2_f32_bf16 v252, v149, s78, v252
    v_dot2_f32_bf16 v248, v134, s78, v248
    v_dot2_f32_bf16 v249, v138, s78, v249
    v_dot2_f32_bf16 v250, v142, s78, v250
    v_dot2_f32_bf16 v251, v146, s78, v251
    v_dot2_f32_bf16 v252, v150, s78, v252
    v_dot2_f32_bf16 v248, v135, s78, v248
    v_dot2_f32_bf16 v249, v139, s78, v249
    v_dot2_f32_bf16 v250, v143, s78, v250
    v_dot2_f32_bf16 v251, v147, s78, v251
    v_dot2_f32_bf16 v252, v151, s78, v252
L_cs_32:
    s_waitcnt lgkmcnt(0)
    v_mfma_f32_16x16x32_bf16 v[32:35], v[112:115], a[24:27], v[32:35]
    ds_read_b64_tr_b16 v[132:133], v19 offset:47104
    buffer_load_dwordx4 v7, s[4:7], s53 offen offset:3072 lds
    v_mfma_f32_16x16x32_bf16 v[36:39], v[112:115], a[104:107], v[36:39]
    ds_read_b64_tr_b16 v[134:135], v19 offset:48384
    v_mfma_f32_16x16x32_bf16 v[40:43], v[112:115], a[184:187], v[40:43]
    ds_read_b128 a[28:31], v18 offset:36864
    s_add_u32 m0, s69, 36864
    v_mfma_f32_16x16x32_bf16 v[44:47], v[112:115], v[160:163], v[44:47]
    ds_read_b128 a[108:111], v18 offset:38912
    v_mfma_f32_16x16x32_bf16 v[48:51], v[116:119], a[24:27], v[48:51]
    ds_read_b128 a[188:191], v18 offset:40960
    buffer_load_dwordx4 v8, s[64:67], s54 offen offset:0 lds
    v_mfma_f32_16x16x32_bf16 v[52:55], v[116:119], a[104:107], v[52:55]
    ds_read_b128 v[164:167], v18 offset:43008
    v_mfma_f32_16x16x32_bf16 v[56:59], v[116:119], a[184:187], v[56:59]
    ds_read_b64_tr_b16 v[136:137], v20 offset:47136
    v_mfma_f32_16x16x32_bf16 v[60:63], v[116:119], v[160:163], v[60:63]
    ds_read_b64_tr_b16 v[138:139], v20 offset:48416
    v_mfma_f32_16x16x32_bf16 v[64:67], v[120:123], a[24:27], v[64:67]
    ds_read_b64_tr_b16 v[140:141], v19 offset:47168
    buffer_load_dwordx4 v9, s[64:67], s54 offen offset:1024 lds
    v_mfma_f32_16x16x32_bf16 v[68:71], v[120:123], a[104:107], v[68:71]
    ds_read_b64_tr_b16 v[142:143], v19 offset:48448
    v_mfma_f32_16x16x32_bf16 v[72:75], v[120:123], a[184:187], v[72:75]
    ds_read_b64_tr_b16 v[144:145], v20 offset:47200
    v_mfma_f32_16x16x32_bf16 v[76:79], v[120:123], v[160:163], v[76:79]
    ds_read_b64_tr_b16 v[146:147], v20 offset:48480
    v_mfma_f32_16x16x32_bf16 v[80:83], v[124:127], a[24:27], v[80:83]
    ds_read_b64_tr_b16 v[148:149], v19 offset:47232
    buffer_load_dwordx4 v10, s[64:67], s54 offen offset:2048 lds
    v_mfma_f32_16x16x32_bf16 v[84:87], v[124:127], a[104:107], v[84:87]
    ds_read_b64_tr_b16 v[150:151], v19 offset:48512
    v_mfma_f32_16x16x32_bf16 v[88:91], v[124:127], a[184:187], v[88:91]
    v_mfma_f32_16x16x32_bf16 v[92:95], v[124:127], v[160:163], v[92:95]
    v_mfma_f32_16x16x32_bf16 v[96:99], v[128:131], a[24:27], v[96:99]
    buffer_load_dwordx4 v11, s[64:67], s54 offen offset:3072 lds
    v_mfma_f32_16x16x32_bf16 v[100:103], v[128:131], a[104:107], v[100:103]
    v_mfma_f32_16x16x32_bf16 v[104:107], v[128:131], a[184:187], v[104:107]
    s_add_u32 m0, s69, 40960
    v_mfma_f32_16x16x32_bf16 v[108:111], v[128:131], v[160:163], v[108:111]
    s_cmp_lg_u32 s48, 0
    s_cbranch_scc1 L_cs_33
    v_dot2_f32_bf16 v248, v112, s78, v248
    v_dot2_f32_bf16 v249, v116, s78, v249
    v_dot2_f32_bf16 v250, v120, s78, v250
    v_dot2_f32_bf16 v251, v124, s78, v251
    v_dot2_f32_bf16 v252, v128, s78, v252
    v_dot2_f32_bf16 v248, v113, s78, v248
    v_dot2_f32_bf16 v249, v117, s78, v249
    v_dot2_f32_bf16 v250, v121, s78, v250
    v_dot2_f32_bf16 v251, v125, s78, v251
    v_dot2_f32_bf16 v252, v129, s78, v252
    v_dot2_f32_bf16 v248, v114, s78, v248
    v_dot2_f32_bf16 v249, v118, s78, v249
    v_dot2_f32_bf16 v250, v122, s78, v250
    v_dot2_f32_bf16 v251, v126, s78, v251
    v_dot2_f32_bf16 v252, v130, s78, v252
    v_dot2_f32_bf16 v248, v115, s78, v248
    v_dot2_f32_bf16 v249, v119, s78, v249
    v_dot2_f32_bf16 v250, v123, s78, v250
    v_dot2_f32_bf16 v251, v127, s78, v251
    v_dot2_f32_bf16 v252, v131, s78, v252
L_cs_33:
    s_waitcnt lgkmcnt(0)
    s_waitcnt vmcnt(8)
    s_barrier
    s_mov_b32 exec_lo, 0x1
    s_mov_b32 exec_hi, 0x0
    s_nop 0
    v_readfirstlane_b32 s2, v254
    v_readfirstlane_b32 s3, v255
    v_or_b32 v254, v254, v255
    v_cmp_eq_u32 vcc, 0, v254
    s_mov_b64 exec, -1
    s_cmp_eq_u64 vcc, 0
    s_cbranch_scc1 L_pollok_34
    s_mov_b32 exec_lo, 0x1
    s_mov_b32 exec_hi, 0x0
    s_mov_b32 s84, 1048576
L_poll_35:
    global_load_dwordx2 v[254:255], v253, s[38:39] sc1
    s_waitcnt vmcnt(0)
    s_nop 0
    v_readfirstlane_b32 s2, v254
    v_readfirstlane_b32 s3, v255
    v_or_b32 v254, v254, v255
    v_cmp_eq_u32 vcc, 0, v254
    s_cmp_eq_u64 vcc, 0
    s_cbranch_scc1 L_polled_36
    s_sub_u32 s84, s84, 1
    s_cmp_eq_u32 s84, 0
    s_cbranch_scc1 L_polltmo_37
    s_sleep 2
    s_branch L_poll_35
L_polltmo_37:
    v_mov_b32 v254, 224
    v_mov_b32 v255, 252
    global_store_dword v255, v254, s[38:39]
L_polled_36:
    s_mov_b64 exec, -1
L_pollok_34:
    s_cmp_lg_u32 s40, 0
    s_cbranch_scc1 L_noflag_38
    s_mov_b64 exec, 1
    v_mov_b32 v240, s2
    v_mov_b32 v241, s3
    v_mov_b32 v242, 0
    buffer_store_dwordx2 v[240:241], v242, s[24:27], s101 offen sc1
    s_mov_b64 exec, -1
L_noflag_38:
    v_mfma_f32_16x16x32_bf16 v[32:35], v[132:135], a[28:31], v[32:35]
    ds_read_b64_tr_b16 v[112:113], v15 offset:0
    buffer_load_dwordx4 v12, s[64:67], s54 offen offset:0 lds
    v_mfma_f32_16x16x32_bf16 v[36:39], v[132:135], a[108:111], v[36:39]
    ds_read_b64_tr_b16 v[114:115], v15 offset:1280
    s_add_u32 s53, s53, 128
    v_mfma_f32_16x16x32_bf16 v[40:43], v[132:135], a[188:191], v[40:43]
    ds_read_b128 a[32:35], v13 offset:0
    s_add_u32 s54, s54, s73
    v_mfma_f32_16x16x32_bf16 v[44:47], v[132:135], v[164:167], v[44:47]
    ds_read_b128 a[112:115], v13 offset:2048
    v_mfma_f32_16x16x32_bf16 v[48:51], v[136:139], a[28:31], v[48:51]
    ds_read_b128 a[192:195], v13 offset:4096
    v_mfma_f32_16x16x32_bf16 v[52:55], v[136:139], a[108:111], v[52:55]
    ds_read_b128 v[168:171], v13 offset:6144
    v_mfma_f32_16x16x32_bf16 v[56:59], v[136:139], a[188:191], v[56:59]
    ds_read_b64_tr_b16 v[116:117], v16 offset:32
    v_mfma_f32_16x16x32_bf16 v[60:63], v[136:139], v[164:167], v[60:63]
    ds_read_b64_tr_b16 v[118:119], v16 offset:1312
    v_mfma_f32_16x16x32_bf16 v[64:67], v[140:143], a[28:31], v[64:67]
    ds_read_b64_tr_b16 v[120:121], v15 offset:64
    v_mfma_f32_16x16x32_bf16 v[68:71], v[140:143], a[108:111], v[68:71]
    ds_read_b64_tr_b16 v[122:123], v15 offset:1344
    v_mfma_f32_16x16x32_bf16 v[72:75], v[140:143], a[188:191], v[72:75]
    ds_read_b64_tr_b16 v[124:125], v16 offset:96
    v_mfma_f32_16x16x32_bf16 v[76:79], v[140:143], v[164:167], v[76:79]
    ds_read_b64_tr_b16 v[126:127], v16 offset:1376
    v_mfma_f32_16x16x32_bf16 v[80:83], v[144:147], a[28:31], v[80:83]
    ds_read_b64_tr_b16 v[128:129], v15 offset:128
    v_mfma_f32_16x16x32_bf16 v[84:87], v[144:147], a[108:111], v[84:87]
    ds_read_b64_tr_b16 v[130:131], v15 offset:1408
    v_mfma_f32_16x16x32_bf16 v[88:91], v[144:147], a[188:191], v[88:91]
    s_cmp_ge_u32 s53, 1280
    s_cselect_b32 s55, 1280, 0
    s_cselect_b32 s56, s76, 0
    v_mfma_f32_16x16x32_bf16 v[92:95], v[144:147], v[164:167], v[92:95]
    s_sub_u32 s53, s53, s55
    s_sub_u32 s54, s54, s56
    v_mfma_f32_16x16x32_bf16 v[96:99], v[148:151], a[28:31], v[96:99]
    s_add_u32 m0, s83, 73728
    s_nop 0
    buffer_load_dwordx4 v4, s[4:7], s53 offen offset:0 lds
    v_mfma_f32_16x16x32_bf16 v[100:103], v[148:151], a[108:111], v[100:103]
    buffer_load_dwordx4 v5, s[4:7], s53 offen offset:1024 lds
    buffer_load_dwordx4 v6, s[4:7], s53 offen offset:2048 lds
    v_mfma_f32_16x16x32_bf16 v[104:107], v[148:151], a[188:191], v[104:107]
    buffer_load_dwordx4 v7, s[4:7], s53 offen offset:3072 lds
    s_add_u32 m0, s69, 73728
    v_mfma_f32_16x16x32_bf16 v[108:111], v[148:151], v[164:167], v[108:111]
    s_cmp_lg_u32 s48, 1
    s_cbranch_scc1 L_cs_39
    v_dot2_f32_bf16 v248, v132, s78, v248
    v_dot2_f32_bf16 v249, v136, s78, v249
    v_dot2_f32_bf16 v250, v140, s78, v250
    v_dot2_f32_bf16 v251, v144, s78, v251
    v_dot2_f32_bf16 v252, v148, s78, v252
    v_dot2_f32_bf16 v248, v133, s78, v248
    v_dot2_f32_bf16 v249, v137, s78, v249
    v_dot2_f32_bf16 v250, v141, s78, v250
    v_dot2_f32_bf16 v251, v145, s78, v251
    v_dot2_f32_bf16 v252, v149, s78, v252
    v_dot2_f32_bf16 v248, v134, s78, v248
    v_dot2_f32_bf16 v249, v138, s78, v249
    v_dot2_f32_bf16 v250, v142, s78, v250
    v_dot2_f32_bf16 v251, v146, s78, v251
    v_dot2_f32_bf16 v252, v150, s78, v252
    v_dot2_f32_bf16 v248, v135, s78, v248
    v_dot2_f32_bf16 v249, v139, s78, v249
    v_dot2_f32_bf16 v250, v143, s78, v250
    v_dot2_f32_bf16 v251, v147, s78, v251
    v_dot2_f32_bf16 v252, v151, s78, v252
L_cs_39:
    s_waitcnt lgkmcnt(0)
    v_mfma_f32_16x16x32_bf16 v[32:35], v[112:115], a[32:35], v[32:35]
    ds_read_b64_tr_b16 v[132:133], v15 offset:10240
    buffer_load_dwordx4 v8, s[64:67], s54 offen offset:0 lds
    v_mfma_f32_16x16x32_bf16 v[36:39], v[112:115], a[112:115], v[36:39]
    ds_read_b64_tr_b16 v[134:135], v15 offset:11520
    v_mfma_f32_16x16x32_bf16 v[40:43], v[112:115], a[192:195], v[40:43]
    ds_read_b128 a[36:39], v14 offset:0
    v_mfma_f32_16x16x32_bf16 v[44:47], v[112:115], v[168:171], v[44:47]
    ds_read_b128 a[116:119], v14 offset:2048
    v_mfma_f32_16x16x32_bf16 v[48:51], v[116:119], a[32:35], v[48:51]
    ds_read_b128 a[196:199], v14 offset:4096
    buffer_load_dwordx4 v9, s[64:67], s54 offen offset:1024 lds
    v_mfma_f32_16x16x32_bf16 v[52:55], v[116:119], a[112:115], v[52:55]
    ds_read_b128 v[172:175], v14 offset:6144
    v_mfma_f32_16x16x32_bf16 v[56:59], v[116:119], a[192:195], v[56:59]
    ds_read_b64_tr_b16 v[136:137], v16 offset:10272
    v_mfma_f32_16x16x32_bf16 v[60:63], v[116:119], v[168:171], v[60:63]
    ds_read_b64_tr_b16 v[138:139], v16 offset:11552
    v_mfma_f32_16x16x32_bf16 v[64:67], v[120:123], a[32:35], v[64:67]
    ds_read_b64_tr_b16 v[140:141], v15 offset:10304
    buffer_load_dwordx4 v10, s[64:67], s54 offen offset:2048 lds
    v_mfma_f32_16x16x32_bf16 v[68:71], v[120:123], a[112:115], v[68:71]
    ds_read_b64_tr_b16 v[142:143], v15 offset:11584
    v_mfma_f32_16x16x32_bf16 v[72:75], v[120:123], a[192:195], v[72:75]
    ds_read_b64_tr_b16 v[144:145], v16 offset:10336
    v_mfma_f32_16x16x32_bf16 v[76:79], v[120:123], v[168:171], v[76:79]
    ds_read_b64_tr_b16 v[146:147], v16 offset:11616
    v_mfma_f32_16x16x32_bf16 v[80:83], v[124:127], a[32:35], v[80:83]
    ds_read_b64_tr_b16 v[148:149], v15 offset:10368
    buffer_load_dwordx4 v11, s[64:67], s54 offen offset:3072 lds
    v_mfma_f32_16x16x32_bf16 v[84:87], v[124:127], a[112:115], v[84:87]
    ds_read_b64_tr_b16 v[150:151], v15 offset:11648
    v_mfma_f32_16x16x32_bf16 v[88:91], v[124:127], a[192:195], v[88:91]
    s_add_u32 m0, s69, 77824
    v_mfma_f32_16x16x32_bf16 v[92:95], v[124:127], v[168:171], v[92:95]
    v_mfma_f32_16x16x32_bf16 v[96:99], v[128:131], a[32:35], v[96:99]
    buffer_load_dwordx4 v12, s[64:67], s54 offen offset:0 lds
    v_mfma_f32_16x16x32_bf16 v[100:103], v[128:131], a[112:115], v[100:103]
    s_add_u32 s53, s53, 128
    s_add_u32 s54, s54, s73
    v_mfma_f32_16x16x32_bf16 v[104:107], v[128:131], a[192:195], v[104:107]
    s_cmp_ge_u32 s53, 1280
    s_cselect_b32 s55, 1280, 0
    s_cselect_b32 s56, s76, 0
    v_mfma_f32_16x16x32_bf16 v[108:111], v[128:131], v[168:171], v[108:111]
    s_sub_u32 s53, s53, s55
    s_sub_u32 s54, s54, s56
    s_cmp_lg_u32 s48, 0
    s_cbranch_scc1 L_cs_40
    v_dot2_f32_bf16 v248, v112, s78, v248
    v_dot2_f32_bf16 v249, v116, s78, v249
    v_dot2_f32_bf16 v250, v120, s78, v250
    v_dot2_f32_bf16 v251, v124, s78, v251
    v_dot2_f32_bf16 v252, v128, s78, v252
    v_dot2_f32_bf16 v248, v113, s78, v248
    v_dot2_f32_bf16 v249, v117, s78, v249
    v_dot2_f32_bf16 v250, v121, s78, v250
    v_dot2_f32_bf16 v251, v125, s78, v251
    v_dot2_f32_bf16 v252, v129, s78, v252
    v_dot2_f32_bf16 v248, v114, s78, v248
    v_dot2_f32_bf16 v249, v118, s78, v249
    v_dot2_f32_bf16 v250, v122, s78, v250
    v_dot2_f32_bf16 v251, v126, s78, v251
    v_dot2_f32_bf16 v252, v130, s78, v252
    v_dot2_f32_bf16 v248, v115, s78, v248
    v_dot2_f32_bf16 v249, v119, s78, v249
    v_dot2_f32_bf16 v250, v123, s78, v250
    v_dot2_f32_bf16 v251, v127, s78, v251
    v_dot2_f32_bf16 v252, v131, s78, v252
L_cs_40:
    s_waitcnt lgkmcnt(0)
    s_waitcnt vmcnt(9)
    s_barrier
    v_mfma_f32_16x16x32_bf16 v[32:35], v[132:135], a[36:39], v[32:35]
    ds_read_b64_tr_b16 v[112:113], v15 offset:36864
    s_add_u32 m0, s83, 110592
    v_mfma_f32_16x16x32_bf16 v[36:39], v[132:135], a[116:119], v[36:39]
    ds_read_b64_tr_b16 v[114:115], v15 offset:38144
    buffer_load_dwordx4 v4, s[4:7], s53 offen offset:0 lds
    v_mfma_f32_16x16x32_bf16 v[40:43], v[132:135], a[196:199], v[40:43]
    ds_read_b128 a[40:43], v13 offset:36864
    v_mfma_f32_16x16x32_bf16 v[44:47], v[132:135], v[172:175], v[44:47]
    ds_read_b128 a[120:123], v13 offset:38912
    v_mfma_f32_16x16x32_bf16 v[48:51], v[136:139], a[36:39], v[48:51]
    ds_read_b128 a[200:203], v13 offset:40960
    buffer_load_dwordx4 v5, s[4:7], s53 offen offset:1024 lds
    v_mfma_f32_16x16x32_bf16 v[52:55], v[136:139], a[116:119], v[52:55]
    ds_read_b128 v[176:179], v13 offset:43008
    v_mfma_f32_16x16x32_bf16 v[56:59], v[136:139], a[196:199], v[56:59]
    ds_read_b64_tr_b16 v[116:117], v16 offset:36896
    v_mfma_f32_16x16x32_bf16 v[60:63], v[136:139], v[172:175], v[60:63]
    ds_read_b64_tr_b16 v[118:119], v16 offset:38176
    v_mfma_f32_16x16x32_bf16 v[64:67], v[140:143], a[36:39], v[64:67]
    ds_read_b64_tr_b16 v[120:121], v15 offset:36928
    buffer_load_dwordx4 v6, s[4:7], s53 offen offset:2048 lds
    v_mfma_f32_16x16x32_bf16 v[68:71], v[140:143], a[116:119], v[68:71]
    ds_read_b64_tr_b16 v[122:123], v15 offset:38208
    v_mfma_f32_16x16x32_bf16 v[72:75], v[140:143], a[196:199], v[72:75]
    ds_read_b64_tr_b16 v[124:125], v16 offset:36960
    v_mfma_f32_16x16x32_bf16 v[76:79], v[140:143], v[172:175], v[76:79]
    ds_read_b64_tr_b16 v[126:127], v16 offset:38240
    v_mfma_f32_16x16x32_bf16 v[80:83], v[144:147], a[36:39], v[80:83]
    ds_read_b64_tr_b16 v[128:129], v15 offset:36992
    buffer_load_dwordx4 v7, s[4:7], s53 offen offset:3072 lds
    v_mfma_f32_16x16x32_bf16 v[84:87], v[144:147], a[116:119], v[84:87]
    ds_read_b64_tr_b16 v[130:131], v15 offset:38272
    v_mfma_f32_16x16x32_bf16 v[88:91], v[144:147], a[196:199], v[88:91]
    s_add_u32 m0, s69, 110592
    v_mfma_f32_16x16x32_bf16 v[92:95], v[144:147], v[172:175], v[92:95]
    v_mfma_f32_16x16x32_bf16 v[96:99], v[148:151], a[36:39], v[96:99]
    buffer_load_dwordx4 v8, s[64:67], s54 offen offset:0 lds
    v_mfma_f32_16x16x32_bf16 v[100:103], v[148:151], a[116:119], v[100:103]
    v_mfma_f32_16x16x32_bf16 v[104:107], v[148:151], a[196:199], v[104:107]
    v_mfma_f32_16x16x32_bf16 v[108:111], v[148:151], v[172:175], v[108:111]
    s_cmp_lg_u32 s48, 1
    s_cbranch_scc1 L_cs_41
    v_dot2_f32_bf16 v248, v132, s78, v248
    v_dot2_f32_bf16 v249, v136, s78, v249
    v_dot2_f32_bf16 v250, v140, s78, v250
    v_dot2_f32_bf16 v251, v144, s78, v251
    v_dot2_f32_bf16 v252, v148, s78, v252
    v_dot2_f32_bf16 v248, v133, s78, v248
    v_dot2_f32_bf16 v249, v137, s78, v249
    v_dot2_f32_bf16 v250, v141, s78, v250
    v_dot2_f32_bf16 v251, v145, s78, v251
    v_dot2_f32_bf16 v252, v149, s78, v252
    v_dot2_f32_bf16 v248, v134, s78, v248
    v_dot2_f32_bf16 v249, v138, s78, v249
    v_dot2_f32_bf16 v250, v142, s78, v250
    v_dot2_f32_bf16 v251, v146, s78, v251
    v_dot2_f32_bf16 v252, v150, s78, v252
    v_dot2_f32_bf16 v248, v135, s78, v248
    v_dot2_f32_bf16 v249, v139, s78, v249
    v_dot2_f32_bf16 v250, v143, s78, v250
    v_dot2_f32_bf16 v251, v147, s78, v251
    v_dot2_f32_bf16 v252, v151, s78, v252
L_cs_41:
    s_waitcnt lgkmcnt(0)
    v_mfma_f32_16x16x32_bf16 v[32:35], v[112:115], a[40:43], v[32:35]
    ds_read_b64_tr_b16 v[132:133], v15 offset:47104
    buffer_load_dwordx4 v9, s[64:67], s54 offen offset:1024 lds
    v_mfma_f32_16x16x32_bf16 v[36:39], v[112:115], a[120:123], v[36:39]
    ds_read_b64_tr_b16 v[134:135], v15 offset:48384
    v_mfma_f32_16x16x32_bf16 v[40:43], v[112:115], a[200:203], v[40:43]
    ds_read_b128 a[44:47], v14 offset:36864
    v_mfma_f32_16x16x32_bf16 v[44:47], v[112:115], v[176:179], v[44:47]
    ds_read_b128 a[124:127], v14 offset:38912
    v_mfma_f32_16x16x32_bf16 v[48:51], v[116:119], a[40:43], v[48:51]
    ds_read_b128 a[204:207], v14 offset:40960
    buffer_load_dwordx4 v10, s[64:67], s54 offen offset:2048 lds
    v_mfma_f32_16x16x32_bf16 v[52:55], v[116:119], a[120:123], v[52:55]
    ds_read_b128 v[180:183], v14 offset:43008
    v_mfma_f32_16x16x32_bf16 v[56:59], v[116:119], a[200:203], v[56:59]
    ds_read_b64_tr_b16 v[136:137], v16 offset:47136
    v_mfma_f32_16x16x32_bf16 v[60:63], v[116:119], v[176:179], v[60:63]
    ds_read_b64_tr_b16 v[138:139], v16 offset:48416
    v_mfma_f32_16x16x32_bf16 v[64:67], v[120:123], a[40:43], v[64:67]
    ds_read_b64_tr_b16 v[140:141], v15 offset:47168
    buffer_load_dwordx4 v11, s[64:67], s54 offen offset:3072 lds
    v_mfma_f32_16x16x32_bf16 v[68:71], v[120:123], a[120:123], v[68:71]
    ds_read_b64_tr_b16 v[142:143], v15 offset:48448
    v_mfma_f32_16x16x32_bf16 v[72:75], v[120:123], a[200:203], v[72:75]
    ds_read_b64_tr_b16 v[144:145], v16 offset:47200
    s_add_u32 m0, s69, 114688
    v_mfma_f32_16x16x32_bf16 v[76:79], v[120:123], v[176:179], v[76:79]
    ds_read_b64_tr_b16 v[146:147], v16 offset:48480
    v_mfma_f32_16x16x32_bf16 v[80:83], v[124:127], a[40:43], v[80:83]
    ds_read_b64_tr_b16 v[148:149], v15 offset:47232
    buffer_load_dwordx4 v12, s[64:67], s54 offen offset:0 lds
    v_mfma_f32_16x16x32_bf16 v[84:87], v[124:127], a[120:123], v[84:87]
    ds_read_b64_tr_b16 v[150:151], v15 offset:48512
    s_add_u32 s53, s53, 128
    v_mfma_f32_16x16x32_bf16 v[88:91], v[124:127], a[200:203], v[88:91]
    s_add_u32 s54, s54, s73
    v_mfma_f32_16x16x32_bf16 v[92:95], v[124:127], v[176:179], v[92:95]
    s_cmp_ge_u32 s53, 1280
    s_cselect_b32 s55, 1280, 0
    s_cselect_b32 s56, s76, 0
    v_mfma_f32_16x16x32_bf16 v[96:99], v[128:131], a[40:43], v[96:99]
    s_sub_u32 s53, s53, s55
    s_sub_u32 s54, s54, s56
    v_mfma_f32_16x16x32_bf16 v[100:103], v[128:131], a[120:123], v[100:103]
    s_add_u32 m0, s83, 0
    s_nop 0
    buffer_load_dwordx4 v4, s[4:7], s53 offen offset:0 lds
    v_mfma_f32_16x16x32_bf16 v[104:107], v[128:131], a[200:203], v[104:107]
    v_mfma_f32_16x16x32_bf16 v[108:111], v[128:131], v[176:179], v[108:111]
    s_cmp_lg_u32 s48, 0
    s_cbranch_scc1 L_cs_42
    v_dot2_f32_bf16 v248, v112, s78, v248
    v_dot2_f32_bf16 v249, v116, s78, v249
    v_dot2_f32_bf16 v250, v120, s78, v250
    v_dot2_f32_bf16 v251, v124, s78, v251
    v_dot2_f32_bf16 v252, v128, s78, v252
    v_dot2_f32_bf16 v248, v113, s78, v248
    v_dot2_f32_bf16 v249, v117, s78, v249
    v_dot2_f32_bf16 v250, v121, s78, v250
    v_dot2_f32_bf16 v251, v125, s78, v251
    v_dot2_f32_bf16 v252, v129, s78, v252
    v_dot2_f32_bf16 v248, v114, s78, v248
    v_dot2_f32_bf16 v249, v118, s78, v249
    v_dot2_f32_bf16 v250, v122, s78, v250
    v_dot2_f32_bf16 v251, v126, s78, v251
    v_dot2_f32_bf16 v252, v130, s78, v252
    v_dot2_f32_bf16 v248, v115, s78, v248
    v_dot2_f32_bf16 v249, v119, s78, v249
    v_dot2_f32_bf16 v250, v123, s78, v250
    v_dot2_f32_bf16 v251, v127, s78, v251
    v_dot2_f32_bf16 v252, v131, s78, v252
L_cs_42:
    s_waitcnt lgkmcnt(0)
    s_waitcnt vmcnt(10)
    s_barrier
    v_mfma_f32_16x16x32_bf16 v[32:35], v[132:135], a[44:47], v[32:35]
    ds_read_b64_tr_b16 v[112:113], v19 offset:0
    buffer_load_dwordx4 v5, s[4:7], s53 offen offset:1024 lds
    v_mfma_f32_16x16x32_bf16 v[36:39], v[132:135], a[124:127], v[36:39]
    ds_read_b64_tr_b16 v[114:115], v19 offset:1280
    v_mfma_f32_16x16x32_bf16 v[40:43], v[132:135], a[204:207], v[40:43]
    ds_read_b128 a[48:51], v17 offset:0
    v_mfma_f32_16x16x32_bf16 v[44:47], v[132:135], v[180:183], v[44:47]
    ds_read_b128 a[128:131], v17 offset:2048
    v_mfma_f32_16x16x32_bf16 v[48:51], v[136:139], a[44:47], v[48:51]
    ds_read_b128 a[208:211], v17 offset:4096
    buffer_load_dwordx4 v6, s[4:7], s53 offen offset:2048 lds
    v_mfma_f32_16x16x32_bf16 v[52:55], v[136:139], a[124:127], v[52:55]
    ds_read_b128 v[184:187], v17 offset:6144
    v_mfma_f32_16x16x32_bf16 v[56:59], v[136:139], a[204:207], v[56:59]
    ds_read_b64_tr_b16 v[116:117], v20 offset:32
    v_mfma_f32_16x16x32_bf16 v[60:63], v[136:139], v[180:183], v[60:63]
    ds_read_b64_tr_b16 v[118:119], v20 offset:1312
    v_mfma_f32_16x16x32_bf16 v[64:67], v[140:143], a[44:47], v[64:67]
    ds_read_b64_tr_b16 v[120:121], v19 offset:64
    buffer_load_dwordx4 v7, s[4:7], s53 offen offset:3072 lds
    v_mfma_f32_16x16x32_bf16 v[68:71], v[140:143], a[124:127], v[68:71]
    ds_read_b64_tr_b16 v[122:123], v19 offset:1344
    v_mfma_f32_16x16x32_bf16 v[72:75], v[140:143], a[204:207], v[72:75]
    ds_read_b64_tr_b16 v[124:125], v20 offset:96
    s_add_u32 m0, s69, 0
    v_mfma_f32_16x16x32_bf16 v[76:79], v[140:143], v[180:183], v[76:79]
    ds_read_b64_tr_b16 v[126:127], v20 offset:1376
    v_mfma_f32_16x16x32_bf16 v[80:83], v[144:147], a[44:47], v[80:83]
    ds_read_b64_tr_b16 v[128:129], v19 offset:128
    buffer_load_dwordx4 v8, s[64:67], s54 offen offset:0 lds
    v_mfma_f32_16x16x32_bf16 v[84:87], v[144:147], a[124:127], v[84:87]
    ds_read_b64_tr_b16 v[130:131], v19 offset:1408
    v_mfma_f32_16x16x32_bf16 v[88:91], v[144:147], a[204:207], v[88:91]
    v_mfma_f32_16x16x32_bf16 v[92:95], v[144:147], v[180:183], v[92:95]
    v_mfma_f32_16x16x32_bf16 v[96:99], v[148:151], a[44:47], v[96:99]
    buffer_load_dwordx4 v9, s[64:67], s54 offen offset:1024 lds
    v_mfma_f32_16x16x32_bf16 v[100:103], v[148:151], a[124:127], v[100:103]
    v_mfma_f32_16x16x32_bf16 v[104:107], v[148:151], a[204:207], v[104:107]
    v_mfma_f32_16x16x32_bf16 v[108:111], v[148:151], v[180:183], v[108:111]
    s_cmp_lg_u32 s48, 1
    s_cbranch_scc1 L_cs_43
    v_dot2_f32_bf16 v248, v132, s78, v248
    v_dot2_f32_bf16 v249, v136, s78, v249
    v_dot2_f32_bf16 v250, v140, s78, v250
    v_dot2_f32_bf16 v251, v144, s78, v251
    v_dot2_f32_bf16 v252, v148, s78, v252
    v_dot2_f32_bf16 v248, v133, s78, v248
    v_dot2_f32_bf16 v249, v137, s78, v249
    v_dot2_f32_bf16 v250, v141, s78, v250
    v_dot2_f32_bf16 v251, v145, s78, v251
    v_dot2_f32_bf16 v252, v149, s78, v252
    v_dot2_f32_bf16 v248, v134, s78, v248
    v_dot2_f32_bf16 v249, v138, s78, v249
    v_dot2_f32_bf16 v250, v142, s78, v250
    v_dot2_f32_bf16 v251, v146, s78, v251
    v_dot2_f32_bf16 v252, v150, s78, v252
    v_dot2_f32_bf16 v248, v135, s78, v248
    v_dot2_f32_bf16 v249, v139, s78, v249
    v_dot2_f32_bf16 v250, v143, s78, v250
    v_dot2_f32_bf16 v251, v147, s78, v251
    v_dot2_f32_bf16 v252, v151, s78, v252
L_cs_43:
    s_waitcnt lgkmcnt(0)
    v_mfma_f32_16x16x32_bf16 v[32:35], v[112:115], a[48:51], v[32:35]
    ds_read_b64_tr_b16 v[132:133], v19 offset:10240
    buffer_load_dwordx4 v10, s[64:67], s54 offen offset:2048 lds
    v_mfma_f32_16x16x32_bf16 v[36:39], v[112:115], a[128:131], v[36:39]
    ds_read_b64_tr_b16 v[134:135], v19 offset:11520
    v_mfma_f32_16x16x32_bf16 v[40:43], v[112:115], a[208:211], v[40:43]
    ds_read_b128 a[52:55], v18 offset:0
    v_mfma_f32_16x16x32_bf16 v[44:47], v[112:115], v[184:187], v[44:47]
    ds_read_b128 a[132:135], v18 offset:2048
    v_mfma_f32_16x16x32_bf16 v[48:51], v[116:119], a[48:51], v[48:51]
    ds_read_b128 a[212:215], v18 offset:4096
    buffer_load_dwordx4 v11, s[64:67], s54 offen offset:3072 lds
    v_mfma_f32_16x16x32_bf16 v[52:55], v[116:119], a[128:131], v[52:55]
    ds_read_b128 v[188:191], v18 offset:6144
    v_mfma_f32_16x16x32_bf16 v[56:59], v[116:119], a[208:211], v[56:59]
    ds_read_b64_tr_b16 v[136:137], v20 offset:10272
    s_add_u32 m0, s69, 4096
    v_mfma_f32_16x16x32_bf16 v[60:63], v[116:119], v[184:187], v[60:63]
    ds_read_b64_tr_b16 v[138:139], v20 offset:11552
    v_mfma_f32_16x16x32_bf16 v[64:67], v[120:123], a[48:51], v[64:67]
    ds_read_b64_tr_b16 v[140:141], v19 offset:10304
    buffer_load_dwordx4 v12, s[64:67], s54 offen offset:0 lds
    v_mfma_f32_16x16x32_bf16 v[68:71], v[120:123], a[128:131], v[68:71]
    ds_read_b64_tr_b16 v[142:143], v19 offset:11584
    s_add_u32 s53, s53, 128
    v_mfma_f32_16x16x32_bf16 v[72:75], v[120:123], a[208:211], v[72:75]
    ds_read_b64_tr_b16 v[144:145], v20 offset:10336
    s_add_u32 s54, s54, s73
    v_mfma_f32_16x16x32_bf16 v[76:79], v[120:123], v[184:187], v[76:79]
    ds_read_b64_tr_b16 v[146:147], v20 offset:11616
    v_mfma_f32_16x16x32_bf16 v[80:83], v[124:127], a[48:51], v[80:83]
    ds_read_b64_tr_b16 v[148:149], v19 offset:10368
    v_mfma_f32_16x16x32_bf16 v[84:87], v[124:127], a[128:131], v[84:87]
    ds_read_b64_tr_b16 v[150:151], v19 offset:11648
    v_mfma_f32_16x16x32_bf16 v[88:91], v[124:127], a[208:211], v[88:91]
    s_cmp_ge_u32 s53, 1280
    s_cselect_b32 s55, 1280, 0
    s_cselect_b32 s56, s76, 0
    v_mfma_f32_16x16x32_bf16 v[92:95], v[124:127], v[184:187], v[92:95]
    s_sub_u32 s53, s53, s55
    s_sub_u32 s54, s54, s56
    v_mfma_f32_16x16x32_bf16 v[96:99], v[128:131], a[48:51], v[96:99]
    s_add_u32 m0, s83, 36864
    s_nop 0
    buffer_load_dwordx4 v4, s[4:7], s53 offen offset:0 lds
    v_mfma_f32_16x16x32_bf16 v[100:103], v[128:131], a[128:131], v[100:103]
    buffer_load_dwordx4 v5, s[4:7], s53 offen offset:1024 lds
    v_mfma_f32_16x16x32_bf16 v[104:107], v[128:131], a[208:211], v[104:107]
    v_mfma_f32_16x16x32_bf16 v[108:111], v[128:131], v[184:187], v[108:111]
    s_cmp_lg_u32 s48, 0
    s_cbranch_scc1 L_cs_44
    v_dot2_f32_bf16 v248, v112, s78, v248
    v_dot2_f32_bf16 v249, v116, s78, v249
    v_dot2_f32_bf16 v250, v120, s78, v250
    v_dot2_f32_bf16 v251, v124, s78, v251
    v_dot2_f32_bf16 v252, v128, s78, v252
    v_dot2_f32_bf16 v248, v113, s78, v248
    v_dot2_f32_bf16 v249, v117, s78, v249
    v_dot2_f32_bf16 v250, v121, s78, v250
    v_dot2_f32_bf16 v251, v125, s78, v251
    v_dot2_f32_bf16 v252, v129, s78, v252
    v_dot2_f32_bf16 v248, v114, s78, v248
    v_dot2_f32_bf16 v249, v118, s78, v249
    v_dot2_f32_bf16 v250, v122, s78, v250
    v_dot2_f32_bf16 v251, v126, s78, v251
    v_dot2_f32_bf16 v252, v130, s78, v252
    v_dot2_f32_bf16 v248, v115, s78, v248
    v_dot2_f32_bf16 v249, v119, s78, v249
    v_dot2_f32_bf16 v250, v123, s78, v250
    v_dot2_f32_bf16 v251, v127, s78, v251
    v_dot2_f32_bf16 v252, v131, s78, v252
L_cs_44:
    s_waitcnt lgkmcnt(0)
    s_waitcnt vmcnt(11)
    s_barrier
    v_mfma_f32_16x16x32_bf16 v[32:35], v[132:135], a[52:55], v[32:35]
    ds_read_b64_tr_b16 v[112:113], v19 offset:36864
    buffer_load_dwordx4 v6, s[4:7], s53 offen offset:2048 lds
    v_mfma_f32_16x16x32_bf16 v[36:39], v[132:135], a[132:135], v[36:39]
    ds_read_b64_tr_b16 v[114:115], v19 offset:38144
    v_mfma_f32_16x16x32_bf16 v[40:43], v[132:135], a[212:215], v[40:43]
    ds_read_b128 a[56:59], v17 offset:36864
    v_mfma_f32_16x16x32_bf16 v[44:47], v[132:135], v[188:191], v[44:47]
    ds_read_b128 a[136:139], v17 offset:38912
    v_mfma_f32_16x16x32_bf16 v[48:51], v[136:139], a[52:55], v[48:51]
    ds_read_b128 a[216:219], v17 offset:40960
    buffer_load_dwordx4 v7, s[4:7], s53 offen offset:3072 lds
    v_mfma_f32_16x16x32_bf16 v[52:55], v[136:139], a[132:135], v[52:55]
    ds_read_b128 v[192:195], v17 offset:43008
    v_mfma_f32_16x16x32_bf16 v[56:59], v[136:139], a[212:215], v[56:59]
    ds_read_b64_tr_b16 v[116:117], v20 offset:36896
    s_add_u32 m0, s69, 36864
    v_mfma_f32_16x16x32_bf16 v[60:63], v[136:139], v[188:191], v[60:63]
    ds_read_b64_tr_b16 v[118:119], v20 offset:38176
    v_mfma_f32_16x16x32_bf16 v[64:67], v[140:143], a[52:55], v[64:67]
    ds_read_b64_tr_b16 v[120:121], v19 offset:36928
    buffer_load_dwordx4 v8, s[64:67], s54 offen offset:0 lds
    v_mfma_f32_16x16x32_bf16 v[68:71], v[140:143], a[132:135], v[68:71]
    ds_read_b64_tr_b16 v[122:123], v19 offset:38208
    v_mfma_f32_16x16x32_bf16 v[72:75], v[140:143], a[212:215], v[72:75]
    ds_read_b64_tr_b16 v[124:125], v20 offset:36960
    v_mfma_f32_16x16x32_bf16 v[76:79], v[140:143], v[188:191], v[76:79]
    ds_read_b64_tr_b16 v[126:127], v20 offset:38240
    v_mfma_f32_16x16x32_bf16 v[80:83], v[144:147], a[52:55], v[80:83]
    ds_read_b64_tr_b16 v[128:129], v19 offset:36992
    buffer_load_dwordx4 v9, s[64:67], s54 offen offset:1024 lds
    v_mfma_f32_16x16x32_bf16 v[84:87], v[144:147], a[132:135], v[84:87]
    ds_read_b64_tr_b16 v[130:131], v19 offset:38272
    v_mfma_f32_16x16x32_bf16 v[88:91], v[144:147], a[212:215], v[88:91]
    v_mfma_f32_16x16x32_bf16 v[92:95], v[144:147], v[188:191], v[92:95]
    v_mfma_f32_16x16x32_bf16 v[96:99], v[148:151], a[52:55], v[96:99]
    buffer_load_dwordx4 v10, s[64:67], s54 offen offset:2048 lds
    v_mfma_f32_16x16x32_bf16 v[100:103], v[148:151], a[132:135], v[100:103]
    v_mfma_f32_16x16x32_bf16 v[104:107], v[148:151], a[212:215], v[104:107]
    v_mfma_f32_16x16x32_bf16 v[108:111], v[148:151], v[188:191], v[108:111]
    s_cmp_lg_u32 s48, 1
    s_cbranch_scc1 L_cs_45
    v_dot2_f32_bf16 v248, v132, s78, v248
    v_dot2_f32_bf16 v249, v136, s78, v249
    v_dot2_f32_bf16 v250, v140, s78, v250
    v_dot2_f32_bf16 v251, v144, s78, v251
    v_dot2_f32_bf16 v252, v148, s78, v252
    v_dot2_f32_bf16 v248, v133, s78, v248
    v_dot2_f32_bf16 v249, v137, s78, v249
    v_dot2_f32_bf16 v250, v141, s78, v250
    v_dot2_f32_bf16 v251, v145, s78, v251
    v_dot2_f32_bf16 v252, v149, s78, v252
    v_dot2_f32_bf16 v248, v134, s78, v248
    v_dot2_f32_bf16 v249, v138, s78, v249
    v_dot2_f32_bf16 v250, v142, s78, v250
    v_dot2_f32_bf16 v251, v146, s78, v251
    v_dot2_f32_bf16 v252, v150, s78, v252
    v_dot2_f32_bf16 v248, v135, s78, v248
    v_dot2_f32_bf16 v249, v139, s78, v249
    v_dot2_f32_bf16 v250, v143, s78, v250
    v_dot2_f32_bf16 v251, v147, s78, v251
    v_dot2_f32_bf16 v252, v151, s78, v252
L_cs_45:
    s_waitcnt lgkmcnt(0)
    v_mfma_f32_16x16x32_bf16 v[32:35], v[112:115], a[56:59], v[32:35]
    ds_read_b64_tr_b16 v[132:133], v19 offset:47104
    buffer_load_dwordx4 v11, s[64:67], s54 offen offset:3072 lds
    v_mfma_f32_16x16x32_bf16 v[36:39], v[112:115], a[136:139], v[36:39]
    ds_read_b64_tr_b16 v[134:135], v19 offset:48384
    v_mfma_f32_16x16x32_bf16 v[40:43], v[112:115], a[216:219], v[40:43]
    ds_read_b128 a[60:63], v18 offset:36864
    s_add_u32 m0, s69, 40960
    v_mfma_f32_16x16x32_bf16 v[44:47], v[112:115], v[192:195], v[44:47]
    ds_read_b128 a[140:143], v18 offset:38912
    v_mfma_f32_16x16x32_bf16 v[48:51], v[116:119], a[56:59], v[48:51]
    ds_read_b128 a[220:223], v18 offset:40960
    buffer_load_dwordx4 v12, s[64:67], s54 offen offset:0 lds
    v_mfma_f32_16x16x32_bf16 v[52:55], v[116:119], a[136:139], v[52:55]
    ds_read_b128 v[196:199], v18 offset:43008
    s_mul_i32 s55, s40, 8192
    v_mfma_f32_16x16x32_bf16 v[56:59], v[116:119], a[216:219], v[56:59]
    ds_read_b64_tr_b16 v[136:137], v20 offset:47136
    s_add_u32 m0, s55, 73728
    v_mfma_f32_16x16x32_bf16 v[60:63], v[116:119], v[192:195], v[60:63]
    ds_read_b64_tr_b16 v[138:139], v20 offset:48416
    s_mul_i32 s56, s40, 128
    v_mfma_f32_16x16x32_bf16 v[64:67], v[120:123], a[56:59], v[64:67]
    ds_read_b64_tr_b16 v[140:141], v19 offset:47168
    s_add_u32 s56, s56, 0
    v_mfma_f32_16x16x32_bf16 v[68:71], v[120:123], a[136:139], v[68:71]
    ds_read_b64_tr_b16 v[142:143], v19 offset:48448
    s_lshr_b32 s57, s56, 6
    v_mfma_f32_16x16x32_bf16 v[72:75], v[120:123], a[216:219], v[72:75]
    ds_read_b64_tr_b16 v[144:145], v20 offset:47200
    s_and_b32 s56, s56, 63
    v_mfma_f32_16x16x32_bf16 v[76:79], v[120:123], v[192:195], v[76:79]
    ds_read_b64_tr_b16 v[146:147], v20 offset:48480
    s_add_u32 s57, s57, s82
    v_mfma_f32_16x16x32_bf16 v[80:83], v[124:127], a[56:59], v[80:83]
    ds_read_b64_tr_b16 v[148:149], v19 offset:47232
    v_mfma_f32_16x16x32_bf16 v[84:87], v[124:127], a[136:139], v[84:87]
    ds_read_b64_tr_b16 v[150:151], v19 offset:48512
    v_mfma_f32_16x16x32_bf16 v[88:91], v[124:127], a[216:219], v[88:91]
    s_cmp_ge_u32 s57, 10
    s_cselect_b32 s58, 10, 0
    v_mfma_f32_16x16x32_bf16 v[92:95], v[124:127], v[192:195], v[92:95]
    s_sub_u32 s57, s57, s58
    s_lshl_b32 s57, s57, 6
    v_mfma_f32_16x16x32_bf16 v[96:99], v[128:131], a[56:59], v[96:99]
    s_add_u32 s56, s56, s57
    s_mul_i32 s56, s56, 3072
    v_mfma_f32_16x16x32_bf16 v[100:103], v[128:131], a[136:139], v[100:103]
    s_lshl_b32 s57, s68, 1
    s_add_u32 s56, s56, s57
    v_mfma_f32_16x16x32_bf16 v[104:107], v[128:131], a[216:219], v[104:107]
    buffer_load_dwordx4 v21, s[16:19], s56 offen offset:0 lds
    buffer_load_dwordx4 v22, s[16:19], s56 offen offset:1024 lds
    v_mfma_f32_16x16x32_bf16 v[108:111], v[128:131], v[192:195], v[108:111]
    buffer_load_dwordx4 v23, s[16:19], s56 offen offset:2048 lds
    s_cmp_lg_u32 s48, 0
    s_cbranch_scc1 L_cs_46
    v_dot2_f32_bf16 v248, v112, s78, v248
    v_dot2_f32_bf16 v249, v116, s78, v249
    v_dot2_f32_bf16 v250, v120, s78, v250
    v_dot2_f32_bf16 v251, v124, s78, v251
    v_dot2_f32_bf16 v252, v128, s78, v252
    v_dot2_f32_bf16 v248, v113, s78, v248
    v_dot2_f32_bf16 v249, v117, s78, v249
    v_dot2_f32_bf16 v250, v121, s78, v250
    v_dot2_f32_bf16 v251, v125, s78, v251
    v_dot2_f32_bf16 v252, v129, s78, v252
    v_dot2_f32_bf16 v248, v114, s78, v248
    v_dot2_f32_bf16 v249, v118, s78, v249
    v_dot2_f32_bf16 v250, v122, s78, v250
    v_dot2_f32_bf16 v251, v126, s78, v251
    v_dot2_f32_bf16 v252, v130, s78, v252
    v_dot2_f32_bf16 v248, v115, s78, v248
    v_dot2_f32_bf16 v249, v119, s78, v249
    v_dot2_f32_bf16 v250, v123, s78, v250
    v_dot2_f32_bf16 v251, v127, s78, v251
    v_dot2_f32_bf16 v252, v131, s78, v252
L_cs_46:
    s_waitcnt lgkmcnt(0)
    s_waitcnt vmcnt(12)
    s_barrier
    s_lshl_b32 s88, s46, 11
    s_add_u32 s88, s88, 163840
    v_and_b32 v242, 15, v0
    v_lshlrev_b32 v242, 7, v242
    v_add_u32 v242, s88, v242
    s_mov_b32 exec_lo, 0xffff
    s_mov_b32 exec_hi, 0x0
    buffer_load_dwordx2 v[240:241], v242, s[24:27], 0 offen sc1
    s_mov_b64 exec, -1
    v_mfma_f32_16x16x32_bf16 v[32:35], v[132:135], a[60:63], v[32:35]
    ds_read_b64_tr_b16 v[112:113], v15 offset:0
    buffer_load_dwordx4 v24, s[16:19], s56 offen offset:3072 lds
    v_mfma_f32_16x16x32_bf16 v[36:39], v[132:135], a[140:143], v[36:39]
    ds_read_b64_tr_b16 v[114:115], v15 offset:1280
    s_mul_i32 s55, s40, 8192
    v_mfma_f32_16x16x32_bf16 v[40:43], v[132:135], a[220:223], v[40:43]
    ds_read_b128 a[64:67], v13 offset:0
    s_add_u32 m0, s55, 77824
    v_mfma_f32_16x16x32_bf16 v[44:47], v[132:135], v[196:199], v[44:47]
    ds_read_b128 a[144:147], v13 offset:2048
    s_mul_i32 s56, s40, 128
    v_mfma_f32_16x16x32_bf16 v[48:51], v[136:139], a[60:63], v[48:51]
    ds_read_b128 a[224:227], v13 offset:4096
    s_add_u32 s56, s56, 64
    v_mfma_f32_16x16x32_bf16 v[52:55], v[136:139], a[140:143], v[52:55]
    ds_read_b128 v[200:203], v13 offset:6144
    s_lshr_b32 s57, s56, 6
    v_mfma_f32_16x16x32_bf16 v[56:59], v[136:139], a[220:223], v[56:59]
    ds_read_b64_tr_b16 v[116:117], v16 offset:32
    s_and_b32 s56, s56, 63
    v_mfma_f32_16x16x32_bf16 v[60:63], v[136:139], v[196:199], v[60:63]
    ds_read_b64_tr_b16 v[118:119], v16 offset:1312
    s_add_u32 s57, s57, s82
    v_mfma_f32_16x16x32_bf16 v[64:67], v[140:143], a[60:63], v[64:67]
    ds_read_b64_tr_b16 v[120:121], v15 offset:64
    v_mfma_f32_16x16x32_bf16 v[68:71], v[140:143], a[140:143], v[68:71]
    ds_read_b64_tr_b16 v[122:123], v15 offset:1344
    v_mfma_f32_16x16x32_bf16 v[72:75], v[140:143], a[220:223], v[72:75]
    ds_read_b64_tr_b16 v[124:125], v16 offset:96
    v_mfma_f32_16x16x32_bf16 v[76:79], v[140:143], v[196:199], v[76:79]
    ds_read_b64_tr_b16 v[126:127], v16 offset:1376
    v_mfma_f32_16x16x32_bf16 v[80:83], v[144:147], a[60:63], v[80:83]
    ds_read_b64_tr_b16 v[128:129], v15 offset:128
    v_mfma_f32_16x16x32_bf16 v[84:87], v[144:147], a[140:143], v[84:87]
    ds_read_b64_tr_b16 v[130:131], v15 offset:1408
    v_mfma_f32_16x16x32_bf16 v[88:91], v[144:147], a[220:223], v[88:91]
    s_cmp_ge_u32 s57, 10
    s_cselect_b32 s58, 10, 0
    v_mfma_f32_16x16x32_bf16 v[92:95], v[144:147], v[196:199], v[92:95]
    s_sub_u32 s57, s57, s58
    s_lshl_b32 s57, s57, 6
    v_mfma_f32_16x16x32_bf16 v[96:99], v[148:151], a[60:63], v[96:99]
    s_add_u32 s56, s56, s57
    s_mul_i32 s56, s56, 3072
    v_mfma_f32_16x16x32_bf16 v[100:103], v[148:151], a[140:143], v[100:103]
    s_lshl_b32 s57, s68, 1
    s_add_u32 s56, s56, s57
    v_mfma_f32_16x16x32_bf16 v[104:107], v[148:151], a[220:223], v[104:107]
    buffer_load_dwordx4 v21, s[16:19], s56 offen offset:0 lds
    buffer_load_dwordx4 v22, s[16:19], s56 offen offset:1024 lds
    v_mfma_f32_16x16x32_bf16 v[108:111], v[148:151], v[196:199], v[108:111]
    buffer_load_dwordx4 v23, s[16:19], s56 offen offset:2048 lds
    buffer_load_dwordx4 v24, s[16:19], s56 offen offset:3072 lds
    s_cmp_lg_u32 s48, 1
    s_cbranch_scc1 L_cs_47
    v_dot2_f32_bf16 v248, v132, s78, v248
    v_dot2_f32_bf16 v249, v136, s78, v249
    v_dot2_f32_bf16 v250, v140, s78, v250
    v_dot2_f32_bf16 v251, v144, s78, v251
    v_dot2_f32_bf16 v252, v148, s78, v252
    v_dot2_f32_bf16 v248, v133, s78, v248
    v_dot2_f32_bf16 v249, v137, s78, v249
    v_dot2_f32_bf16 v250, v141, s78, v250
    v_dot2_f32_bf16 v251, v145, s78, v251
    v_dot2_f32_bf16 v252, v149, s78, v252
    v_dot2_f32_bf16 v248, v134, s78, v248
    v_dot2_f32_bf16 v249, v138, s78, v249
    v_dot2_f32_bf16 v250, v142, s78, v250
    v_dot2_f32_bf16 v251, v146, s78, v251
    v_dot2_f32_bf16 v252, v150, s78, v252
    v_dot2_f32_bf16 v248, v135, s78, v248
    v_dot2_f32_bf16 v249, v139, s78, v249
    v_dot2_f32_bf16 v250, v143, s78, v250
    v_dot2_f32_bf16 v251, v147, s78, v251
    v_dot2_f32_bf16 v252, v151, s78, v252
L_cs_47:
    s_waitcnt lgkmcnt(0)
    v_mfma_f32_16x16x32_bf16 v[32:35], v[112:115], a[64:67], v[32:35]
    ds_read_b64_tr_b16 v[132:133], v15 offset:10240
    s_mul_i32 s55, s40, 2048
    v_mfma_f32_16x16x32_bf16 v[36:39], v[112:115], a[144:147], v[36:39]
    ds_read_b64_tr_b16 v[134:135], v15 offset:11520
    s_add_u32 m0, s55, 110592
    v_mfma_f32_16x16x32_bf16 v[40:43], v[112:115], a[224:227], v[40:43]
    ds_read_b128 a[68:71], v14 offset:0
    s_mul_i32 s56, s40, 32
    v_mfma_f32_16x16x32_bf16 v[44:47], v[112:115], v[200:203], v[44:47]
    ds_read_b128 a[148:151], v14 offset:2048
    s_add_u32 s56, s56, 512
    v_mfma_f32_16x16x32_bf16 v[48:51], v[116:119], a[64:67], v[48:51]
    ds_read_b128 a[228:231], v14 offset:4096
    s_lshr_b32 s57, s56, 6
    v_mfma_f32_16x16x32_bf16 v[52:55], v[116:119], a[144:147], v[52:55]
    ds_read_b128 v[204:207], v14 offset:6144
    s_and_b32 s56, s56, 63
    v_mfma_f32_16x16x32_bf16 v[56:59], v[116:119], a[224:227], v[56:59]
    ds_read_b64_tr_b16 v[136:137], v16 offset:10272
    s_add_u32 s57, s57, s82
    v_mfma_f32_16x16x32_bf16 v[60:63], v[116:119], v[200:203], v[60:63]
    ds_read_b64_tr_b16 v[138:139], v16 offset:11552
    v_mfma_f32_16x16x32_bf16 v[64:67], v[120:123], a[64:67], v[64:67]
    ds_read_b64_tr_b16 v[140:141], v15 offset:10304
    v_mfma_f32_16x16x32_bf16 v[68:71], v[120:123], a[144:147], v[68:71]
    ds_read_b64_tr_b16 v[142:143], v15 offset:11584
    v_mfma_f32_16x16x32_bf16 v[72:75], v[120:123], a[224:227], v[72:75]
    ds_read_b64_tr_b16 v[144:145], v16 offset:10336
    v_mfma_f32_16x16x32_bf16 v[76:79], v[120:123], v[200:203], v[76:79]
    ds_read_b64_tr_b16 v[146:147], v16 offset:11616
    v_mfma_f32_16x16x32_bf16 v[80:83], v[124:127], a[64:67], v[80:83]
    ds_read_b64_tr_b16 v[148:149], v15 offset:10368
    v_mfma_f32_16x16x32_bf16 v[84:87], v[124:127], a[144:147], v[84:87]
    ds_read_b64_tr_b16 v[150:151], v15 offset:11648
    v_mfma_f32_16x16x32_bf16 v[88:91], v[124:127], a[224:227], v[88:91]
    s_cmp_ge_u32 s57, 10
    s_cselect_b32 s58, 10, 0
    v_mfma_f32_16x16x32_bf16 v[92:95], v[124:127], v[200:203], v[92:95]
    s_sub_u32 s57, s57, s58
    s_lshl_b32 s57, s57, 6
    v_mfma_f32_16x16x32_bf16 v[96:99], v[128:131], a[64:67], v[96:99]
    s_add_u32 s56, s56, s57
    s_mul_i32 s56, s56, 3072
    v_mfma_f32_16x16x32_bf16 v[100:103], v[128:131], a[144:147], v[100:103]
    s_lshl_b32 s57, s68, 1
    s_add_u32 s56, s56, s57
    v_mfma_f32_16x16x32_bf16 v[104:107], v[128:131], a[224:227], v[104:107]
    buffer_load_dwordx4 v21, s[16:19], s56 offen offset:0 lds
    buffer_load_dwordx4 v22, s[16:19], s56 offen offset:1024 lds
    v_mfma_f32_16x16x32_bf16 v[108:111], v[128:131], v[200:203], v[108:111]
    s_cmp_lg_u32 s48, 0
    s_cbranch_scc1 L_cs_48
    v_dot2_f32_bf16 v248, v112, s78, v248
    v_dot2_f32_bf16 v249, v116, s78, v249
    v_dot2_f32_bf16 v250, v120, s78, v250
    v_dot2_f32_bf16 v251, v124, s78, v251
    v_dot2_f32_bf16 v252, v128, s78, v252
    v_dot2_f32_bf16 v248, v113, s78, v248
    v_dot2_f32_bf16 v249, v117, s78, v249
    v_dot2_f32_bf16 v250, v121, s78, v250
    v_dot2_f32_bf16 v251, v125, s78, v251
    v_dot2_f32_bf16 v252, v129, s78, v252
    v_dot2_f32_bf16 v248, v114, s78, v248
    v_dot2_f32_bf16 v249, v118, s78, v249
    v_dot2_f32_bf16 v250, v122, s78, v250
    v_dot2_f32_bf16 v251, v126, s78, v251
    v_dot2_f32_bf16 v252, v130, s78, v252
    v_dot2_f32_bf16 v248, v115, s78, v248
    v_dot2_f32_bf16 v249, v119, s78, v249
    v_dot2_f32_bf16 v250, v123, s78, v250
    v_dot2_f32_bf16 v251, v127, s78, v251
    v_dot2_f32_bf16 v252, v131, s78, v252
L_cs_48:
    s_waitcnt lgkmcnt(0)
    s_waitcnt vmcnt(11)
    s_barrier
    v_mfma_f32_16x16x32_bf16 v[32:35], v[132:135], a[68:71], v[32:35]
    ds_read_b64_tr_b16 v[112:113], v15 offset:36864
    v_mfma_f32_16x16x32_bf16 v[36:39], v[132:135], a[148:151], v[36:39]
    ds_read_b64_tr_b16 v[114:115], v15 offset:38144
    v_mfma_f32_16x16x32_bf16 v[40:43], v[132:135], a[228:231], v[40:43]
    ds_read_b128 a[72:75], v13 offset:36864
    v_mfma_f32_16x16x32_bf16 v[44:47], v[132:135], v[204:207], v[44:47]
    ds_read_b128 a[152:155], v13 offset:38912
    v_mfma_f32_16x16x32_bf16 v[48:51], v[136:139], a[68:71], v[48:51]
    ds_read_b128 a[232:235], v13 offset:40960
    v_mfma_f32_16x16x32_bf16 v[52:55], v[136:139], a[148:151], v[52:55]
    ds_read_b128 v[208:211], v13 offset:43008
    v_mfma_f32_16x16x32_bf16 v[56:59], v[136:139], a[228:231], v[56:59]
    ds_read_b64_tr_b16 v[116:117], v16 offset:36896
    v_mfma_f32_16x16x32_bf16 v[60:63], v[136:139], v[204:207], v[60:63]
    ds_read_b64_tr_b16 v[118:119], v16 offset:38176
    v_mfma_f32_16x16x32_bf16 v[64:67], v[140:143], a[68:71], v[64:67]
    ds_read_b64_tr_b16 v[120:121], v15 offset:36928
    v_mfma_f32_16x16x32_bf16 v[68:71], v[140:143], a[148:151], v[68:71]
    ds_read_b64_tr_b16 v[122:123], v15 offset:38208
    v_mfma_f32_16x16x32_bf16 v[72:75], v[140:143], a[228:231], v[72:75]
    ds_read_b64_tr_b16 v[124:125], v16 offset:36960
    v_mfma_f32_16x16x32_bf16 v[76:79], v[140:143], v[204:207], v[76:79]
    ds_read_b64_tr_b16 v[126:127], v16 offset:38240
    v_mfma_f32_16x16x32_bf16 v[80:83], v[144:147], a[68:71], v[80:83]
    ds_read_b64_tr_b16 v[128:129], v15 offset:36992
    v_mfma_f32_16x16x32_bf16 v[84:87], v[144:147], a[148:151], v[84:87]
    ds_read_b64_tr_b16 v[130:131], v15 offset:38272
    v_mfma_f32_16x16x32_bf16 v[88:91], v[144:147], a[228:231], v[88:91]
    v_mfma_f32_16x16x32_bf16 v[92:95], v[144:147], v[204:207], v[92:95]
    v_mfma_f32_16x16x32_bf16 v[96:99], v[148:151], a[68:71], v[96:99]
    v_mfma_f32_16x16x32_bf16 v[100:103], v[148:151], a[148:151], v[100:103]
    v_mfma_f32_16x16x32_bf16 v[104:107], v[148:151], a[228:231], v[104:107]
    v_mfma_f32_16x16x32_bf16 v[108:111], v[148:151], v[204:207], v[108:111]
    s_cmp_lg_u32 s48, 1
    s_cbranch_scc1 L_cs_49
    v_dot2_f32_bf16 v248, v132, s78, v248
    v_dot2_f32_bf16 v249, v136, s78, v249
    v_dot2_f32_bf16 v250, v140, s78, v250
    v_dot2_f32_bf16 v251, v144, s78, v251
    v_dot2_f32_bf16 v252, v148, s78, v252
    v_dot2_f32_bf16 v248, v133, s78, v248
    v_dot2_f32_bf16 v249, v137, s78, v249
    v_dot2_f32_bf16 v250, v141, s78, v250
    v_dot2_f32_bf16 v251, v145, s78, v251
    v_dot2_f32_bf16 v252, v149, s78, v252
    v_dot2_f32_bf16 v248, v134, s78, v248
    v_dot2_f32_bf16 v249, v138, s78, v249
    v_dot2_f32_bf16 v250, v142, s78, v250
    v_dot2_f32_bf16 v251, v146, s78, v251
    v_dot2_f32_bf16 v252, v150, s78, v252
    v_dot2_f32_bf16 v248, v135, s78, v248
    v_dot2_f32_bf16 v249, v139, s78, v249
    v_dot2_f32_bf16 v250, v143, s78, v250
    v_dot2_f32_bf16 v251, v147, s78, v251
    v_dot2_f32_bf16 v252, v151, s78, v252
L_cs_49:
    s_waitcnt lgkmcnt(0)
    v_mfma_f32_16x16x32_bf16 v[32:35], v[112:115], a[72:75], v[32:35]
    ds_read_b64_tr_b16 v[132:133], v15 offset:47104
    v_mfma_f32_16x16x32_bf16 v[36:39], v[112:115], a[152:155], v[36:39]
    ds_read_b64_tr_b16 v[134:135], v15 offset:48384
    v_mfma_f32_16x16x32_bf16 v[40:43], v[112:115], a[232:235], v[40:43]
    ds_read_b128 a[76:79], v14 offset:36864
    v_mfma_f32_16x16x32_bf16 v[44:47], v[112:115], v[208:211], v[44:47]
    ds_read_b128 a[156:159], v14 offset:38912
    v_mfma_f32_16x16x32_bf16 v[48:51], v[116:119], a[72:75], v[48:51]
    ds_read_b128 a[236:239], v14 offset:40960
    v_mfma_f32_16x16x32_bf16 v[52:55], v[116:119], a[152:155], v[52:55]
    ds_read_b128 v[212:215], v14 offset:43008
    v_mfma_f32_16x16x32_bf16 v[56:59], v[116:119], a[232:235], v[56:59]
    ds_read_b64_tr_b16 v[136:137], v16 offset:47136
    v_mfma_f32_16x16x32_bf16 v[60:63], v[116:119], v[208:211], v[60:63]
    ds_read_b64_tr_b16 v[138:139], v16 offset:48416
    v_mfma_f32_16x16x32_bf16 v[64:67], v[120:123], a[72:75], v[64:67]
    ds_read_b64_tr_b16 v[140:141], v15 offset:47168
    v_mfma_f32_16x16x32_bf16 v[68:71], v[120:123], a[152:155], v[68:71]
    ds_read_b64_tr_b16 v[142:143], v15 offset:48448
    v_mfma_f32_16x16x32_bf16 v[72:75], v[120:123], a[232:235], v[72:75]
    ds_read_b64_tr_b16 v[144:145], v16 offset:47200
    v_mfma_f32_16x16x32_bf16 v[76:79], v[120:123], v[208:211], v[76:79]
    ds_read_b64_tr_b16 v[146:147], v16 offset:48480
    v_mfma_f32_16x16x32_bf16 v[80:83], v[124:127], a[72:75], v[80:83]
    ds_read_b64_tr_b16 v[148:149], v15 offset:47232
    v_mfma_f32_16x16x32_bf16 v[84:87], v[124:127], a[152:155], v[84:87]
    ds_read_b64_tr_b16 v[150:151], v15 offset:48512
    v_mfma_f32_16x16x32_bf16 v[88:91], v[124:127], a[232:235], v[88:91]
    v_mfma_f32_16x16x32_bf16 v[92:95], v[124:127], v[208:211], v[92:95]
    v_mfma_f32_16x16x32_bf16 v[96:99], v[128:131], a[72:75], v[96:99]
    v_mfma_f32_16x16x32_bf16 v[100:103], v[128:131], a[152:155], v[100:103]
    v_mfma_f32_16x16x32_bf16 v[104:107], v[128:131], a[232:235], v[104:107]
    v_mfma_f32_16x16x32_bf16 v[108:111], v[128:131], v[208:211], v[108:111]
    s_cmp_lg_u32 s48, 0
    s_cbranch_scc1 L_cs_50
    v_dot2_f32_bf16 v248, v112, s78, v248
    v_dot2_f32_bf16 v249, v116, s78, v249
    v_dot2_f32_bf16 v250, v120, s78, v250
    v_dot2_f32_bf16 v251, v124, s78, v251
    v_dot2_f32_bf16 v252, v128, s78, v252
    v_dot2_f32_bf16 v248, v113, s78, v248
    v_dot2_f32_bf16 v249, v117, s78, v249
    v_dot2_f32_bf16 v250, v121, s78, v250
    v_dot2_f32_bf16 v251, v125, s78, v251
    v_dot2_f32_bf16 v252, v129, s78, v252
    v_dot2_f32_bf16 v248, v114, s78, v248
    v_dot2_f32_bf16 v249, v118, s78, v249
    v_dot2_f32_bf16 v250, v122, s78, v250
    v_dot2_f32_bf16 v251, v126, s78, v251
    v_dot2_f32_bf16 v252, v130, s78, v252
    v_dot2_f32_bf16 v248, v115, s78, v248
    v_dot2_f32_bf16 v249, v119, s78, v249
    v_dot2_f32_bf16 v250, v123, s78, v250
    v_dot2_f32_bf16 v251, v127, s78, v251
    v_dot2_f32_bf16 v252, v131, s78, v252
L_cs_50:
    s_waitcnt lgkmcnt(0)
    v_mfma_f32_16x16x32_bf16 v[32:35], v[132:135], a[76:79], v[32:35]
    v_mfma_f32_16x16x32_bf16 v[36:39], v[132:135], a[156:159], v[36:39]
    v_mfma_f32_16x16x32_bf16 v[40:43], v[132:135], a[236:239], v[40:43]
    v_mfma_f32_16x16x32_bf16 v[44:47], v[132:135], v[212:215], v[44:47]
    v_mfma_f32_16x16x32_bf16 v[48:51], v[136:139], a[76:79], v[48:51]
    v_mfma_f32_16x16x32_bf16 v[52:55], v[136:139], a[156:159], v[52:55]
    v_mfma_f32_16x16x32_bf16 v[56:59], v[136:139], a[236:239], v[56:59]
    v_mfma_f32_16x16x32_bf16 v[60:63], v[136:139], v[212:215], v[60:63]
    v_mfma_f32_16x16x32_bf16 v[64:67], v[140:143], a[76:79], v[64:67]
    v_mfma_f32_16x16x32_bf16 v[68:71], v[140:143], a[156:159], v[68:71]
    v_mfma_f32_16x16x32_bf16 v[72:75], v[140:143], a[236:239], v[72:75]
    v_mfma_f32_16x16x32_bf16 v[76:79], v[140:143], v[212:215], v[76:79]
    v_mfma_f32_16x16x32_bf16 v[80:83], v[144:147], a[76:79], v[80:83]
    v_mfma_f32_16x16x32_bf16 v[84:87], v[144:147], a[156:159], v[84:87]
    v_mfma_f32_16x16x32_bf16 v[88:91], v[144:147], a[236:239], v[88:91]
    v_mfma_f32_16x16x32_bf16 v[92:95], v[144:147], v[212:215], v[92:95]
    v_mfma_f32_16x16x32_bf16 v[96:99], v[148:151], a[76:79], v[96:99]
    v_mfma_f32_16x16x32_bf16 v[100:103], v[148:151], a[156:159], v[100:103]
    v_mfma_f32_16x16x32_bf16 v[104:107], v[148:151], a[236:239], v[104:107]
    v_mfma_f32_16x16x32_bf16 v[108:111], v[148:151], v[212:215], v[108:111]
    s_cmp_lg_u32 s48, 1
    s_cbranch_scc1 L_cs_51
    v_dot2_f32_bf16 v248, v132, s78, v248
    v_dot2_f32_bf16 v249, v136, s78, v249
    v_dot2_f32_bf16 v250, v140, s78, v250
    v_dot2_f32_bf16 v251, v144, s78, v251
    v_dot2_f32_bf16 v252, v148, s78, v252
    v_dot2_f32_bf16 v248, v133, s78, v248
    v_dot2_f32_bf16 v249, v137, s78, v249
    v_dot2_f32_bf16 v250, v141, s78, v250
    v_dot2_f32_bf16 v251, v145, s78, v251
    v_dot2_f32_bf16 v252, v149, s78, v252
    v_dot2_f32_bf16 v248, v134, s78, v248
    v_dot2_f32_bf16 v249, v138, s78, v249
    v_dot2_f32_bf16 v250, v142, s78, v250
    v_dot2_f32_bf16 v251, v146, s78, v251
    v_dot2_f32_bf16 v252, v150, s78, v252
    v_dot2_f32_bf16 v248, v135, s78, v248
    v_dot2_f32_bf16 v249, v139, s78, v249
    v_dot2_f32_bf16 v250, v143, s78, v250
    v_dot2_f32_bf16 v251, v147, s78, v251
    v_dot2_f32_bf16 v252, v151, s78, v252
L_cs_51:
    s_mul_i32 s79, s49, 80
    s_add_u32 s79, s79, s52
    s_nop 7
    s_waitcnt vmcnt(7)
    s_mov_b32 exec_lo, 0xffff
    s_mov_b32 exec_hi, 0x0
    v_xor_b32 v240, s2, v240
    v_xor_b32 v241, s3, v241
    v_or_b32 v240, v240, v241
    v_cmp_ne_u32 vcc, 0, v240
    s_mov_b64 exec, -1
    s_cmp_eq_u64 vcc, 0
    s_cbranch_scc1 L_pollok_52
    s_mov_b32 exec_lo, 0xffff
    s_mov_b32 exec_hi, 0x0
    s_mov_b32 s84, 1048576
L_poll_53:
    buffer_load_dwordx2 v[240:241], v242, s[24:27], 0 offen sc1
    s_waitcnt vmcnt(0)
    v_xor_b32 v240, s2, v240
    v_xor_b32 v241, s3, v241
    v_or_b32 v240, v240, v241
    v_cmp_ne_u32 vcc, 0, v240
    s_cmp_eq_u64 vcc, 0
    s_cbranch_scc1 L_polled_54
    s_sub_u32 s84, s84, 1
    s_cmp_eq_u32 s84, 0
    s_cbranch_scc1 L_polltmo_55
    s_sleep 2
    s_branch L_poll_53
L_polltmo_55:
    v_mov_b32 v240, 225
    v_mov_b32 v241, 252
    global_store_dword v241, v240, s[38:39]
L_polled_54:
    s_mov_b64 exec, -1
L_pollok_52:
    s_lshl_b32 s55, s48, 6
    s_add_u32 s55, s55, s50
    v_add_u32 v216, s55, v2
    v_lshlrev_b32 v216, 4, v216
    buffer_load_dwordx4 v[112:115], v216, s[24:27], 0 offen offset:0 sc1
    buffer_load_dwordx4 v[116:119], v216, s[24:27], 0 offen offset:256 sc1
    buffer_load_dwordx4 v[120:123], v216, s[24:27], 0 offen offset:512 sc1
    buffer_load_dwordx4 v[124:127], v216, s[24:27], 0 offen offset:768 sc1
    v_lshlrev_b32 v217, 3, v3
    s_lshl_b32 s56, s79, 1
    v_add_u32 v217, s56, v217
    global_load_dwordx2 v[128:129], v217, s[32:33] offset:0
    global_load_dwordx2 v[130:131], v217, s[32:33] offset:32
    global_load_dwordx2 v[132:133], v217, s[32:33] offset:64
    global_load_dwordx2 v[134:135], v217, s[32:33] offset:96
    global_load_dwordx2 v[136:137], v217, s[32:33] offset:128
    s_nop 2
    v_mov_b32 v218, v248
    s_nop 1
    v_permlane32_swap_b32 v218, v248
    v_add_f32 v248, v248, v218
    v_mov_b32 v218, v248
    s_nop 1
    v_permlane16_swap_b32 v218, v248
    v_add_f32 v248, v248, v218
    v_mov_b32 v218, v249
    s_nop 1
    v_permlane32_swap_b32 v218, v249
    v_add_f32 v249, v249, v218
    v_mov_b32 v218, v249
    s_nop 1
    v_permlane16_swap_b32 v218, v249
    v_add_f32 v249, v249, v218
    v_mov_b32 v218, v250
    s_nop 1
    v_permlane32_swap_b32 v218, v250
    v_add_f32 v250, v250, v218
    v_mov_b32 v218, v250
    s_nop 1
    v_permlane16_swap_b32 v218, v250
    v_add_f32 v250, v250, v218
    v_mov_b32 v218, v251
    s_nop 1
    v_permlane32_swap_b32 v218, v251
    v_add_f32 v251, v251, v218
    v_mov_b32 v218, v251
    s_nop 1
    v_permlane16_swap_b32 v218, v251
    v_add_f32 v251, v251, v218
    v_mov_b32 v218, v252
    s_nop 1
    v_permlane32_swap_b32 v218, v252
    v_add_f32 v252, v252, v218
    v_mov_b32 v218, v252
    s_nop 1
    v_permlane16_swap_b32 v218, v252
    v_add_f32 v252, v252, v218
    s_mul_i32 s55, s40, 320
    s_add_u32 s55, s55, 150016
    v_lshl_add_u32 v218, v2, 2, s55
    ds_write_b32 v218, v248 offset:0
    ds_write_b32 v218, v249 offset:64
    ds_write_b32 v218, v250 offset:128
    ds_write_b32 v218, v251 offset:192
    ds_write_b32 v218, v252 offset:256
    s_waitcnt lgkmcnt(0)
    s_barrier
    s_mul_i32 s55, s49, 640
    s_add_u32 s55, s55, 150016
    v_lshl_add_u32 v217, v3, 4, s55
    s_waitcnt vmcnt(0)
    s_cmp_eq_u32 s49, 1
    s_cbranch_scc1 L_cc1_56
    v_mov_b32 v242, 0xc0135761
    v_mov_b32 v243, 0xc0135761
    v_mov_b32 v244, 0xbdd2d3e8
    v_mov_b32 v245, 0xbdd2d3e8
    s_mov_b32 s74, 1.0
    s_mov_b32 s75, 1.0
    s_lshr_b32 s56, s50, 4
    s_lshl_b32 s57, s48, 2
    s_add_u32 s56, s56, s57
    s_mul_i32 s56, s56, 49152
    s_add_u32 s72, s56, 10485760
    v_lshlrev_b32 v246, 4, v1
    ds_read_b128 v[140:143], v217 offset:0
    ds_read_b128 v[144:147], v217 offset:320
    s_waitcnt lgkmcnt(0)
    v_pk_add_f32 v[140:141], v[140:141], v[144:145]
    v_pk_add_f32 v[142:143], v[142:143], v[146:147]
    v_lshlrev_b32 v218, 16, v128
    v_and_b32 v219, 0xffff0000, v128
    v_lshlrev_b32 v220, 16, v129
    v_and_b32 v221, 0xffff0000, v129
    v_pk_fma_f32 v[32:33], v[140:141], v[112:113], v[32:33] op_sel_hi:[1,0,1] neg_lo:[1,0,0] neg_hi:[1,0,0]
    v_pk_fma_f32 v[32:33], v[32:33], v[112:113], v[218:219] op_sel:[0,1,0] op_sel_hi:[1,1,1]
    v_pk_mul_f32 v[222:223], v[32:33], v[32:33]
    v_pk_fma_f32 v[222:223], v[222:223], v[244:245], v[242:243]
    v_pk_mul_f32 v[222:223], v[222:223], v[32:33]
    v_pk_fma_f32 v[34:35], v[142:143], v[112:113], v[34:35] op_sel_hi:[1,0,1] neg_lo:[1,0,0] neg_hi:[1,0,0]
    v_pk_fma_f32 v[34:35], v[34:35], v[112:113], v[220:221] op_sel:[0,1,0] op_sel_hi:[1,1,1]
    v_pk_mul_f32 v[224:225], v[34:35], v[34:35]
    v_pk_fma_f32 v[224:225], v[224:225], v[244:245], v[242:243]
    v_pk_mul_f32 v[224:225], v[224:225], v[34:35]
    v_exp_f32 v222, v222
    v_exp_f32 v223, v223
    v_exp_f32 v224, v224
    v_exp_f32 v225, v225
    v_pk_add_f32 v[222:223], v[222:223], s[74:75]
    v_pk_mul_f32 v[32:33], v[32:33], v[114:115] op_sel:[0,1] op_sel_hi:[1,1]
    v_pk_add_f32 v[224:225], v[224:225], s[74:75]
    v_pk_mul_f32 v[34:35], v[34:35], v[114:115] op_sel:[0,1] op_sel_hi:[1,1]
    v_rcp_f32 v222, v222
    v_rcp_f32 v223, v223
    v_rcp_f32 v224, v224
    v_rcp_f32 v225, v225
    s_nop 0
    v_pk_mul_f32 v[32:33], v[32:33], v[222:223]
    v_pk_mul_f32 v[34:35], v[34:35], v[224:225]
    v_cvt_pk_bf16_f32 v226, v32, v33
    v_cvt_pk_bf16_f32 v227, v34, v35
    v_pk_fma_f32 v[36:37], v[140:141], v[116:117], v[36:37] op_sel_hi:[1,0,1] neg_lo:[1,0,0] neg_hi:[1,0,0]
    v_pk_fma_f32 v[36:37], v[36:37], v[116:117], v[218:219] op_sel:[0,1,0] op_sel_hi:[1,1,1]
    v_pk_mul_f32 v[222:223], v[36:37], v[36:37]
    v_pk_fma_f32 v[222:223], v[222:223], v[244:245], v[242:243]
    v_pk_mul_f32 v[222:223], v[222:223], v[36:37]
    v_pk_fma_f32 v[38:39], v[142:143], v[116:117], v[38:39] op_sel_hi:[1,0,1] neg_lo:[1,0,0] neg_hi:[1,0,0]
    v_pk_fma_f32 v[38:39], v[38:39], v[116:117], v[220:221] op_sel:[0,1,0] op_sel_hi:[1,1,1]
    v_pk_mul_f32 v[224:225], v[38:39], v[38:39]
    v_pk_fma_f32 v[224:225], v[224:225], v[244:245], v[242:243]
    v_pk_mul_f32 v[224:225], v[224:225], v[38:39]
    v_exp_f32 v222, v222
    v_exp_f32 v223, v223
    v_exp_f32 v224, v224
    v_exp_f32 v225, v225
    v_pk_add_f32 v[222:223], v[222:223], s[74:75]
    v_pk_mul_f32 v[36:37], v[36:37], v[118:119] op_sel:[0,1] op_sel_hi:[1,1]
    v_pk_add_f32 v[224:225], v[224:225], s[74:75]
    v_pk_mul_f32 v[38:39], v[38:39], v[118:119] op_sel:[0,1] op_sel_hi:[1,1]
    v_rcp_f32 v222, v222
    v_rcp_f32 v223, v223
    v_rcp_f32 v224, v224
    v_rcp_f32 v225, v225
    s_nop 0
    v_pk_mul_f32 v[36:37], v[36:37], v[222:223]
    v_pk_mul_f32 v[38:39], v[38:39], v[224:225]
    v_cvt_pk_bf16_f32 v230, v36, v37
    v_cvt_pk_bf16_f32 v231, v38, v39
    v_pk_fma_f32 v[40:41], v[140:141], v[120:121], v[40:41] op_sel_hi:[1,0,1] neg_lo:[1,0,0] neg_hi:[1,0,0]
    v_pk_fma_f32 v[40:41], v[40:41], v[120:121], v[218:219] op_sel:[0,1,0] op_sel_hi:[1,1,1]
    v_pk_mul_f32 v[222:223], v[40:41], v[40:41]
    v_pk_fma_f32 v[222:223], v[222:223], v[244:245], v[242:243]
    v_pk_mul_f32 v[222:223], v[222:223], v[40:41]
    v_pk_fma_f32 v[42:43], v[142:143], v[120:121], v[42:43] op_sel_hi:[1,0,1] neg_lo:[1,0,0] neg_hi:[1,0,0]
    v_pk_fma_f32 v[42:43], v[42:43], v[120:121], v[220:221] op_sel:[0,1,0] op_sel_hi:[1,1,1]
    v_pk_mul_f32 v[224:225], v[42:43], v[42:43]
    v_pk_fma_f32 v[224:225], v[224:225], v[244:245], v[242:243]
    v_pk_mul_f32 v[224:225], v[224:225], v[42:43]
    v_exp_f32 v222, v222
    v_exp_f32 v223, v223
    v_exp_f32 v224, v224
    v_exp_f32 v225, v225
    v_pk_add_f32 v[222:223], v[222:223], s[74:75]
    v_pk_mul_f32 v[40:41], v[40:41], v[122:123] op_sel:[0,1] op_sel_hi:[1,1]
    v_pk_add_f32 v[224:225], v[224:225], s[74:75]
    v_pk_mul_f32 v[42:43], v[42:43], v[122:123] op_sel:[0,1] op_sel_hi:[1,1]
    v_rcp_f32 v222, v222
    v_rcp_f32 v223, v223
    v_rcp_f32 v224, v224
    v_rcp_f32 v225, v225
    s_nop 0
    v_pk_mul_f32 v[40:41], v[40:41], v[222:223]
    v_pk_mul_f32 v[42:43], v[42:43], v[224:225]
    v_cvt_pk_bf16_f32 v234, v40, v41
    v_cvt_pk_bf16_f32 v235, v42, v43
    v_pk_fma_f32 v[44:45], v[140:141], v[124:125], v[44:45] op_sel_hi:[1,0,1] neg_lo:[1,0,0] neg_hi:[1,0,0]
    v_pk_fma_f32 v[44:45], v[44:45], v[124:125], v[218:219] op_sel:[0,1,0] op_sel_hi:[1,1,1]
    v_pk_mul_f32 v[222:223], v[44:45], v[44:45]
    v_pk_fma_f32 v[222:223], v[222:223], v[244:245], v[242:243]
    v_pk_mul_f32 v[222:223], v[222:223], v[44:45]
    v_pk_fma_f32 v[46:47], v[142:143], v[124:125], v[46:47] op_sel_hi:[1,0,1] neg_lo:[1,0,0] neg_hi:[1,0,0]
    v_pk_fma_f32 v[46:47], v[46:47], v[124:125], v[220:221] op_sel:[0,1,0] op_sel_hi:[1,1,1]
    v_pk_mul_f32 v[224:225], v[46:47], v[46:47]
    v_pk_fma_f32 v[224:225], v[224:225], v[244:245], v[242:243]
    v_pk_mul_f32 v[224:225], v[224:225], v[46:47]
    v_exp_f32 v222, v222
    v_exp_f32 v223, v223
    v_exp_f32 v224, v224
    v_exp_f32 v225, v225
    v_pk_add_f32 v[222:223], v[222:223], s[74:75]
    v_pk_mul_f32 v[44:45], v[44:45], v[126:127] op_sel:[0,1] op_sel_hi:[1,1]
    v_pk_add_f32 v[224:225], v[224:225], s[74:75]
    v_pk_mul_f32 v[46:47], v[46:47], v[126:127] op_sel:[0,1] op_sel_hi:[1,1]
    v_rcp_f32 v222, v222
    v_rcp_f32 v223, v223
    v_rcp_f32 v224, v224
    v_rcp_f32 v225, v225
    s_nop 0
    v_pk_mul_f32 v[44:45], v[44:45], v[222:223]
    v_pk_mul_f32 v[46:47], v[46:47], v[224:225]
    v_cvt_pk_bf16_f32 v238, v44, v45
    v_cvt_pk_bf16_f32 v239, v46, v47
    ds_read_b128 v[140:143], v217 offset:64
    ds_read_b128 v[144:147], v217 offset:384
    s_waitcnt lgkmcnt(0)
    v_pk_add_f32 v[140:141], v[140:141], v[144:145]
    v_pk_add_f32 v[142:143], v[142:143], v[146:147]
    v_lshlrev_b32 v218, 16, v130
    v_and_b32 v219, 0xffff0000, v130
    v_lshlrev_b32 v220, 16, v131
    v_and_b32 v221, 0xffff0000, v131
    v_pk_fma_f32 v[48:49], v[140:141], v[112:113], v[48:49] op_sel_hi:[1,0,1] neg_lo:[1,0,0] neg_hi:[1,0,0]
    v_pk_fma_f32 v[48:49], v[48:49], v[112:113], v[218:219] op_sel:[0,1,0] op_sel_hi:[1,1,1]
    v_pk_mul_f32 v[222:223], v[48:49], v[48:49]
    v_pk_fma_f32 v[222:223], v[222:223], v[244:245], v[242:243]
    v_pk_mul_f32 v[222:223], v[222:223], v[48:49]
    v_pk_fma_f32 v[50:51], v[142:143], v[112:113], v[50:51] op_sel_hi:[1,0,1] neg_lo:[1,0,0] neg_hi:[1,0,0]
    v_pk_fma_f32 v[50:51], v[50:51], v[112:113], v[220:221] op_sel:[0,1,0] op_sel_hi:[1,1,1]
    v_pk_mul_f32 v[224:225], v[50:51], v[50:51]
    v_pk_fma_f32 v[224:225], v[224:225], v[244:245], v[242:243]
    v_pk_mul_f32 v[224:225], v[224:225], v[50:51]
    v_exp_f32 v222, v222
    v_exp_f32 v223, v223
    v_exp_f32 v224, v224
    v_exp_f32 v225, v225
    v_pk_add_f32 v[222:223], v[222:223], s[74:75]
    v_pk_mul_f32 v[48:49], v[48:49], v[114:115] op_sel:[0,1] op_sel_hi:[1,1]
    v_pk_add_f32 v[224:225], v[224:225], s[74:75]
    v_pk_mul_f32 v[50:51], v[50:51], v[114:115] op_sel:[0,1] op_sel_hi:[1,1]
    v_rcp_f32 v222, v222
    v_rcp_f32 v223, v223
    v_rcp_f32 v224, v224
    v_rcp_f32 v225, v225
    s_nop 0
    v_pk_mul_f32 v[48:49], v[48:49], v[222:223]
    v_pk_mul_f32 v[50:51], v[50:51], v[224:225]
    v_cvt_pk_bf16_f32 v228, v48, v49
    v_cvt_pk_bf16_f32 v229, v50, v51
    s_lshr_b32 s56, s79, 4
    s_add_u32 s56, s56, 1
    s_lshr_b32 s56, s56, 1
    s_lshl_b32 s56, s56, 10
    s_add_u32 s56, s56, s72
    s_add_u32 s58, s56, 0
    buffer_store_dwordx4 v[226:229], v246, s[24:27], s58 offen sc1
    v_pk_fma_f32 v[52:53], v[140:141], v[116:117], v[52:53] op_sel_hi:[1,0,1] neg_lo:[1,0,0] neg_hi:[1,0,0]
    v_pk_fma_f32 v[52:53], v[52:53], v[116:117], v[218:219] op_sel:[0,1,0] op_sel_hi:[1,1,1]
    v_pk_mul_f32 v[222:223], v[52:53], v[52:53]
    v_pk_fma_f32 v[222:223], v[222:223], v[244:245], v[242:243]
    v_pk_mul_f32 v[222:223], v[222:223], v[52:53]
    v_pk_fma_f32 v[54:55], v[142:143], v[116:117], v[54:55] op_sel_hi:[1,0,1] neg_lo:[1,0,0] neg_hi:[1,0,0]
    v_pk_fma_f32 v[54:55], v[54:55], v[116:117], v[220:221] op_sel:[0,1,0] op_sel_hi:[1,1,1]
    v_pk_mul_f32 v[224:225], v[54:55], v[54:55]
    v_pk_fma_f32 v[224:225], v[224:225], v[244:245], v[242:243]
    v_pk_mul_f32 v[224:225], v[224:225], v[54:55]
    v_exp_f32 v222, v222
    v_exp_f32 v223, v223
    v_exp_f32 v224, v224
    v_exp_f32 v225, v225
    v_pk_add_f32 v[222:223], v[222:223], s[74:75]
    v_pk_mul_f32 v[52:53], v[52:53], v[118:119] op_sel:[0,1] op_sel_hi:[1,1]
    v_pk_add_f32 v[224:225], v[224:225], s[74:75]
    v_pk_mul_f32 v[54:55], v[54:55], v[118:119] op_sel:[0,1] op_sel_hi:[1,1]
    v_rcp_f32 v222, v222
    v_rcp_f32 v223, v223
    v_rcp_f32 v224, v224
    v_rcp_f32 v225, v225
    s_nop 0
    v_pk_mul_f32 v[52:53], v[52:53], v[222:223]
    v_pk_mul_f32 v[54:55], v[54:55], v[224:225]
    v_cvt_pk_bf16_f32 v232, v52, v53
    v_cvt_pk_bf16_f32 v233, v54, v55
    s_add_u32 s58, s56, 49152
    buffer_store_dwordx4 v[230:233], v246, s[24:27], s58 offen sc1
    v_pk_fma_f32 v[56:57], v[140:141], v[120:121], v[56:57] op_sel_hi:[1,0,1] neg_lo:[1,0,0] neg_hi:[1,0,0]
    v_pk_fma_f32 v[56:57], v[56:57], v[120:121], v[218:219] op_sel:[0,1,0] op_sel_hi:[1,1,1]
    v_pk_mul_f32 v[222:223], v[56:57], v[56:57]
    v_pk_fma_f32 v[222:223], v[222:223], v[244:245], v[242:243]
    v_pk_mul_f32 v[222:223], v[222:223], v[56:57]
    v_pk_fma_f32 v[58:59], v[142:143], v[120:121], v[58:59] op_sel_hi:[1,0,1] neg_lo:[1,0,0] neg_hi:[1,0,0]
    v_pk_fma_f32 v[58:59], v[58:59], v[120:121], v[220:221] op_sel:[0,1,0] op_sel_hi:[1,1,1]
    v_pk_mul_f32 v[224:225], v[58:59], v[58:59]
    v_pk_fma_f32 v[224:225], v[224:225], v[244:245], v[242:243]
    v_pk_mul_f32 v[224:225], v[224:225], v[58:59]
    v_exp_f32 v222, v222
    v_exp_f32 v223, v223
    v_exp_f32 v224, v224
    v_exp_f32 v225, v225
    v_pk_add_f32 v[222:223], v[222:223], s[74:75]
    v_pk_mul_f32 v[56:57], v[56:57], v[122:123] op_sel:[0,1] op_sel_hi:[1,1]
    v_pk_add_f32 v[224:225], v[224:225], s[74:75]
    v_pk_mul_f32 v[58:59], v[58:59], v[122:123] op_sel:[0,1] op_sel_hi:[1,1]
    v_rcp_f32 v222, v222
    v_rcp_f32 v223, v223
    v_rcp_f32 v224, v224
    v_rcp_f32 v225, v225
    s_nop 0
    v_pk_mul_f32 v[56:57], v[56:57], v[222:223]
    v_pk_mul_f32 v[58:59], v[58:59], v[224:225]
    v_cvt_pk_bf16_f32 v236, v56, v57
    v_cvt_pk_bf16_f32 v237, v58, v59
    s_add_u32 s58, s56, 98304
    buffer_store_dwordx4 v[234:237], v246, s[24:27], s58 offen sc1
    v_pk_fma_f32 v[60:61], v[140:141], v[124:125], v[60:61] op_sel_hi:[1,0,1] neg_lo:[1,0,0] neg_hi:[1,0,0]
    v_pk_fma_f32 v[60:61], v[60:61], v[124:125], v[218:219] op_sel:[0,1,0] op_sel_hi:[1,1,1]
    v_pk_mul_f32 v[222:223], v[60:61], v[60:61]
    v_pk_fma_f32 v[222:223], v[222:223], v[244:245], v[242:243]
    v_pk_mul_f32 v[222:223], v[222:223], v[60:61]
    v_pk_fma_f32 v[62:63], v[142:143], v[124:125], v[62:63] op_sel_hi:[1,0,1] neg_lo:[1,0,0] neg_hi:[1,0,0]
    v_pk_fma_f32 v[62:63], v[62:63], v[124:125], v[220:221] op_sel:[0,1,0] op_sel_hi:[1,1,1]
    v_pk_mul_f32 v[224:225], v[62:63], v[62:63]
    v_pk_fma_f32 v[224:225], v[224:225], v[244:245], v[242:243]
    v_pk_mul_f32 v[224:225], v[224:225], v[62:63]
    v_exp_f32 v222, v222
    v_exp_f32 v223, v223
    v_exp_f32 v224, v224
    v_exp_f32 v225, v225
    v_pk_add_f32 v[222:223], v[222:223], s[74:75]
    v_pk_mul_f32 v[60:61], v[60:61], v[126:127] op_sel:[0,1] op_sel_hi:[1,1]
    v_pk_add_f32 v[224:225], v[224:225], s[74:75]
    v_pk_mul_f32 v[62:63], v[62:63], v[126:127] op_sel:[0,1] op_sel_hi:[1,1]
    v_rcp_f32 v222, v222
    v_rcp_f32 v223, v223
    v_rcp_f32 v224, v224
    v_rcp_f32 v225, v225
    s_nop 0
    v_pk_mul_f32 v[60:61], v[60:61], v[222:223]
    v_pk_mul_f32 v[62:63], v[62:63], v[224:225]
    v_cvt_pk_bf16_f32 v240, v60, v61
    v_cvt_pk_bf16_f32 v241, v62, v63
    s_add_u32 s58, s56, 147456
    buffer_store_dwordx4 v[238:241], v246, s[24:27], s58 offen sc1
    ds_read_b128 v[140:143], v217 offset:128
    ds_read_b128 v[144:147], v217 offset:448
    s_waitcnt lgkmcnt(0)
    v_pk_add_f32 v[140:141], v[140:141], v[144:145]
    v_pk_add_f32 v[142:143], v[142:143], v[146:147]
    v_lshlrev_b32 v218, 16, v132
    v_and_b32 v219, 0xffff0000, v132
    v_lshlrev_b32 v220, 16, v133
    v_and_b32 v221, 0xffff0000, v133
    v_pk_fma_f32 v[64:65], v[140:141], v[112:113], v[64:65] op_sel_hi:[1,0,1] neg_lo:[1,0,0] neg_hi:[1,0,0]
    v_pk_fma_f32 v[64:65], v[64:65], v[112:113], v[218:219] op_sel:[0,1,0] op_sel_hi:[1,1,1]
    v_pk_mul_f32 v[222:223], v[64:65], v[64:65]
    v_pk_fma_f32 v[222:223], v[222:223], v[244:245], v[242:243]
    v_pk_mul_f32 v[222:223], v[222:223], v[64:65]
    v_pk_fma_f32 v[66:67], v[142:143], v[112:113], v[66:67] op_sel_hi:[1,0,1] neg_lo:[1,0,0] neg_hi:[1,0,0]
    v_pk_fma_f32 v[66:67], v[66:67], v[112:113], v[220:221] op_sel:[0,1,0] op_sel_hi:[1,1,1]
    v_pk_mul_f32 v[224:225], v[66:67], v[66:67]
    v_pk_fma_f32 v[224:225], v[224:225], v[244:245], v[242:243]
    v_pk_mul_f32 v[224:225], v[224:225], v[66:67]
    v_exp_f32 v222, v222
    v_exp_f32 v223, v223
    v_exp_f32 v224, v224
    v_exp_f32 v225, v225
    v_pk_add_f32 v[222:223], v[222:223], s[74:75]
    v_pk_mul_f32 v[64:65], v[64:65], v[114:115] op_sel:[0,1] op_sel_hi:[1,1]
    v_pk_add_f32 v[224:225], v[224:225], s[74:75]
    v_pk_mul_f32 v[66:67], v[66:67], v[114:115] op_sel:[0,1] op_sel_hi:[1,1]
    v_rcp_f32 v222, v222
    v_rcp_f32 v223, v223
    v_rcp_f32 v224, v224
    v_rcp_f32 v225, v225
    s_nop 0
    v_pk_mul_f32 v[64:65], v[64:65], v[222:223]
    v_pk_mul_f32 v[66:67], v[66:67], v[224:225]
    v_cvt_pk_bf16_f32 v226, v64, v65
    v_cvt_pk_bf16_f32 v227, v66, v67
    v_pk_fma_f32 v[68:69], v[140:141], v[116:117], v[68:69] op_sel_hi:[1,0,1] neg_lo:[1,0,0] neg_hi:[1,0,0]
    v_pk_fma_f32 v[68:69], v[68:69], v[116:117], v[218:219] op_sel:[0,1,0] op_sel_hi:[1,1,1]
    v_pk_mul_f32 v[222:223], v[68:69], v[68:69]
    v_pk_fma_f32 v[222:223], v[222:223], v[244:245], v[242:243]
    v_pk_mul_f32 v[222:223], v[222:223], v[68:69]
    v_pk_fma_f32 v[70:71], v[142:143], v[116:117], v[70:71] op_sel_hi:[1,0,1] neg_lo:[1,0,0] neg_hi:[1,0,0]
    v_pk_fma_f32 v[70:71], v[70:71], v[116:117], v[220:221] op_sel:[0,1,0] op_sel_hi:[1,1,1]
    v_pk_mul_f32 v[224:225], v[70:71], v[70:71]
    v_pk_fma_f32 v[224:225], v[224:225], v[244:245], v[242:243]
    v_pk_mul_f32 v[224:225], v[224:225], v[70:71]
    v_exp_f32 v222, v222
    v_exp_f32 v223, v223
    v_exp_f32 v224, v224
    v_exp_f32 v225, v225
    v_pk_add_f32 v[222:223], v[222:223], s[74:75]
    v_pk_mul_f32 v[68:69], v[68:69], v[118:119] op_sel:[0,1] op_sel_hi:[1,1]
    v_pk_add_f32 v[224:225], v[224:225], s[74:75]
    v_pk_mul_f32 v[70:71], v[70:71], v[118:119] op_sel:[0,1] op_sel_hi:[1,1]
    v_rcp_f32 v222, v222
    v_rcp_f32 v223, v223
    v_rcp_f32 v224, v224
    v_rcp_f32 v225, v225
    s_nop 0
    v_pk_mul_f32 v[68:69], v[68:69], v[222:223]
    v_pk_mul_f32 v[70:71], v[70:71], v[224:225]
    v_cvt_pk_bf16_f32 v230, v68, v69
    v_cvt_pk_bf16_f32 v231, v70, v71
    v_pk_fma_f32 v[72:73], v[140:141], v[120:121], v[72:73] op_sel_hi:[1,0,1] neg_lo:[1,0,0] neg_hi:[1,0,0]
    v_pk_fma_f32 v[72:73], v[72:73], v[120:121], v[218:219] op_sel:[0,1,0] op_sel_hi:[1,1,1]
    v_pk_mul_f32 v[222:223], v[72:73], v[72:73]
    v_pk_fma_f32 v[222:223], v[222:223], v[244:245], v[242:243]
    v_pk_mul_f32 v[222:223], v[222:223], v[72:73]
    v_pk_fma_f32 v[74:75], v[142:143], v[120:121], v[74:75] op_sel_hi:[1,0,1] neg_lo:[1,0,0] neg_hi:[1,0,0]
    v_pk_fma_f32 v[74:75], v[74:75], v[120:121], v[220:221] op_sel:[0,1,0] op_sel_hi:[1,1,1]
    v_pk_mul_f32 v[224:225], v[74:75], v[74:75]
    v_pk_fma_f32 v[224:225], v[224:225], v[244:245], v[242:243]
    v_pk_mul_f32 v[224:225], v[224:225], v[74:75]
    v_exp_f32 v222, v222
    v_exp_f32 v223, v223
    v_exp_f32 v224, v224
    v_exp_f32 v225, v225
    v_pk_add_f32 v[222:223], v[222:223], s[74:75]
    v_pk_mul_f32 v[72:73], v[72:73], v[122:123] op_sel:[0,1] op_sel_hi:[1,1]
    v_pk_add_f32 v[224:225], v[224:225], s[74:75]
    v_pk_mul_f32 v[74:75], v[74:75], v[122:123] op_sel:[0,1] op_sel_hi:[1,1]
    v_rcp_f32 v222, v222
    v_rcp_f32 v223, v223
    v_rcp_f32 v224, v224
    v_rcp_f32 v225, v225
    s_nop 0
    v_pk_mul_f32 v[72:73], v[72:73], v[222:223]
    v_pk_mul_f32 v[74:75], v[74:75], v[224:225]
    v_cvt_pk_bf16_f32 v234, v72, v73
    v_cvt_pk_bf16_f32 v235, v74, v75
    v_pk_fma_f32 v[76:77], v[140:141], v[124:125], v[76:77] op_sel_hi:[1,0,1] neg_lo:[1,0,0] neg_hi:[1,0,0]
    v_pk_fma_f32 v[76:77], v[76:77], v[124:125], v[218:219] op_sel:[0,1,0] op_sel_hi:[1,1,1]
    v_pk_mul_f32 v[222:223], v[76:77], v[76:77]
    v_pk_fma_f32 v[222:223], v[222:223], v[244:245], v[242:243]
    v_pk_mul_f32 v[222:223], v[222:223], v[76:77]
    v_pk_fma_f32 v[78:79], v[142:143], v[124:125], v[78:79] op_sel_hi:[1,0,1] neg_lo:[1,0,0] neg_hi:[1,0,0]
    v_pk_fma_f32 v[78:79], v[78:79], v[124:125], v[220:221] op_sel:[0,1,0] op_sel_hi:[1,1,1]
    v_pk_mul_f32 v[224:225], v[78:79], v[78:79]
    v_pk_fma_f32 v[224:225], v[224:225], v[244:245], v[242:243]
    v_pk_mul_f32 v[224:225], v[224:225], v[78:79]
    v_exp_f32 v222, v222
    v_exp_f32 v223, v223
    v_exp_f32 v224, v224
    v_exp_f32 v225, v225
    v_pk_add_f32 v[222:223], v[222:223], s[74:75]
    v_pk_mul_f32 v[76:77], v[76:77], v[126:127] op_sel:[0,1] op_sel_hi:[1,1]
    v_pk_add_f32 v[224:225], v[224:225], s[74:75]
    v_pk_mul_f32 v[78:79], v[78:79], v[126:127] op_sel:[0,1] op_sel_hi:[1,1]
    v_rcp_f32 v222, v222
    v_rcp_f32 v223, v223
    v_rcp_f32 v224, v224
    v_rcp_f32 v225, v225
    s_nop 0
    v_pk_mul_f32 v[76:77], v[76:77], v[222:223]
    v_pk_mul_f32 v[78:79], v[78:79], v[224:225]
    v_cvt_pk_bf16_f32 v238, v76, v77
    v_cvt_pk_bf16_f32 v239, v78, v79
    ds_read_b128 v[140:143], v217 offset:192
    ds_read_b128 v[144:147], v217 offset:512
    s_waitcnt lgkmcnt(0)
    v_pk_add_f32 v[140:141], v[140:141], v[144:145]
    v_pk_add_f32 v[142:143], v[142:143], v[146:147]
    v_lshlrev_b32 v218, 16, v134
    v_and_b32 v219, 0xffff0000, v134
    v_lshlrev_b32 v220, 16, v135
    v_and_b32 v221, 0xffff0000, v135
    v_pk_fma_f32 v[80:81], v[140:141], v[112:113], v[80:81] op_sel_hi:[1,0,1] neg_lo:[1,0,0] neg_hi:[1,0,0]
    v_pk_fma_f32 v[80:81], v[80:81], v[112:113], v[218:219] op_sel:[0,1,0] op_sel_hi:[1,1,1]
    v_pk_mul_f32 v[222:223], v[80:81], v[80:81]
    v_pk_fma_f32 v[222:223], v[222:223], v[244:245], v[242:243]
    v_pk_mul_f32 v[222:223], v[222:223], v[80:81]
    v_pk_fma_f32 v[82:83], v[142:143], v[112:113], v[82:83] op_sel_hi:[1,0,1] neg_lo:[1,0,0] neg_hi:[1,0,0]
    v_pk_fma_f32 v[82:83], v[82:83], v[112:113], v[220:221] op_sel:[0,1,0] op_sel_hi:[1,1,1]
    v_pk_mul_f32 v[224:225], v[82:83], v[82:83]
    v_pk_fma_f32 v[224:225], v[224:225], v[244:245], v[242:243]
    v_pk_mul_f32 v[224:225], v[224:225], v[82:83]
    v_exp_f32 v222, v222
    v_exp_f32 v223, v223
    v_exp_f32 v224, v224
    v_exp_f32 v225, v225
    v_pk_add_f32 v[222:223], v[222:223], s[74:75]
    v_pk_mul_f32 v[80:81], v[80:81], v[114:115] op_sel:[0,1] op_sel_hi:[1,1]
    v_pk_add_f32 v[224:225], v[224:225], s[74:75]
    v_pk_mul_f32 v[82:83], v[82:83], v[114:115] op_sel:[0,1] op_sel_hi:[1,1]
    v_rcp_f32 v222, v222
    v_rcp_f32 v223, v223
    v_rcp_f32 v224, v224
    v_rcp_f32 v225, v225
    s_nop 0
    v_pk_mul_f32 v[80:81], v[80:81], v[222:223]
    v_pk_mul_f32 v[82:83], v[82:83], v[224:225]
    v_cvt_pk_bf16_f32 v228, v80, v81
    v_cvt_pk_bf16_f32 v229, v82, v83
    s_lshr_b32 s56, s79, 4
    s_add_u32 s56, s56, 3
    s_lshr_b32 s56, s56, 1
    s_lshl_b32 s56, s56, 10
    s_add_u32 s56, s56, s72
    s_add_u32 s58, s56, 0
    buffer_store_dwordx4 v[226:229], v246, s[24:27], s58 offen sc1
    v_pk_fma_f32 v[84:85], v[140:141], v[116:117], v[84:85] op_sel_hi:[1,0,1] neg_lo:[1,0,0] neg_hi:[1,0,0]
    v_pk_fma_f32 v[84:85], v[84:85], v[116:117], v[218:219] op_sel:[0,1,0] op_sel_hi:[1,1,1]
    v_pk_mul_f32 v[222:223], v[84:85], v[84:85]
    v_pk_fma_f32 v[222:223], v[222:223], v[244:245], v[242:243]
    v_pk_mul_f32 v[222:223], v[222:223], v[84:85]
    v_pk_fma_f32 v[86:87], v[142:143], v[116:117], v[86:87] op_sel_hi:[1,0,1] neg_lo:[1,0,0] neg_hi:[1,0,0]
    v_pk_fma_f32 v[86:87], v[86:87], v[116:117], v[220:221] op_sel:[0,1,0] op_sel_hi:[1,1,1]
    v_pk_mul_f32 v[224:225], v[86:87], v[86:87]
    v_pk_fma_f32 v[224:225], v[224:225], v[244:245], v[242:243]
    v_pk_mul_f32 v[224:225], v[224:225], v[86:87]
    v_exp_f32 v222, v222
    v_exp_f32 v223, v223
    v_exp_f32 v224, v224
    v_exp_f32 v225, v225
    v_pk_add_f32 v[222:223], v[222:223], s[74:75]
    v_pk_mul_f32 v[84:85], v[84:85], v[118:119] op_sel:[0,1] op_sel_hi:[1,1]
    v_pk_add_f32 v[224:225], v[224:225], s[74:75]
    v_pk_mul_f32 v[86:87], v[86:87], v[118:119] op_sel:[0,1] op_sel_hi:[1,1]
    v_rcp_f32 v222, v222
    v_rcp_f32 v223, v223
    v_rcp_f32 v224, v224
    v_rcp_f32 v225, v225
    s_nop 0
    v_pk_mul_f32 v[84:85], v[84:85], v[222:223]
    v_pk_mul_f32 v[86:87], v[86:87], v[224:225]
    v_cvt_pk_bf16_f32 v232, v84, v85
    v_cvt_pk_bf16_f32 v233, v86, v87
    s_add_u32 s58, s56, 49152
    buffer_store_dwordx4 v[230:233], v246, s[24:27], s58 offen sc1
    v_pk_fma_f32 v[88:89], v[140:141], v[120:121], v[88:89] op_sel_hi:[1,0,1] neg_lo:[1,0,0] neg_hi:[1,0,0]
    v_pk_fma_f32 v[88:89], v[88:89], v[120:121], v[218:219] op_sel:[0,1,0] op_sel_hi:[1,1,1]
    v_pk_mul_f32 v[222:223], v[88:89], v[88:89]
    v_pk_fma_f32 v[222:223], v[222:223], v[244:245], v[242:243]
    v_pk_mul_f32 v[222:223], v[222:223], v[88:89]
    v_pk_fma_f32 v[90:91], v[142:143], v[120:121], v[90:91] op_sel_hi:[1,0,1] neg_lo:[1,0,0] neg_hi:[1,0,0]
    v_pk_fma_f32 v[90:91], v[90:91], v[120:121], v[220:221] op_sel:[0,1,0] op_sel_hi:[1,1,1]
    v_pk_mul_f32 v[224:225], v[90:91], v[90:91]
    v_pk_fma_f32 v[224:225], v[224:225], v[244:245], v[242:243]
    v_pk_mul_f32 v[224:225], v[224:225], v[90:91]
    v_exp_f32 v222, v222
    v_exp_f32 v223, v223
    v_exp_f32 v224, v224
    v_exp_f32 v225, v225
    v_pk_add_f32 v[222:223], v[222:223], s[74:75]
    v_pk_mul_f32 v[88:89], v[88:89], v[122:123] op_sel:[0,1] op_sel_hi:[1,1]
    v_pk_add_f32 v[224:225], v[224:225], s[74:75]
    v_pk_mul_f32 v[90:91], v[90:91], v[122:123] op_sel:[0,1] op_sel_hi:[1,1]
    v_rcp_f32 v222, v222
    v_rcp_f32 v223, v223
    v_rcp_f32 v224, v224
    v_rcp_f32 v225, v225
    s_nop 0
    v_pk_mul_f32 v[88:89], v[88:89], v[222:223]
    v_pk_mul_f32 v[90:91], v[90:91], v[224:225]
    v_cvt_pk_bf16_f32 v236, v88, v89
    v_cvt_pk_bf16_f32 v237, v90, v91
    s_add_u32 s58, s56, 98304
    buffer_store_dwordx4 v[234:237], v246, s[24:27], s58 offen sc1
    v_pk_fma_f32 v[92:93], v[140:141], v[124:125], v[92:93] op_sel_hi:[1,0,1] neg_lo:[1,0,0] neg_hi:[1,0,0]
    v_pk_fma_f32 v[92:93], v[92:93], v[124:125], v[218:219] op_sel:[0,1,0] op_sel_hi:[1,1,1]
    v_pk_mul_f32 v[222:223], v[92:93], v[92:93]
    v_pk_fma_f32 v[222:223], v[222:223], v[244:245], v[242:243]
    v_pk_mul_f32 v[222:223], v[222:223], v[92:93]
    v_pk_fma_f32 v[94:95], v[142:143], v[124:125], v[94:95] op_sel_hi:[1,0,1] neg_lo:[1,0,0] neg_hi:[1,0,0]
    v_pk_fma_f32 v[94:95], v[94:95], v[124:125], v[220:221] op_sel:[0,1,0] op_sel_hi:[1,1,1]
    v_pk_mul_f32 v[224:225], v[94:95], v[94:95]
    v_pk_fma_f32 v[224:225], v[224:225], v[244:245], v[242:243]
    v_pk_mul_f32 v[224:225], v[224:225], v[94:95]
    v_exp_f32 v222, v222
    v_exp_f32 v223, v223
    v_exp_f32 v224, v224
    v_exp_f32 v225, v225
    v_pk_add_f32 v[222:223], v[222:223], s[74:75]
    v_pk_mul_f32 v[92:93], v[92:93], v[126:127] op_sel:[0,1] op_sel_hi:[1,1]
    v_pk_add_f32 v[224:225], v[224:225], s[74:75]
    v_pk_mul_f32 v[94:95], v[94:95], v[126:127] op_sel:[0,1] op_sel_hi:[1,1]
    v_rcp_f32 v222, v222
    v_rcp_f32 v223, v223
    v_rcp_f32 v224, v224
    v_rcp_f32 v225, v225
    s_nop 0
    v_pk_mul_f32 v[92:93], v[92:93], v[222:223]
    v_pk_mul_f32 v[94:95], v[94:95], v[224:225]
    v_cvt_pk_bf16_f32 v240, v92, v93
    v_cvt_pk_bf16_f32 v241, v94, v95
    s_add_u32 s58, s56, 147456
    buffer_store_dwordx4 v[238:241], v246, s[24:27], s58 offen sc1
    ds_read_b128 v[140:143], v217 offset:256
    ds_read_b128 v[144:147], v217 offset:576
    s_waitcnt lgkmcnt(0)
    v_pk_add_f32 v[140:141], v[140:141], v[144:145]
    v_pk_add_f32 v[142:143], v[142:143], v[146:147]
    v_lshlrev_b32 v218, 16, v136
    v_and_b32 v219, 0xffff0000, v136
    v_lshlrev_b32 v220, 16, v137
    v_and_b32 v221, 0xffff0000, v137
    v_pk_fma_f32 v[96:97], v[140:141], v[112:113], v[96:97] op_sel_hi:[1,0,1] neg_lo:[1,0,0] neg_hi:[1,0,0]
    v_pk_fma_f32 v[96:97], v[96:97], v[112:113], v[218:219] op_sel:[0,1,0] op_sel_hi:[1,1,1]
    v_pk_mul_f32 v[222:223], v[96:97], v[96:97]
    v_pk_fma_f32 v[222:223], v[222:223], v[244:245], v[242:243]
    v_pk_mul_f32 v[222:223], v[222:223], v[96:97]
    v_pk_fma_f32 v[98:99], v[142:143], v[112:113], v[98:99] op_sel_hi:[1,0,1] neg_lo:[1,0,0] neg_hi:[1,0,0]
    v_pk_fma_f32 v[98:99], v[98:99], v[112:113], v[220:221] op_sel:[0,1,0] op_sel_hi:[1,1,1]
    v_pk_mul_f32 v[224:225], v[98:99], v[98:99]
    v_pk_fma_f32 v[224:225], v[224:225], v[244:245], v[242:243]
    v_pk_mul_f32 v[224:225], v[224:225], v[98:99]
    v_exp_f32 v222, v222
    v_exp_f32 v223, v223
    v_exp_f32 v224, v224
    v_exp_f32 v225, v225
    v_pk_add_f32 v[222:223], v[222:223], s[74:75]
    v_pk_mul_f32 v[96:97], v[96:97], v[114:115] op_sel:[0,1] op_sel_hi:[1,1]
    v_pk_add_f32 v[224:225], v[224:225], s[74:75]
    v_pk_mul_f32 v[98:99], v[98:99], v[114:115] op_sel:[0,1] op_sel_hi:[1,1]
    v_rcp_f32 v222, v222
    v_rcp_f32 v223, v223
    v_rcp_f32 v224, v224
    v_rcp_f32 v225, v225
    s_nop 0
    v_pk_mul_f32 v[96:97], v[96:97], v[222:223]
    v_pk_mul_f32 v[98:99], v[98:99], v[224:225]
    v_cvt_pk_bf16_f32 v226, v96, v97
    v_cvt_pk_bf16_f32 v227, v98, v99
    s_lshr_b32 s56, s79, 4
    s_add_u32 s56, s56, 4
    s_lshr_b32 s56, s56, 1
    s_lshl_b32 s56, s56, 10
    s_add_u32 s56, s56, s72
    s_add_u32 s58, s56, 0
    buffer_store_dwordx2 v[226:227], v246, s[24:27], s58 offen sc1
    v_pk_fma_f32 v[100:101], v[140:141], v[116:117], v[100:101] op_sel_hi:[1,0,1] neg_lo:[1,0,0] neg_hi:[1,0,0]
    v_pk_fma_f32 v[100:101], v[100:101], v[116:117], v[218:219] op_sel:[0,1,0] op_sel_hi:[1,1,1]
    v_pk_mul_f32 v[222:223], v[100:101], v[100:101]
    v_pk_fma_f32 v[222:223], v[222:223], v[244:245], v[242:243]
    v_pk_mul_f32 v[222:223], v[222:223], v[100:101]
    v_pk_fma_f32 v[102:103], v[142:143], v[116:117], v[102:103] op_sel_hi:[1,0,1] neg_lo:[1,0,0] neg_hi:[1,0,0]
    v_pk_fma_f32 v[102:103], v[102:103], v[116:117], v[220:221] op_sel:[0,1,0] op_sel_hi:[1,1,1]
    v_pk_mul_f32 v[224:225], v[102:103], v[102:103]
    v_pk_fma_f32 v[224:225], v[224:225], v[244:245], v[242:243]
    v_pk_mul_f32 v[224:225], v[224:225], v[102:103]
    v_exp_f32 v222, v222
    v_exp_f32 v223, v223
    v_exp_f32 v224, v224
    v_exp_f32 v225, v225
    v_pk_add_f32 v[222:223], v[222:223], s[74:75]
    v_pk_mul_f32 v[100:101], v[100:101], v[118:119] op_sel:[0,1] op_sel_hi:[1,1]
    v_pk_add_f32 v[224:225], v[224:225], s[74:75]
    v_pk_mul_f32 v[102:103], v[102:103], v[118:119] op_sel:[0,1] op_sel_hi:[1,1]
    v_rcp_f32 v222, v222
    v_rcp_f32 v223, v223
    v_rcp_f32 v224, v224
    v_rcp_f32 v225, v225
    s_nop 0
    v_pk_mul_f32 v[100:101], v[100:101], v[222:223]
    v_pk_mul_f32 v[102:103], v[102:103], v[224:225]
    v_cvt_pk_bf16_f32 v230, v100, v101
    v_cvt_pk_bf16_f32 v231, v102, v103
    s_add_u32 s58, s56, 49152
    buffer_store_dwordx2 v[230:231], v246, s[24:27], s58 offen sc1
    v_pk_fma_f32 v[104:105], v[140:141], v[120:121], v[104:105] op_sel_hi:[1,0,1] neg_lo:[1,0,0] neg_hi:[1,0,0]
    v_pk_fma_f32 v[104:105], v[104:105], v[120:121], v[218:219] op_sel:[0,1,0] op_sel_hi:[1,1,1]
    v_pk_mul_f32 v[222:223], v[104:105], v[104:105]
    v_pk_fma_f32 v[222:223], v[222:223], v[244:245], v[242:243]
    v_pk_mul_f32 v[222:223], v[222:223], v[104:105]
    v_pk_fma_f32 v[106:107], v[142:143], v[120:121], v[106:107] op_sel_hi:[1,0,1] neg_lo:[1,0,0] neg_hi:[1,0,0]
    v_pk_fma_f32 v[106:107], v[106:107], v[120:121], v[220:221] op_sel:[0,1,0] op_sel_hi:[1,1,1]
    v_pk_mul_f32 v[224:225], v[106:107], v[106:107]
    v_pk_fma_f32 v[224:225], v[224:225], v[244:245], v[242:243]
    v_pk_mul_f32 v[224:225], v[224:225], v[106:107]
    v_exp_f32 v222, v222
    v_exp_f32 v223, v223
    v_exp_f32 v224, v224
    v_exp_f32 v225, v225
    v_pk_add_f32 v[222:223], v[222:223], s[74:75]
    v_pk_mul_f32 v[104:105], v[104:105], v[122:123] op_sel:[0,1] op_sel_hi:[1,1]
    v_pk_add_f32 v[224:225], v[224:225], s[74:75]
    v_pk_mul_f32 v[106:107], v[106:107], v[122:123] op_sel:[0,1] op_sel_hi:[1,1]
    v_rcp_f32 v222, v222
    v_rcp_f32 v223, v223
    v_rcp_f32 v224, v224
    v_rcp_f32 v225, v225
    s_nop 0
    v_pk_mul_f32 v[104:105], v[104:105], v[222:223]
    v_pk_mul_f32 v[106:107], v[106:107], v[224:225]
    v_cvt_pk_bf16_f32 v234, v104, v105
    v_cvt_pk_bf16_f32 v235, v106, v107
    s_add_u32 s58, s56, 98304
    buffer_store_dwordx2 v[234:235], v246, s[24:27], s58 offen sc1
    v_pk_fma_f32 v[108:109], v[140:141], v[124:125], v[108:109] op_sel_hi:[1,0,1] neg_lo:[1,0,0] neg_hi:[1,0,0]
    v_pk_fma_f32 v[108:109], v[108:109], v[124:125], v[218:219] op_sel:[0,1,0] op_sel_hi:[1,1,1]
    v_pk_mul_f32 v[222:223], v[108:109], v[108:109]
    v_pk_fma_f32 v[222:223], v[222:223], v[244:245], v[242:243]
    v_pk_mul_f32 v[222:223], v[222:223], v[108:109]
    v_pk_fma_f32 v[110:111], v[142:143], v[124:125], v[110:111] op_sel_hi:[1,0,1] neg_lo:[1,0,0] neg_hi:[1,0,0]
    v_pk_fma_f32 v[110:111], v[110:111], v[124:125], v[220:221] op_sel:[0,1,0] op_sel_hi:[1,1,1]
    v_pk_mul_f32 v[224:225], v[110:111], v[110:111]
    v_pk_fma_f32 v[224:225], v[224:225], v[244:245], v[242:243]
    v_pk_mul_f32 v[224:225], v[224:225], v[110:111]
    v_exp_f32 v222, v222
    v_exp_f32 v223, v223
    v_exp_f32 v224, v224
    v_exp_f32 v225, v225
    v_pk_add_f32 v[222:223], v[222:223], s[74:75]
    v_pk_mul_f32 v[108:109], v[108:109], v[126:127] op_sel:[0,1] op_sel_hi:[1,1]
    v_pk_add_f32 v[224:225], v[224:225], s[74:75]
    v_pk_mul_f32 v[110:111], v[110:111], v[126:127] op_sel:[0,1] op_sel_hi:[1,1]
    v_rcp_f32 v222, v222
    v_rcp_f32 v223, v223
    v_rcp_f32 v224, v224
    v_rcp_f32 v225, v225
    s_nop 0
    v_pk_mul_f32 v[108:109], v[108:109], v[222:223]
    v_pk_mul_f32 v[110:111], v[110:111], v[224:225]
    v_cvt_pk_bf16_f32 v238, v108, v109
    v_cvt_pk_bf16_f32 v239, v110, v111
    s_add_u32 s58, s56, 147456
    buffer_store_dwordx2 v[238:239], v246, s[24:27], s58 offen sc1
    s_branch L_ccj_57
L_cc1_56:
    v_mov_b32 v242, 0xc0135761
    v_mov_b32 v243, 0xc0135761
    v_mov_b32 v244, 0xbdd2d3e8
    v_mov_b32 v245, 0xbdd2d3e8
    s_mov_b32 s74, 1.0
    s_mov_b32 s75, 1.0
    s_lshr_b32 s56, s50, 4
    s_lshl_b32 s57, s48, 2
    s_add_u32 s56, s56, s57
    s_mul_i32 s56, s56, 49152
    s_add_u32 s72, s56, 10485760
    v_lshlrev_b32 v246, 4, v1
    ds_read_b128 v[140:143], v217 offset:0
    ds_read_b128 v[144:147], v217 offset:320
    s_waitcnt lgkmcnt(0)
    v_pk_add_f32 v[140:141], v[140:141], v[144:145]
    v_pk_add_f32 v[142:143], v[142:143], v[146:147]
    v_lshlrev_b32 v218, 16, v128
    v_and_b32 v219, 0xffff0000, v128
    v_lshlrev_b32 v220, 16, v129
    v_and_b32 v221, 0xffff0000, v129
    v_pk_fma_f32 v[32:33], v[140:141], v[112:113], v[32:33] op_sel_hi:[1,0,1] neg_lo:[1,0,0] neg_hi:[1,0,0]
    v_pk_fma_f32 v[32:33], v[32:33], v[112:113], v[218:219] op_sel:[0,1,0] op_sel_hi:[1,1,1]
    v_pk_mul_f32 v[222:223], v[32:33], v[32:33]
    v_pk_fma_f32 v[222:223], v[222:223], v[244:245], v[242:243]
    v_pk_mul_f32 v[222:223], v[222:223], v[32:33]
    v_pk_fma_f32 v[34:35], v[142:143], v[112:113], v[34:35] op_sel_hi:[1,0,1] neg_lo:[1,0,0] neg_hi:[1,0,0]
    v_pk_fma_f32 v[34:35], v[34:35], v[112:113], v[220:221] op_sel:[0,1,0] op_sel_hi:[1,1,1]
    v_pk_mul_f32 v[224:225], v[34:35], v[34:35]
    v_pk_fma_f32 v[224:225], v[224:225], v[244:245], v[242:243]
    v_pk_mul_f32 v[224:225], v[224:225], v[34:35]
    v_exp_f32 v222, v222
    v_exp_f32 v223, v223
    v_exp_f32 v224, v224
    v_exp_f32 v225, v225
    v_pk_add_f32 v[222:223], v[222:223], s[74:75]
    v_pk_mul_f32 v[32:33], v[32:33], v[114:115] op_sel:[0,1] op_sel_hi:[1,1]
    v_pk_add_f32 v[224:225], v[224:225], s[74:75]
    v_pk_mul_f32 v[34:35], v[34:35], v[114:115] op_sel:[0,1] op_sel_hi:[1,1]
    v_rcp_f32 v222, v222
    v_rcp_f32 v223, v223
    v_rcp_f32 v224, v224
    v_rcp_f32 v225, v225
    s_nop 0
    v_pk_mul_f32 v[32:33], v[32:33], v[222:223]
    v_pk_mul_f32 v[34:35], v[34:35], v[224:225]
    v_cvt_pk_bf16_f32 v226, v32, v33
    v_cvt_pk_bf16_f32 v227, v34, v35
    s_lshr_b32 s56, s79, 4
    s_add_u32 s56, s56, 0
    s_lshr_b32 s56, s56, 1
    s_lshl_b32 s56, s56, 10
    s_add_u32 s56, s56, s72
    s_add_u32 s58, s56, 8
    buffer_store_dwordx2 v[226:227], v246, s[24:27], s58 offen sc1
    v_pk_fma_f32 v[36:37], v[140:141], v[116:117], v[36:37] op_sel_hi:[1,0,1] neg_lo:[1,0,0] neg_hi:[1,0,0]
    v_pk_fma_f32 v[36:37], v[36:37], v[116:117], v[218:219] op_sel:[0,1,0] op_sel_hi:[1,1,1]
    v_pk_mul_f32 v[222:223], v[36:37], v[36:37]
    v_pk_fma_f32 v[222:223], v[222:223], v[244:245], v[242:243]
    v_pk_mul_f32 v[222:223], v[222:223], v[36:37]
    v_pk_fma_f32 v[38:39], v[142:143], v[116:117], v[38:39] op_sel_hi:[1,0,1] neg_lo:[1,0,0] neg_hi:[1,0,0]
    v_pk_fma_f32 v[38:39], v[38:39], v[116:117], v[220:221] op_sel:[0,1,0] op_sel_hi:[1,1,1]
    v_pk_mul_f32 v[224:225], v[38:39], v[38:39]
    v_pk_fma_f32 v[224:225], v[224:225], v[244:245], v[242:243]
    v_pk_mul_f32 v[224:225], v[224:225], v[38:39]
    v_exp_f32 v222, v222
    v_exp_f32 v223, v223
    v_exp_f32 v224, v224
    v_exp_f32 v225, v225
    v_pk_add_f32 v[222:223], v[222:223], s[74:75]
    v_pk_mul_f32 v[36:37], v[36:37], v[118:119] op_sel:[0,1] op_sel_hi:[1,1]
    v_pk_add_f32 v[224:225], v[224:225], s[74:75]
    v_pk_mul_f32 v[38:39], v[38:39], v[118:119] op_sel:[0,1] op_sel_hi:[1,1]
    v_rcp_f32 v222, v222
    v_rcp_f32 v223, v223
    v_rcp_f32 v224, v224
    v_rcp_f32 v225, v225
    s_nop 0
    v_pk_mul_f32 v[36:37], v[36:37], v[222:223]
    v_pk_mul_f32 v[38:39], v[38:39], v[224:225]
    v_cvt_pk_bf16_f32 v230, v36, v37
    v_cvt_pk_bf16_f32 v231, v38, v39
    s_add_u32 s58, s56, 49160
    buffer_store_dwordx2 v[230:231], v246, s[24:27], s58 offen sc1
    v_pk_fma_f32 v[40:41], v[140:141], v[120:121], v[40:41] op_sel_hi:[1,0,1] neg_lo:[1,0,0] neg_hi:[1,0,0]
    v_pk_fma_f32 v[40:41], v[40:41], v[120:121], v[218:219] op_sel:[0,1,0] op_sel_hi:[1,1,1]
    v_pk_mul_f32 v[222:223], v[40:41], v[40:41]
    v_pk_fma_f32 v[222:223], v[222:223], v[244:245], v[242:243]
    v_pk_mul_f32 v[222:223], v[222:223], v[40:41]
    v_pk_fma_f32 v[42:43], v[142:143], v[120:121], v[42:43] op_sel_hi:[1,0,1] neg_lo:[1,0,0] neg_hi:[1,0,0]
    v_pk_fma_f32 v[42:43], v[42:43], v[120:121], v[220:221] op_sel:[0,1,0] op_sel_hi:[1,1,1]
    v_pk_mul_f32 v[224:225], v[42:43], v[42:43]
    v_pk_fma_f32 v[224:225], v[224:225], v[244:245], v[242:243]
    v_pk_mul_f32 v[224:225], v[224:225], v[42:43]
    v_exp_f32 v222, v222
    v_exp_f32 v223, v223
    v_exp_f32 v224, v224
    v_exp_f32 v225, v225
    v_pk_add_f32 v[222:223], v[222:223], s[74:75]
    v_pk_mul_f32 v[40:41], v[40:41], v[122:123] op_sel:[0,1] op_sel_hi:[1,1]
    v_pk_add_f32 v[224:225], v[224:225], s[74:75]
    v_pk_mul_f32 v[42:43], v[42:43], v[122:123] op_sel:[0,1] op_sel_hi:[1,1]
    v_rcp_f32 v222, v222
    v_rcp_f32 v223, v223
    v_rcp_f32 v224, v224
    v_rcp_f32 v225, v225
    s_nop 0
    v_pk_mul_f32 v[40:41], v[40:41], v[222:223]
    v_pk_mul_f32 v[42:43], v[42:43], v[224:225]
    v_cvt_pk_bf16_f32 v234, v40, v41
    v_cvt_pk_bf16_f32 v235, v42, v43
    s_add_u32 s58, s56, 98312
    buffer_store_dwordx2 v[234:235], v246, s[24:27], s58 offen sc1
    v_pk_fma_f32 v[44:45], v[140:141], v[124:125], v[44:45] op_sel_hi:[1,0,1] neg_lo:[1,0,0] neg_hi:[1,0,0]
    v_pk_fma_f32 v[44:45], v[44:45], v[124:125], v[218:219] op_sel:[0,1,0] op_sel_hi:[1,1,1]
    v_pk_mul_f32 v[222:223], v[44:45], v[44:45]
    v_pk_fma_f32 v[222:223], v[222:223], v[244:245], v[242:243]
    v_pk_mul_f32 v[222:223], v[222:223], v[44:45]
    v_pk_fma_f32 v[46:47], v[142:143], v[124:125], v[46:47] op_sel_hi:[1,0,1] neg_lo:[1,0,0] neg_hi:[1,0,0]
    v_pk_fma_f32 v[46:47], v[46:47], v[124:125], v[220:221] op_sel:[0,1,0] op_sel_hi:[1,1,1]
    v_pk_mul_f32 v[224:225], v[46:47], v[46:47]
    v_pk_fma_f32 v[224:225], v[224:225], v[244:245], v[242:243]
    v_pk_mul_f32 v[224:225], v[224:225], v[46:47]
    v_exp_f32 v222, v222
    v_exp_f32 v223, v223
    v_exp_f32 v224, v224
    v_exp_f32 v225, v225
    v_pk_add_f32 v[222:223], v[222:223], s[74:75]
    v_pk_mul_f32 v[44:45], v[44:45], v[126:127] op_sel:[0,1] op_sel_hi:[1,1]
    v_pk_add_f32 v[224:225], v[224:225], s[74:75]
    v_pk_mul_f32 v[46:47], v[46:47], v[126:127] op_sel:[0,1] op_sel_hi:[1,1]
    v_rcp_f32 v222, v222
    v_rcp_f32 v223, v223
    v_rcp_f32 v224, v224
    v_rcp_f32 v225, v225
    s_nop 0
    v_pk_mul_f32 v[44:45], v[44:45], v[222:223]
    v_pk_mul_f32 v[46:47], v[46:47], v[224:225]
    v_cvt_pk_bf16_f32 v238, v44, v45
    v_cvt_pk_bf16_f32 v239, v46, v47
    s_add_u32 s58, s56, 147464
    buffer_store_dwordx2 v[238:239], v246, s[24:27], s58 offen sc1
    ds_read_b128 v[140:143], v217 offset:64
    ds_read_b128 v[144:147], v217 offset:384
    s_waitcnt lgkmcnt(0)
    v_pk_add_f32 v[140:141], v[140:141], v[144:145]
    v_pk_add_f32 v[142:143], v[142:143], v[146:147]
    v_lshlrev_b32 v218, 16, v130
    v_and_b32 v219, 0xffff0000, v130
    v_lshlrev_b32 v220, 16, v131
    v_and_b32 v221, 0xffff0000, v131
    v_pk_fma_f32 v[48:49], v[140:141], v[112:113], v[48:49] op_sel_hi:[1,0,1] neg_lo:[1,0,0] neg_hi:[1,0,0]
    v_pk_fma_f32 v[48:49], v[48:49], v[112:113], v[218:219] op_sel:[0,1,0] op_sel_hi:[1,1,1]
    v_pk_mul_f32 v[222:223], v[48:49], v[48:49]
    v_pk_fma_f32 v[222:223], v[222:223], v[244:245], v[242:243]
    v_pk_mul_f32 v[222:223], v[222:223], v[48:49]
    v_pk_fma_f32 v[50:51], v[142:143], v[112:113], v[50:51] op_sel_hi:[1,0,1] neg_lo:[1,0,0] neg_hi:[1,0,0]
    v_pk_fma_f32 v[50:51], v[50:51], v[112:113], v[220:221] op_sel:[0,1,0] op_sel_hi:[1,1,1]
    v_pk_mul_f32 v[224:225], v[50:51], v[50:51]
    v_pk_fma_f32 v[224:225], v[224:225], v[244:245], v[242:243]
    v_pk_mul_f32 v[224:225], v[224:225], v[50:51]
    v_exp_f32 v222, v222
    v_exp_f32 v223, v223
    v_exp_f32 v224, v224
    v_exp_f32 v225, v225
    v_pk_add_f32 v[222:223], v[222:223], s[74:75]
    v_pk_mul_f32 v[48:49], v[48:49], v[114:115] op_sel:[0,1] op_sel_hi:[1,1]
    v_pk_add_f32 v[224:225], v[224:225], s[74:75]
    v_pk_mul_f32 v[50:51], v[50:51], v[114:115] op_sel:[0,1] op_sel_hi:[1,1]
    v_rcp_f32 v222, v222
    v_rcp_f32 v223, v223
    v_rcp_f32 v224, v224
    v_rcp_f32 v225, v225
    s_nop 0
    v_pk_mul_f32 v[48:49], v[48:49], v[222:223]
    v_pk_mul_f32 v[50:51], v[50:51], v[224:225]
    v_cvt_pk_bf16_f32 v226, v48, v49
    v_cvt_pk_bf16_f32 v227, v50, v51
    v_pk_fma_f32 v[52:53], v[140:141], v[116:117], v[52:53] op_sel_hi:[1,0,1] neg_lo:[1,0,0] neg_hi:[1,0,0]
    v_pk_fma_f32 v[52:53], v[52:53], v[116:117], v[218:219] op_sel:[0,1,0] op_sel_hi:[1,1,1]
    v_pk_mul_f32 v[222:223], v[52:53], v[52:53]
    v_pk_fma_f32 v[222:223], v[222:223], v[244:245], v[242:243]
    v_pk_mul_f32 v[222:223], v[222:223], v[52:53]
    v_pk_fma_f32 v[54:55], v[142:143], v[116:117], v[54:55] op_sel_hi:[1,0,1] neg_lo:[1,0,0] neg_hi:[1,0,0]
    v_pk_fma_f32 v[54:55], v[54:55], v[116:117], v[220:221] op_sel:[0,1,0] op_sel_hi:[1,1,1]
    v_pk_mul_f32 v[224:225], v[54:55], v[54:55]
    v_pk_fma_f32 v[224:225], v[224:225], v[244:245], v[242:243]
    v_pk_mul_f32 v[224:225], v[224:225], v[54:55]
    v_exp_f32 v222, v222
    v_exp_f32 v223, v223
    v_exp_f32 v224, v224
    v_exp_f32 v225, v225
    v_pk_add_f32 v[222:223], v[222:223], s[74:75]
    v_pk_mul_f32 v[52:53], v[52:53], v[118:119] op_sel:[0,1] op_sel_hi:[1,1]
    v_pk_add_f32 v[224:225], v[224:225], s[74:75]
    v_pk_mul_f32 v[54:55], v[54:55], v[118:119] op_sel:[0,1] op_sel_hi:[1,1]
    v_rcp_f32 v222, v222
    v_rcp_f32 v223, v223
    v_rcp_f32 v224, v224
    v_rcp_f32 v225, v225
    s_nop 0
    v_pk_mul_f32 v[52:53], v[52:53], v[222:223]
    v_pk_mul_f32 v[54:55], v[54:55], v[224:225]
    v_cvt_pk_bf16_f32 v230, v52, v53
    v_cvt_pk_bf16_f32 v231, v54, v55
    v_pk_fma_f32 v[56:57], v[140:141], v[120:121], v[56:57] op_sel_hi:[1,0,1] neg_lo:[1,0,0] neg_hi:[1,0,0]
    v_pk_fma_f32 v[56:57], v[56:57], v[120:121], v[218:219] op_sel:[0,1,0] op_sel_hi:[1,1,1]
    v_pk_mul_f32 v[222:223], v[56:57], v[56:57]
    v_pk_fma_f32 v[222:223], v[222:223], v[244:245], v[242:243]
    v_pk_mul_f32 v[222:223], v[222:223], v[56:57]
    v_pk_fma_f32 v[58:59], v[142:143], v[120:121], v[58:59] op_sel_hi:[1,0,1] neg_lo:[1,0,0] neg_hi:[1,0,0]
    v_pk_fma_f32 v[58:59], v[58:59], v[120:121], v[220:221] op_sel:[0,1,0] op_sel_hi:[1,1,1]
    v_pk_mul_f32 v[224:225], v[58:59], v[58:59]
    v_pk_fma_f32 v[224:225], v[224:225], v[244:245], v[242:243]
    v_pk_mul_f32 v[224:225], v[224:225], v[58:59]
    v_exp_f32 v222, v222
    v_exp_f32 v223, v223
    v_exp_f32 v224, v224
    v_exp_f32 v225, v225
    v_pk_add_f32 v[222:223], v[222:223], s[74:75]
    v_pk_mul_f32 v[56:57], v[56:57], v[122:123] op_sel:[0,1] op_sel_hi:[1,1]
    v_pk_add_f32 v[224:225], v[224:225], s[74:75]
    v_pk_mul_f32 v[58:59], v[58:59], v[122:123] op_sel:[0,1] op_sel_hi:[1,1]
    v_rcp_f32 v222, v222
    v_rcp_f32 v223, v223
    v_rcp_f32 v224, v224
    v_rcp_f32 v225, v225
    s_nop 0
    v_pk_mul_f32 v[56:57], v[56:57], v[222:223]
    v_pk_mul_f32 v[58:59], v[58:59], v[224:225]
    v_cvt_pk_bf16_f32 v234, v56, v57
    v_cvt_pk_bf16_f32 v235, v58, v59
    v_pk_fma_f32 v[60:61], v[140:141], v[124:125], v[60:61] op_sel_hi:[1,0,1] neg_lo:[1,0,0] neg_hi:[1,0,0]
    v_pk_fma_f32 v[60:61], v[60:61], v[124:125], v[218:219] op_sel:[0,1,0] op_sel_hi:[1,1,1]
    v_pk_mul_f32 v[222:223], v[60:61], v[60:61]
    v_pk_fma_f32 v[222:223], v[222:223], v[244:245], v[242:243]
    v_pk_mul_f32 v[222:223], v[222:223], v[60:61]
    v_pk_fma_f32 v[62:63], v[142:143], v[124:125], v[62:63] op_sel_hi:[1,0,1] neg_lo:[1,0,0] neg_hi:[1,0,0]
    v_pk_fma_f32 v[62:63], v[62:63], v[124:125], v[220:221] op_sel:[0,1,0] op_sel_hi:[1,1,1]
    v_pk_mul_f32 v[224:225], v[62:63], v[62:63]
    v_pk_fma_f32 v[224:225], v[224:225], v[244:245], v[242:243]
    v_pk_mul_f32 v[224:225], v[224:225], v[62:63]
    v_exp_f32 v222, v222
    v_exp_f32 v223, v223
    v_exp_f32 v224, v224
    v_exp_f32 v225, v225
    v_pk_add_f32 v[222:223], v[222:223], s[74:75]
    v_pk_mul_f32 v[60:61], v[60:61], v[126:127] op_sel:[0,1] op_sel_hi:[1,1]
    v_pk_add_f32 v[224:225], v[224:225], s[74:75]
    v_pk_mul_f32 v[62:63], v[62:63], v[126:127] op_sel:[0,1] op_sel_hi:[1,1]
    v_rcp_f32 v222, v222
    v_rcp_f32 v223, v223
    v_rcp_f32 v224, v224
    v_rcp_f32 v225, v225
    s_nop 0
    v_pk_mul_f32 v[60:61], v[60:61], v[222:223]
    v_pk_mul_f32 v[62:63], v[62:63], v[224:225]
    v_cvt_pk_bf16_f32 v238, v60, v61
    v_cvt_pk_bf16_f32 v239, v62, v63
    ds_read_b128 v[140:143], v217 offset:128
    ds_read_b128 v[144:147], v217 offset:448
    s_waitcnt lgkmcnt(0)
    v_pk_add_f32 v[140:141], v[140:141], v[144:145]
    v_pk_add_f32 v[142:143], v[142:143], v[146:147]
    v_lshlrev_b32 v218, 16, v132
    v_and_b32 v219, 0xffff0000, v132
    v_lshlrev_b32 v220, 16, v133
    v_and_b32 v221, 0xffff0000, v133
    v_pk_fma_f32 v[64:65], v[140:141], v[112:113], v[64:65] op_sel_hi:[1,0,1] neg_lo:[1,0,0] neg_hi:[1,0,0]
    v_pk_fma_f32 v[64:65], v[64:65], v[112:113], v[218:219] op_sel:[0,1,0] op_sel_hi:[1,1,1]
    v_pk_mul_f32 v[222:223], v[64:65], v[64:65]
    v_pk_fma_f32 v[222:223], v[222:223], v[244:245], v[242:243]
    v_pk_mul_f32 v[222:223], v[222:223], v[64:65]
    v_pk_fma_f32 v[66:67], v[142:143], v[112:113], v[66:67] op_sel_hi:[1,0,1] neg_lo:[1,0,0] neg_hi:[1,0,0]
    v_pk_fma_f32 v[66:67], v[66:67], v[112:113], v[220:221] op_sel:[0,1,0] op_sel_hi:[1,1,1]
    v_pk_mul_f32 v[224:225], v[66:67], v[66:67]
    v_pk_fma_f32 v[224:225], v[224:225], v[244:245], v[242:243]
    v_pk_mul_f32 v[224:225], v[224:225], v[66:67]
    v_exp_f32 v222, v222
    v_exp_f32 v223, v223
    v_exp_f32 v224, v224
    v_exp_f32 v225, v225
    v_pk_add_f32 v[222:223], v[222:223], s[74:75]
    v_pk_mul_f32 v[64:65], v[64:65], v[114:115] op_sel:[0,1] op_sel_hi:[1,1]
    v_pk_add_f32 v[224:225], v[224:225], s[74:75]
    v_pk_mul_f32 v[66:67], v[66:67], v[114:115] op_sel:[0,1] op_sel_hi:[1,1]
    v_rcp_f32 v222, v222
    v_rcp_f32 v223, v223
    v_rcp_f32 v224, v224
    v_rcp_f32 v225, v225
    s_nop 0
    v_pk_mul_f32 v[64:65], v[64:65], v[222:223]
    v_pk_mul_f32 v[66:67], v[66:67], v[224:225]
    v_cvt_pk_bf16_f32 v228, v64, v65
    v_cvt_pk_bf16_f32 v229, v66, v67
    s_lshr_b32 s56, s79, 4
    s_add_u32 s56, s56, 2
    s_lshr_b32 s56, s56, 1
    s_lshl_b32 s56, s56, 10
    s_add_u32 s56, s56, s72
    s_add_u32 s58, s56, 0
    buffer_store_dwordx4 v[226:229], v246, s[24:27], s58 offen sc1
    v_pk_fma_f32 v[68:69], v[140:141], v[116:117], v[68:69] op_sel_hi:[1,0,1] neg_lo:[1,0,0] neg_hi:[1,0,0]
    v_pk_fma_f32 v[68:69], v[68:69], v[116:117], v[218:219] op_sel:[0,1,0] op_sel_hi:[1,1,1]
    v_pk_mul_f32 v[222:223], v[68:69], v[68:69]
    v_pk_fma_f32 v[222:223], v[222:223], v[244:245], v[242:243]
    v_pk_mul_f32 v[222:223], v[222:223], v[68:69]
    v_pk_fma_f32 v[70:71], v[142:143], v[116:117], v[70:71] op_sel_hi:[1,0,1] neg_lo:[1,0,0] neg_hi:[1,0,0]
    v_pk_fma_f32 v[70:71], v[70:71], v[116:117], v[220:221] op_sel:[0,1,0] op_sel_hi:[1,1,1]
    v_pk_mul_f32 v[224:225], v[70:71], v[70:71]
    v_pk_fma_f32 v[224:225], v[224:225], v[244:245], v[242:243]
    v_pk_mul_f32 v[224:225], v[224:225], v[70:71]
    v_exp_f32 v222, v222
    v_exp_f32 v223, v223
    v_exp_f32 v224, v224
    v_exp_f32 v225, v225
    v_pk_add_f32 v[222:223], v[222:223], s[74:75]
    v_pk_mul_f32 v[68:69], v[68:69], v[118:119] op_sel:[0,1] op_sel_hi:[1,1]
    v_pk_add_f32 v[224:225], v[224:225], s[74:75]
    v_pk_mul_f32 v[70:71], v[70:71], v[118:119] op_sel:[0,1] op_sel_hi:[1,1]
    v_rcp_f32 v222, v222
    v_rcp_f32 v223, v223
    v_rcp_f32 v224, v224
    v_rcp_f32 v225, v225
    s_nop 0
    v_pk_mul_f32 v[68:69], v[68:69], v[222:223]
    v_pk_mul_f32 v[70:71], v[70:71], v[224:225]
    v_cvt_pk_bf16_f32 v232, v68, v69
    v_cvt_pk_bf16_f32 v233, v70, v71
    s_add_u32 s58, s56, 49152
    buffer_store_dwordx4 v[230:233], v246, s[24:27], s58 offen sc1
    v_pk_fma_f32 v[72:73], v[140:141], v[120:121], v[72:73] op_sel_hi:[1,0,1] neg_lo:[1,0,0] neg_hi:[1,0,0]
    v_pk_fma_f32 v[72:73], v[72:73], v[120:121], v[218:219] op_sel:[0,1,0] op_sel_hi:[1,1,1]
    v_pk_mul_f32 v[222:223], v[72:73], v[72:73]
    v_pk_fma_f32 v[222:223], v[222:223], v[244:245], v[242:243]
    v_pk_mul_f32 v[222:223], v[222:223], v[72:73]
    v_pk_fma_f32 v[74:75], v[142:143], v[120:121], v[74:75] op_sel_hi:[1,0,1] neg_lo:[1,0,0] neg_hi:[1,0,0]
    v_pk_fma_f32 v[74:75], v[74:75], v[120:121], v[220:221] op_sel:[0,1,0] op_sel_hi:[1,1,1]
    v_pk_mul_f32 v[224:225], v[74:75], v[74:75]
    v_pk_fma_f32 v[224:225], v[224:225], v[244:245], v[242:243]
    v_pk_mul_f32 v[224:225], v[224:225], v[74:75]
    v_exp_f32 v222, v222
    v_exp_f32 v223, v223
    v_exp_f32 v224, v224
    v_exp_f32 v225, v225
    v_pk_add_f32 v[222:223], v[222:223], s[74:75]
    v_pk_mul_f32 v[72:73], v[72:73], v[122:123] op_sel:[0,1] op_sel_hi:[1,1]
    v_pk_add_f32 v[224:225], v[224:225], s[74:75]
    v_pk_mul_f32 v[74:75], v[74:75], v[122:123] op_sel:[0,1] op_sel_hi:[1,1]
    v_rcp_f32 v222, v222
    v_rcp_f32 v223, v223
    v_rcp_f32 v224, v224
    v_rcp_f32 v225, v225
    s_nop 0
    v_pk_mul_f32 v[72:73], v[72:73], v[222:223]
    v_pk_mul_f32 v[74:75], v[74:75], v[224:225]
    v_cvt_pk_bf16_f32 v236, v72, v73
    v_cvt_pk_bf16_f32 v237, v74, v75
    s_add_u32 s58, s56, 98304
    buffer_store_dwordx4 v[234:237], v246, s[24:27], s58 offen sc1
    v_pk_fma_f32 v[76:77], v[140:141], v[124:125], v[76:77] op_sel_hi:[1,0,1] neg_lo:[1,0,0] neg_hi:[1,0,0]
    v_pk_fma_f32 v[76:77], v[76:77], v[124:125], v[218:219] op_sel:[0,1,0] op_sel_hi:[1,1,1]
    v_pk_mul_f32 v[222:223], v[76:77], v[76:77]
    v_pk_fma_f32 v[222:223], v[222:223], v[244:245], v[242:243]
    v_pk_mul_f32 v[222:223], v[222:223], v[76:77]
    v_pk_fma_f32 v[78:79], v[142:143], v[124:125], v[78:79] op_sel_hi:[1,0,1] neg_lo:[1,0,0] neg_hi:[1,0,0]
    v_pk_fma_f32 v[78:79], v[78:79], v[124:125], v[220:221] op_sel:[0,1,0] op_sel_hi:[1,1,1]
    v_pk_mul_f32 v[224:225], v[78:79], v[78:79]
    v_pk_fma_f32 v[224:225], v[224:225], v[244:245], v[242:243]
    v_pk_mul_f32 v[224:225], v[224:225], v[78:79]
    v_exp_f32 v222, v222
    v_exp_f32 v223, v223
    v_exp_f32 v224, v224
    v_exp_f32 v225, v225
    v_pk_add_f32 v[222:223], v[222:223], s[74:75]
    v_pk_mul_f32 v[76:77], v[76:77], v[126:127] op_sel:[0,1] op_sel_hi:[1,1]
    v_pk_add_f32 v[224:225], v[224:225], s[74:75]
    v_pk_mul_f32 v[78:79], v[78:79], v[126:127] op_sel:[0,1] op_sel_hi:[1,1]
    v_rcp_f32 v222, v222
    v_rcp_f32 v223, v223
    v_rcp_f32 v224, v224
    v_rcp_f32 v225, v225
    s_nop 0
    v_pk_mul_f32 v[76:77], v[76:77], v[222:223]
    v_pk_mul_f32 v[78:79], v[78:79], v[224:225]
    v_cvt_pk_bf16_f32 v240, v76, v77
    v_cvt_pk_bf16_f32 v241, v78, v79
    s_add_u32 s58, s56, 147456
    buffer_store_dwordx4 v[238:241], v246, s[24:27], s58 offen sc1
    ds_read_b128 v[140:143], v217 offset:192
    ds_read_b128 v[144:147], v217 offset:512
    s_waitcnt lgkmcnt(0)
    v_pk_add_f32 v[140:141], v[140:141], v[144:145]
    v_pk_add_f32 v[142:143], v[142:143], v[146:147]
    v_lshlrev_b32 v218, 16, v134
    v_and_b32 v219, 0xffff0000, v134
    v_lshlrev_b32 v220, 16, v135
    v_and_b32 v221, 0xffff0000, v135
    v_pk_fma_f32 v[80:81], v[140:141], v[112:113], v[80:81] op_sel_hi:[1,0,1] neg_lo:[1,0,0] neg_hi:[1,0,0]
    v_pk_fma_f32 v[80:81], v[80:81], v[112:113], v[218:219] op_sel:[0,1,0] op_sel_hi:[1,1,1]
    v_pk_mul_f32 v[222:223], v[80:81], v[80:81]
    v_pk_fma_f32 v[222:223], v[222:223], v[244:245], v[242:243]
    v_pk_mul_f32 v[222:223], v[222:223], v[80:81]
    v_pk_fma_f32 v[82:83], v[142:143], v[112:113], v[82:83] op_sel_hi:[1,0,1] neg_lo:[1,0,0] neg_hi:[1,0,0]
    v_pk_fma_f32 v[82:83], v[82:83], v[112:113], v[220:221] op_sel:[0,1,0] op_sel_hi:[1,1,1]
    v_pk_mul_f32 v[224:225], v[82:83], v[82:83]
    v_pk_fma_f32 v[224:225], v[224:225], v[244:245], v[242:243]
    v_pk_mul_f32 v[224:225], v[224:225], v[82:83]
    v_exp_f32 v222, v222
    v_exp_f32 v223, v223
    v_exp_f32 v224, v224
    v_exp_f32 v225, v225
    v_pk_add_f32 v[222:223], v[222:223], s[74:75]
    v_pk_mul_f32 v[80:81], v[80:81], v[114:115] op_sel:[0,1] op_sel_hi:[1,1]
    v_pk_add_f32 v[224:225], v[224:225], s[74:75]
    v_pk_mul_f32 v[82:83], v[82:83], v[114:115] op_sel:[0,1] op_sel_hi:[1,1]
    v_rcp_f32 v222, v222
    v_rcp_f32 v223, v223
    v_rcp_f32 v224, v224
    v_rcp_f32 v225, v225
    s_nop 0
    v_pk_mul_f32 v[80:81], v[80:81], v[222:223]
    v_pk_mul_f32 v[82:83], v[82:83], v[224:225]
    v_cvt_pk_bf16_f32 v226, v80, v81
    v_cvt_pk_bf16_f32 v227, v82, v83
    v_pk_fma_f32 v[84:85], v[140:141], v[116:117], v[84:85] op_sel_hi:[1,0,1] neg_lo:[1,0,0] neg_hi:[1,0,0]
    v_pk_fma_f32 v[84:85], v[84:85], v[116:117], v[218:219] op_sel:[0,1,0] op_sel_hi:[1,1,1]
    v_pk_mul_f32 v[222:223], v[84:85], v[84:85]
    v_pk_fma_f32 v[222:223], v[222:223], v[244:245], v[242:243]
    v_pk_mul_f32 v[222:223], v[222:223], v[84:85]
    v_pk_fma_f32 v[86:87], v[142:143], v[116:117], v[86:87] op_sel_hi:[1,0,1] neg_lo:[1,0,0] neg_hi:[1,0,0]
    v_pk_fma_f32 v[86:87], v[86:87], v[116:117], v[220:221] op_sel:[0,1,0] op_sel_hi:[1,1,1]
    v_pk_mul_f32 v[224:225], v[86:87], v[86:87]
    v_pk_fma_f32 v[224:225], v[224:225], v[244:245], v[242:243]
    v_pk_mul_f32 v[224:225], v[224:225], v[86:87]
    v_exp_f32 v222, v222
    v_exp_f32 v223, v223
    v_exp_f32 v224, v224
    v_exp_f32 v225, v225
    v_pk_add_f32 v[222:223], v[222:223], s[74:75]
    v_pk_mul_f32 v[84:85], v[84:85], v[118:119] op_sel:[0,1] op_sel_hi:[1,1]
    v_pk_add_f32 v[224:225], v[224:225], s[74:75]
    v_pk_mul_f32 v[86:87], v[86:87], v[118:119] op_sel:[0,1] op_sel_hi:[1,1]
    v_rcp_f32 v222, v222
    v_rcp_f32 v223, v223
    v_rcp_f32 v224, v224
    v_rcp_f32 v225, v225
    s_nop 0
    v_pk_mul_f32 v[84:85], v[84:85], v[222:223]
    v_pk_mul_f32 v[86:87], v[86:87], v[224:225]
    v_cvt_pk_bf16_f32 v230, v84, v85
    v_cvt_pk_bf16_f32 v231, v86, v87
    v_pk_fma_f32 v[88:89], v[140:141], v[120:121], v[88:89] op_sel_hi:[1,0,1] neg_lo:[1,0,0] neg_hi:[1,0,0]
    v_pk_fma_f32 v[88:89], v[88:89], v[120:121], v[218:219] op_sel:[0,1,0] op_sel_hi:[1,1,1]
    v_pk_mul_f32 v[222:223], v[88:89], v[88:89]
    v_pk_fma_f32 v[222:223], v[222:223], v[244:245], v[242:243]
    v_pk_mul_f32 v[222:223], v[222:223], v[88:89]
    v_pk_fma_f32 v[90:91], v[142:143], v[120:121], v[90:91] op_sel_hi:[1,0,1] neg_lo:[1,0,0] neg_hi:[1,0,0]
    v_pk_fma_f32 v[90:91], v[90:91], v[120:121], v[220:221] op_sel:[0,1,0] op_sel_hi:[1,1,1]
    v_pk_mul_f32 v[224:225], v[90:91], v[90:91]
    v_pk_fma_f32 v[224:225], v[224:225], v[244:245], v[242:243]
    v_pk_mul_f32 v[224:225], v[224:225], v[90:91]
    v_exp_f32 v222, v222
    v_exp_f32 v223, v223
    v_exp_f32 v224, v224
    v_exp_f32 v225, v225
    v_pk_add_f32 v[222:223], v[222:223], s[74:75]
    v_pk_mul_f32 v[88:89], v[88:89], v[122:123] op_sel:[0,1] op_sel_hi:[1,1]
    v_pk_add_f32 v[224:225], v[224:225], s[74:75]
    v_pk_mul_f32 v[90:91], v[90:91], v[122:123] op_sel:[0,1] op_sel_hi:[1,1]
    v_rcp_f32 v222, v222
    v_rcp_f32 v223, v223
    v_rcp_f32 v224, v224
    v_rcp_f32 v225, v225
    s_nop 0
    v_pk_mul_f32 v[88:89], v[88:89], v[222:223]
    v_pk_mul_f32 v[90:91], v[90:91], v[224:225]
    v_cvt_pk_bf16_f32 v234, v88, v89
    v_cvt_pk_bf16_f32 v235, v90, v91
    v_pk_fma_f32 v[92:93], v[140:141], v[124:125], v[92:93] op_sel_hi:[1,0,1] neg_lo:[1,0,0] neg_hi:[1,0,0]
    v_pk_fma_f32 v[92:93], v[92:93], v[124:125], v[218:219] op_sel:[0,1,0] op_sel_hi:[1,1,1]
    v_pk_mul_f32 v[222:223], v[92:93], v[92:93]
    v_pk_fma_f32 v[222:223], v[222:223], v[244:245], v[242:243]
    v_pk_mul_f32 v[222:223], v[222:223], v[92:93]
    v_pk_fma_f32 v[94:95], v[142:143], v[124:125], v[94:95] op_sel_hi:[1,0,1] neg_lo:[1,0,0] neg_hi:[1,0,0]
    v_pk_fma_f32 v[94:95], v[94:95], v[124:125], v[220:221] op_sel:[0,1,0] op_sel_hi:[1,1,1]
    v_pk_mul_f32 v[224:225], v[94:95], v[94:95]
    v_pk_fma_f32 v[224:225], v[224:225], v[244:245], v[242:243]
    v_pk_mul_f32 v[224:225], v[224:225], v[94:95]
    v_exp_f32 v222, v222
    v_exp_f32 v223, v223
    v_exp_f32 v224, v224
    v_exp_f32 v225, v225
    v_pk_add_f32 v[222:223], v[222:223], s[74:75]
    v_pk_mul_f32 v[92:93], v[92:93], v[126:127] op_sel:[0,1] op_sel_hi:[1,1]
    v_pk_add_f32 v[224:225], v[224:225], s[74:75]
    v_pk_mul_f32 v[94:95], v[94:95], v[126:127] op_sel:[0,1] op_sel_hi:[1,1]
    v_rcp_f32 v222, v222
    v_rcp_f32 v223, v223
    v_rcp_f32 v224, v224
    v_rcp_f32 v225, v225
    s_nop 0
    v_pk_mul_f32 v[92:93], v[92:93], v[222:223]
    v_pk_mul_f32 v[94:95], v[94:95], v[224:225]
    v_cvt_pk_bf16_f32 v238, v92, v93
    v_cvt_pk_bf16_f32 v239, v94, v95
    ds_read_b128 v[140:143], v217 offset:256
    ds_read_b128 v[144:147], v217 offset:576
    s_waitcnt lgkmcnt(0)
    v_pk_add_f32 v[140:141], v[140:141], v[144:145]
    v_pk_add_f32 v[142:143], v[142:143], v[146:147]
    v_lshlrev_b32 v218, 16, v136
    v_and_b32 v219, 0xffff0000, v136
    v_lshlrev_b32 v220, 16, v137
    v_and_b32 v221, 0xffff0000, v137
    v_pk_fma_f32 v[96:97], v[140:141], v[112:113], v[96:97] op_sel_hi:[1,0,1] neg_lo:[1,0,0] neg_hi:[1,0,0]
    v_pk_fma_f32 v[96:97], v[96:97], v[112:113], v[218:219] op_sel:[0,1,0] op_sel_hi:[1,1,1]
    v_pk_mul_f32 v[222:223], v[96:97], v[96:97]
    v_pk_fma_f32 v[222:223], v[222:223], v[244:245], v[242:243]
    v_pk_mul_f32 v[222:223], v[222:223], v[96:97]
    v_pk_fma_f32 v[98:99], v[142:143], v[112:113], v[98:99] op_sel_hi:[1,0,1] neg_lo:[1,0,0] neg_hi:[1,0,0]
    v_pk_fma_f32 v[98:99], v[98:99], v[112:113], v[220:221] op_sel:[0,1,0] op_sel_hi:[1,1,1]
    v_pk_mul_f32 v[224:225], v[98:99], v[98:99]
    v_pk_fma_f32 v[224:225], v[224:225], v[244:245], v[242:243]
    v_pk_mul_f32 v[224:225], v[224:225], v[98:99]
    v_exp_f32 v222, v222
    v_exp_f32 v223, v223
    v_exp_f32 v224, v224
    v_exp_f32 v225, v225
    v_pk_add_f32 v[222:223], v[222:223], s[74:75]
    v_pk_mul_f32 v[96:97], v[96:97], v[114:115] op_sel:[0,1] op_sel_hi:[1,1]
    v_pk_add_f32 v[224:225], v[224:225], s[74:75]
    v_pk_mul_f32 v[98:99], v[98:99], v[114:115] op_sel:[0,1] op_sel_hi:[1,1]
    v_rcp_f32 v222, v222
    v_rcp_f32 v223, v223
    v_rcp_f32 v224, v224
    v_rcp_f32 v225, v225
    s_nop 0
    v_pk_mul_f32 v[96:97], v[96:97], v[222:223]
    v_pk_mul_f32 v[98:99], v[98:99], v[224:225]
    v_cvt_pk_bf16_f32 v228, v96, v97
    v_cvt_pk_bf16_f32 v229, v98, v99
    s_lshr_b32 s56, s79, 4
    s_add_u32 s56, s56, 4
    s_lshr_b32 s56, s56, 1
    s_lshl_b32 s56, s56, 10
    s_add_u32 s56, s56, s72
    s_add_u32 s58, s56, 0
    buffer_store_dwordx4 v[226:229], v246, s[24:27], s58 offen sc1
    v_pk_fma_f32 v[100:101], v[140:141], v[116:117], v[100:101] op_sel_hi:[1,0,1] neg_lo:[1,0,0] neg_hi:[1,0,0]
    v_pk_fma_f32 v[100:101], v[100:101], v[116:117], v[218:219] op_sel:[0,1,0] op_sel_hi:[1,1,1]
    v_pk_mul_f32 v[222:223], v[100:101], v[100:101]
    v_pk_fma_f32 v[222:223], v[222:223], v[244:245], v[242:243]
    v_pk_mul_f32 v[222:223], v[222:223], v[100:101]
    v_pk_fma_f32 v[102:103], v[142:143], v[116:117], v[102:103] op_sel_hi:[1,0,1] neg_lo:[1,0,0] neg_hi:[1,0,0]
    v_pk_fma_f32 v[102:103], v[102:103], v[116:117], v[220:221] op_sel:[0,1,0] op_sel_hi:[1,1,1]
    v_pk_mul_f32 v[224:225], v[102:103], v[102:103]
    v_pk_fma_f32 v[224:225], v[224:225], v[244:245], v[242:243]
    v_pk_mul_f32 v[224:225], v[224:225], v[102:103]
    v_exp_f32 v222, v222
    v_exp_f32 v223, v223
    v_exp_f32 v224, v224
    v_exp_f32 v225, v225
    v_pk_add_f32 v[222:223], v[222:223], s[74:75]
    v_pk_mul_f32 v[100:101], v[100:101], v[118:119] op_sel:[0,1] op_sel_hi:[1,1]
    v_pk_add_f32 v[224:225], v[224:225], s[74:75]
    v_pk_mul_f32 v[102:103], v[102:103], v[118:119] op_sel:[0,1] op_sel_hi:[1,1]
    v_rcp_f32 v222, v222
    v_rcp_f32 v223, v223
    v_rcp_f32 v224, v224
    v_rcp_f32 v225, v225
    s_nop 0
    v_pk_mul_f32 v[100:101], v[100:101], v[222:223]
    v_pk_mul_f32 v[102:103], v[102:103], v[224:225]
    v_cvt_pk_bf16_f32 v232, v100, v101
    v_cvt_pk_bf16_f32 v233, v102, v103
    s_add_u32 s58, s56, 49152
    buffer_store_dwordx4 v[230:233], v246, s[24:27], s58 offen sc1
    v_pk_fma_f32 v[104:105], v[140:141], v[120:121], v[104:105] op_sel_hi:[1,0,1] neg_lo:[1,0,0] neg_hi:[1,0,0]
    v_pk_fma_f32 v[104:105], v[104:105], v[120:121], v[218:219] op_sel:[0,1,0] op_sel_hi:[1,1,1]
    v_pk_mul_f32 v[222:223], v[104:105], v[104:105]
    v_pk_fma_f32 v[222:223], v[222:223], v[244:245], v[242:243]
    v_pk_mul_f32 v[222:223], v[222:223], v[104:105]
    v_pk_fma_f32 v[106:107], v[142:143], v[120:121], v[106:107] op_sel_hi:[1,0,1] neg_lo:[1,0,0] neg_hi:[1,0,0]
    v_pk_fma_f32 v[106:107], v[106:107], v[120:121], v[220:221] op_sel:[0,1,0] op_sel_hi:[1,1,1]
    v_pk_mul_f32 v[224:225], v[106:107], v[106:107]
    v_pk_fma_f32 v[224:225], v[224:225], v[244:245], v[242:243]
    v_pk_mul_f32 v[224:225], v[224:225], v[106:107]
    v_exp_f32 v222, v222
    v_exp_f32 v223, v223
    v_exp_f32 v224, v224
    v_exp_f32 v225, v225
    v_pk_add_f32 v[222:223], v[222:223], s[74:75]
    v_pk_mul_f32 v[104:105], v[104:105], v[122:123] op_sel:[0,1] op_sel_hi:[1,1]
    v_pk_add_f32 v[224:225], v[224:225], s[74:75]
    v_pk_mul_f32 v[106:107], v[106:107], v[122:123] op_sel:[0,1] op_sel_hi:[1,1]
    v_rcp_f32 v222, v222
    v_rcp_f32 v223, v223
    v_rcp_f32 v224, v224
    v_rcp_f32 v225, v225
    s_nop 0
    v_pk_mul_f32 v[104:105], v[104:105], v[222:223]
    v_pk_mul_f32 v[106:107], v[106:107], v[224:225]
    v_cvt_pk_bf16_f32 v236, v104, v105
    v_cvt_pk_bf16_f32 v237, v106, v107
    s_add_u32 s58, s56, 98304
    buffer_store_dwordx4 v[234:237], v246, s[24:27], s58 offen sc1
    v_pk_fma_f32 v[108:109], v[140:141], v[124:125], v[108:109] op_sel_hi:[1,0,1] neg_lo:[1,0,0] neg_hi:[1,0,0]
    v_pk_fma_f32 v[108:109], v[108:109], v[124:125], v[218:219] op_sel:[0,1,0] op_sel_hi:[1,1,1]
    v_pk_mul_f32 v[222:223], v[108:109], v[108:109]
    v_pk_fma_f32 v[222:223], v[222:223], v[244:245], v[242:243]
    v_pk_mul_f32 v[222:223], v[222:223], v[108:109]
    v_pk_fma_f32 v[110:111], v[142:143], v[124:125], v[110:111] op_sel_hi:[1,0,1] neg_lo:[1,0,0] neg_hi:[1,0,0]
    v_pk_fma_f32 v[110:111], v[110:111], v[124:125], v[220:221] op_sel:[0,1,0] op_sel_hi:[1,1,1]
    v_pk_mul_f32 v[224:225], v[110:111], v[110:111]
    v_pk_fma_f32 v[224:225], v[224:225], v[244:245], v[242:243]
    v_pk_mul_f32 v[224:225], v[224:225], v[110:111]
    v_exp_f32 v222, v222
    v_exp_f32 v223, v223
    v_exp_f32 v224, v224
    v_exp_f32 v225, v225
    v_pk_add_f32 v[222:223], v[222:223], s[74:75]
    v_pk_mul_f32 v[108:109], v[108:109], v[126:127] op_sel:[0,1] op_sel_hi:[1,1]
    v_pk_add_f32 v[224:225], v[224:225], s[74:75]
    v_pk_mul_f32 v[110:111], v[110:111], v[126:127] op_sel:[0,1] op_sel_hi:[1,1]
    v_rcp_f32 v222, v222
    v_rcp_f32 v223, v223
    v_rcp_f32 v224, v224
    v_rcp_f32 v225, v225
    s_nop 0
    v_pk_mul_f32 v[108:109], v[108:109], v[222:223]
    v_pk_mul_f32 v[110:111], v[110:111], v[224:225]
    v_cvt_pk_bf16_f32 v240, v108, v109
    v_cvt_pk_bf16_f32 v241, v110, v111
    s_add_u32 s58, s56, 147456
    buffer_store_dwordx4 v[238:241], v246, s[24:27], s58 offen sc1
L_ccj_57:
    s_lshl_b32 s79, s49, 4
    s_add_u32 s79, s79, s68
    v_mov_b32 v136, 0x3f803f80
    v_mov_b32 v137, 0x3f803f80
    v_mov_b32 v138, 0x3f803f80
    v_mov_b32 v139, 0x3f803f80
    s_barrier
    v_add_u32 v27, 73728, v25
    ds_read_b64_tr_b16 v[112:113], v27 offset:0
    ds_read_b64_tr_b16 v[114:115], v27 offset:256
    ds_read_b64_tr_b16 v[120:121], v27 offset:2048
    ds_read_b64_tr_b16 v[122:123], v27 offset:2304
    s_waitcnt lgkmcnt(2)
    v_mfma_f32_16x16x32_bf16 v[216:219], v[112:115], a[0:3], 0
    ds_read_b64_tr_b16 v[128:129], v27 offset:4096
    v_mfma_f32_16x16x32_bf16 v[220:223], v[112:115], a[80:83], 0
    ds_read_b64_tr_b16 v[130:131], v27 offset:4352
    s_lshl_b32 s55, s48, 6
    v_mfma_f32_16x16x32_bf16 v[224:227], v[112:115], a[160:163], 0
    v_mfma_f32_16x16x32_bf16 v[228:231], v[112:115], a[240:243], 0
    v_mfma_f32_16x16x32_bf16 v[248:251], v[112:115], v[136:139], 0
    s_waitcnt lgkmcnt(2)
    v_mfma_f32_16x16x32_bf16 v[216:219], v[120:123], a[4:7], v[216:219]
    ds_read_b64_tr_b16 v[112:113], v27 offset:6144
    v_mfma_f32_16x16x32_bf16 v[220:223], v[120:123], a[84:87], v[220:223]
    ds_read_b64_tr_b16 v[114:115], v27 offset:6400
    v_mfma_f32_16x16x32_bf16 v[224:227], v[120:123], a[164:167], v[224:227]
    s_add_u32 s55, s55, s50
    v_mfma_f32_16x16x32_bf16 v[228:231], v[120:123], a[244:247], v[228:231]
    v_mfma_f32_16x16x32_bf16 v[248:251], v[120:123], v[136:139], v[248:251]
    s_waitcnt lgkmcnt(2)
    v_mfma_f32_16x16x32_bf16 v[216:219], v[128:131], a[8:11], v[216:219]
    ds_read_b64_tr_b16 v[120:121], v27 offset:8192
    v_mfma_f32_16x16x32_bf16 v[220:223], v[128:131], a[88:91], v[220:223]
    ds_read_b64_tr_b16 v[122:123], v27 offset:8448
    v_mfma_f32_16x16x32_bf16 v[224:227], v[128:131], a[168:171], v[224:227]
    v_mfma_f32_16x16x32_bf16 v[228:231], v[128:131], a[248:251], v[228:231]
    v_mfma_f32_16x16x32_bf16 v[248:251], v[128:131], v[136:139], v[248:251]
    v_add_u32 v17, s55, v2
    s_waitcnt lgkmcnt(2)
    v_mfma_f32_16x16x32_bf16 v[216:219], v[112:115], a[12:15], v[216:219]
    ds_read_b64_tr_b16 v[128:129], v27 offset:10240
    v_mfma_f32_16x16x32_bf16 v[220:223], v[112:115], a[92:95], v[220:223]
    ds_read_b64_tr_b16 v[130:131], v27 offset:10496
    v_mfma_f32_16x16x32_bf16 v[224:227], v[112:115], a[172:175], v[224:227]
    v_mfma_f32_16x16x32_bf16 v[228:231], v[112:115], a[252:255], v[228:231]
    v_mfma_f32_16x16x32_bf16 v[248:251], v[112:115], v[136:139], v[248:251]
    s_waitcnt lgkmcnt(2)
    v_mfma_f32_16x16x32_bf16 v[216:219], v[120:123], a[16:19], v[216:219]
    ds_read_b64_tr_b16 v[112:113], v27 offset:12288
    v_mfma_f32_16x16x32_bf16 v[220:223], v[120:123], a[96:99], v[220:223]
    ds_read_b64_tr_b16 v[114:115], v27 offset:12544
    v_lshlrev_b32 v17, 4, v17
    v_mfma_f32_16x16x32_bf16 v[224:227], v[120:123], a[176:179], v[224:227]
    v_mfma_f32_16x16x32_bf16 v[228:231], v[120:123], v[152:155], v[228:231]
    v_mfma_f32_16x16x32_bf16 v[248:251], v[120:123], v[136:139], v[248:251]
    s_waitcnt lgkmcnt(2)
    v_mfma_f32_16x16x32_bf16 v[216:219], v[128:131], a[20:23], v[216:219]
    ds_read_b64_tr_b16 v[120:121], v27 offset:14336
    v_mfma_f32_16x16x32_bf16 v[220:223], v[128:131], a[100:103], v[220:223]
    ds_read_b64_tr_b16 v[122:123], v27 offset:14592
    v_mfma_f32_16x16x32_bf16 v[224:227], v[128:131], a[180:183], v[224:227]
    buffer_load_dwordx4 v[32:35], v17, s[24:27], 0 offen offset:0 sc1
    v_mfma_f32_16x16x32_bf16 v[228:231], v[128:131], v[156:159], v[228:231]
    v_mfma_f32_16x16x32_bf16 v[248:251], v[128:131], v[136:139], v[248:251]
    s_waitcnt lgkmcnt(2)
    v_mfma_f32_16x16x32_bf16 v[216:219], v[112:115], a[24:27], v[216:219]
    ds_read_b64_tr_b16 v[128:129], v27 offset:16384
    v_mfma_f32_16x16x32_bf16 v[220:223], v[112:115], a[104:107], v[220:223]
    ds_read_b64_tr_b16 v[130:131], v27 offset:16640
    v_mfma_f32_16x16x32_bf16 v[224:227], v[112:115], a[184:187], v[224:227]
    v_mfma_f32_16x16x32_bf16 v[228:231], v[112:115], v[160:163], v[228:231]
    v_mfma_f32_16x16x32_bf16 v[248:251], v[112:115], v[136:139], v[248:251]
    buffer_load_dwordx4 v[36:39], v17, s[24:27], 0 offen offset:256 sc1
    s_waitcnt lgkmcnt(2)
    v_mfma_f32_16x16x32_bf16 v[216:219], v[120:123], a[28:31], v[216:219]
    ds_read_b64_tr_b16 v[112:113], v27 offset:18432
    v_mfma_f32_16x16x32_bf16 v[220:223], v[120:123], a[108:111], v[220:223]
    ds_read_b64_tr_b16 v[114:115], v27 offset:18688
    v_mfma_f32_16x16x32_bf16 v[224:227], v[120:123], a[188:191], v[224:227]
    v_mfma_f32_16x16x32_bf16 v[228:231], v[120:123], v[164:167], v[228:231]
    v_mfma_f32_16x16x32_bf16 v[248:251], v[120:123], v[136:139], v[248:251]
    s_waitcnt lgkmcnt(2)
    v_mfma_f32_16x16x32_bf16 v[216:219], v[128:131], a[32:35], v[216:219]
    ds_read_b64_tr_b16 v[120:121], v27 offset:20480
    v_mfma_f32_16x16x32_bf16 v[220:223], v[128:131], a[112:115], v[220:223]
    ds_read_b64_tr_b16 v[122:123], v27 offset:20736
    buffer_load_dwordx4 v[40:43], v17, s[24:27], 0 offen offset:512 sc1
    v_mfma_f32_16x16x32_bf16 v[224:227], v[128:131], a[192:195], v[224:227]
    v_mfma_f32_16x16x32_bf16 v[228:231], v[128:131], v[168:171], v[228:231]
    v_mfma_f32_16x16x32_bf16 v[248:251], v[128:131], v[136:139], v[248:251]
    s_waitcnt lgkmcnt(2)
    v_mfma_f32_16x16x32_bf16 v[216:219], v[112:115], a[36:39], v[216:219]
    ds_read_b64_tr_b16 v[128:129], v27 offset:22528
    v_mfma_f32_16x16x32_bf16 v[220:223], v[112:115], a[116:119], v[220:223]
    ds_read_b64_tr_b16 v[130:131], v27 offset:22784
    v_mfma_f32_16x16x32_bf16 v[224:227], v[112:115], a[196:199], v[224:227]
    buffer_load_dwordx4 v[44:47], v17, s[24:27], 0 offen offset:768 sc1
    v_mfma_f32_16x16x32_bf16 v[228:231], v[112:115], v[172:175], v[228:231]
    v_mfma_f32_16x16x32_bf16 v[248:251], v[112:115], v[136:139], v[248:251]
    s_waitcnt lgkmcnt(2)
    v_mfma_f32_16x16x32_bf16 v[216:219], v[120:123], a[40:43], v[216:219]
    ds_read_b64_tr_b16 v[112:113], v27 offset:24576
    v_mfma_f32_16x16x32_bf16 v[220:223], v[120:123], a[120:123], v[220:223]
    ds_read_b64_tr_b16 v[114:115], v27 offset:24832
    v_mfma_f32_16x16x32_bf16 v[224:227], v[120:123], a[200:203], v[224:227]
    v_mfma_f32_16x16x32_bf16 v[228:231], v[120:123], v[176:179], v[228:231]
    v_mfma_f32_16x16x32_bf16 v[248:251], v[120:123], v[136:139], v[248:251]
    v_lshlrev_b32 v18, 3, v3
    s_waitcnt lgkmcnt(2)
    v_mfma_f32_16x16x32_bf16 v[216:219], v[128:131], a[44:47], v[216:219]
    ds_read_b64_tr_b16 v[120:121], v27 offset:26624
    v_mfma_f32_16x16x32_bf16 v[220:223], v[128:131], a[124:127], v[220:223]
    ds_read_b64_tr_b16 v[122:123], v27 offset:26880
    v_mfma_f32_16x16x32_bf16 v[224:227], v[128:131], a[204:207], v[224:227]
    v_mfma_f32_16x16x32_bf16 v[228:231], v[128:131], v[180:183], v[228:231]
    v_mfma_f32_16x16x32_bf16 v[248:251], v[128:131], v[136:139], v[248:251]
    s_waitcnt lgkmcnt(2)
    v_mfma_f32_16x16x32_bf16 v[216:219], v[112:115], a[48:51], v[216:219]
    ds_read_b64_tr_b16 v[128:129], v27 offset:28672
    v_mfma_f32_16x16x32_bf16 v[220:223], v[112:115], a[128:131], v[220:223]
    ds_read_b64_tr_b16 v[130:131], v27 offset:28928
    s_lshl_b32 s56, s79, 1
    v_mfma_f32_16x16x32_bf16 v[224:227], v[112:115], a[208:211], v[224:227]
    v_mfma_f32_16x16x32_bf16 v[228:231], v[112:115], v[184:187], v[228:231]
    v_mfma_f32_16x16x32_bf16 v[248:251], v[112:115], v[136:139], v[248:251]
    s_waitcnt lgkmcnt(2)
    v_mfma_f32_16x16x32_bf16 v[216:219], v[120:123], a[52:55], v[216:219]
    ds_read_b64_tr_b16 v[112:113], v27 offset:30720
    v_mfma_f32_16x16x32_bf16 v[220:223], v[120:123], a[132:135], v[220:223]
    ds_read_b64_tr_b16 v[114:115], v27 offset:30976
    v_mfma_f32_16x16x32_bf16 v[224:227], v[120:123], a[212:215], v[224:227]
    v_add_u32 v18, s56, v18
    v_mfma_f32_16x16x32_bf16 v[228:231], v[120:123], v[188:191], v[228:231]
    v_mfma_f32_16x16x32_bf16 v[248:251], v[120:123], v[136:139], v[248:251]
    s_waitcnt lgkmcnt(2)
    v_mfma_f32_16x16x32_bf16 v[216:219], v[128:131], a[56:59], v[216:219]
    v_add_u32 v27, 110592, v25
    ds_read_b64_tr_b16 v[120:121], v27 offset:0
    v_mfma_f32_16x16x32_bf16 v[220:223], v[128:131], a[136:139], v[220:223]
    ds_read_b64_tr_b16 v[122:123], v27 offset:256
    v_mfma_f32_16x16x32_bf16 v[224:227], v[128:131], a[216:219], v[224:227]
    v_mfma_f32_16x16x32_bf16 v[228:231], v[128:131], v[192:195], v[228:231]
    v_mfma_f32_16x16x32_bf16 v[248:251], v[128:131], v[136:139], v[248:251]
    global_load_dwordx2 v[48:49], v18, s[32:33] offset:0
    s_waitcnt lgkmcnt(2)
    v_mfma_f32_16x16x32_bf16 v[216:219], v[112:115], a[60:63], v[216:219]
    ds_read_b64_tr_b16 v[128:129], v27 offset:2048
    v_mfma_f32_16x16x32_bf16 v[220:223], v[112:115], a[140:143], v[220:223]
    ds_read_b64_tr_b16 v[130:131], v27 offset:2304
    v_mfma_f32_16x16x32_bf16 v[224:227], v[112:115], a[220:223], v[224:227]
    v_mfma_f32_16x16x32_bf16 v[228:231], v[112:115], v[196:199], v[228:231]
    v_mfma_f32_16x16x32_bf16 v[248:251], v[112:115], v[136:139], v[248:251]
    s_waitcnt lgkmcnt(2)
    v_mfma_f32_16x16x32_bf16 v[216:219], v[120:123], a[64:67], v[216:219]
    ds_read_b64_tr_b16 v[112:113], v27 offset:4096
    v_mfma_f32_16x16x32_bf16 v[220:223], v[120:123], a[144:147], v[220:223]
    ds_read_b64_tr_b16 v[114:115], v27 offset:4352
    v_mfma_f32_16x16x32_bf16 v[224:227], v[120:123], a[224:227], v[224:227]
    v_mfma_f32_16x16x32_bf16 v[228:231], v[120:123], v[200:203], v[228:231]
    v_mfma_f32_16x16x32_bf16 v[248:251], v[120:123], v[136:139], v[248:251]
    s_waitcnt lgkmcnt(2)
    v_mfma_f32_16x16x32_bf16 v[216:219], v[128:131], a[68:71], v[216:219]
    ds_read_b64_tr_b16 v[120:121], v27 offset:6144
    v_mfma_f32_16x16x32_bf16 v[220:223], v[128:131], a[148:151], v[220:223]
    ds_read_b64_tr_b16 v[122:123], v27 offset:6400
    v_mfma_f32_16x16x32_bf16 v[224:227], v[128:131], a[228:231], v[224:227]
    v_mfma_f32_16x16x32_bf16 v[228:231], v[128:131], v[204:207], v[228:231]
    v_mfma_f32_16x16x32_bf16 v[248:251], v[128:131], v[136:139], v[248:251]
    s_waitcnt lgkmcnt(2)
    v_mfma_f32_16x16x32_bf16 v[216:219], v[112:115], a[72:75], v[216:219]
    v_mfma_f32_16x16x32_bf16 v[220:223], v[112:115], a[152:155], v[220:223]
    v_mfma_f32_16x16x32_bf16 v[224:227], v[112:115], a[232:235], v[224:227]
    v_mfma_f32_16x16x32_bf16 v[228:231], v[112:115], v[208:211], v[228:231]
    v_mfma_f32_16x16x32_bf16 v[248:251], v[112:115], v[136:139], v[248:251]
    s_waitcnt lgkmcnt(0)
    v_mfma_f32_16x16x32_bf16 v[216:219], v[120:123], a[76:79], v[216:219]
    v_mfma_f32_16x16x32_bf16 v[220:223], v[120:123], a[156:159], v[220:223]
    v_mfma_f32_16x16x32_bf16 v[224:227], v[120:123], a[236:239], v[224:227]
    v_mfma_f32_16x16x32_bf16 v[228:231], v[120:123], v[212:215], v[228:231]
    v_mfma_f32_16x16x32_bf16 v[248:251], v[120:123], v[136:139], v[248:251]
    s_waitcnt vmcnt(0)
    s_barrier
    s_cmp_eq_u32 s49, 1
    s_cbranch_scc1 L_cc1_58
    v_mov_b32 v80, 0xc0135761
    v_mov_b32 v81, 0xc0135761
    v_mov_b32 v82, 0xbdd2d3e8
    v_mov_b32 v83, 0xbdd2d3e8
    s_mov_b32 s74, 1.0
    s_mov_b32 s75, 1.0
    s_lshr_b32 s56, s50, 4
    s_lshl_b32 s57, s48, 2
    s_add_u32 s56, s56, s57
    s_mul_i32 s56, s56, 49152
    s_add_u32 s72, s56, 10485760
    v_lshlrev_b32 v84, 4, v1
    v_lshlrev_b32 v56, 16, v48
    v_and_b32 v57, 0xffff0000, v48
    v_lshlrev_b32 v58, 16, v49
    v_and_b32 v59, 0xffff0000, v49
    v_pk_fma_f32 v[216:217], v[248:249], v[32:33], v[216:217] op_sel_hi:[1,0,1] neg_lo:[1,0,0] neg_hi:[1,0,0]
    v_pk_fma_f32 v[216:217], v[216:217], v[32:33], v[56:57] op_sel:[0,1,0] op_sel_hi:[1,1,1]
    v_pk_mul_f32 v[60:61], v[216:217], v[216:217]
    v_pk_fma_f32 v[60:61], v[60:61], v[82:83], v[80:81]
    v_pk_mul_f32 v[60:61], v[60:61], v[216:217]
    v_pk_fma_f32 v[218:219], v[250:251], v[32:33], v[218:219] op_sel_hi:[1,0,1] neg_lo:[1,0,0] neg_hi:[1,0,0]
    v_pk_fma_f32 v[218:219], v[218:219], v[32:33], v[58:59] op_sel:[0,1,0] op_sel_hi:[1,1,1]
    v_pk_mul_f32 v[62:63], v[218:219], v[218:219]
    v_pk_fma_f32 v[62:63], v[62:63], v[82:83], v[80:81]
    v_pk_mul_f32 v[62:63], v[62:63], v[218:219]
    v_exp_f32 v60, v60
    v_exp_f32 v61, v61
    v_exp_f32 v62, v62
    v_exp_f32 v63, v63
    v_pk_add_f32 v[60:61], v[60:61], s[74:75]
    v_pk_mul_f32 v[216:217], v[216:217], v[34:35] op_sel:[0,1] op_sel_hi:[1,1]
    v_pk_add_f32 v[62:63], v[62:63], s[74:75]
    v_pk_mul_f32 v[218:219], v[218:219], v[34:35] op_sel:[0,1] op_sel_hi:[1,1]
    v_rcp_f32 v60, v60
    v_rcp_f32 v61, v61
    v_rcp_f32 v62, v62
    v_rcp_f32 v63, v63
    s_nop 0
    v_pk_mul_f32 v[216:217], v[216:217], v[60:61]
    v_pk_mul_f32 v[218:219], v[218:219], v[62:63]
    v_cvt_pk_bf16_f32 v64, v216, v217
    v_cvt_pk_bf16_f32 v65, v218, v219
    s_lshr_b32 s56, s79, 4
    s_add_u32 s56, s56, 0
    s_lshr_b32 s56, s56, 1
    s_lshl_b32 s56, s56, 10
    s_add_u32 s56, s56, s72
    s_add_u32 s58, s56, 0
    buffer_store_dwordx2 v[64:65], v84, s[24:27], s58 offen sc1
    v_pk_fma_f32 v[220:221], v[248:249], v[36:37], v[220:221] op_sel_hi:[1,0,1] neg_lo:[1,0,0] neg_hi:[1,0,0]
    v_pk_fma_f32 v[220:221], v[220:221], v[36:37], v[56:57] op_sel:[0,1,0] op_sel_hi:[1,1,1]
    v_pk_mul_f32 v[60:61], v[220:221], v[220:221]
    v_pk_fma_f32 v[60:61], v[60:61], v[82:83], v[80:81]
    v_pk_mul_f32 v[60:61], v[60:61], v[220:221]
    v_pk_fma_f32 v[222:223], v[250:251], v[36:37], v[222:223] op_sel_hi:[1,0,1] neg_lo:[1,0,0] neg_hi:[1,0,0]
    v_pk_fma_f32 v[222:223], v[222:223], v[36:37], v[58:59] op_sel:[0,1,0] op_sel_hi:[1,1,1]
    v_pk_mul_f32 v[62:63], v[222:223], v[222:223]
    v_pk_fma_f32 v[62:63], v[62:63], v[82:83], v[80:81]
    v_pk_mul_f32 v[62:63], v[62:63], v[222:223]
    v_exp_f32 v60, v60
    v_exp_f32 v61, v61
    v_exp_f32 v62, v62
    v_exp_f32 v63, v63
    v_pk_add_f32 v[60:61], v[60:61], s[74:75]
    v_pk_mul_f32 v[220:221], v[220:221], v[38:39] op_sel:[0,1] op_sel_hi:[1,1]
    v_pk_add_f32 v[62:63], v[62:63], s[74:75]
    v_pk_mul_f32 v[222:223], v[222:223], v[38:39] op_sel:[0,1] op_sel_hi:[1,1]
    v_rcp_f32 v60, v60
    v_rcp_f32 v61, v61
    v_rcp_f32 v62, v62
    v_rcp_f32 v63, v63
    s_nop 0
    v_pk_mul_f32 v[220:221], v[220:221], v[60:61]
    v_pk_mul_f32 v[222:223], v[222:223], v[62:63]
    v_cvt_pk_bf16_f32 v68, v220, v221
    v_cvt_pk_bf16_f32 v69, v222, v223
    s_add_u32 s58, s56, 49152
    buffer_store_dwordx2 v[68:69], v84, s[24:27], s58 offen sc1
    v_pk_fma_f32 v[224:225], v[248:249], v[40:41], v[224:225] op_sel_hi:[1,0,1] neg_lo:[1,0,0] neg_hi:[1,0,0]
    v_pk_fma_f32 v[224:225], v[224:225], v[40:41], v[56:57] op_sel:[0,1,0] op_sel_hi:[1,1,1]
    v_pk_mul_f32 v[60:61], v[224:225], v[224:225]
    v_pk_fma_f32 v[60:61], v[60:61], v[82:83], v[80:81]
    v_pk_mul_f32 v[60:61], v[60:61], v[224:225]
    v_pk_fma_f32 v[226:227], v[250:251], v[40:41], v[226:227] op_sel_hi:[1,0,1] neg_lo:[1,0,0] neg_hi:[1,0,0]
    v_pk_fma_f32 v[226:227], v[226:227], v[40:41], v[58:59] op_sel:[0,1,0] op_sel_hi:[1,1,1]
    v_pk_mul_f32 v[62:63], v[226:227], v[226:227]
    v_pk_fma_f32 v[62:63], v[62:63], v[82:83], v[80:81]
    v_pk_mul_f32 v[62:63], v[62:63], v[226:227]
    v_exp_f32 v60, v60
    v_exp_f32 v61, v61
    v_exp_f32 v62, v62
    v_exp_f32 v63, v63
    v_pk_add_f32 v[60:61], v[60:61], s[74:75]
    v_pk_mul_f32 v[224:225], v[224:225], v[42:43] op_sel:[0,1] op_sel_hi:[1,1]
    v_pk_add_f32 v[62:63], v[62:63], s[74:75]
    v_pk_mul_f32 v[226:227], v[226:227], v[42:43] op_sel:[0,1] op_sel_hi:[1,1]
    v_rcp_f32 v60, v60
    v_rcp_f32 v61, v61
    v_rcp_f32 v62, v62
    v_rcp_f32 v63, v63
    s_nop 0
    v_pk_mul_f32 v[224:225], v[224:225], v[60:61]
    v_pk_mul_f32 v[226:227], v[226:227], v[62:63]
    v_cvt_pk_bf16_f32 v72, v224, v225
    v_cvt_pk_bf16_f32 v73, v226, v227
    s_add_u32 s58, s56, 98304
    buffer_store_dwordx2 v[72:73], v84, s[24:27], s58 offen sc1
    v_pk_fma_f32 v[228:229], v[248:249], v[44:45], v[228:229] op_sel_hi:[1,0,1] neg_lo:[1,0,0] neg_hi:[1,0,0]
    v_pk_fma_f32 v[228:229], v[228:229], v[44:45], v[56:57] op_sel:[0,1,0] op_sel_hi:[1,1,1]
    v_pk_mul_f32 v[60:61], v[228:229], v[228:229]
    v_pk_fma_f32 v[60:61], v[60:61], v[82:83], v[80:81]
    v_pk_mul_f32 v[60:61], v[60:61], v[228:229]
    v_pk_fma_f32 v[230:231], v[250:251], v[44:45], v[230:231] op_sel_hi:[1,0,1] neg_lo:[1,0,0] neg_hi:[1,0,0]
    v_pk_fma_f32 v[230:231], v[230:231], v[44:45], v[58:59] op_sel:[0,1,0] op_sel_hi:[1,1,1]
    v_pk_mul_f32 v[62:63], v[230:231], v[230:231]
    v_pk_fma_f32 v[62:63], v[62:63], v[82:83], v[80:81]
    v_pk_mul_f32 v[62:63], v[62:63], v[230:231]
    v_exp_f32 v60, v60
    v_exp_f32 v61, v61
    v_exp_f32 v62, v62
    v_exp_f32 v63, v63
    v_pk_add_f32 v[60:61], v[60:61], s[74:75]
    v_pk_mul_f32 v[228:229], v[228:229], v[46:47] op_sel:[0,1] op_sel_hi:[1,1]
    v_pk_add_f32 v[62:63], v[62:63], s[74:75]
    v_pk_mul_f32 v[230:231], v[230:231], v[46:47] op_sel:[0,1] op_sel_hi:[1,1]
    v_rcp_f32 v60, v60
    v_rcp_f32 v61, v61
    v_rcp_f32 v62, v62
    v_rcp_f32 v63, v63
    s_nop 0
    v_pk_mul_f32 v[228:229], v[228:229], v[60:61]
    v_pk_mul_f32 v[230:231], v[230:231], v[62:63]
    v_cvt_pk_bf16_f32 v76, v228, v229
    v_cvt_pk_bf16_f32 v77, v230, v231
    s_add_u32 s58, s56, 147456
    buffer_store_dwordx2 v[76:77], v84, s[24:27], s58 offen sc1
    s_branch L_ccj_59
L_cc1_58:
    v_mov_b32 v80, 0xc0135761
    v_mov_b32 v81, 0xc0135761
    v_mov_b32 v82, 0xbdd2d3e8
    v_mov_b32 v83, 0xbdd2d3e8
    s_mov_b32 s74, 1.0
    s_mov_b32 s75, 1.0
    s_lshr_b32 s56, s50, 4
    s_lshl_b32 s57, s48, 2
    s_add_u32 s56, s56, s57
    s_mul_i32 s56, s56, 49152
    s_add_u32 s72, s56, 10485760
    v_lshlrev_b32 v84, 4, v1
    v_lshlrev_b32 v56, 16, v48
    v_and_b32 v57, 0xffff0000, v48
    v_lshlrev_b32 v58, 16, v49
    v_and_b32 v59, 0xffff0000, v49
    v_pk_fma_f32 v[216:217], v[248:249], v[32:33], v[216:217] op_sel_hi:[1,0,1] neg_lo:[1,0,0] neg_hi:[1,0,0]
    v_pk_fma_f32 v[216:217], v[216:217], v[32:33], v[56:57] op_sel:[0,1,0] op_sel_hi:[1,1,1]
    v_pk_mul_f32 v[60:61], v[216:217], v[216:217]
    v_pk_fma_f32 v[60:61], v[60:61], v[82:83], v[80:81]
    v_pk_mul_f32 v[60:61], v[60:61], v[216:217]
    v_pk_fma_f32 v[218:219], v[250:251], v[32:33], v[218:219] op_sel_hi:[1,0,1] neg_lo:[1,0,0] neg_hi:[1,0,0]
    v_pk_fma_f32 v[218:219], v[218:219], v[32:33], v[58:59] op_sel:[0,1,0] op_sel_hi:[1,1,1]
    v_pk_mul_f32 v[62:63], v[218:219], v[218:219]
    v_pk_fma_f32 v[62:63], v[62:63], v[82:83], v[80:81]
    v_pk_mul_f32 v[62:63], v[62:63], v[218:219]
    v_exp_f32 v60, v60
    v_exp_f32 v61, v61
    v_exp_f32 v62, v62
    v_exp_f32 v63, v63
    v_pk_add_f32 v[60:61], v[60:61], s[74:75]
    v_pk_mul_f32 v[216:217], v[216:217], v[34:35] op_sel:[0,1] op_sel_hi:[1,1]
    v_pk_add_f32 v[62:63], v[62:63], s[74:75]
    v_pk_mul_f32 v[218:219], v[218:219], v[34:35] op_sel:[0,1] op_sel_hi:[1,1]
    v_rcp_f32 v60, v60
    v_rcp_f32 v61, v61
    v_rcp_f32 v62, v62
    v_rcp_f32 v63, v63
    s_nop 0
    v_pk_mul_f32 v[216:217], v[216:217], v[60:61]
    v_pk_mul_f32 v[218:219], v[218:219], v[62:63]
    v_cvt_pk_bf16_f32 v64, v216, v217
    v_cvt_pk_bf16_f32 v65, v218, v219
    s_lshr_b32 s56, s79, 4
    s_add_u32 s56, s56, 0
    s_lshr_b32 s56, s56, 1
    s_lshl_b32 s56, s56, 10
    s_add_u32 s56, s56, s72
    s_add_u32 s58, s56, 8
    buffer_store_dwordx2 v[64:65], v84, s[24:27], s58 offen sc1
    v_pk_fma_f32 v[220:221], v[248:249], v[36:37], v[220:221] op_sel_hi:[1,0,1] neg_lo:[1,0,0] neg_hi:[1,0,0]
    v_pk_fma_f32 v[220:221], v[220:221], v[36:37], v[56:57] op_sel:[0,1,0] op_sel_hi:[1,1,1]
    v_pk_mul_f32 v[60:61], v[220:221], v[220:221]
    v_pk_fma_f32 v[60:61], v[60:61], v[82:83], v[80:81]
    v_pk_mul_f32 v[60:61], v[60:61], v[220:221]
    v_pk_fma_f32 v[222:223], v[250:251], v[36:37], v[222:223] op_sel_hi:[1,0,1] neg_lo:[1,0,0] neg_hi:[1,0,0]
    v_pk_fma_f32 v[222:223], v[222:223], v[36:37], v[58:59] op_sel:[0,1,0] op_sel_hi:[1,1,1]
    v_pk_mul_f32 v[62:63], v[222:223], v[222:223]
    v_pk_fma_f32 v[62:63], v[62:63], v[82:83], v[80:81]
    v_pk_mul_f32 v[62:63], v[62:63], v[222:223]
    v_exp_f32 v60, v60
    v_exp_f32 v61, v61
    v_exp_f32 v62, v62
    v_exp_f32 v63, v63
    v_pk_add_f32 v[60:61], v[60:61], s[74:75]
    v_pk_mul_f32 v[220:221], v[220:221], v[38:39] op_sel:[0,1] op_sel_hi:[1,1]
    v_pk_add_f32 v[62:63], v[62:63], s[74:75]
    v_pk_mul_f32 v[222:223], v[222:223], v[38:39] op_sel:[0,1] op_sel_hi:[1,1]
    v_rcp_f32 v60, v60
    v_rcp_f32 v61, v61
    v_rcp_f32 v62, v62
    v_rcp_f32 v63, v63
    s_nop 0
    v_pk_mul_f32 v[220:221], v[220:221], v[60:61]
    v_pk_mul_f32 v[222:223], v[222:223], v[62:63]
    v_cvt_pk_bf16_f32 v68, v220, v221
    v_cvt_pk_bf16_f32 v69, v222, v223
    s_add_u32 s58, s56, 49160
    buffer_store_dwordx2 v[68:69], v84, s[24:27], s58 offen sc1
    v_pk_fma_f32 v[224:225], v[248:249], v[40:41], v[224:225] op_sel_hi:[1,0,1] neg_lo:[1,0,0] neg_hi:[1,0,0]
    v_pk_fma_f32 v[224:225], v[224:225], v[40:41], v[56:57] op_sel:[0,1,0] op_sel_hi:[1,1,1]
    v_pk_mul_f32 v[60:61], v[224:225], v[224:225]
    v_pk_fma_f32 v[60:61], v[60:61], v[82:83], v[80:81]
    v_pk_mul_f32 v[60:61], v[60:61], v[224:225]
    v_pk_fma_f32 v[226:227], v[250:251], v[40:41], v[226:227] op_sel_hi:[1,0,1] neg_lo:[1,0,0] neg_hi:[1,0,0]
    v_pk_fma_f32 v[226:227], v[226:227], v[40:41], v[58:59] op_sel:[0,1,0] op_sel_hi:[1,1,1]
    v_pk_mul_f32 v[62:63], v[226:227], v[226:227]
    v_pk_fma_f32 v[62:63], v[62:63], v[82:83], v[80:81]
    v_pk_mul_f32 v[62:63], v[62:63], v[226:227]
    v_exp_f32 v60, v60
    v_exp_f32 v61, v61
    v_exp_f32 v62, v62
    v_exp_f32 v63, v63
    v_pk_add_f32 v[60:61], v[60:61], s[74:75]
    v_pk_mul_f32 v[224:225], v[224:225], v[42:43] op_sel:[0,1] op_sel_hi:[1,1]
    v_pk_add_f32 v[62:63], v[62:63], s[74:75]
    v_pk_mul_f32 v[226:227], v[226:227], v[42:43] op_sel:[0,1] op_sel_hi:[1,1]
    v_rcp_f32 v60, v60
    v_rcp_f32 v61, v61
    v_rcp_f32 v62, v62
    v_rcp_f32 v63, v63
    s_nop 0
    v_pk_mul_f32 v[224:225], v[224:225], v[60:61]
    v_pk_mul_f32 v[226:227], v[226:227], v[62:63]
    v_cvt_pk_bf16_f32 v72, v224, v225
    v_cvt_pk_bf16_f32 v73, v226, v227
    s_add_u32 s58, s56, 98312
    buffer_store_dwordx2 v[72:73], v84, s[24:27], s58 offen sc1
    v_pk_fma_f32 v[228:229], v[248:249], v[44:45], v[228:229] op_sel_hi:[1,0,1] neg_lo:[1,0,0] neg_hi:[1,0,0]
    v_pk_fma_f32 v[228:229], v[228:229], v[44:45], v[56:57] op_sel:[0,1,0] op_sel_hi:[1,1,1]
    v_pk_mul_f32 v[60:61], v[228:229], v[228:229]
    v_pk_fma_f32 v[60:61], v[60:61], v[82:83], v[80:81]
    v_pk_mul_f32 v[60:61], v[60:61], v[228:229]
    v_pk_fma_f32 v[230:231], v[250:251], v[44:45], v[230:231] op_sel_hi:[1,0,1] neg_lo:[1,0,0] neg_hi:[1,0,0]
    v_pk_fma_f32 v[230:231], v[230:231], v[44:45], v[58:59] op_sel:[0,1,0] op_sel_hi:[1,1,1]
    v_pk_mul_f32 v[62:63], v[230:231], v[230:231]
    v_pk_fma_f32 v[62:63], v[62:63], v[82:83], v[80:81]
    v_pk_mul_f32 v[62:63], v[62:63], v[230:231]
    v_exp_f32 v60, v60
    v_exp_f32 v61, v61
    v_exp_f32 v62, v62
    v_exp_f32 v63, v63
    v_pk_add_f32 v[60:61], v[60:61], s[74:75]
    v_pk_mul_f32 v[228:229], v[228:229], v[46:47] op_sel:[0,1] op_sel_hi:[1,1]
    v_pk_add_f32 v[62:63], v[62:63], s[74:75]
    v_pk_mul_f32 v[230:231], v[230:231], v[46:47] op_sel:[0,1] op_sel_hi:[1,1]
    v_rcp_f32 v60, v60
    v_rcp_f32 v61, v61
    v_rcp_f32 v62, v62
    v_rcp_f32 v63, v63
    s_nop 0
    v_pk_mul_f32 v[228:229], v[228:229], v[60:61]
    v_pk_mul_f32 v[230:231], v[230:231], v[62:63]
    v_cvt_pk_bf16_f32 v76, v228, v229
    v_cvt_pk_bf16_f32 v77, v230, v231
    s_add_u32 s58, s56, 147464
    buffer_store_dwordx2 v[76:77], v84, s[24:27], s58 offen sc1
L_ccj_59:
L_p1end_5:
    s_and_b32 s54, s41, 7
    s_lshr_b32 s55, s41, 3
    s_lshl_b32 s46, s54, 2
    s_lshr_b32 s56, s55, 3
    s_add_u32 s46, s46, s56
    s_and_b32 s47, s55, 7
    s_and_b32 s48, s40, 1
    s_lshr_b32 s49, s40, 1
    s_mov_b32 s72, -1
    s_mov_b32 s73, 0
    v_and_b32 v1, 63, v0
    v_and_b32 v13, 31, v0
    s_lshl_b32 s54, s49, 12
    s_add_u32 s54, s54, 102400
    v_lshl_add_u32 v2, v1, 4, s54
    s_lshl_b32 s54, s49, 11
    s_and_b32 s55, s46, 1
    s_lshl_b32 s55, s55, 3
    s_add_u32 s54, s54, s55
    s_add_u32 s54, s54, 110592
    v_lshl_add_u32 v3, v13, 4, s54
    v_lshrrev_b32 v14, 5, v1
    v_mul_u32_u24 v15, 352, v14
    v_min_u32 v16, 21, v13
    v_lshl_add_u32 v15, v16, 4, v15
    s_mul_i32 s54, s49, 5632
    s_add_u32 s54, s54, 114688
    v_add_u32 v4, s54, v15
    v_lshlrev_b32 v5, 4, v1
    s_and_b32 s55, s40, 1
    s_lshl_b32 s56, s49, 5
    s_lshl_b32 s57, s55, 1
    s_add_u32 s57, s57, s56
    s_lshl_b32 s64, s46, 16
    s_lshl_b32 s58, s57, 10
    s_add_u32 s64, s64, s58
    s_add_u32 s64, s64, 4194304
    s_lshr_b32 s65, s46, 1
    s_lshl_b32 s65, s65, 15
    s_lshl_b32 s58, s57, 9
    s_add_u32 s65, s65, s58
    s_add_u32 s65, s65, 6291456
    s_mul_i32 s66, s46, 81920
    s_add_u32 s66, s66, 7340032
    s_lshl_b32 s67, s40, 11
    s_add_u32 s67, s67, 102400
    s_lshl_b32 s71, s40, 10
    s_add_u32 s71, s71, 110592
    s_mul_i32 s58, s40, 3
    s_add_u32 s59, s58, 0
    s_min_u32 s59, s59, 10
    s_lshl_b32 s80, s59, 10
    s_add_u32 s80, s80, 114688
    s_lshl_b32 s59, s59, 6
    v_add_u32 v14, s59, v1
    v_mul_u32_u24 v15, 2979, v14
    v_lshrrev_b32 v15, 16, v15
    v_mul_u32_u24 v16, 22, v15
    v_sub_u32 v14, v14, v16
    v_cmp_gt_u32 s[74:75], 20, v14
    v_mul_u32_u24 v16, 320, v15
    v_lshl_add_u32 v16, v14, 4, v16
    v_lshrrev_b32 v15, 4, v15
    v_mul_u32_u24 v15, 35840, v15
    v_add_u32 v6, v15, v16
    s_add_u32 s59, s58, 1
    s_min_u32 s59, s59, 10
    s_lshl_b32 s81, s59, 10
    s_add_u32 s81, s81, 114688
    s_lshl_b32 s59, s59, 6
    v_add_u32 v14, s59, v1
    v_mul_u32_u24 v15, 2979, v14
    v_lshrrev_b32 v15, 16, v15
    v_mul_u32_u24 v16, 22, v15
    v_sub_u32 v14, v14, v16
    v_cmp_gt_u32 s[76:77], 20, v14
    v_mul_u32_u24 v16, 320, v15
    v_lshl_add_u32 v16, v14, 4, v16
    v_lshrrev_b32 v15, 4, v15
    v_mul_u32_u24 v15, 35840, v15
    v_add_u32 v7, v15, v16
    s_add_u32 s59, s58, 2
    s_min_u32 s59, s59, 10
    s_lshl_b32 s82, s59, 10
    s_add_u32 s82, s82, 114688
    s_lshl_b32 s59, s59, 6
    v_add_u32 v14, s59, v1
    v_mul_u32_u24 v15, 2979, v14
    v_lshrrev_b32 v15, 16, v15
    v_mul_u32_u24 v16, 22, v15
    v_sub_u32 v14, v14, v16
    v_cmp_gt_u32 s[78:79], 20, v14
    v_mul_u32_u24 v16, 320, v15
    v_lshl_add_u32 v16, v14, 4, v16
    v_lshrrev_b32 v15, 4, v15
    v_mul_u32_u24 v15, 35840, v15
    v_add_u32 v8, v15, v16
    v_lshrrev_b32 v208, 5, v1
    v_mul_u32_u24 v208, 23552, v208
    v_mul_u32_u24 v209, 352, v13
    v_add_u32 v208, v208, v209
    v_add_u32 v208, 115008, v208
    v_mov_b32 v212, 0x3f803f80
    v_mov_b32 v216, 0
    v_mov_b32 v213, 0x3f803f80
    v_mov_b32 v217, 0
    v_mov_b32 v214, 0x3f803f80
    v_mov_b32 v218, 0
    v_mov_b32 v215, 0x3f803f80
    v_mov_b32 v219, 0
    ds_write_b128 v208, v[212:215]
    ds_write_b128 v208, v[216:219] offset:16
    v_mov_b32 v220, 149504
    v_mov_b32 v221, 0
    ds_write_b32 v220, v221
    s_lshr_b32 s88, s46, 3
    v_and_b32 v242, 63, v0
    v_subrev_u32 v243, 2, v242
    s_add_u32 s89, s88, 4
    s_lshl_b32 s89, s89, 4
    v_lshrrev_b32 v244, 4, v243
    v_lshlrev_b32 v244, 6, v244
    v_and_b32 v243, 15, v243
    v_add3_u32 v243, v243, v244, s89
    s_lshl_b32 s89, s88, 4
    s_lshl_b32 s90, s47, 1
    s_add_u32 s89, s89, s90
    v_add_u32 v244, s89, v242
    v_cmp_gt_u32 vcc, 2, v242
    s_nop 1
    v_cndmask_b32 v243, v243, v244, vcc
    v_lshlrev_b32 v242, 7, v243
    v_add_u32 v242, 65536, v242
    s_mov_b32 exec_lo, 0xffffffff
    s_mov_b32 exec_hi, 0x3
    s_mov_b32 s84, 1048576
L_poll_60:
    buffer_load_dwordx2 v[240:241], v242, s[24:27], 0 offen sc1
    s_waitcnt vmcnt(0)
    v_xor_b32 v240, s2, v240
    v_xor_b32 v241, s3, v241
    v_or_b32 v240, v240, v241
    v_cmp_ne_u32 vcc, 0, v240
    s_cmp_eq_u64 vcc, 0
    s_cbranch_scc1 L_polled_61
    s_sub_u32 s84, s84, 1
    s_cmp_eq_u32 s84, 0
    s_cbranch_scc1 L_polltmo_62
    s_sleep 2
    s_branch L_poll_60
L_polltmo_62:
    v_mov_b32 v240, 226
    v_mov_b32 v241, 252
    global_store_dword v241, v240, s[38:39]
L_polled_61:
    s_mov_b64 exec, -1
    s_lshl_b32 s54, s47, 3
    s_lshl_b32 s55, s48, 2
    s_add_u32 s54, s54, s55
    s_lshl_b32 s55, s46, 16
    s_lshl_b32 s56, s54, 10
    s_add_u32 s55, s55, s56
    s_add_u32 s55, s55, 1048576
    s_lshr_b32 s56, s46, 1
    s_lshl_b32 s56, s56, 15
    s_lshl_b32 s57, s54, 9
    s_add_u32 s56, s56, s57
    s_and_b32 s57, s46, 1
    s_lshl_b32 s57, s57, 3
    s_add_u32 s56, s56, s57
    s_add_u32 s56, s56, 3145728
    v_lshlrev_b32 v208, 4, v13
    v_mov_b32 v24, 0
    v_mov_b32 v25, 0
    v_mov_b32 v30, 0
    v_mov_b32 v31, 0
    v_mov_b32 v36, 0
    v_mov_b32 v37, 0
    v_mov_b32 v42, 0
    v_mov_b32 v43, 0
    buffer_load_dwordx4 v[20:23], v5, s[24:27], s55 offen offset:0 sc1
    buffer_load_dwordx4 v[26:29], v5, s[24:27], s55 offen offset:1024 sc1
    buffer_load_dwordx4 v[32:35], v5, s[24:27], s55 offen offset:2048 sc1
    buffer_load_dwordx4 v[38:41], v5, s[24:27], s55 offen offset:3072 sc1
    s_mov_b64 exec, s[72:73]
    buffer_load_dwordx2 v[24:25], v208, s[24:27], s56 offen offset:0 sc1
    buffer_load_dwordx2 v[30:31], v208, s[24:27], s56 offen offset:512 sc1
    buffer_load_dwordx2 v[36:37], v208, s[24:27], s56 offen offset:1024 sc1
    buffer_load_dwordx2 v[42:43], v208, s[24:27], s56 offen offset:1536 sc1
    s_mov_b64 exec, -1
    s_mov_b32 s50, s64
    s_mov_b32 s51, s65
    s_mov_b32 s52, s66
    s_add_u32 m0, s67, 0
    s_nop 0
    buffer_load_dwordx4 v5, s[24:27], s50 offen sc1 lds
    s_add_u32 m0, s67, 0
    s_nop 0
    buffer_load_dwordx4 v5, s[24:27], s50 offen offset:1024 sc1 lds
    s_add_u32 m0, s71, 0
    s_nop 0
    buffer_load_dwordx4 v5, s[24:27], s51 offen sc1 lds
    s_add_u32 m0, s80, 0
    s_mov_b64 exec, s[74:75]
    buffer_load_dwordx4 v6, s[24:27], s52 offen sc1 lds
    s_mov_b64 exec, -1
    s_add_u32 m0, s81, 0
    s_mov_b64 exec, s[76:77]
    buffer_load_dwordx4 v7, s[24:27], s52 offen sc1 lds
    s_mov_b64 exec, -1
    s_add_u32 m0, s82, 0
    s_mov_b64 exec, s[78:79]
    buffer_load_dwordx4 v8, s[24:27], s52 offen sc1 lds
    s_mov_b64 exec, -1
    s_add_u32 s50, s50, 4096
    s_add_u32 s51, s51, 2048
    s_add_u32 s52, s52, 5120
    s_lshl_b32 s54, s47, 3
    s_lshl_b32 s55, s48, 2
    s_add_u32 s54, s54, s55
    s_lshl_b32 s55, s49, 1
    s_add_u32 s54, s54, s55
    s_lshl_b32 s55, s54, 9
    v_lshlrev_b32 v14, 4, v13
    buffer_load_dword v9, v14, s[24:27], s55 offen offset:8 sc1
    buffer_load_dword v10, v14, s[24:27], s55 offen offset:520 sc1
    s_mul_i32 s62, s54, 40960
    s_add_u32 s62, s62, 16777216
    v_lshrrev_b32 v14, 4, v13
    v_mul_u32_u24 v14, 20480, v14
    v_and_b32 v15, 15, v13
    v_lshl_add_u32 v14, v15, 4, v14
    v_cmp_le_u32 vcc, 32, v1
    s_mul_i32 s56, s46, 5
    s_add_u32 s59, s56, 0
    s_lshr_b32 s57, s59, 3
    s_lshl_b32 s57, s57, 10
    s_and_b32 s60, s59, 3
    s_lshl_b32 s60, s60, 8
    s_add_u32 s57, s57, s60
    s_bfe_u32 s60, s59, 0x10002
    s_lshl_b32 s60, s60, 3
    s_add_u32 s57, s57, s60
    s_add_u32 s59, s56, 1
    s_lshr_b32 s58, s59, 3
    s_lshl_b32 s58, s58, 10
    s_and_b32 s60, s59, 3
    s_lshl_b32 s60, s60, 8
    s_add_u32 s58, s58, s60
    s_bfe_u32 s60, s59, 0x10002
    s_lshl_b32 s60, s60, 3
    s_add_u32 s58, s58, s60
    v_add_u32 v16, s57, v14
    v_add_u32 v17, s58, v14
    v_cndmask_b32 v128, v16, v17, vcc
    s_add_u32 s59, s56, 2
    s_lshr_b32 s57, s59, 3
    s_lshl_b32 s57, s57, 10
    s_and_b32 s60, s59, 3
    s_lshl_b32 s60, s60, 8
    s_add_u32 s57, s57, s60
    s_bfe_u32 s60, s59, 0x10002
    s_lshl_b32 s60, s60, 3
    s_add_u32 s57, s57, s60
    s_add_u32 s59, s56, 3
    s_lshr_b32 s58, s59, 3
    s_lshl_b32 s58, s58, 10
    s_and_b32 s60, s59, 3
    s_lshl_b32 s60, s60, 8
    s_add_u32 s58, s58, s60
    s_bfe_u32 s60, s59, 0x10002
    s_lshl_b32 s60, s60, 3
    s_add_u32 s58, s58, s60
    v_add_u32 v16, s57, v14
    v_add_u32 v17, s58, v14
    v_cndmask_b32 v129, v16, v17, vcc
    s_add_u32 s59, s56, 4
    s_lshr_b32 s57, s59, 3
    s_lshl_b32 s57, s57, 10
    s_and_b32 s60, s59, 3
    s_lshl_b32 s60, s60, 8
    s_add_u32 s57, s57, s60
    s_bfe_u32 s60, s59, 0x10002
    s_lshl_b32 s60, s60, 3
    s_add_u32 s57, s57, s60
    s_add_u32 s59, s56, 5
    s_lshr_b32 s58, s59, 3
    s_lshl_b32 s58, s58, 10
    s_and_b32 s60, s59, 3
    s_lshl_b32 s60, s60, 8
    s_add_u32 s58, s58, s60
    s_bfe_u32 s60, s59, 0x10002
    s_lshl_b32 s60, s60, 3
    s_add_u32 s58, s58, s60
    v_add_u32 v16, s57, v14
    v_add_u32 v17, s58, v14
    v_cndmask_b32 v130, v16, v17, vcc
    s_xor_b32 s54, s40, 0
    s_mul_i32 s55, s54, 6144
    s_add_u32 s55, s55, 102400
    s_cmp_eq_u32 s54, 3
    s_cselect_b32 s55, 150016, s55
    v_lshl_add_u32 v131, v1, 4, s55
    s_xor_b32 s54, s40, 2
    s_mul_i32 s55, s54, 6144
    s_add_u32 s55, s55, 102400
    s_cmp_eq_u32 s54, 3
    s_cselect_b32 s55, 150016, s55
    v_lshl_add_u32 v132, v1, 4, s55
    s_and_b32 s54, s41, 7
    s_lshr_b32 s55, s41, 3
    s_lshr_b32 s42, s54, 1
    s_lshl_b32 s42, s42, 3
    s_and_b32 s56, s55, 7
    s_add_u32 s42, s42, s56
    s_and_b32 s43, s54, 1
    s_lshl_b32 s43, s43, 2
    s_lshr_b32 s57, s55, 3
    s_add_u32 s43, s43, s57
    v_and_b32 v249, 63, v0
    v_lshlrev_b32 v126, 4, v249
    v_add_u32 v120, 0, v126
    v_add_u32 v121, 49152, v126
    v_add_u32 v122, 98304, v126
    v_add_u32 v123, 147456, v126
    s_lshl_b32 s83, s40, 8
    s_add_u32 s83, s83, s41
    v_add_u32 v246, 0, v249
    v_mul_u32_u24 v247, 6554, v246
    v_lshrrev_b32 v247, 16, v247
    v_mul_u32_u24 v248, 10, v247
    v_sub_u32 v248, v246, v248
    v_lshlrev_b32 v248, 4, v248
    v_mul_u32_u24 v247, 1280, v247
    v_add_u32 v133, v247, v248
    v_add_u32 v246, 64, v249
    v_mul_u32_u24 v247, 6554, v246
    v_lshrrev_b32 v247, 16, v247
    v_mul_u32_u24 v248, 10, v247
    v_sub_u32 v248, v246, v248
    v_lshlrev_b32 v248, 4, v248
    v_mul_u32_u24 v247, 1280, v247
    v_add_u32 v134, v247, v248
    v_subrev_u32 v134, 1024, v134
    v_add_u32 v246, 128, v249
    v_mul_u32_u24 v247, 6554, v246
    v_lshrrev_b32 v247, 16, v247
    v_mul_u32_u24 v248, 10, v247
    v_sub_u32 v248, v246, v248
    v_lshlrev_b32 v248, 4, v248
    v_mul_u32_u24 v247, 1280, v247
    v_add_u32 v135, v247, v248
    v_subrev_u32 v135, 2048, v135
    v_add_u32 v246, 192, v249
    v_mul_u32_u24 v247, 6554, v246
    v_lshrrev_b32 v247, 16, v247
    v_mul_u32_u24 v248, 10, v247
    v_sub_u32 v248, v246, v248
    v_lshlrev_b32 v248, 4, v248
    v_mul_u32_u24 v247, 1280, v247
    v_add_u32 v136, v247, v248
    v_subrev_u32 v136, 3072, v136
    v_add_u32 v246, 256, v249
    v_mul_u32_u24 v247, 6554, v246
    v_lshrrev_b32 v247, 16, v247
    v_mul_u32_u24 v248, 10, v247
    v_sub_u32 v248, v246, v248
    v_lshlrev_b32 v248, 4, v248
    v_mul_u32_u24 v247, 1280, v247
    v_add_u32 v137, v247, v248
    s_mul_i32 s70, s40, 25600
    v_add_u32 v124, s70, v126
    v_lshrrev_b32 v246, 2, v249
    v_mul_u32_u24 v246, 160, v246
    v_and_b32 v247, 3, v249
    v_lshl_add_u32 v246, v247, 3, v246
    v_add_u32 v125, s70, v246
    s_mul_i32 s44, s42, 192
    s_mul_i32 s54, s40, 12
    s_add_u32 s44, s44, s54
    s_lshl_b32 s44, s44, 10
    s_add_u32 s44, s44, 10485760
    s_add_u32 s63, s44, 4096
    s_add_u32 s61, s44, 8192
    s_mul_i32 s45, s42, 80
    s_mul_i32 s54, s40, 5
    s_add_u32 s45, s45, s54
    s_lshl_b32 s45, s45, 10
    s_add_u32 s45, s45, 16777216
    s_mul_i32 s54, s43, 68
    s_mul_i32 s55, s40, 12
    s_add_u32 s55, s55, s54
    s_mul_i32 s68, s55, 5120
    s_add_u32 s68, s68, 20971520
    s_mul_i32 s55, s40, 5
    s_add_u32 s55, s55, s54
    s_add_u32 s55, s55, 48
    s_mul_i32 s69, s55, 5120
    s_add_u32 s69, s69, 20971520
    v_accvgpr_write_b32 a0, 0
    v_accvgpr_write_b32 a1, 0
    v_accvgpr_write_b32 a2, 0
    v_accvgpr_write_b32 a3, 0
    v_accvgpr_write_b32 a4, 0
    v_accvgpr_write_b32 a5, 0
    v_accvgpr_write_b32 a6, 0
    v_accvgpr_write_b32 a7, 0
    v_accvgpr_write_b32 a8, 0
    v_accvgpr_write_b32 a9, 0
    v_accvgpr_write_b32 a10, 0
    v_accvgpr_write_b32 a11, 0
    v_accvgpr_write_b32 a12, 0
    v_accvgpr_write_b32 a13, 0
    v_accvgpr_write_b32 a14, 0
    v_accvgpr_write_b32 a15, 0
    v_accvgpr_write_b32 a16, 0
    v_accvgpr_write_b32 a17, 0
    v_accvgpr_write_b32 a18, 0
    v_accvgpr_write_b32 a19, 0
    v_accvgpr_write_b32 a20, 0
    v_accvgpr_write_b32 a21, 0
    v_accvgpr_write_b32 a22, 0
    v_accvgpr_write_b32 a23, 0
    v_accvgpr_write_b32 a24, 0
    v_accvgpr_write_b32 a25, 0
    v_accvgpr_write_b32 a26, 0
    v_accvgpr_write_b32 a27, 0
    v_accvgpr_write_b32 a28, 0
    v_accvgpr_write_b32 a29, 0
    v_accvgpr_write_b32 a30, 0
    v_accvgpr_write_b32 a31, 0
    v_accvgpr_write_b32 a32, 0
    v_accvgpr_write_b32 a33, 0
    v_accvgpr_write_b32 a34, 0
    v_accvgpr_write_b32 a35, 0
    v_accvgpr_write_b32 a36, 0
    v_accvgpr_write_b32 a37, 0
    v_accvgpr_write_b32 a38, 0
    v_accvgpr_write_b32 a39, 0
    v_accvgpr_write_b32 a40, 0
    v_accvgpr_write_b32 a41, 0
    v_accvgpr_write_b32 a42, 0
    v_accvgpr_write_b32 a43, 0
    v_accvgpr_write_b32 a44, 0
    v_accvgpr_write_b32 a45, 0
    v_accvgpr_write_b32 a46, 0
    v_accvgpr_write_b32 a47, 0
    v_accvgpr_write_b32 a48, 0
    v_accvgpr_write_b32 a49, 0
    v_accvgpr_write_b32 a50, 0
    v_accvgpr_write_b32 a51, 0
    v_accvgpr_write_b32 a52, 0
    v_accvgpr_write_b32 a53, 0
    v_accvgpr_write_b32 a54, 0
    v_accvgpr_write_b32 a55, 0
    v_accvgpr_write_b32 a56, 0
    v_accvgpr_write_b32 a57, 0
    v_accvgpr_write_b32 a58, 0
    v_accvgpr_write_b32 a59, 0
    v_accvgpr_write_b32 a60, 0
    v_accvgpr_write_b32 a61, 0
    v_accvgpr_write_b32 a62, 0
    v_accvgpr_write_b32 a63, 0
    v_mov_b32 v112, 0
    v_mov_b32 v64, 0
    v_mov_b32 v113, 0
    v_mov_b32 v65, 0
    v_mov_b32 v114, 0
    v_mov_b32 v66, 0
    v_mov_b32 v115, 0
    v_mov_b32 v67, 0
    v_mov_b32 v116, 0
    v_mov_b32 v68, 0
    v_mov_b32 v117, 0
    v_mov_b32 v69, 0
    v_mov_b32 v118, 0
    v_mov_b32 v70, 0
    v_mov_b32 v119, 0
    v_mov_b32 v71, 0
    s_waitcnt vmcnt(0)
    s_waitcnt lgkmcnt(0)
    s_barrier
    s_cmp_lg_u32 s40, 0
    s_cbranch_scc1 L_noflag_63
    s_mov_b64 exec, 1
    v_mov_b32 v240, s2
    v_mov_b32 v241, s3
    v_mov_b32 v242, 0
    buffer_store_dwordx2 v[240:241], v242, s[24:27], s99 offen sc1
    s_mov_b64 exec, -1
L_noflag_63:
    s_add_u32 m0, s67, 23552
    s_nop 0
    buffer_load_dwordx4 v5, s[24:27], s50 offen sc1 lds
    s_add_u32 m0, s67, 23552
    s_nop 0
    buffer_load_dwordx4 v5, s[24:27], s50 offen offset:1024 sc1 lds
    s_add_u32 m0, s71, 23552
    s_nop 0
    buffer_load_dwordx4 v5, s[24:27], s51 offen sc1 lds
    s_add_u32 m0, s80, 23552
    s_mov_b64 exec, s[74:75]
    buffer_load_dwordx4 v6, s[24:27], s52 offen sc1 lds
    s_mov_b64 exec, -1
    s_add_u32 m0, s81, 23552
    s_mov_b64 exec, s[76:77]
    buffer_load_dwordx4 v7, s[24:27], s52 offen sc1 lds
    s_mov_b64 exec, -1
    s_add_u32 m0, s82, 23552
    s_mov_b64 exec, s[78:79]
    buffer_load_dwordx4 v8, s[24:27], s52 offen sc1 lds
    s_mov_b64 exec, -1
    s_add_u32 s50, s50, 4096
    s_add_u32 s51, s51, 2048
    s_add_u32 s52, s52, 5120
    ds_read_b128 v[44:47], v2 offset:0
    ds_read_b64 v[48:49], v3 offset:0
    s_waitcnt lgkmcnt(0)
    v_mfma_f32_32x32x16_bf16 v[72:87], v[44:47], v[20:23], 0
    v_mfma_f32_32x32x8_bf16 v[72:87], v[48:49], v[24:25], v[72:87]
    ds_read_b128 v[56:59], v4 offset:0
    ds_read_b128 v[60:63], v4 offset:704
    s_nop 11
    v_mfma_f32_32x32x16_bf16 v[88:103], v[44:47], v[26:29], 0
    ds_read_b128 v[50:53], v2 offset:1024
    v_exp_f32 v72, v72
    v_exp_f32 v73, v73
    v_exp_f32 v74, v74
    v_exp_f32 v75, v75
    v_mfma_f32_32x32x8_bf16 v[88:103], v[48:49], v[30:31], v[88:103]
    ds_read_b64 v[54:55], v3 offset:512
    v_exp_f32 v76, v76
    v_exp_f32 v77, v77
    v_exp_f32 v78, v78
    v_exp_f32 v79, v79
    v_cvt_pk_bf16_f32 v104, v72, v73
    v_cvt_pk_bf16_f32 v105, v74, v75
    v_mfma_f32_32x32x16_bf16 a[48:63], v[64:67], v[112:115], a[48:63]
    v_exp_f32 v80, v80
    v_exp_f32 v81, v81
    v_exp_f32 v82, v82
    v_exp_f32 v83, v83
    v_cvt_pk_bf16_f32 v106, v76, v77
    v_cvt_pk_bf16_f32 v107, v78, v79
    v_mfma_f32_32x32x16_bf16 a[48:63], v[68:71], v[116:119], a[48:63]
    v_exp_f32 v84, v84
    v_exp_f32 v85, v85
    v_exp_f32 v86, v86
    v_exp_f32 v87, v87
    v_cvt_pk_bf16_f32 v108, v80, v81
    v_cvt_pk_bf16_f32 v109, v82, v83
    v_cvt_pk_bf16_f32 v110, v84, v85
    v_cvt_pk_bf16_f32 v111, v86, v87
    v_mfma_f32_32x32x16_bf16 v[72:87], v[44:47], v[32:35], 0
    v_exp_f32 v88, v88
    v_exp_f32 v89, v89
    v_exp_f32 v90, v90
    v_exp_f32 v91, v91
    v_mfma_f32_32x32x8_bf16 v[72:87], v[48:49], v[36:37], v[72:87]
    v_exp_f32 v92, v92
    v_exp_f32 v93, v93
    v_exp_f32 v94, v94
    v_exp_f32 v95, v95
    v_cvt_pk_bf16_f32 v112, v88, v89
    v_cvt_pk_bf16_f32 v113, v90, v91
    s_waitcnt lgkmcnt(2)
    v_mfma_f32_32x32x16_bf16 a[0:15], v[56:59], v[104:107], a[0:15]
    ds_read_b128 v[64:67], v4 offset:1408
    v_exp_f32 v96, v96
    v_exp_f32 v97, v97
    v_exp_f32 v98, v98
    v_exp_f32 v99, v99
    v_cvt_pk_bf16_f32 v114, v92, v93
    v_cvt_pk_bf16_f32 v115, v94, v95
    v_mfma_f32_32x32x16_bf16 a[0:15], v[60:63], v[108:111], a[0:15]
    v_exp_f32 v100, v100
    v_exp_f32 v101, v101
    v_exp_f32 v102, v102
    v_exp_f32 v103, v103
    v_cvt_pk_bf16_f32 v116, v96, v97
    v_cvt_pk_bf16_f32 v117, v98, v99
    v_cvt_pk_bf16_f32 v118, v100, v101
    v_cvt_pk_bf16_f32 v119, v102, v103
    v_mfma_f32_32x32x16_bf16 v[88:103], v[44:47], v[38:41], 0
    v_exp_f32 v72, v72
    v_exp_f32 v73, v73
    v_exp_f32 v74, v74
    v_exp_f32 v75, v75
    v_mfma_f32_32x32x8_bf16 v[88:103], v[48:49], v[42:43], v[88:103]
    v_exp_f32 v76, v76
    v_exp_f32 v77, v77
    v_exp_f32 v78, v78
    v_exp_f32 v79, v79
    v_cvt_pk_bf16_f32 v104, v72, v73
    v_cvt_pk_bf16_f32 v105, v74, v75
    v_mfma_f32_32x32x16_bf16 a[16:31], v[56:59], v[112:115], a[16:31]
    ds_read_b128 v[68:71], v4 offset:2112
    v_exp_f32 v80, v80
    v_exp_f32 v81, v81
    v_exp_f32 v82, v82
    v_exp_f32 v83, v83
    v_cvt_pk_bf16_f32 v106, v76, v77
    v_cvt_pk_bf16_f32 v107, v78, v79
    v_mfma_f32_32x32x16_bf16 a[16:31], v[60:63], v[116:119], a[16:31]
    v_exp_f32 v84, v84
    v_exp_f32 v85, v85
    v_exp_f32 v86, v86
    v_exp_f32 v87, v87
    v_cvt_pk_bf16_f32 v108, v80, v81
    v_cvt_pk_bf16_f32 v109, v82, v83
    v_cvt_pk_bf16_f32 v110, v84, v85
    v_cvt_pk_bf16_f32 v111, v86, v87
    s_waitcnt lgkmcnt(2)
    v_mfma_f32_32x32x16_bf16 v[72:87], v[50:53], v[20:23], 0
    v_exp_f32 v88, v88
    v_exp_f32 v89, v89
    v_exp_f32 v90, v90
    v_exp_f32 v91, v91
    v_mfma_f32_32x32x8_bf16 v[72:87], v[54:55], v[24:25], v[72:87]
    v_exp_f32 v92, v92
    v_exp_f32 v93, v93
    v_exp_f32 v94, v94
    v_exp_f32 v95, v95
    v_cvt_pk_bf16_f32 v112, v88, v89
    v_cvt_pk_bf16_f32 v113, v90, v91
    v_mfma_f32_32x32x16_bf16 a[32:47], v[56:59], v[104:107], a[32:47]
    v_exp_f32 v96, v96
    v_exp_f32 v97, v97
    v_exp_f32 v98, v98
    v_exp_f32 v99, v99
    v_cvt_pk_bf16_f32 v114, v92, v93
    v_cvt_pk_bf16_f32 v115, v94, v95
    v_mfma_f32_32x32x16_bf16 a[32:47], v[60:63], v[108:111], a[32:47]
    s_cmp_ge_u32 s83, 544
    s_cbranch_scc1 L_nowt_64
    s_mul_i32 s101, s83, 964
    s_lshr_b32 s101, s101, 16
    s_mul_i32 s85, s101, 68
    s_sub_u32 s85, s83, s85
    s_mul_i32 s101, s101, 160
    s_cmp_lt_u32 s85, 48
    s_cselect_b32 s89, 0, 48
    s_cselect_b32 s92, s20, s12
    s_cselect_b32 s93, s21, s13
    s_cselect_b32 s94, s22, s14
    s_mov_b32 s95, 0x00020000
    s_sub_u32 s85, s85, s89
    s_mul_i32 s85, s85, 40960
    s_add_u32 s85, s85, s101
    s_add_u32 m0, s70, 0
    s_nop 0
    buffer_load_dwordx4 v133, s[92:95], s85 offen offset:0 lds
    s_add_u32 m0, s70, 0
    s_nop 0
    buffer_load_dwordx4 v134, s[92:95], s85 offen offset:1024 lds
    s_add_u32 m0, s70, 0
    s_nop 0
    buffer_load_dwordx4 v135, s[92:95], s85 offen offset:2048 lds
    s_add_u32 m0, s70, 0
    s_nop 0
    buffer_load_dwordx4 v136, s[92:95], s85 offen offset:3072 lds
    s_add_u32 m0, s70, 4096
    s_nop 0
    buffer_load_dwordx4 v137, s[92:95], s85 offen offset:0 lds
L_nowt_64:
    v_exp_f32 v100, v100
    v_exp_f32 v101, v101
    v_exp_f32 v102, v102
    v_exp_f32 v103, v103
    v_cvt_pk_bf16_f32 v116, v96, v97
    v_cvt_pk_bf16_f32 v117, v98, v99
    v_cvt_pk_bf16_f32 v118, v100, v101
    v_cvt_pk_bf16_f32 v119, v102, v103
    v_mfma_f32_32x32x16_bf16 v[88:103], v[50:53], v[26:29], 0
    ds_read_b128 v[44:47], v2 offset:2048
    v_exp_f32 v72, v72
    v_exp_f32 v73, v73
    v_exp_f32 v74, v74
    v_exp_f32 v75, v75
    v_mfma_f32_32x32x8_bf16 v[88:103], v[54:55], v[30:31], v[88:103]
    ds_read_b64 v[48:49], v3 offset:1024
    v_exp_f32 v76, v76
    v_exp_f32 v77, v77
    v_exp_f32 v78, v78
    v_exp_f32 v79, v79
    v_cvt_pk_bf16_f32 v104, v72, v73
    v_cvt_pk_bf16_f32 v105, v74, v75
    v_mfma_f32_32x32x16_bf16 a[48:63], v[56:59], v[112:115], a[48:63]
    v_exp_f32 v80, v80
    v_exp_f32 v81, v81
    v_exp_f32 v82, v82
    v_exp_f32 v83, v83
    v_cvt_pk_bf16_f32 v106, v76, v77
    v_cvt_pk_bf16_f32 v107, v78, v79
    v_mfma_f32_32x32x16_bf16 a[48:63], v[60:63], v[116:119], a[48:63]
    v_exp_f32 v84, v84
    v_exp_f32 v85, v85
    v_exp_f32 v86, v86
    v_exp_f32 v87, v87
    v_cvt_pk_bf16_f32 v108, v80, v81
    v_cvt_pk_bf16_f32 v109, v82, v83
    v_cvt_pk_bf16_f32 v110, v84, v85
    v_cvt_pk_bf16_f32 v111, v86, v87
    v_mfma_f32_32x32x16_bf16 v[72:87], v[50:53], v[32:35], 0
    v_exp_f32 v88, v88
    v_exp_f32 v89, v89
    v_exp_f32 v90, v90
    v_exp_f32 v91, v91
    v_mfma_f32_32x32x8_bf16 v[72:87], v[54:55], v[36:37], v[72:87]
    v_exp_f32 v92, v92
    v_exp_f32 v93, v93
    v_exp_f32 v94, v94
    v_exp_f32 v95, v95
    v_cvt_pk_bf16_f32 v112, v88, v89
    v_cvt_pk_bf16_f32 v113, v90, v91
    s_waitcnt lgkmcnt(2)
    v_mfma_f32_32x32x16_bf16 a[0:15], v[64:67], v[104:107], a[0:15]
    ds_read_b128 v[56:59], v4 offset:2816
    v_exp_f32 v96, v96
    v_exp_f32 v97, v97
    v_exp_f32 v98, v98
    v_exp_f32 v99, v99
    v_cvt_pk_bf16_f32 v114, v92, v93
    v_cvt_pk_bf16_f32 v115, v94, v95
    v_mfma_f32_32x32x16_bf16 a[0:15], v[68:71], v[108:111], a[0:15]
    v_exp_f32 v100, v100
    v_exp_f32 v101, v101
    v_exp_f32 v102, v102
    v_exp_f32 v103, v103
    v_cvt_pk_bf16_f32 v116, v96, v97
    v_cvt_pk_bf16_f32 v117, v98, v99
    v_cvt_pk_bf16_f32 v118, v100, v101
    v_cvt_pk_bf16_f32 v119, v102, v103
    v_mfma_f32_32x32x16_bf16 v[88:103], v[50:53], v[38:41], 0
    v_exp_f32 v72, v72
    v_exp_f32 v73, v73
    v_exp_f32 v74, v74
    v_exp_f32 v75, v75
    v_mfma_f32_32x32x8_bf16 v[88:103], v[54:55], v[42:43], v[88:103]
    v_exp_f32 v76, v76
    v_exp_f32 v77, v77
    v_exp_f32 v78, v78
    v_exp_f32 v79, v79
    v_cvt_pk_bf16_f32 v104, v72, v73
    v_cvt_pk_bf16_f32 v105, v74, v75
    v_mfma_f32_32x32x16_bf16 a[16:31], v[64:67], v[112:115], a[16:31]
    ds_read_b128 v[60:63], v4 offset:3520
    v_exp_f32 v80, v80
    v_exp_f32 v81, v81
    v_exp_f32 v82, v82
    v_exp_f32 v83, v83
    v_cvt_pk_bf16_f32 v106, v76, v77
    v_cvt_pk_bf16_f32 v107, v78, v79
    v_mfma_f32_32x32x16_bf16 a[16:31], v[68:71], v[116:119], a[16:31]
    v_exp_f32 v84, v84
    v_exp_f32 v85, v85
    v_exp_f32 v86, v86
    v_exp_f32 v87, v87
    v_cvt_pk_bf16_f32 v108, v80, v81
    v_cvt_pk_bf16_f32 v109, v82, v83
    v_cvt_pk_bf16_f32 v110, v84, v85
    v_cvt_pk_bf16_f32 v111, v86, v87
    s_waitcnt lgkmcnt(2)
    v_mfma_f32_32x32x16_bf16 v[72:87], v[44:47], v[20:23], 0
    v_exp_f32 v88, v88
    v_exp_f32 v89, v89
    v_exp_f32 v90, v90
    v_exp_f32 v91, v91
    v_mfma_f32_32x32x8_bf16 v[72:87], v[48:49], v[24:25], v[72:87]
    v_exp_f32 v92, v92
    v_exp_f32 v93, v93
    v_exp_f32 v94, v94
    v_exp_f32 v95, v95
    v_cvt_pk_bf16_f32 v112, v88, v89
    v_cvt_pk_bf16_f32 v113, v90, v91
    v_mfma_f32_32x32x16_bf16 a[32:47], v[64:67], v[104:107], a[32:47]
    v_exp_f32 v96, v96
    v_exp_f32 v97, v97
    v_exp_f32 v98, v98
    v_exp_f32 v99, v99
    v_cvt_pk_bf16_f32 v114, v92, v93
    v_cvt_pk_bf16_f32 v115, v94, v95
    v_mfma_f32_32x32x16_bf16 a[32:47], v[68:71], v[108:111], a[32:47]
    v_exp_f32 v100, v100
    v_exp_f32 v101, v101
    v_exp_f32 v102, v102
    v_exp_f32 v103, v103
    v_cvt_pk_bf16_f32 v116, v96, v97
    v_cvt_pk_bf16_f32 v117, v98, v99
    v_cvt_pk_bf16_f32 v118, v100, v101
    v_cvt_pk_bf16_f32 v119, v102, v103
    v_mfma_f32_32x32x16_bf16 v[88:103], v[44:47], v[26:29], 0
    ds_read_b128 v[50:53], v2 offset:3072
    v_exp_f32 v72, v72
    v_exp_f32 v73, v73
    v_exp_f32 v74, v74
    v_exp_f32 v75, v75
    v_mfma_f32_32x32x8_bf16 v[88:103], v[48:49], v[30:31], v[88:103]
    ds_read_b64 v[54:55], v3 offset:1536
    v_exp_f32 v76, v76
    v_exp_f32 v77, v77
    v_exp_f32 v78, v78
    v_exp_f32 v79, v79
    v_cvt_pk_bf16_f32 v104, v72, v73
    v_cvt_pk_bf16_f32 v105, v74, v75
    v_mfma_f32_32x32x16_bf16 a[48:63], v[64:67], v[112:115], a[48:63]
    v_exp_f32 v80, v80
    v_exp_f32 v81, v81
    v_exp_f32 v82, v82
    v_exp_f32 v83, v83
    v_cvt_pk_bf16_f32 v106, v76, v77
    v_cvt_pk_bf16_f32 v107, v78, v79
    v_mfma_f32_32x32x16_bf16 a[48:63], v[68:71], v[116:119], a[48:63]
    v_exp_f32 v84, v84
    v_exp_f32 v85, v85
    v_exp_f32 v86, v86
    v_exp_f32 v87, v87
    v_cvt_pk_bf16_f32 v108, v80, v81
    v_cvt_pk_bf16_f32 v109, v82, v83
    v_cvt_pk_bf16_f32 v110, v84, v85
    v_cvt_pk_bf16_f32 v111, v86, v87
    v_mfma_f32_32x32x16_bf16 v[72:87], v[44:47], v[32:35], 0
    v_exp_f32 v88, v88
    v_exp_f32 v89, v89
    v_exp_f32 v90, v90
    v_exp_f32 v91, v91
    v_mfma_f32_32x32x8_bf16 v[72:87], v[48:49], v[36:37], v[72:87]
    v_exp_f32 v92, v92
    v_exp_f32 v93, v93
    v_exp_f32 v94, v94
    v_exp_f32 v95, v95
    v_cvt_pk_bf16_f32 v112, v88, v89
    v_cvt_pk_bf16_f32 v113, v90, v91
    s_waitcnt lgkmcnt(2)
    v_mfma_f32_32x32x16_bf16 a[0:15], v[56:59], v[104:107], a[0:15]
    ds_read_b128 v[64:67], v4 offset:4224
    v_exp_f32 v96, v96
    v_exp_f32 v97, v97
    v_exp_f32 v98, v98
    v_exp_f32 v99, v99
    v_cvt_pk_bf16_f32 v114, v92, v93
    v_cvt_pk_bf16_f32 v115, v94, v95
    v_mfma_f32_32x32x16_bf16 a[0:15], v[60:63], v[108:111], a[0:15]
    v_exp_f32 v100, v100
    v_exp_f32 v101, v101
    v_exp_f32 v102, v102
    v_exp_f32 v103, v103
    v_cvt_pk_bf16_f32 v116, v96, v97
    v_cvt_pk_bf16_f32 v117, v98, v99
    v_cvt_pk_bf16_f32 v118, v100, v101
    v_cvt_pk_bf16_f32 v119, v102, v103
    v_mfma_f32_32x32x16_bf16 v[88:103], v[44:47], v[38:41], 0
    v_exp_f32 v72, v72
    v_exp_f32 v73, v73
    v_exp_f32 v74, v74
    v_exp_f32 v75, v75
    v_mfma_f32_32x32x8_bf16 v[88:103], v[48:49], v[42:43], v[88:103]
    v_exp_f32 v76, v76
    v_exp_f32 v77, v77
    v_exp_f32 v78, v78
    v_exp_f32 v79, v79
    v_cvt_pk_bf16_f32 v104, v72, v73
    v_cvt_pk_bf16_f32 v105, v74, v75
    v_mfma_f32_32x32x16_bf16 a[16:31], v[56:59], v[112:115], a[16:31]
    ds_read_b128 v[68:71], v4 offset:4928
    v_exp_f32 v80, v80
    v_exp_f32 v81, v81
    v_exp_f32 v82, v82
    v_exp_f32 v83, v83
    v_cvt_pk_bf16_f32 v106, v76, v77
    v_cvt_pk_bf16_f32 v107, v78, v79
    v_mfma_f32_32x32x16_bf16 a[16:31], v[60:63], v[116:119], a[16:31]
    v_exp_f32 v84, v84
    v_exp_f32 v85, v85
    v_exp_f32 v86, v86
    v_exp_f32 v87, v87
    v_cvt_pk_bf16_f32 v108, v80, v81
    v_cvt_pk_bf16_f32 v109, v82, v83
    v_cvt_pk_bf16_f32 v110, v84, v85
    v_cvt_pk_bf16_f32 v111, v86, v87
    s_waitcnt lgkmcnt(2)
    v_mfma_f32_32x32x16_bf16 v[72:87], v[50:53], v[20:23], 0
    v_exp_f32 v88, v88
    v_exp_f32 v89, v89
    v_exp_f32 v90, v90
    v_exp_f32 v91, v91
    v_mfma_f32_32x32x8_bf16 v[72:87], v[54:55], v[24:25], v[72:87]
    v_exp_f32 v92, v92
    v_exp_f32 v93, v93
    v_exp_f32 v94, v94
    v_exp_f32 v95, v95
    v_cvt_pk_bf16_f32 v112, v88, v89
    v_cvt_pk_bf16_f32 v113, v90, v91
    v_mfma_f32_32x32x16_bf16 a[32:47], v[56:59], v[104:107], a[32:47]
    v_exp_f32 v96, v96
    v_exp_f32 v97, v97
    v_exp_f32 v98, v98
    v_exp_f32 v99, v99
    v_cvt_pk_bf16_f32 v114, v92, v93
    v_cvt_pk_bf16_f32 v115, v94, v95
    v_mfma_f32_32x32x16_bf16 a[32:47], v[60:63], v[108:111], a[32:47]
    v_exp_f32 v100, v100
    v_exp_f32 v101, v101
    v_exp_f32 v102, v102
    v_exp_f32 v103, v103
    v_cvt_pk_bf16_f32 v116, v96, v97
    v_cvt_pk_bf16_f32 v117, v98, v99
    v_cvt_pk_bf16_f32 v118, v100, v101
    v_cvt_pk_bf16_f32 v119, v102, v103
    s_waitcnt vmcnt(0)
    s_waitcnt lgkmcnt(0)
    s_barrier
    v_mfma_f32_32x32x16_bf16 v[88:103], v[50:53], v[26:29], 0
    ds_read_b128 v[44:47], v2 offset:23552
    v_exp_f32 v72, v72
    v_exp_f32 v73, v73
    v_exp_f32 v74, v74
    v_exp_f32 v75, v75
    v_mfma_f32_32x32x8_bf16 v[88:103], v[54:55], v[30:31], v[88:103]
    ds_read_b64 v[48:49], v3 offset:23552
    v_exp_f32 v76, v76
    v_exp_f32 v77, v77
    v_exp_f32 v78, v78
    v_exp_f32 v79, v79
    v_cvt_pk_bf16_f32 v104, v72, v73
    v_cvt_pk_bf16_f32 v105, v74, v75
    v_mfma_f32_32x32x16_bf16 a[48:63], v[56:59], v[112:115], a[48:63]
    v_exp_f32 v80, v80
    v_exp_f32 v81, v81
    v_exp_f32 v82, v82
    v_exp_f32 v83, v83
    v_cvt_pk_bf16_f32 v106, v76, v77
    v_cvt_pk_bf16_f32 v107, v78, v79
    v_mfma_f32_32x32x16_bf16 a[48:63], v[60:63], v[116:119], a[48:63]
    s_add_u32 m0, s67, 0
    s_nop 0
    buffer_load_dwordx4 v5, s[24:27], s50 offen sc1 lds
    v_exp_f32 v84, v84
    v_exp_f32 v85, v85
    v_exp_f32 v86, v86
    v_exp_f32 v87, v87
    v_cvt_pk_bf16_f32 v108, v80, v81
    v_cvt_pk_bf16_f32 v109, v82, v83
    v_cvt_pk_bf16_f32 v110, v84, v85
    v_cvt_pk_bf16_f32 v111, v86, v87
    v_mfma_f32_32x32x16_bf16 v[72:87], v[50:53], v[32:35], 0
    v_exp_f32 v88, v88
    v_exp_f32 v89, v89
    v_exp_f32 v90, v90
    v_exp_f32 v91, v91
    v_mfma_f32_32x32x8_bf16 v[72:87], v[54:55], v[36:37], v[72:87]
    v_exp_f32 v92, v92
    v_exp_f32 v93, v93
    v_exp_f32 v94, v94
    v_exp_f32 v95, v95
    v_cvt_pk_bf16_f32 v112, v88, v89
    v_cvt_pk_bf16_f32 v113, v90, v91
    v_mfma_f32_32x32x16_bf16 a[0:15], v[64:67], v[104:107], a[0:15]
    ds_read_b128 v[56:59], v4 offset:23552
    v_exp_f32 v96, v96
    v_exp_f32 v97, v97
    v_exp_f32 v98, v98
    v_exp_f32 v99, v99
    v_cvt_pk_bf16_f32 v114, v92, v93
    v_cvt_pk_bf16_f32 v115, v94, v95
    v_mfma_f32_32x32x16_bf16 a[0:15], v[68:71], v[108:111], a[0:15]
    s_add_u32 m0, s67, 0
    s_nop 0
    buffer_load_dwordx4 v5, s[24:27], s50 offen offset:1024 sc1 lds
    v_exp_f32 v100, v100
    v_exp_f32 v101, v101
    v_exp_f32 v102, v102
    v_exp_f32 v103, v103
    v_cvt_pk_bf16_f32 v116, v96, v97
    v_cvt_pk_bf16_f32 v117, v98, v99
    v_cvt_pk_bf16_f32 v118, v100, v101
    v_cvt_pk_bf16_f32 v119, v102, v103
    v_mfma_f32_32x32x16_bf16 v[88:103], v[50:53], v[38:41], 0
    v_exp_f32 v72, v72
    v_exp_f32 v73, v73
    v_exp_f32 v74, v74
    v_exp_f32 v75, v75
    v_mfma_f32_32x32x8_bf16 v[88:103], v[54:55], v[42:43], v[88:103]
    v_exp_f32 v76, v76
    v_exp_f32 v77, v77
    v_exp_f32 v78, v78
    v_exp_f32 v79, v79
    v_cvt_pk_bf16_f32 v104, v72, v73
    v_cvt_pk_bf16_f32 v105, v74, v75
    v_mfma_f32_32x32x16_bf16 a[16:31], v[64:67], v[112:115], a[16:31]
    ds_read_b128 v[60:63], v4 offset:24256
    v_exp_f32 v80, v80
    v_exp_f32 v81, v81
    v_exp_f32 v82, v82
    v_exp_f32 v83, v83
    v_cvt_pk_bf16_f32 v106, v76, v77
    v_cvt_pk_bf16_f32 v107, v78, v79
    v_mfma_f32_32x32x16_bf16 a[16:31], v[68:71], v[116:119], a[16:31]
    s_add_u32 m0, s71, 0
    s_nop 0
    buffer_load_dwordx4 v5, s[24:27], s51 offen sc1 lds
    v_exp_f32 v84, v84
    v_exp_f32 v85, v85
    v_exp_f32 v86, v86
    v_exp_f32 v87, v87
    v_cvt_pk_bf16_f32 v108, v80, v81
    v_cvt_pk_bf16_f32 v109, v82, v83
    v_cvt_pk_bf16_f32 v110, v84, v85
    v_cvt_pk_bf16_f32 v111, v86, v87
    s_waitcnt lgkmcnt(2)
    v_mfma_f32_32x32x16_bf16 v[72:87], v[44:47], v[20:23], 0
    v_exp_f32 v88, v88
    v_exp_f32 v89, v89
    v_exp_f32 v90, v90
    v_exp_f32 v91, v91
    v_mfma_f32_32x32x8_bf16 v[72:87], v[48:49], v[24:25], v[72:87]
    v_exp_f32 v92, v92
    v_exp_f32 v93, v93
    v_exp_f32 v94, v94
    v_exp_f32 v95, v95
    v_cvt_pk_bf16_f32 v112, v88, v89
    v_cvt_pk_bf16_f32 v113, v90, v91
    v_mfma_f32_32x32x16_bf16 a[32:47], v[64:67], v[104:107], a[32:47]
    v_exp_f32 v96, v96
    v_exp_f32 v97, v97
    v_exp_f32 v98, v98
    v_exp_f32 v99, v99
    v_cvt_pk_bf16_f32 v114, v92, v93
    v_cvt_pk_bf16_f32 v115, v94, v95
    v_mfma_f32_32x32x16_bf16 a[32:47], v[68:71], v[108:111], a[32:47]
    s_add_u32 m0, s80, 0
    s_mov_b64 exec, s[74:75]
    buffer_load_dwordx4 v6, s[24:27], s52 offen sc1 lds
    s_mov_b64 exec, -1
    v_exp_f32 v100, v100
    v_exp_f32 v101, v101
    v_exp_f32 v102, v102
    v_exp_f32 v103, v103
    v_cvt_pk_bf16_f32 v116, v96, v97
    v_cvt_pk_bf16_f32 v117, v98, v99
    v_cvt_pk_bf16_f32 v118, v100, v101
    v_cvt_pk_bf16_f32 v119, v102, v103
    v_mfma_f32_32x32x16_bf16 v[88:103], v[44:47], v[26:29], 0
    ds_read_b128 v[50:53], v2 offset:24576
    v_exp_f32 v72, v72
    v_exp_f32 v73, v73
    v_exp_f32 v74, v74
    v_exp_f32 v75, v75
    v_mfma_f32_32x32x8_bf16 v[88:103], v[48:49], v[30:31], v[88:103]
    ds_read_b64 v[54:55], v3 offset:24064
    v_exp_f32 v76, v76
    v_exp_f32 v77, v77
    v_exp_f32 v78, v78
    v_exp_f32 v79, v79
    v_cvt_pk_bf16_f32 v104, v72, v73
    v_cvt_pk_bf16_f32 v105, v74, v75
    v_mfma_f32_32x32x16_bf16 a[48:63], v[64:67], v[112:115], a[48:63]
    v_exp_f32 v80, v80
    v_exp_f32 v81, v81
    v_exp_f32 v82, v82
    v_exp_f32 v83, v83
    v_cvt_pk_bf16_f32 v106, v76, v77
    v_cvt_pk_bf16_f32 v107, v78, v79
    v_mfma_f32_32x32x16_bf16 a[48:63], v[68:71], v[116:119], a[48:63]
    s_add_u32 m0, s81, 0
    s_mov_b64 exec, s[76:77]
    buffer_load_dwordx4 v7, s[24:27], s52 offen sc1 lds
    s_mov_b64 exec, -1
    v_exp_f32 v84, v84
    v_exp_f32 v85, v85
    v_exp_f32 v86, v86
    v_exp_f32 v87, v87
    v_cvt_pk_bf16_f32 v108, v80, v81
    v_cvt_pk_bf16_f32 v109, v82, v83
    v_cvt_pk_bf16_f32 v110, v84, v85
    v_cvt_pk_bf16_f32 v111, v86, v87
    v_mfma_f32_32x32x16_bf16 v[72:87], v[44:47], v[32:35], 0
    v_exp_f32 v88, v88
    v_exp_f32 v89, v89
    v_exp_f32 v90, v90
    v_exp_f32 v91, v91
    v_mfma_f32_32x32x8_bf16 v[72:87], v[48:49], v[36:37], v[72:87]
    v_exp_f32 v92, v92
    v_exp_f32 v93, v93
    v_exp_f32 v94, v94
    v_exp_f32 v95, v95
    v_cvt_pk_bf16_f32 v112, v88, v89
    v_cvt_pk_bf16_f32 v113, v90, v91
    s_waitcnt lgkmcnt(2)
    v_mfma_f32_32x32x16_bf16 a[0:15], v[56:59], v[104:107], a[0:15]
    ds_read_b128 v[64:67], v4 offset:24960
    v_exp_f32 v96, v96
    v_exp_f32 v97, v97
    v_exp_f32 v98, v98
    v_exp_f32 v99, v99
    v_cvt_pk_bf16_f32 v114, v92, v93
    v_cvt_pk_bf16_f32 v115, v94, v95
    v_mfma_f32_32x32x16_bf16 a[0:15], v[60:63], v[108:111], a[0:15]
    s_add_u32 m0, s82, 0
    s_mov_b64 exec, s[78:79]
    buffer_load_dwordx4 v8, s[24:27], s52 offen sc1 lds
    s_mov_b64 exec, -1
    v_exp_f32 v100, v100
    v_exp_f32 v101, v101
    v_exp_f32 v102, v102
    v_exp_f32 v103, v103
    v_cvt_pk_bf16_f32 v116, v96, v97
    v_cvt_pk_bf16_f32 v117, v98, v99
    v_cvt_pk_bf16_f32 v118, v100, v101
    v_cvt_pk_bf16_f32 v119, v102, v103
    v_mfma_f32_32x32x16_bf16 v[88:103], v[44:47], v[38:41], 0
    v_exp_f32 v72, v72
    v_exp_f32 v73, v73
    v_exp_f32 v74, v74
    v_exp_f32 v75, v75
    v_mfma_f32_32x32x8_bf16 v[88:103], v[48:49], v[42:43], v[88:103]
    v_exp_f32 v76, v76
    v_exp_f32 v77, v77
    v_exp_f32 v78, v78
    v_exp_f32 v79, v79
    v_cvt_pk_bf16_f32 v104, v72, v73
    v_cvt_pk_bf16_f32 v105, v74, v75
    v_mfma_f32_32x32x16_bf16 a[16:31], v[56:59], v[112:115], a[16:31]
    ds_read_b128 v[68:71], v4 offset:25664
    v_exp_f32 v80, v80
    v_exp_f32 v81, v81
    v_exp_f32 v82, v82
    v_exp_f32 v83, v83
    v_cvt_pk_bf16_f32 v106, v76, v77
    v_cvt_pk_bf16_f32 v107, v78, v79
    v_mfma_f32_32x32x16_bf16 a[16:31], v[60:63], v[116:119], a[16:31]
    s_add_u32 s50, s50, 4096
    s_add_u32 s51, s51, 2048
    s_add_u32 s52, s52, 5120
    v_exp_f32 v84, v84
    v_exp_f32 v85, v85
    v_exp_f32 v86, v86
    v_exp_f32 v87, v87
    v_cvt_pk_bf16_f32 v108, v80, v81
    v_cvt_pk_bf16_f32 v109, v82, v83
    v_cvt_pk_bf16_f32 v110, v84, v85
    v_cvt_pk_bf16_f32 v111, v86, v87
    s_waitcnt lgkmcnt(2)
    v_mfma_f32_32x32x16_bf16 v[72:87], v[50:53], v[20:23], 0
    v_exp_f32 v88, v88
    v_exp_f32 v89, v89
    v_exp_f32 v90, v90
    v_exp_f32 v91, v91
    v_mfma_f32_32x32x8_bf16 v[72:87], v[54:55], v[24:25], v[72:87]
    v_exp_f32 v92, v92
    v_exp_f32 v93, v93
    v_exp_f32 v94, v94
    v_exp_f32 v95, v95
    v_cvt_pk_bf16_f32 v112, v88, v89
    v_cvt_pk_bf16_f32 v113, v90, v91
    v_mfma_f32_32x32x16_bf16 a[32:47], v[56:59], v[104:107], a[32:47]
    v_exp_f32 v96, v96
    v_exp_f32 v97, v97
    v_exp_f32 v98, v98
    v_exp_f32 v99, v99
    v_cvt_pk_bf16_f32 v114, v92, v93
    v_cvt_pk_bf16_f32 v115, v94, v95
    v_mfma_f32_32x32x16_bf16 a[32:47], v[60:63], v[108:111], a[32:47]
    s_cmp_ge_u32 s83, 544
    s_cbranch_scc1 L_nowt_65
    s_waitcnt vmcnt(6)
    ds_read_b64_tr_b16 v[144:145], v125 offset:0
    ds_read_b64_tr_b16 v[146:147], v125 offset:2560
    ds_read_b64_tr_b16 v[148:149], v125 offset:32
    ds_read_b64_tr_b16 v[150:151], v125 offset:2592
    ds_read_b64_tr_b16 v[152:153], v125 offset:64
    ds_read_b64_tr_b16 v[154:155], v125 offset:2624
    ds_read_b64_tr_b16 v[156:157], v125 offset:96
    ds_read_b64_tr_b16 v[158:159], v125 offset:2656
    ds_read_b64_tr_b16 v[160:161], v125 offset:128
    ds_read_b64_tr_b16 v[162:163], v125 offset:2688
    s_waitcnt lgkmcnt(0)
    s_mul_i32 s85, s83, 5120
    s_add_u32 s85, s85, 20971520
    s_add_u32 s101, s85, 4096
    buffer_store_dwordx4 v[144:147], v126, s[24:27], s85 offen offset:0 sc1
    buffer_store_dwordx4 v[148:151], v126, s[24:27], s85 offen offset:1024 sc1
    buffer_store_dwordx4 v[152:155], v126, s[24:27], s85 offen offset:2048 sc1
    buffer_store_dwordx4 v[156:159], v126, s[24:27], s85 offen offset:3072 sc1
    buffer_store_dwordx4 v[160:163], v126, s[24:27], s101 offen offset:0 sc1
L_nowt_65:
    v_exp_f32 v100, v100
    v_exp_f32 v101, v101
    v_exp_f32 v102, v102
    v_exp_f32 v103, v103
    v_cvt_pk_bf16_f32 v116, v96, v97
    v_cvt_pk_bf16_f32 v117, v98, v99
    v_cvt_pk_bf16_f32 v118, v100, v101
    v_cvt_pk_bf16_f32 v119, v102, v103
    v_mfma_f32_32x32x16_bf16 v[88:103], v[50:53], v[26:29], 0
    ds_read_b128 v[44:47], v2 offset:25600
    v_exp_f32 v72, v72
    v_exp_f32 v73, v73
    v_exp_f32 v74, v74
    v_exp_f32 v75, v75
    v_mfma_f32_32x32x8_bf16 v[88:103], v[54:55], v[30:31], v[88:103]
    ds_read_b64 v[48:49], v3 offset:24576
    v_exp_f32 v76, v76
    v_exp_f32 v77, v77
    v_exp_f32 v78, v78
    v_exp_f32 v79, v79
    v_cvt_pk_bf16_f32 v104, v72, v73
    v_cvt_pk_bf16_f32 v105, v74, v75
    v_mfma_f32_32x32x16_bf16 a[48:63], v[56:59], v[112:115], a[48:63]
    v_exp_f32 v80, v80
    v_exp_f32 v81, v81
    v_exp_f32 v82, v82
    v_exp_f32 v83, v83
    v_cvt_pk_bf16_f32 v106, v76, v77
    v_cvt_pk_bf16_f32 v107, v78, v79
    v_mfma_f32_32x32x16_bf16 a[48:63], v[60:63], v[116:119], a[48:63]
    s_lshr_b32 s88, s42, 1
    s_lshl_b32 s88, s88, 11
    s_add_u32 s88, s88, 98304
    v_and_b32 v242, 15, v0
    v_lshlrev_b32 v242, 7, v242
    v_add_u32 v242, s88, v242
    s_mov_b32 exec_lo, 0xffff
    s_mov_b32 exec_hi, 0x0
    buffer_load_dwordx2 v[240:241], v242, s[24:27], 0 offen sc1
    s_mov_b64 exec, -1
    v_exp_f32 v84, v84
    v_exp_f32 v85, v85
    v_exp_f32 v86, v86
    v_exp_f32 v87, v87
    v_cvt_pk_bf16_f32 v108, v80, v81
    v_cvt_pk_bf16_f32 v109, v82, v83
    v_cvt_pk_bf16_f32 v110, v84, v85
    v_cvt_pk_bf16_f32 v111, v86, v87
    v_mfma_f32_32x32x16_bf16 v[72:87], v[50:53], v[32:35], 0
    v_exp_f32 v88, v88
    v_exp_f32 v89, v89
    v_exp_f32 v90, v90
    v_exp_f32 v91, v91
    v_mfma_f32_32x32x8_bf16 v[72:87], v[54:55], v[36:37], v[72:87]
    v_exp_f32 v92, v92
    v_exp_f32 v93, v93
    v_exp_f32 v94, v94
    v_exp_f32 v95, v95
    v_cvt_pk_bf16_f32 v112, v88, v89
    v_cvt_pk_bf16_f32 v113, v90, v91
    s_waitcnt lgkmcnt(2)
    v_mfma_f32_32x32x16_bf16 a[0:15], v[64:67], v[104:107], a[0:15]
    ds_read_b128 v[56:59], v4 offset:26368
    v_exp_f32 v96, v96
    v_exp_f32 v97, v97
    v_exp_f32 v98, v98
    v_exp_f32 v99, v99
    v_cvt_pk_bf16_f32 v114, v92, v93
    v_cvt_pk_bf16_f32 v115, v94, v95
    v_mfma_f32_32x32x16_bf16 a[0:15], v[68:71], v[108:111], a[0:15]
    v_exp_f32 v100, v100
    v_exp_f32 v101, v101
    v_exp_f32 v102, v102
    v_exp_f32 v103, v103
    v_cvt_pk_bf16_f32 v116, v96, v97
    v_cvt_pk_bf16_f32 v117, v98, v99
    v_cvt_pk_bf16_f32 v118, v100, v101
    v_cvt_pk_bf16_f32 v119, v102, v103
    v_mfma_f32_32x32x16_bf16 v[88:103], v[50:53], v[38:41], 0
    v_exp_f32 v72, v72
    v_exp_f32 v73, v73
    v_exp_f32 v74, v74
    v_exp_f32 v75, v75
    v_mfma_f32_32x32x8_bf16 v[88:103], v[54:55], v[42:43], v[88:103]
    v_exp_f32 v76, v76
    v_exp_f32 v77, v77
    v_exp_f32 v78, v78
    v_exp_f32 v79, v79
    v_cvt_pk_bf16_f32 v104, v72, v73
    v_cvt_pk_bf16_f32 v105, v74, v75
    v_mfma_f32_32x32x16_bf16 a[16:31], v[64:67], v[112:115], a[16:31]
    ds_read_b128 v[60:63], v4 offset:27072
    v_exp_f32 v80, v80
    v_exp_f32 v81, v81
    v_exp_f32 v82, v82
    v_exp_f32 v83, v83
    v_cvt_pk_bf16_f32 v106, v76, v77
    v_cvt_pk_bf16_f32 v107, v78, v79
    v_mfma_f32_32x32x16_bf16 a[16:31], v[68:71], v[116:119], a[16:31]
    v_exp_f32 v84, v84
    v_exp_f32 v85, v85
    v_exp_f32 v86, v86
    v_exp_f32 v87, v87
    v_cvt_pk_bf16_f32 v108, v80, v81
    v_cvt_pk_bf16_f32 v109, v82, v83
    v_cvt_pk_bf16_f32 v110, v84, v85
    v_cvt_pk_bf16_f32 v111, v86, v87
    s_waitcnt lgkmcnt(2)
    v_mfma_f32_32x32x16_bf16 v[72:87], v[44:47], v[20:23], 0
    v_exp_f32 v88, v88
    v_exp_f32 v89, v89
    v_exp_f32 v90, v90
    v_exp_f32 v91, v91
    v_mfma_f32_32x32x8_bf16 v[72:87], v[48:49], v[24:25], v[72:87]
    v_exp_f32 v92, v92
    v_exp_f32 v93, v93
    v_exp_f32 v94, v94
    v_exp_f32 v95, v95
    v_cvt_pk_bf16_f32 v112, v88, v89
    v_cvt_pk_bf16_f32 v113, v90, v91
    v_mfma_f32_32x32x16_bf16 a[32:47], v[64:67], v[104:107], a[32:47]
    v_exp_f32 v96, v96
    v_exp_f32 v97, v97
    v_exp_f32 v98, v98
    v_exp_f32 v99, v99
    v_cvt_pk_bf16_f32 v114, v92, v93
    v_cvt_pk_bf16_f32 v115, v94, v95
    v_mfma_f32_32x32x16_bf16 a[32:47], v[68:71], v[108:111], a[32:47]
    v_exp_f32 v100, v100
    v_exp_f32 v101, v101
    v_exp_f32 v102, v102
    v_exp_f32 v103, v103
    v_cvt_pk_bf16_f32 v116, v96, v97
    v_cvt_pk_bf16_f32 v117, v98, v99
    v_cvt_pk_bf16_f32 v118, v100, v101
    v_cvt_pk_bf16_f32 v119, v102, v103
    v_mfma_f32_32x32x16_bf16 v[88:103], v[44:47], v[26:29], 0
    ds_read_b128 v[50:53], v2 offset:26624
    v_exp_f32 v72, v72
    v_exp_f32 v73, v73
    v_exp_f32 v74, v74
    v_exp_f32 v75, v75
    v_mfma_f32_32x32x8_bf16 v[88:103], v[48:49], v[30:31], v[88:103]
    ds_read_b64 v[54:55], v3 offset:25088
    v_exp_f32 v76, v76
    v_exp_f32 v77, v77
    v_exp_f32 v78, v78
    v_exp_f32 v79, v79
    v_cvt_pk_bf16_f32 v104, v72, v73
    v_cvt_pk_bf16_f32 v105, v74, v75
    v_mfma_f32_32x32x16_bf16 a[48:63], v[64:67], v[112:115], a[48:63]
    v_exp_f32 v80, v80
    v_exp_f32 v81, v81
    v_exp_f32 v82, v82
    v_exp_f32 v83, v83
    v_cvt_pk_bf16_f32 v106, v76, v77
    v_cvt_pk_bf16_f32 v107, v78, v79
    v_mfma_f32_32x32x16_bf16 a[48:63], v[68:71], v[116:119], a[48:63]
    v_exp_f32 v84, v84
    v_exp_f32 v85, v85
    v_exp_f32 v86, v86
    v_exp_f32 v87, v87
    v_cvt_pk_bf16_f32 v108, v80, v81
    v_cvt_pk_bf16_f32 v109, v82, v83
    v_cvt_pk_bf16_f32 v110, v84, v85
    v_cvt_pk_bf16_f32 v111, v86, v87
    v_mfma_f32_32x32x16_bf16 v[72:87], v[44:47], v[32:35], 0
    v_exp_f32 v88, v88
    v_exp_f32 v89, v89
    v_exp_f32 v90, v90
    v_exp_f32 v91, v91
    v_mfma_f32_32x32x8_bf16 v[72:87], v[48:49], v[36:37], v[72:87]
    v_exp_f32 v92, v92
    v_exp_f32 v93, v93
    v_exp_f32 v94, v94
    v_exp_f32 v95, v95
    v_cvt_pk_bf16_f32 v112, v88, v89
    v_cvt_pk_bf16_f32 v113, v90, v91
    s_waitcnt lgkmcnt(2)
    v_mfma_f32_32x32x16_bf16 a[0:15], v[56:59], v[104:107], a[0:15]
    ds_read_b128 v[64:67], v4 offset:27776
    v_exp_f32 v96, v96
    v_exp_f32 v97, v97
    v_exp_f32 v98, v98
    v_exp_f32 v99, v99
    v_cvt_pk_bf16_f32 v114, v92, v93
    v_cvt_pk_bf16_f32 v115, v94, v95
    v_mfma_f32_32x32x16_bf16 a[0:15], v[60:63], v[108:111], a[0:15]
    v_exp_f32 v100, v100
    v_exp_f32 v101, v101
    v_exp_f32 v102, v102
    v_exp_f32 v103, v103
    v_cvt_pk_bf16_f32 v116, v96, v97
    v_cvt_pk_bf16_f32 v117, v98, v99
    v_cvt_pk_bf16_f32 v118, v100, v101
    v_cvt_pk_bf16_f32 v119, v102, v103
    v_mfma_f32_32x32x16_bf16 v[88:103], v[44:47], v[38:41], 0
    v_exp_f32 v72, v72
    v_exp_f32 v73, v73
    v_exp_f32 v74, v74
    v_exp_f32 v75, v75
    v_mfma_f32_32x32x8_bf16 v[88:103], v[48:49], v[42:43], v[88:103]
    v_exp_f32 v76, v76
    v_exp_f32 v77, v77
    v_exp_f32 v78, v78
    v_exp_f32 v79, v79
    v_cvt_pk_bf16_f32 v104, v72, v73
    v_cvt_pk_bf16_f32 v105, v74, v75
    v_mfma_f32_32x32x16_bf16 a[16:31], v[56:59], v[112:115], a[16:31]
    ds_read_b128 v[68:71], v4 offset:28480
    v_exp_f32 v80, v80
    v_exp_f32 v81, v81
    v_exp_f32 v82, v82
    v_exp_f32 v83, v83
    v_cvt_pk_bf16_f32 v106, v76, v77
    v_cvt_pk_bf16_f32 v107, v78, v79
    v_mfma_f32_32x32x16_bf16 a[16:31], v[60:63], v[116:119], a[16:31]
    s_waitcnt vmcnt(0)
    s_mov_b32 exec_lo, 0xffff
    s_mov_b32 exec_hi, 0x0
    v_xor_b32 v240, s2, v240
    v_xor_b32 v241, s3, v241
    v_or_b32 v240, v240, v241
    v_cmp_ne_u32 vcc, 0, v240
    s_mov_b64 exec, -1
    s_cmp_eq_u64 vcc, 0
    s_cbranch_scc1 L_pollok_66
    s_mov_b32 exec_lo, 0xffff
    s_mov_b32 exec_hi, 0x0
    s_mov_b32 s84, 1048576
L_poll_67:
    buffer_load_dwordx2 v[240:241], v242, s[24:27], 0 offen sc1
    s_waitcnt vmcnt(0)
    v_xor_b32 v240, s2, v240
    v_xor_b32 v241, s3, v241
    v_or_b32 v240, v240, v241
    v_cmp_ne_u32 vcc, 0, v240
    s_cmp_eq_u64 vcc, 0
    s_cbranch_scc1 L_polled_68
    s_sub_u32 s84, s84, 1
    s_cmp_eq_u32 s84, 0
    s_cbranch_scc1 L_polltmo_69
    s_sleep 2
    s_branch L_poll_67
L_polltmo_69:
    v_mov_b32 v240, 227
    v_mov_b32 v241, 252
    global_store_dword v241, v240, s[38:39]
L_polled_68:
    s_mov_b64 exec, -1
L_pollok_66:
    v_exp_f32 v84, v84
    v_exp_f32 v85, v85
    v_exp_f32 v86, v86
    v_exp_f32 v87, v87
    v_cvt_pk_bf16_f32 v108, v80, v81
    v_cvt_pk_bf16_f32 v109, v82, v83
    v_cvt_pk_bf16_f32 v110, v84, v85
    v_cvt_pk_bf16_f32 v111, v86, v87
    s_waitcnt lgkmcnt(2)
    v_mfma_f32_32x32x16_bf16 v[72:87], v[50:53], v[20:23], 0
    v_exp_f32 v88, v88
    v_exp_f32 v89, v89
    v_exp_f32 v90, v90
    v_exp_f32 v91, v91
    v_mfma_f32_32x32x8_bf16 v[72:87], v[54:55], v[24:25], v[72:87]
    v_exp_f32 v92, v92
    v_exp_f32 v93, v93
    v_exp_f32 v94, v94
    v_exp_f32 v95, v95
    v_cvt_pk_bf16_f32 v112, v88, v89
    v_cvt_pk_bf16_f32 v113, v90, v91
    v_mfma_f32_32x32x16_bf16 a[32:47], v[56:59], v[104:107], a[32:47]
    v_exp_f32 v96, v96
    v_exp_f32 v97, v97
    v_exp_f32 v98, v98
    v_exp_f32 v99, v99
    v_cvt_pk_bf16_f32 v114, v92, v93
    v_cvt_pk_bf16_f32 v115, v94, v95
    v_mfma_f32_32x32x16_bf16 a[32:47], v[60:63], v[108:111], a[32:47]
    buffer_load_dwordx4 a[64:67], v120, s[24:27], s44 offen offset:0 sc1
    v_exp_f32 v100, v100
    v_exp_f32 v101, v101
    v_exp_f32 v102, v102
    v_exp_f32 v103, v103
    v_cvt_pk_bf16_f32 v116, v96, v97
    v_cvt_pk_bf16_f32 v117, v98, v99
    v_cvt_pk_bf16_f32 v118, v100, v101
    v_cvt_pk_bf16_f32 v119, v102, v103
    s_waitcnt lgkmcnt(0)
    s_barrier
    v_mfma_f32_32x32x16_bf16 v[88:103], v[50:53], v[26:29], 0
    ds_read_b128 v[44:47], v2 offset:0
    v_exp_f32 v72, v72
    v_exp_f32 v73, v73
    v_exp_f32 v74, v74
    v_exp_f32 v75, v75
    v_mfma_f32_32x32x8_bf16 v[88:103], v[54:55], v[30:31], v[88:103]
    ds_read_b64 v[48:49], v3 offset:0
    v_exp_f32 v76, v76
    v_exp_f32 v77, v77
    v_exp_f32 v78, v78
    v_exp_f32 v79, v79
    v_cvt_pk_bf16_f32 v104, v72, v73
    v_cvt_pk_bf16_f32 v105, v74, v75
    v_mfma_f32_32x32x16_bf16 a[48:63], v[56:59], v[112:115], a[48:63]
    v_exp_f32 v80, v80
    v_exp_f32 v81, v81
    v_exp_f32 v82, v82
    v_exp_f32 v83, v83
    v_cvt_pk_bf16_f32 v106, v76, v77
    v_cvt_pk_bf16_f32 v107, v78, v79
    v_mfma_f32_32x32x16_bf16 a[48:63], v[60:63], v[116:119], a[48:63]
    s_add_u32 m0, s67, 23552
    s_nop 0
    buffer_load_dwordx4 v5, s[24:27], s50 offen sc1 lds
    buffer_load_dwordx4 a[68:71], v121, s[24:27], s44 offen offset:0 sc1
    v_exp_f32 v84, v84
    v_exp_f32 v85, v85
    v_exp_f32 v86, v86
    v_exp_f32 v87, v87
    v_cvt_pk_bf16_f32 v108, v80, v81
    v_cvt_pk_bf16_f32 v109, v82, v83
    v_cvt_pk_bf16_f32 v110, v84, v85
    v_cvt_pk_bf16_f32 v111, v86, v87
    v_mfma_f32_32x32x16_bf16 v[72:87], v[50:53], v[32:35], 0
    v_exp_f32 v88, v88
    v_exp_f32 v89, v89
    v_exp_f32 v90, v90
    v_exp_f32 v91, v91
    v_mfma_f32_32x32x8_bf16 v[72:87], v[54:55], v[36:37], v[72:87]
    v_exp_f32 v92, v92
    v_exp_f32 v93, v93
    v_exp_f32 v94, v94
    v_exp_f32 v95, v95
    v_cvt_pk_bf16_f32 v112, v88, v89
    v_cvt_pk_bf16_f32 v113, v90, v91
    v_mfma_f32_32x32x16_bf16 a[0:15], v[64:67], v[104:107], a[0:15]
    ds_read_b128 v[56:59], v4 offset:0
    v_exp_f32 v96, v96
    v_exp_f32 v97, v97
    v_exp_f32 v98, v98
    v_exp_f32 v99, v99
    v_cvt_pk_bf16_f32 v114, v92, v93
    v_cvt_pk_bf16_f32 v115, v94, v95
    v_mfma_f32_32x32x16_bf16 a[0:15], v[68:71], v[108:111], a[0:15]
    s_add_u32 m0, s67, 23552
    s_nop 0
    buffer_load_dwordx4 v5, s[24:27], s50 offen offset:1024 sc1 lds
    buffer_load_dwordx4 a[72:75], v122, s[24:27], s44 offen offset:0 sc1
    v_exp_f32 v100, v100
    v_exp_f32 v101, v101
    v_exp_f32 v102, v102
    v_exp_f32 v103, v103
    v_cvt_pk_bf16_f32 v116, v96, v97
    v_cvt_pk_bf16_f32 v117, v98, v99
    v_cvt_pk_bf16_f32 v118, v100, v101
    v_cvt_pk_bf16_f32 v119, v102, v103
    v_mfma_f32_32x32x16_bf16 v[88:103], v[50:53], v[38:41], 0
    v_exp_f32 v72, v72
    v_exp_f32 v73, v73
    v_exp_f32 v74, v74
    v_exp_f32 v75, v75
    v_mfma_f32_32x32x8_bf16 v[88:103], v[54:55], v[42:43], v[88:103]
    v_exp_f32 v76, v76
    v_exp_f32 v77, v77
    v_exp_f32 v78, v78
    v_exp_f32 v79, v79
    v_cvt_pk_bf16_f32 v104, v72, v73
    v_cvt_pk_bf16_f32 v105, v74, v75
    v_mfma_f32_32x32x16_bf16 a[16:31], v[64:67], v[112:115], a[16:31]
    ds_read_b128 v[60:63], v4 offset:704
    v_exp_f32 v80, v80
    v_exp_f32 v81, v81
    v_exp_f32 v82, v82
    v_exp_f32 v83, v83
    v_cvt_pk_bf16_f32 v106, v76, v77
    v_cvt_pk_bf16_f32 v107, v78, v79
    v_mfma_f32_32x32x16_bf16 a[16:31], v[68:71], v[116:119], a[16:31]
    s_add_u32 m0, s71, 23552
    s_nop 0
    buffer_load_dwordx4 v5, s[24:27], s51 offen sc1 lds
    buffer_load_dwordx4 a[76:79], v123, s[24:27], s44 offen offset:0 sc1
    v_exp_f32 v84, v84
    v_exp_f32 v85, v85
    v_exp_f32 v86, v86
    v_exp_f32 v87, v87
    v_cvt_pk_bf16_f32 v108, v80, v81
    v_cvt_pk_bf16_f32 v109, v82, v83
    v_cvt_pk_bf16_f32 v110, v84, v85
    v_cvt_pk_bf16_f32 v111, v86, v87
    s_waitcnt lgkmcnt(2)
    v_mfma_f32_32x32x16_bf16 v[72:87], v[44:47], v[20:23], 0
    v_exp_f32 v88, v88
    v_exp_f32 v89, v89
    v_exp_f32 v90, v90
    v_exp_f32 v91, v91
    v_mfma_f32_32x32x8_bf16 v[72:87], v[48:49], v[24:25], v[72:87]
    v_exp_f32 v92, v92
    v_exp_f32 v93, v93
    v_exp_f32 v94, v94
    v_exp_f32 v95, v95
    v_cvt_pk_bf16_f32 v112, v88, v89
    v_cvt_pk_bf16_f32 v113, v90, v91
    v_mfma_f32_32x32x16_bf16 a[32:47], v[64:67], v[104:107], a[32:47]
    v_exp_f32 v96, v96
    v_exp_f32 v97, v97
    v_exp_f32 v98, v98
    v_exp_f32 v99, v99
    v_cvt_pk_bf16_f32 v114, v92, v93
    v_cvt_pk_bf16_f32 v115, v94, v95
    v_mfma_f32_32x32x16_bf16 a[32:47], v[68:71], v[108:111], a[32:47]
    s_add_u32 m0, s80, 23552
    s_mov_b64 exec, s[74:75]
    buffer_load_dwordx4 v6, s[24:27], s52 offen sc1 lds
    s_mov_b64 exec, -1
    buffer_load_dwordx4 a[80:83], v120, s[24:27], s44 offen offset:1024 sc1
    v_exp_f32 v100, v100
    v_exp_f32 v101, v101
    v_exp_f32 v102, v102
    v_exp_f32 v103, v103
    v_cvt_pk_bf16_f32 v116, v96, v97
    v_cvt_pk_bf16_f32 v117, v98, v99
    v_cvt_pk_bf16_f32 v118, v100, v101
    v_cvt_pk_bf16_f32 v119, v102, v103
    v_mfma_f32_32x32x16_bf16 v[88:103], v[44:47], v[26:29], 0
    ds_read_b128 v[50:53], v2 offset:1024
    v_exp_f32 v72, v72
    v_exp_f32 v73, v73
    v_exp_f32 v74, v74
    v_exp_f32 v75, v75
    v_mfma_f32_32x32x8_bf16 v[88:103], v[48:49], v[30:31], v[88:103]
    ds_read_b64 v[54:55], v3 offset:512
    v_exp_f32 v76, v76
    v_exp_f32 v77, v77
    v_exp_f32 v78, v78
    v_exp_f32 v79, v79
    v_cvt_pk_bf16_f32 v104, v72, v73
    v_cvt_pk_bf16_f32 v105, v74, v75
    v_mfma_f32_32x32x16_bf16 a[48:63], v[64:67], v[112:115], a[48:63]
    v_exp_f32 v80, v80
    v_exp_f32 v81, v81
    v_exp_f32 v82, v82
    v_exp_f32 v83, v83
    v_cvt_pk_bf16_f32 v106, v76, v77
    v_cvt_pk_bf16_f32 v107, v78, v79
    v_mfma_f32_32x32x16_bf16 a[48:63], v[68:71], v[116:119], a[48:63]
    s_add_u32 m0, s81, 23552
    s_mov_b64 exec, s[76:77]
    buffer_load_dwordx4 v7, s[24:27], s52 offen sc1 lds
    s_mov_b64 exec, -1
    buffer_load_dwordx4 a[84:87], v121, s[24:27], s44 offen offset:1024 sc1
    v_exp_f32 v84, v84
    v_exp_f32 v85, v85
    v_exp_f32 v86, v86
    v_exp_f32 v87, v87
    v_cvt_pk_bf16_f32 v108, v80, v81
    v_cvt_pk_bf16_f32 v109, v82, v83
    v_cvt_pk_bf16_f32 v110, v84, v85
    v_cvt_pk_bf16_f32 v111, v86, v87
    v_mfma_f32_32x32x16_bf16 v[72:87], v[44:47], v[32:35], 0
    v_exp_f32 v88, v88
    v_exp_f32 v89, v89
    v_exp_f32 v90, v90
    v_exp_f32 v91, v91
    v_mfma_f32_32x32x8_bf16 v[72:87], v[48:49], v[36:37], v[72:87]
    v_exp_f32 v92, v92
    v_exp_f32 v93, v93
    v_exp_f32 v94, v94
    v_exp_f32 v95, v95
    v_cvt_pk_bf16_f32 v112, v88, v89
    v_cvt_pk_bf16_f32 v113, v90, v91
    s_waitcnt lgkmcnt(2)
    v_mfma_f32_32x32x16_bf16 a[0:15], v[56:59], v[104:107], a[0:15]
    ds_read_b128 v[64:67], v4 offset:1408
    v_exp_f32 v96, v96
    v_exp_f32 v97, v97
    v_exp_f32 v98, v98
    v_exp_f32 v99, v99
    v_cvt_pk_bf16_f32 v114, v92, v93
    v_cvt_pk_bf16_f32 v115, v94, v95
    v_mfma_f32_32x32x16_bf16 a[0:15], v[60:63], v[108:111], a[0:15]
    s_add_u32 m0, s82, 23552
    s_mov_b64 exec, s[78:79]
    buffer_load_dwordx4 v8, s[24:27], s52 offen sc1 lds
    s_mov_b64 exec, -1
    buffer_load_dwordx4 a[88:91], v122, s[24:27], s44 offen offset:1024 sc1
    v_exp_f32 v100, v100
    v_exp_f32 v101, v101
    v_exp_f32 v102, v102
    v_exp_f32 v103, v103
    v_cvt_pk_bf16_f32 v116, v96, v97
    v_cvt_pk_bf16_f32 v117, v98, v99
    v_cvt_pk_bf16_f32 v118, v100, v101
    v_cvt_pk_bf16_f32 v119, v102, v103
    v_mfma_f32_32x32x16_bf16 v[88:103], v[44:47], v[38:41], 0
    v_exp_f32 v72, v72
    v_exp_f32 v73, v73
    v_exp_f32 v74, v74
    v_exp_f32 v75, v75
    v_mfma_f32_32x32x8_bf16 v[88:103], v[48:49], v[42:43], v[88:103]
    v_exp_f32 v76, v76
    v_exp_f32 v77, v77
    v_exp_f32 v78, v78
    v_exp_f32 v79, v79
    v_cvt_pk_bf16_f32 v104, v72, v73
    v_cvt_pk_bf16_f32 v105, v74, v75
    v_mfma_f32_32x32x16_bf16 a[16:31], v[56:59], v[112:115], a[16:31]
    ds_read_b128 v[68:71], v4 offset:2112
    v_exp_f32 v80, v80
    v_exp_f32 v81, v81
    v_exp_f32 v82, v82
    v_exp_f32 v83, v83
    v_cvt_pk_bf16_f32 v106, v76, v77
    v_cvt_pk_bf16_f32 v107, v78, v79
    v_mfma_f32_32x32x16_bf16 a[16:31], v[60:63], v[116:119], a[16:31]
    s_add_u32 s50, s50, 4096
    s_add_u32 s51, s51, 2048
    s_add_u32 s52, s52, 5120
    buffer_load_dwordx4 a[92:95], v123, s[24:27], s44 offen offset:1024 sc1
    v_exp_f32 v84, v84
    v_exp_f32 v85, v85
    v_exp_f32 v86, v86
    v_exp_f32 v87, v87
    v_cvt_pk_bf16_f32 v108, v80, v81
    v_cvt_pk_bf16_f32 v109, v82, v83
    v_cvt_pk_bf16_f32 v110, v84, v85
    v_cvt_pk_bf16_f32 v111, v86, v87
    s_waitcnt lgkmcnt(2)
    v_mfma_f32_32x32x16_bf16 v[72:87], v[50:53], v[20:23], 0
    v_exp_f32 v88, v88
    v_exp_f32 v89, v89
    v_exp_f32 v90, v90
    v_exp_f32 v91, v91
    v_mfma_f32_32x32x8_bf16 v[72:87], v[54:55], v[24:25], v[72:87]
    v_exp_f32 v92, v92
    v_exp_f32 v93, v93
    v_exp_f32 v94, v94
    v_exp_f32 v95, v95
    v_cvt_pk_bf16_f32 v112, v88, v89
    v_cvt_pk_bf16_f32 v113, v90, v91
    v_mfma_f32_32x32x16_bf16 a[32:47], v[56:59], v[104:107], a[32:47]
    v_exp_f32 v96, v96
    v_exp_f32 v97, v97
    v_exp_f32 v98, v98
    v_exp_f32 v99, v99
    v_cvt_pk_bf16_f32 v114, v92, v93
    v_cvt_pk_bf16_f32 v115, v94, v95
    v_mfma_f32_32x32x16_bf16 a[32:47], v[60:63], v[108:111], a[32:47]
    s_cmp_ge_u32 s83, 544
    s_cbranch_scc1 L_nowt_70
    s_waitcnt vmcnt(15)
    s_lshl_b32 s85, s83, 7
    s_add_u32 s85, s85, 262144
    s_mov_b64 exec, 1
    v_mov_b32 v144, s2
    v_mov_b32 v145, s3
    v_mov_b32 v146, 0
    buffer_store_dwordx2 v[144:145], v146, s[24:27], s85 offen sc1
    s_mov_b64 exec, -1
L_nowt_70:
    v_exp_f32 v100, v100
    v_exp_f32 v101, v101
    v_exp_f32 v102, v102
    v_exp_f32 v103, v103
    v_cvt_pk_bf16_f32 v116, v96, v97
    v_cvt_pk_bf16_f32 v117, v98, v99
    v_cvt_pk_bf16_f32 v118, v100, v101
    v_cvt_pk_bf16_f32 v119, v102, v103
    v_mfma_f32_32x32x16_bf16 v[88:103], v[50:53], v[26:29], 0
    ds_read_b128 v[44:47], v2 offset:2048
    v_exp_f32 v72, v72
    v_exp_f32 v73, v73
    v_exp_f32 v74, v74
    v_exp_f32 v75, v75
    v_mfma_f32_32x32x8_bf16 v[88:103], v[54:55], v[30:31], v[88:103]
    ds_read_b64 v[48:49], v3 offset:1024
    v_exp_f32 v76, v76
    v_exp_f32 v77, v77
    v_exp_f32 v78, v78
    v_exp_f32 v79, v79
    v_cvt_pk_bf16_f32 v104, v72, v73
    v_cvt_pk_bf16_f32 v105, v74, v75
    v_mfma_f32_32x32x16_bf16 a[48:63], v[56:59], v[112:115], a[48:63]
    v_exp_f32 v80, v80
    v_exp_f32 v81, v81
    v_exp_f32 v82, v82
    v_exp_f32 v83, v83
    v_cvt_pk_bf16_f32 v106, v76, v77
    v_cvt_pk_bf16_f32 v107, v78, v79
    v_mfma_f32_32x32x16_bf16 a[48:63], v[60:63], v[116:119], a[48:63]
    buffer_load_dwordx4 a[96:99], v120, s[24:27], s44 offen offset:2048 sc1
    v_exp_f32 v84, v84
    v_exp_f32 v85, v85
    v_exp_f32 v86, v86
    v_exp_f32 v87, v87
    v_cvt_pk_bf16_f32 v108, v80, v81
    v_cvt_pk_bf16_f32 v109, v82, v83
    v_cvt_pk_bf16_f32 v110, v84, v85
    v_cvt_pk_bf16_f32 v111, v86, v87
    v_mfma_f32_32x32x16_bf16 v[72:87], v[50:53], v[32:35], 0
    v_exp_f32 v88, v88
    v_exp_f32 v89, v89
    v_exp_f32 v90, v90
    v_exp_f32 v91, v91
    v_mfma_f32_32x32x8_bf16 v[72:87], v[54:55], v[36:37], v[72:87]
    v_exp_f32 v92, v92
    v_exp_f32 v93, v93
    v_exp_f32 v94, v94
    v_exp_f32 v95, v95
    v_cvt_pk_bf16_f32 v112, v88, v89
    v_cvt_pk_bf16_f32 v113, v90, v91
    s_waitcnt lgkmcnt(2)
    v_mfma_f32_32x32x16_bf16 a[0:15], v[64:67], v[104:107], a[0:15]
    ds_read_b128 v[56:59], v4 offset:2816
    v_exp_f32 v96, v96
    v_exp_f32 v97, v97
    v_exp_f32 v98, v98
    v_exp_f32 v99, v99
    v_cvt_pk_bf16_f32 v114, v92, v93
    v_cvt_pk_bf16_f32 v115, v94, v95
    v_mfma_f32_32x32x16_bf16 a[0:15], v[68:71], v[108:111], a[0:15]
    buffer_load_dwordx4 a[100:103], v121, s[24:27], s44 offen offset:2048 sc1
    v_exp_f32 v100, v100
    v_exp_f32 v101, v101
    v_exp_f32 v102, v102
    v_exp_f32 v103, v103
    v_cvt_pk_bf16_f32 v116, v96, v97
    v_cvt_pk_bf16_f32 v117, v98, v99
    v_cvt_pk_bf16_f32 v118, v100, v101
    v_cvt_pk_bf16_f32 v119, v102, v103
    v_mfma_f32_32x32x16_bf16 v[88:103], v[50:53], v[38:41], 0
    v_exp_f32 v72, v72
    v_exp_f32 v73, v73
    v_exp_f32 v74, v74
    v_exp_f32 v75, v75
    v_mfma_f32_32x32x8_bf16 v[88:103], v[54:55], v[42:43], v[88:103]
    v_exp_f32 v76, v76
    v_exp_f32 v77, v77
    v_exp_f32 v78, v78
    v_exp_f32 v79, v79
    v_cvt_pk_bf16_f32 v104, v72, v73
    v_cvt_pk_bf16_f32 v105, v74, v75
    v_mfma_f32_32x32x16_bf16 a[16:31], v[64:67], v[112:115], a[16:31]
    ds_read_b128 v[60:63], v4 offset:3520
    v_exp_f32 v80, v80
    v_exp_f32 v81, v81
    v_exp_f32 v82, v82
    v_exp_f32 v83, v83
    v_cvt_pk_bf16_f32 v106, v76, v77
    v_cvt_pk_bf16_f32 v107, v78, v79
    v_mfma_f32_32x32x16_bf16 a[16:31], v[68:71], v[116:119], a[16:31]
    buffer_load_dwordx4 a[104:107], v122, s[24:27], s44 offen offset:2048 sc1
    v_exp_f32 v84, v84
    v_exp_f32 v85, v85
    v_exp_f32 v86, v86
    v_exp_f32 v87, v87
    v_cvt_pk_bf16_f32 v108, v80, v81
    v_cvt_pk_bf16_f32 v109, v82, v83
    v_cvt_pk_bf16_f32 v110, v84, v85
    v_cvt_pk_bf16_f32 v111, v86, v87
    s_waitcnt lgkmcnt(2)
    v_mfma_f32_32x32x16_bf16 v[72:87], v[44:47], v[20:23], 0
    v_exp_f32 v88, v88
    v_exp_f32 v89, v89
    v_exp_f32 v90, v90
    v_exp_f32 v91, v91
    v_mfma_f32_32x32x8_bf16 v[72:87], v[48:49], v[24:25], v[72:87]
    v_exp_f32 v92, v92
    v_exp_f32 v93, v93
    v_exp_f32 v94, v94
    v_exp_f32 v95, v95
    v_cvt_pk_bf16_f32 v112, v88, v89
    v_cvt_pk_bf16_f32 v113, v90, v91
    v_mfma_f32_32x32x16_bf16 a[32:47], v[64:67], v[104:107], a[32:47]
    v_exp_f32 v96, v96
    v_exp_f32 v97, v97
    v_exp_f32 v98, v98
    v_exp_f32 v99, v99
    v_cvt_pk_bf16_f32 v114, v92, v93
    v_cvt_pk_bf16_f32 v115, v94, v95
    v_mfma_f32_32x32x16_bf16 a[32:47], v[68:71], v[108:111], a[32:47]
    buffer_load_dwordx4 a[108:111], v123, s[24:27], s44 offen offset:2048 sc1
    v_exp_f32 v100, v100
    v_exp_f32 v101, v101
    v_exp_f32 v102, v102
    v_exp_f32 v103, v103
    v_cvt_pk_bf16_f32 v116, v96, v97
    v_cvt_pk_bf16_f32 v117, v98, v99
    v_cvt_pk_bf16_f32 v118, v100, v101
    v_cvt_pk_bf16_f32 v119, v102, v103
    v_mfma_f32_32x32x16_bf16 v[88:103], v[44:47], v[26:29], 0
    ds_read_b128 v[50:53], v2 offset:3072
    v_exp_f32 v72, v72
    v_exp_f32 v73, v73
    v_exp_f32 v74, v74
    v_exp_f32 v75, v75
    v_mfma_f32_32x32x8_bf16 v[88:103], v[48:49], v[30:31], v[88:103]
    ds_read_b64 v[54:55], v3 offset:1536
    v_exp_f32 v76, v76
    v_exp_f32 v77, v77
    v_exp_f32 v78, v78
    v_exp_f32 v79, v79
    v_cvt_pk_bf16_f32 v104, v72, v73
    v_cvt_pk_bf16_f32 v105, v74, v75
    v_mfma_f32_32x32x16_bf16 a[48:63], v[64:67], v[112:115], a[48:63]
    v_exp_f32 v80, v80
    v_exp_f32 v81, v81
    v_exp_f32 v82, v82
    v_exp_f32 v83, v83
    v_cvt_pk_bf16_f32 v106, v76, v77
    v_cvt_pk_bf16_f32 v107, v78, v79
    v_mfma_f32_32x32x16_bf16 a[48:63], v[68:71], v[116:119], a[48:63]
    buffer_load_dwordx4 a[112:115], v120, s[24:27], s44 offen offset:3072 sc1
    v_exp_f32 v84, v84
    v_exp_f32 v85, v85
    v_exp_f32 v86, v86
    v_exp_f32 v87, v87
    v_cvt_pk_bf16_f32 v108, v80, v81
    v_cvt_pk_bf16_f32 v109, v82, v83
    v_cvt_pk_bf16_f32 v110, v84, v85
    v_cvt_pk_bf16_f32 v111, v86, v87
    v_mfma_f32_32x32x16_bf16 v[72:87], v[44:47], v[32:35], 0
    v_exp_f32 v88, v88
    v_exp_f32 v89, v89
    v_exp_f32 v90, v90
    v_exp_f32 v91, v91
    v_mfma_f32_32x32x8_bf16 v[72:87], v[48:49], v[36:37], v[72:87]
    v_exp_f32 v92, v92
    v_exp_f32 v93, v93
    v_exp_f32 v94, v94
    v_exp_f32 v95, v95
    v_cvt_pk_bf16_f32 v112, v88, v89
    v_cvt_pk_bf16_f32 v113, v90, v91
    s_waitcnt lgkmcnt(2)
    v_mfma_f32_32x32x16_bf16 a[0:15], v[56:59], v[104:107], a[0:15]
    ds_read_b128 v[64:67], v4 offset:4224
    v_exp_f32 v96, v96
    v_exp_f32 v97, v97
    v_exp_f32 v98, v98
    v_exp_f32 v99, v99
    v_cvt_pk_bf16_f32 v114, v92, v93
    v_cvt_pk_bf16_f32 v115, v94, v95
    v_mfma_f32_32x32x16_bf16 a[0:15], v[60:63], v[108:111], a[0:15]
    buffer_load_dwordx4 a[116:119], v121, s[24:27], s44 offen offset:3072 sc1
    v_exp_f32 v100, v100
    v_exp_f32 v101, v101
    v_exp_f32 v102, v102
    v_exp_f32 v103, v103
    v_cvt_pk_bf16_f32 v116, v96, v97
    v_cvt_pk_bf16_f32 v117, v98, v99
    v_cvt_pk_bf16_f32 v118, v100, v101
    v_cvt_pk_bf16_f32 v119, v102, v103
    v_mfma_f32_32x32x16_bf16 v[88:103], v[44:47], v[38:41], 0
    v_exp_f32 v72, v72
    v_exp_f32 v73, v73
    v_exp_f32 v74, v74
    v_exp_f32 v75, v75
    v_mfma_f32_32x32x8_bf16 v[88:103], v[48:49], v[42:43], v[88:103]
    v_exp_f32 v76, v76
    v_exp_f32 v77, v77
    v_exp_f32 v78, v78
    v_exp_f32 v79, v79
    v_cvt_pk_bf16_f32 v104, v72, v73
    v_cvt_pk_bf16_f32 v105, v74, v75
    v_mfma_f32_32x32x16_bf16 a[16:31], v[56:59], v[112:115], a[16:31]
    ds_read_b128 v[68:71], v4 offset:4928
    v_exp_f32 v80, v80
    v_exp_f32 v81, v81
    v_exp_f32 v82, v82
    v_exp_f32 v83, v83
    v_cvt_pk_bf16_f32 v106, v76, v77
    v_cvt_pk_bf16_f32 v107, v78, v79
    v_mfma_f32_32x32x16_bf16 a[16:31], v[60:63], v[116:119], a[16:31]
    buffer_load_dwordx4 a[120:123], v122, s[24:27], s44 offen offset:3072 sc1
    v_exp_f32 v84, v84
    v_exp_f32 v85, v85
    v_exp_f32 v86, v86
    v_exp_f32 v87, v87
    v_cvt_pk_bf16_f32 v108, v80, v81
    v_cvt_pk_bf16_f32 v109, v82, v83
    v_cvt_pk_bf16_f32 v110, v84, v85
    v_cvt_pk_bf16_f32 v111, v86, v87
    s_waitcnt lgkmcnt(2)
    v_mfma_f32_32x32x16_bf16 v[72:87], v[50:53], v[20:23], 0
    v_exp_f32 v88, v88
    v_exp_f32 v89, v89
    v_exp_f32 v90, v90
    v_exp_f32 v91, v91
    v_mfma_f32_32x32x8_bf16 v[72:87], v[54:55], v[24:25], v[72:87]
    v_exp_f32 v92, v92
    v_exp_f32 v93, v93
    v_exp_f32 v94, v94
    v_exp_f32 v95, v95
    v_cvt_pk_bf16_f32 v112, v88, v89
    v_cvt_pk_bf16_f32 v113, v90, v91
    v_mfma_f32_32x32x16_bf16 a[32:47], v[56:59], v[104:107], a[32:47]
    v_exp_f32 v96, v96
    v_exp_f32 v97, v97
    v_exp_f32 v98, v98
    v_exp_f32 v99, v99
    v_cvt_pk_bf16_f32 v114, v92, v93
    v_cvt_pk_bf16_f32 v115, v94, v95
    v_mfma_f32_32x32x16_bf16 a[32:47], v[60:63], v[108:111], a[32:47]
    buffer_load_dwordx4 a[124:127], v123, s[24:27], s44 offen offset:3072 sc1
    v_exp_f32 v100, v100
    v_exp_f32 v101, v101
    v_exp_f32 v102, v102
    v_exp_f32 v103, v103
    v_cvt_pk_bf16_f32 v116, v96, v97
    v_cvt_pk_bf16_f32 v117, v98, v99
    v_cvt_pk_bf16_f32 v118, v100, v101
    v_cvt_pk_bf16_f32 v119, v102, v103
    s_waitcnt vmcnt(10)
    s_waitcnt lgkmcnt(0)
    s_barrier
    v_mfma_f32_32x32x16_bf16 v[88:103], v[50:53], v[26:29], 0
    ds_read_b128 v[44:47], v2 offset:23552
    v_exp_f32 v72, v72
    v_exp_f32 v73, v73
    v_exp_f32 v74, v74
    v_exp_f32 v75, v75
    v_mfma_f32_32x32x8_bf16 v[88:103], v[54:55], v[30:31], v[88:103]
    ds_read_b64 v[48:49], v3 offset:23552
    v_exp_f32 v76, v76
    v_exp_f32 v77, v77
    v_exp_f32 v78, v78
    v_exp_f32 v79, v79
    v_cvt_pk_bf16_f32 v104, v72, v73
    v_cvt_pk_bf16_f32 v105, v74, v75
    v_mfma_f32_32x32x16_bf16 a[48:63], v[56:59], v[112:115], a[48:63]
    v_exp_f32 v80, v80
    v_exp_f32 v81, v81
    v_exp_f32 v82, v82
    v_exp_f32 v83, v83
    v_cvt_pk_bf16_f32 v106, v76, v77
    v_cvt_pk_bf16_f32 v107, v78, v79
    v_mfma_f32_32x32x16_bf16 a[48:63], v[60:63], v[116:119], a[48:63]
    s_add_u32 m0, s67, 0
    s_nop 0
    buffer_load_dwordx4 v5, s[24:27], s50 offen sc1 lds
    buffer_load_dwordx4 a[128:131], v120, s[24:27], s63 offen offset:0 sc1
    v_exp_f32 v84, v84
    v_exp_f32 v85, v85
    v_exp_f32 v86, v86
    v_exp_f32 v87, v87
    v_cvt_pk_bf16_f32 v108, v80, v81
    v_cvt_pk_bf16_f32 v109, v82, v83
    v_cvt_pk_bf16_f32 v110, v84, v85
    v_cvt_pk_bf16_f32 v111, v86, v87
    v_mfma_f32_32x32x16_bf16 v[72:87], v[50:53], v[32:35], 0
    v_exp_f32 v88, v88
    v_exp_f32 v89, v89
    v_exp_f32 v90, v90
    v_exp_f32 v91, v91
    v_mfma_f32_32x32x8_bf16 v[72:87], v[54:55], v[36:37], v[72:87]
    v_exp_f32 v92, v92
    v_exp_f32 v93, v93
    v_exp_f32 v94, v94
    v_exp_f32 v95, v95
    v_cvt_pk_bf16_f32 v112, v88, v89
    v_cvt_pk_bf16_f32 v113, v90, v91
    v_mfma_f32_32x32x16_bf16 a[0:15], v[64:67], v[104:107], a[0:15]
    ds_read_b128 v[56:59], v4 offset:23552
    v_exp_f32 v96, v96
    v_exp_f32 v97, v97
    v_exp_f32 v98, v98
    v_exp_f32 v99, v99
    v_cvt_pk_bf16_f32 v114, v92, v93
    v_cvt_pk_bf16_f32 v115, v94, v95
    v_mfma_f32_32x32x16_bf16 a[0:15], v[68:71], v[108:111], a[0:15]
    s_add_u32 m0, s67, 0
    s_nop 0
    buffer_load_dwordx4 v5, s[24:27], s50 offen offset:1024 sc1 lds
    buffer_load_dwordx4 a[132:135], v121, s[24:27], s63 offen offset:0 sc1
    v_exp_f32 v100, v100
    v_exp_f32 v101, v101
    v_exp_f32 v102, v102
    v_exp_f32 v103, v103
    v_cvt_pk_bf16_f32 v116, v96, v97
    v_cvt_pk_bf16_f32 v117, v98, v99
    v_cvt_pk_bf16_f32 v118, v100, v101
    v_cvt_pk_bf16_f32 v119, v102, v103
    v_mfma_f32_32x32x16_bf16 v[88:103], v[50:53], v[38:41], 0
    v_exp_f32 v72, v72
    v_exp_f32 v73, v73
    v_exp_f32 v74, v74
    v_exp_f32 v75, v75
    v_mfma_f32_32x32x8_bf16 v[88:103], v[54:55], v[42:43], v[88:103]
    v_exp_f32 v76, v76
    v_exp_f32 v77, v77
    v_exp_f32 v78, v78
    v_exp_f32 v79, v79
    v_cvt_pk_bf16_f32 v104, v72, v73
    v_cvt_pk_bf16_f32 v105, v74, v75
    v_mfma_f32_32x32x16_bf16 a[16:31], v[64:67], v[112:115], a[16:31]
    ds_read_b128 v[60:63], v4 offset:24256
    v_exp_f32 v80, v80
    v_exp_f32 v81, v81
    v_exp_f32 v82, v82
    v_exp_f32 v83, v83
    v_cvt_pk_bf16_f32 v106, v76, v77
    v_cvt_pk_bf16_f32 v107, v78, v79
    v_mfma_f32_32x32x16_bf16 a[16:31], v[68:71], v[116:119], a[16:31]
    s_add_u32 m0, s71, 0
    s_nop 0
    buffer_load_dwordx4 v5, s[24:27], s51 offen sc1 lds
    buffer_load_dwordx4 a[136:139], v122, s[24:27], s63 offen offset:0 sc1
    v_exp_f32 v84, v84
    v_exp_f32 v85, v85
    v_exp_f32 v86, v86
    v_exp_f32 v87, v87
    v_cvt_pk_bf16_f32 v108, v80, v81
    v_cvt_pk_bf16_f32 v109, v82, v83
    v_cvt_pk_bf16_f32 v110, v84, v85
    v_cvt_pk_bf16_f32 v111, v86, v87
    s_waitcnt lgkmcnt(2)
    v_mfma_f32_32x32x16_bf16 v[72:87], v[44:47], v[20:23], 0
    v_exp_f32 v88, v88
    v_exp_f32 v89, v89
    v_exp_f32 v90, v90
    v_exp_f32 v91, v91
    v_mfma_f32_32x32x8_bf16 v[72:87], v[48:49], v[24:25], v[72:87]
    v_exp_f32 v92, v92
    v_exp_f32 v93, v93
    v_exp_f32 v94, v94
    v_exp_f32 v95, v95
    v_cvt_pk_bf16_f32 v112, v88, v89
    v_cvt_pk_bf16_f32 v113, v90, v91
    v_mfma_f32_32x32x16_bf16 a[32:47], v[64:67], v[104:107], a[32:47]
    v_exp_f32 v96, v96
    v_exp_f32 v97, v97
    v_exp_f32 v98, v98
    v_exp_f32 v99, v99
    v_cvt_pk_bf16_f32 v114, v92, v93
    v_cvt_pk_bf16_f32 v115, v94, v95
    v_mfma_f32_32x32x16_bf16 a[32:47], v[68:71], v[108:111], a[32:47]
    s_add_u32 m0, s80, 0
    s_mov_b64 exec, s[74:75]
    buffer_load_dwordx4 v6, s[24:27], s52 offen sc1 lds
    s_mov_b64 exec, -1
    buffer_load_dwordx4 a[140:143], v123, s[24:27], s63 offen offset:0 sc1
    v_exp_f32 v100, v100
    v_exp_f32 v101, v101
    v_exp_f32 v102, v102
    v_exp_f32 v103, v103
    v_cvt_pk_bf16_f32 v116, v96, v97
    v_cvt_pk_bf16_f32 v117, v98, v99
    v_cvt_pk_bf16_f32 v118, v100, v101
    v_cvt_pk_bf16_f32 v119, v102, v103
    v_mfma_f32_32x32x16_bf16 v[88:103], v[44:47], v[26:29], 0
    ds_read_b128 v[50:53], v2 offset:24576
    v_exp_f32 v72, v72
    v_exp_f32 v73, v73
    v_exp_f32 v74, v74
    v_exp_f32 v75, v75
    v_mfma_f32_32x32x8_bf16 v[88:103], v[48:49], v[30:31], v[88:103]
    ds_read_b64 v[54:55], v3 offset:24064
    v_exp_f32 v76, v76
    v_exp_f32 v77, v77
    v_exp_f32 v78, v78
    v_exp_f32 v79, v79
    v_cvt_pk_bf16_f32 v104, v72, v73
    v_cvt_pk_bf16_f32 v105, v74, v75
    v_mfma_f32_32x32x16_bf16 a[48:63], v[64:67], v[112:115], a[48:63]
    v_exp_f32 v80, v80
    v_exp_f32 v81, v81
    v_exp_f32 v82, v82
    v_exp_f32 v83, v83
    v_cvt_pk_bf16_f32 v106, v76, v77
    v_cvt_pk_bf16_f32 v107, v78, v79
    v_mfma_f32_32x32x16_bf16 a[48:63], v[68:71], v[116:119], a[48:63]
    s_add_u32 m0, s81, 0
    s_mov_b64 exec, s[76:77]
    buffer_load_dwordx4 v7, s[24:27], s52 offen sc1 lds
    s_mov_b64 exec, -1
    buffer_load_dwordx4 a[144:147], v120, s[24:27], s63 offen offset:1024 sc1
    v_exp_f32 v84, v84
    v_exp_f32 v85, v85
    v_exp_f32 v86, v86
    v_exp_f32 v87, v87
    v_cvt_pk_bf16_f32 v108, v80, v81
    v_cvt_pk_bf16_f32 v109, v82, v83
    v_cvt_pk_bf16_f32 v110, v84, v85
    v_cvt_pk_bf16_f32 v111, v86, v87
    v_mfma_f32_32x32x16_bf16 v[72:87], v[44:47], v[32:35], 0
    v_exp_f32 v88, v88
    v_exp_f32 v89, v89
    v_exp_f32 v90, v90
    v_exp_f32 v91, v91
    v_mfma_f32_32x32x8_bf16 v[72:87], v[48:49], v[36:37], v[72:87]
    v_exp_f32 v92, v92
    v_exp_f32 v93, v93
    v_exp_f32 v94, v94
    v_exp_f32 v95, v95
    v_cvt_pk_bf16_f32 v112, v88, v89
    v_cvt_pk_bf16_f32 v113, v90, v91
    s_waitcnt lgkmcnt(2)
    v_mfma_f32_32x32x16_bf16 a[0:15], v[56:59], v[104:107], a[0:15]
    ds_read_b128 v[64:67], v4 offset:24960
    v_exp_f32 v96, v96
    v_exp_f32 v97, v97
    v_exp_f32 v98, v98
    v_exp_f32 v99, v99
    v_cvt_pk_bf16_f32 v114, v92, v93
    v_cvt_pk_bf16_f32 v115, v94, v95
    v_mfma_f32_32x32x16_bf16 a[0:15], v[60:63], v[108:111], a[0:15]
    s_add_u32 m0, s82, 0
    s_mov_b64 exec, s[78:79]
    buffer_load_dwordx4 v8, s[24:27], s52 offen sc1 lds
    s_mov_b64 exec, -1
    buffer_load_dwordx4 a[148:151], v121, s[24:27], s63 offen offset:1024 sc1
    v_exp_f32 v100, v100
    v_exp_f32 v101, v101
    v_exp_f32 v102, v102
    v_exp_f32 v103, v103
    v_cvt_pk_bf16_f32 v116, v96, v97
    v_cvt_pk_bf16_f32 v117, v98, v99
    v_cvt_pk_bf16_f32 v118, v100, v101
    v_cvt_pk_bf16_f32 v119, v102, v103
    v_mfma_f32_32x32x16_bf16 v[88:103], v[44:47], v[38:41], 0
    v_exp_f32 v72, v72
    v_exp_f32 v73, v73
    v_exp_f32 v74, v74
    v_exp_f32 v75, v75
    v_mfma_f32_32x32x8_bf16 v[88:103], v[48:49], v[42:43], v[88:103]
    v_exp_f32 v76, v76
    v_exp_f32 v77, v77
    v_exp_f32 v78, v78
    v_exp_f32 v79, v79
    v_cvt_pk_bf16_f32 v104, v72, v73
    v_cvt_pk_bf16_f32 v105, v74, v75
    v_mfma_f32_32x32x16_bf16 a[16:31], v[56:59], v[112:115], a[16:31]
    ds_read_b128 v[68:71], v4 offset:25664
    v_exp_f32 v80, v80
    v_exp_f32 v81, v81
    v_exp_f32 v82, v82
    v_exp_f32 v83, v83
    v_cvt_pk_bf16_f32 v106, v76, v77
    v_cvt_pk_bf16_f32 v107, v78, v79
    v_mfma_f32_32x32x16_bf16 a[16:31], v[60:63], v[116:119], a[16:31]
    s_add_u32 s50, s50, 4096
    s_add_u32 s51, s51, 2048
    s_add_u32 s52, s52, 5120
    buffer_load_dwordx4 a[152:155], v122, s[24:27], s63 offen offset:1024 sc1
    v_exp_f32 v84, v84
    v_exp_f32 v85, v85
    v_exp_f32 v86, v86
    v_exp_f32 v87, v87
    v_cvt_pk_bf16_f32 v108, v80, v81
    v_cvt_pk_bf16_f32 v109, v82, v83
    v_cvt_pk_bf16_f32 v110, v84, v85
    v_cvt_pk_bf16_f32 v111, v86, v87
    s_waitcnt lgkmcnt(2)
    v_mfma_f32_32x32x16_bf16 v[72:87], v[50:53], v[20:23], 0
    v_exp_f32 v88, v88
    v_exp_f32 v89, v89
    v_exp_f32 v90, v90
    v_exp_f32 v91, v91
    v_mfma_f32_32x32x8_bf16 v[72:87], v[54:55], v[24:25], v[72:87]
    v_exp_f32 v92, v92
    v_exp_f32 v93, v93
    v_exp_f32 v94, v94
    v_exp_f32 v95, v95
    v_cvt_pk_bf16_f32 v112, v88, v89
    v_cvt_pk_bf16_f32 v113, v90, v91
    v_mfma_f32_32x32x16_bf16 a[32:47], v[56:59], v[104:107], a[32:47]
    v_exp_f32 v96, v96
    v_exp_f32 v97, v97
    v_exp_f32 v98, v98
    v_exp_f32 v99, v99
    v_cvt_pk_bf16_f32 v114, v92, v93
    v_cvt_pk_bf16_f32 v115, v94, v95
    v_mfma_f32_32x32x16_bf16 a[32:47], v[60:63], v[108:111], a[32:47]
    buffer_load_dwordx4 a[156:159], v123, s[24:27], s63 offen offset:1024 sc1
    v_exp_f32 v100, v100
    v_exp_f32 v101, v101
    v_exp_f32 v102, v102
    v_exp_f32 v103, v103
    v_cvt_pk_bf16_f32 v116, v96, v97
    v_cvt_pk_bf16_f32 v117, v98, v99
    v_cvt_pk_bf16_f32 v118, v100, v101
    v_cvt_pk_bf16_f32 v119, v102, v103
    v_mfma_f32_32x32x16_bf16 v[88:103], v[50:53], v[26:29], 0
    ds_read_b128 v[44:47], v2 offset:25600
    v_exp_f32 v72, v72
    v_exp_f32 v73, v73
    v_exp_f32 v74, v74
    v_exp_f32 v75, v75
    v_mfma_f32_32x32x8_bf16 v[88:103], v[54:55], v[30:31], v[88:103]
    ds_read_b64 v[48:49], v3 offset:24576
    v_exp_f32 v76, v76
    v_exp_f32 v77, v77
    v_exp_f32 v78, v78
    v_exp_f32 v79, v79
    v_cvt_pk_bf16_f32 v104, v72, v73
    v_cvt_pk_bf16_f32 v105, v74, v75
    v_mfma_f32_32x32x16_bf16 a[48:63], v[56:59], v[112:115], a[48:63]
    v_exp_f32 v80, v80
    v_exp_f32 v81, v81
    v_exp_f32 v82, v82
    v_exp_f32 v83, v83
    v_cvt_pk_bf16_f32 v106, v76, v77
    v_cvt_pk_bf16_f32 v107, v78, v79
    v_mfma_f32_32x32x16_bf16 a[48:63], v[60:63], v[116:119], a[48:63]
    s_mul_i32 s85, s43, 68
    s_mul_i32 s101, s40, 12
    s_add_u32 s101, s101, s85
    v_and_b32 v242, 63, v0
    v_add_u32 v243, s101, v242
    s_mul_i32 s101, s40, 5
    s_add_u32 s101, s101, s85
    s_add_u32 s101, s101, 36
    v_add_u32 v244, s101, v242
    v_cmp_gt_u32 vcc, 12, v242
    s_nop 1
    v_cndmask_b32 v242, v244, v243, vcc
    v_lshlrev_b32 v242, 7, v242
    v_add_u32 v242, 262144, v242
    s_mov_b32 exec_lo, 0x1ffff
    s_mov_b32 exec_hi, 0x0
    buffer_load_dwordx2 v[240:241], v242, s[24:27], 0 offen sc1
    s_mov_b64 exec, -1
    v_exp_f32 v84, v84
    v_exp_f32 v85, v85
    v_exp_f32 v86, v86
    v_exp_f32 v87, v87
    v_cvt_pk_bf16_f32 v108, v80, v81
    v_cvt_pk_bf16_f32 v109, v82, v83
    v_cvt_pk_bf16_f32 v110, v84, v85
    v_cvt_pk_bf16_f32 v111, v86, v87
    v_mfma_f32_32x32x16_bf16 v[72:87], v[50:53], v[32:35], 0
    v_exp_f32 v88, v88
    v_exp_f32 v89, v89
    v_exp_f32 v90, v90
    v_exp_f32 v91, v91
    v_mfma_f32_32x32x8_bf16 v[72:87], v[54:55], v[36:37], v[72:87]
    v_exp_f32 v92, v92
    v_exp_f32 v93, v93
    v_exp_f32 v94, v94
    v_exp_f32 v95, v95
    v_cvt_pk_bf16_f32 v112, v88, v89
    v_cvt_pk_bf16_f32 v113, v90, v91
    s_waitcnt lgkmcnt(2)
    v_mfma_f32_32x32x16_bf16 a[0:15], v[64:67], v[104:107], a[0:15]
    ds_read_b128 v[56:59], v4 offset:26368
    v_exp_f32 v96, v96
    v_exp_f32 v97, v97
    v_exp_f32 v98, v98
    v_exp_f32 v99, v99
    v_cvt_pk_bf16_f32 v114, v92, v93
    v_cvt_pk_bf16_f32 v115, v94, v95
    v_mfma_f32_32x32x16_bf16 a[0:15], v[68:71], v[108:111], a[0:15]
    buffer_load_dwordx4 a[160:163], v120, s[24:27], s63 offen offset:2048 sc1
    v_exp_f32 v100, v100
    v_exp_f32 v101, v101
    v_exp_f32 v102, v102
    v_exp_f32 v103, v103
    v_cvt_pk_bf16_f32 v116, v96, v97
    v_cvt_pk_bf16_f32 v117, v98, v99
    v_cvt_pk_bf16_f32 v118, v100, v101
    v_cvt_pk_bf16_f32 v119, v102, v103
    v_mfma_f32_32x32x16_bf16 v[88:103], v[50:53], v[38:41], 0
    v_exp_f32 v72, v72
    v_exp_f32 v73, v73
    v_exp_f32 v74, v74
    v_exp_f32 v75, v75
    v_mfma_f32_32x32x8_bf16 v[88:103], v[54:55], v[42:43], v[88:103]
    v_exp_f32 v76, v76
    v_exp_f32 v77, v77
    v_exp_f32 v78, v78
    v_exp_f32 v79, v79
    v_cvt_pk_bf16_f32 v104, v72, v73
    v_cvt_pk_bf16_f32 v105, v74, v75
    v_mfma_f32_32x32x16_bf16 a[16:31], v[64:67], v[112:115], a[16:31]
    ds_read_b128 v[60:63], v4 offset:27072
    v_exp_f32 v80, v80
    v_exp_f32 v81, v81
    v_exp_f32 v82, v82
    v_exp_f32 v83, v83
    v_cvt_pk_bf16_f32 v106, v76, v77
    v_cvt_pk_bf16_f32 v107, v78, v79
    v_mfma_f32_32x32x16_bf16 a[16:31], v[68:71], v[116:119], a[16:31]
    buffer_load_dwordx4 a[164:167], v121, s[24:27], s63 offen offset:2048 sc1
    v_exp_f32 v84, v84
    v_exp_f32 v85, v85
    v_exp_f32 v86, v86
    v_exp_f32 v87, v87
    v_cvt_pk_bf16_f32 v108, v80, v81
    v_cvt_pk_bf16_f32 v109, v82, v83
    v_cvt_pk_bf16_f32 v110, v84, v85
    v_cvt_pk_bf16_f32 v111, v86, v87
    s_waitcnt lgkmcnt(2)
    v_mfma_f32_32x32x16_bf16 v[72:87], v[44:47], v[20:23], 0
    v_exp_f32 v88, v88
    v_exp_f32 v89, v89
    v_exp_f32 v90, v90
    v_exp_f32 v91, v91
    v_mfma_f32_32x32x8_bf16 v[72:87], v[48:49], v[24:25], v[72:87]
    v_exp_f32 v92, v92
    v_exp_f32 v93, v93
    v_exp_f32 v94, v94
    v_exp_f32 v95, v95
    v_cvt_pk_bf16_f32 v112, v88, v89
    v_cvt_pk_bf16_f32 v113, v90, v91
    v_mfma_f32_32x32x16_bf16 a[32:47], v[64:67], v[104:107], a[32:47]
    v_exp_f32 v96, v96
    v_exp_f32 v97, v97
    v_exp_f32 v98, v98
    v_exp_f32 v99, v99
    v_cvt_pk_bf16_f32 v114, v92, v93
    v_cvt_pk_bf16_f32 v115, v94, v95
    v_mfma_f32_32x32x16_bf16 a[32:47], v[68:71], v[108:111], a[32:47]
    buffer_load_dwordx4 a[168:171], v122, s[24:27], s63 offen offset:2048 sc1
    v_exp_f32 v100, v100
    v_exp_f32 v101, v101
    v_exp_f32 v102, v102
    v_exp_f32 v103, v103
    v_cvt_pk_bf16_f32 v116, v96, v97
    v_cvt_pk_bf16_f32 v117, v98, v99
    v_cvt_pk_bf16_f32 v118, v100, v101
    v_cvt_pk_bf16_f32 v119, v102, v103
    v_mfma_f32_32x32x16_bf16 v[88:103], v[44:47], v[26:29], 0
    ds_read_b128 v[50:53], v2 offset:26624
    v_exp_f32 v72, v72
    v_exp_f32 v73, v73
    v_exp_f32 v74, v74
    v_exp_f32 v75, v75
    v_mfma_f32_32x32x8_bf16 v[88:103], v[48:49], v[30:31], v[88:103]
    ds_read_b64 v[54:55], v3 offset:25088
    v_exp_f32 v76, v76
    v_exp_f32 v77, v77
    v_exp_f32 v78, v78
    v_exp_f32 v79, v79
    v_cvt_pk_bf16_f32 v104, v72, v73
    v_cvt_pk_bf16_f32 v105, v74, v75
    v_mfma_f32_32x32x16_bf16 a[48:63], v[64:67], v[112:115], a[48:63]
    v_exp_f32 v80, v80
    v_exp_f32 v81, v81
    v_exp_f32 v82, v82
    v_exp_f32 v83, v83
    v_cvt_pk_bf16_f32 v106, v76, v77
    v_cvt_pk_bf16_f32 v107, v78, v79
    v_mfma_f32_32x32x16_bf16 a[48:63], v[68:71], v[116:119], a[48:63]
    buffer_load_dwordx4 a[172:175], v123, s[24:27], s63 offen offset:2048 sc1
    v_exp_f32 v84, v84
    v_exp_f32 v85, v85
    v_exp_f32 v86, v86
    v_exp_f32 v87, v87
    v_cvt_pk_bf16_f32 v108, v80, v81
    v_cvt_pk_bf16_f32 v109, v82, v83
    v_cvt_pk_bf16_f32 v110, v84, v85
    v_cvt_pk_bf16_f32 v111, v86, v87
    v_mfma_f32_32x32x16_bf16 v[72:87], v[44:47], v[32:35], 0
    v_exp_f32 v88, v88
    v_exp_f32 v89, v89
    v_exp_f32 v90, v90
    v_exp_f32 v91, v91
    v_mfma_f32_32x32x8_bf16 v[72:87], v[48:49], v[36:37], v[72:87]
    v_exp_f32 v92, v92
    v_exp_f32 v93, v93
    v_exp_f32 v94, v94
    v_exp_f32 v95, v95
    v_cvt_pk_bf16_f32 v112, v88, v89
    v_cvt_pk_bf16_f32 v113, v90, v91
    s_waitcnt lgkmcnt(2)
    v_mfma_f32_32x32x16_bf16 a[0:15], v[56:59], v[104:107], a[0:15]
    ds_read_b128 v[64:67], v4 offset:27776
    v_exp_f32 v96, v96
    v_exp_f32 v97, v97
    v_exp_f32 v98, v98
    v_exp_f32 v99, v99
    v_cvt_pk_bf16_f32 v114, v92, v93
    v_cvt_pk_bf16_f32 v115, v94, v95
    v_mfma_f32_32x32x16_bf16 a[0:15], v[60:63], v[108:111], a[0:15]
    buffer_load_dwordx4 a[176:179], v120, s[24:27], s63 offen offset:3072 sc1
    v_exp_f32 v100, v100
    v_exp_f32 v101, v101
    v_exp_f32 v102, v102
    v_exp_f32 v103, v103
    v_cvt_pk_bf16_f32 v116, v96, v97
    v_cvt_pk_bf16_f32 v117, v98, v99
    v_cvt_pk_bf16_f32 v118, v100, v101
    v_cvt_pk_bf16_f32 v119, v102, v103
    v_mfma_f32_32x32x16_bf16 v[88:103], v[44:47], v[38:41], 0
    v_exp_f32 v72, v72
    v_exp_f32 v73, v73
    v_exp_f32 v74, v74
    v_exp_f32 v75, v75
    v_mfma_f32_32x32x8_bf16 v[88:103], v[48:49], v[42:43], v[88:103]
    v_exp_f32 v76, v76
    v_exp_f32 v77, v77
    v_exp_f32 v78, v78
    v_exp_f32 v79, v79
    v_cvt_pk_bf16_f32 v104, v72, v73
    v_cvt_pk_bf16_f32 v105, v74, v75
    v_mfma_f32_32x32x16_bf16 a[16:31], v[56:59], v[112:115], a[16:31]
    ds_read_b128 v[68:71], v4 offset:28480
    v_exp_f32 v80, v80
    v_exp_f32 v81, v81
    v_exp_f32 v82, v82
    v_exp_f32 v83, v83
    v_cvt_pk_bf16_f32 v106, v76, v77
    v_cvt_pk_bf16_f32 v107, v78, v79
    v_mfma_f32_32x32x16_bf16 a[16:31], v[60:63], v[116:119], a[16:31]
    s_waitcnt vmcnt(5)
    s_mov_b32 exec_lo, 0x1ffff
    s_mov_b32 exec_hi, 0x0
    v_xor_b32 v240, s2, v240
    v_xor_b32 v241, s3, v241
    v_or_b32 v240, v240, v241
    v_cmp_ne_u32 vcc, 0, v240
    s_mov_b64 exec, -1
    s_cmp_eq_u64 vcc, 0
    s_cbranch_scc1 L_pollok_71
    s_mov_b32 exec_lo, 0x1ffff
    s_mov_b32 exec_hi, 0x0
    s_mov_b32 s84, 1048576
L_poll_72:
    buffer_load_dwordx2 v[240:241], v242, s[24:27], 0 offen sc1
    s_waitcnt vmcnt(0)
    v_xor_b32 v240, s2, v240
    v_xor_b32 v241, s3, v241
    v_or_b32 v240, v240, v241
    v_cmp_ne_u32 vcc, 0, v240
    s_cmp_eq_u64 vcc, 0
    s_cbranch_scc1 L_polled_73
    s_sub_u32 s84, s84, 1
    s_cmp_eq_u32 s84, 0
    s_cbranch_scc1 L_polltmo_74
    s_sleep 2
    s_branch L_poll_72
L_polltmo_74:
    v_mov_b32 v240, 229
    v_mov_b32 v241, 252
    global_store_dword v241, v240, s[38:39]
L_polled_73:
    s_mov_b64 exec, -1
L_pollok_71:
    v_exp_f32 v84, v84
    v_exp_f32 v85, v85
    v_exp_f32 v86, v86
    v_exp_f32 v87, v87
    v_cvt_pk_bf16_f32 v108, v80, v81
    v_cvt_pk_bf16_f32 v109, v82, v83
    v_cvt_pk_bf16_f32 v110, v84, v85
    v_cvt_pk_bf16_f32 v111, v86, v87
    s_waitcnt lgkmcnt(2)
    v_mfma_f32_32x32x16_bf16 v[72:87], v[50:53], v[20:23], 0
    v_exp_f32 v88, v88
    v_exp_f32 v89, v89
    v_exp_f32 v90, v90
    v_exp_f32 v91, v91
    v_mfma_f32_32x32x8_bf16 v[72:87], v[54:55], v[24:25], v[72:87]
    v_exp_f32 v92, v92
    v_exp_f32 v93, v93
    v_exp_f32 v94, v94
    v_exp_f32 v95, v95
    v_cvt_pk_bf16_f32 v112, v88, v89
    v_cvt_pk_bf16_f32 v113, v90, v91
    v_mfma_f32_32x32x16_bf16 a[32:47], v[56:59], v[104:107], a[32:47]
    v_exp_f32 v96, v96
    v_exp_f32 v97, v97
    v_exp_f32 v98, v98
    v_exp_f32 v99, v99
    v_cvt_pk_bf16_f32 v114, v92, v93
    v_cvt_pk_bf16_f32 v115, v94, v95
    v_mfma_f32_32x32x16_bf16 a[32:47], v[60:63], v[108:111], a[32:47]
    buffer_load_dwordx4 a[180:183], v121, s[24:27], s63 offen offset:3072 sc1
    v_exp_f32 v100, v100
    v_exp_f32 v101, v101
    v_exp_f32 v102, v102
    v_exp_f32 v103, v103
    v_cvt_pk_bf16_f32 v116, v96, v97
    v_cvt_pk_bf16_f32 v117, v98, v99
    v_cvt_pk_bf16_f32 v118, v100, v101
    v_cvt_pk_bf16_f32 v119, v102, v103
    s_waitcnt lgkmcnt(0)
    s_barrier
    v_mfma_f32_32x32x16_bf16 v[88:103], v[50:53], v[26:29], 0
    ds_read_b128 v[44:47], v2 offset:0
    v_exp_f32 v72, v72
    v_exp_f32 v73, v73
    v_exp_f32 v74, v74
    v_exp_f32 v75, v75
    v_mfma_f32_32x32x8_bf16 v[88:103], v[54:55], v[30:31], v[88:103]
    ds_read_b64 v[48:49], v3 offset:0
    v_exp_f32 v76, v76
    v_exp_f32 v77, v77
    v_exp_f32 v78, v78
    v_exp_f32 v79, v79
    v_cvt_pk_bf16_f32 v104, v72, v73
    v_cvt_pk_bf16_f32 v105, v74, v75
    v_mfma_f32_32x32x16_bf16 a[48:63], v[56:59], v[112:115], a[48:63]
    v_exp_f32 v80, v80
    v_exp_f32 v81, v81
    v_exp_f32 v82, v82
    v_exp_f32 v83, v83
    v_cvt_pk_bf16_f32 v106, v76, v77
    v_cvt_pk_bf16_f32 v107, v78, v79
    v_mfma_f32_32x32x16_bf16 a[48:63], v[60:63], v[116:119], a[48:63]
    s_add_u32 m0, s67, 23552
    s_nop 0
    buffer_load_dwordx4 v5, s[24:27], s50 offen sc1 lds
    buffer_load_dwordx4 a[184:187], v122, s[24:27], s63 offen offset:3072 sc1
    v_exp_f32 v84, v84
    v_exp_f32 v85, v85
    v_exp_f32 v86, v86
    v_exp_f32 v87, v87
    v_cvt_pk_bf16_f32 v108, v80, v81
    v_cvt_pk_bf16_f32 v109, v82, v83
    v_cvt_pk_bf16_f32 v110, v84, v85
    v_cvt_pk_bf16_f32 v111, v86, v87
    v_mfma_f32_32x32x16_bf16 v[72:87], v[50:53], v[32:35], 0
    v_exp_f32 v88, v88
    v_exp_f32 v89, v89
    v_exp_f32 v90, v90
    v_exp_f32 v91, v91
    v_mfma_f32_32x32x8_bf16 v[72:87], v[54:55], v[36:37], v[72:87]
    v_exp_f32 v92, v92
    v_exp_f32 v93, v93
    v_exp_f32 v94, v94
    v_exp_f32 v95, v95
    v_cvt_pk_bf16_f32 v112, v88, v89
    v_cvt_pk_bf16_f32 v113, v90, v91
    v_mfma_f32_32x32x16_bf16 a[0:15], v[64:67], v[104:107], a[0:15]
    ds_read_b128 v[56:59], v4 offset:0
    v_exp_f32 v96, v96
    v_exp_f32 v97, v97
    v_exp_f32 v98, v98
    v_exp_f32 v99, v99
    v_cvt_pk_bf16_f32 v114, v92, v93
    v_cvt_pk_bf16_f32 v115, v94, v95
    v_mfma_f32_32x32x16_bf16 a[0:15], v[68:71], v[108:111], a[0:15]
    s_add_u32 m0, s67, 23552
    s_nop 0
    buffer_load_dwordx4 v5, s[24:27], s50 offen offset:1024 sc1 lds
    buffer_load_dwordx4 a[188:191], v123, s[24:27], s63 offen offset:3072 sc1
    v_exp_f32 v100, v100
    v_exp_f32 v101, v101
    v_exp_f32 v102, v102
    v_exp_f32 v103, v103
    v_cvt_pk_bf16_f32 v116, v96, v97
    v_cvt_pk_bf16_f32 v117, v98, v99
    v_cvt_pk_bf16_f32 v118, v100, v101
    v_cvt_pk_bf16_f32 v119, v102, v103
    v_mfma_f32_32x32x16_bf16 v[88:103], v[50:53], v[38:41], 0
    v_exp_f32 v72, v72
    v_exp_f32 v73, v73
    v_exp_f32 v74, v74
    v_exp_f32 v75, v75
    v_mfma_f32_32x32x8_bf16 v[88:103], v[54:55], v[42:43], v[88:103]
    v_exp_f32 v76, v76
    v_exp_f32 v77, v77
    v_exp_f32 v78, v78
    v_exp_f32 v79, v79
    v_cvt_pk_bf16_f32 v104, v72, v73
    v_cvt_pk_bf16_f32 v105, v74, v75
    v_mfma_f32_32x32x16_bf16 a[16:31], v[64:67], v[112:115], a[16:31]
    ds_read_b128 v[60:63], v4 offset:704
    v_exp_f32 v80, v80
    v_exp_f32 v81, v81
    v_exp_f32 v82, v82
    v_exp_f32 v83, v83
    v_cvt_pk_bf16_f32 v106, v76, v77
    v_cvt_pk_bf16_f32 v107, v78, v79
    v_mfma_f32_32x32x16_bf16 a[16:31], v[68:71], v[116:119], a[16:31]
    s_add_u32 m0, s71, 23552
    s_nop 0
    buffer_load_dwordx4 v5, s[24:27], s51 offen sc1 lds
    buffer_load_dwordx4 a[192:195], v120, s[24:27], s61 offen offset:0 sc1
    v_exp_f32 v84, v84
    v_exp_f32 v85, v85
    v_exp_f32 v86, v86
    v_exp_f32 v87, v87
    v_cvt_pk_bf16_f32 v108, v80, v81
    v_cvt_pk_bf16_f32 v109, v82, v83
    v_cvt_pk_bf16_f32 v110, v84, v85
    v_cvt_pk_bf16_f32 v111, v86, v87
    s_waitcnt lgkmcnt(2)
    v_mfma_f32_32x32x16_bf16 v[72:87], v[44:47], v[20:23], 0
    v_exp_f32 v88, v88
    v_exp_f32 v89, v89
    v_exp_f32 v90, v90
    v_exp_f32 v91, v91
    v_mfma_f32_32x32x8_bf16 v[72:87], v[48:49], v[24:25], v[72:87]
    v_exp_f32 v92, v92
    v_exp_f32 v93, v93
    v_exp_f32 v94, v94
    v_exp_f32 v95, v95
    v_cvt_pk_bf16_f32 v112, v88, v89
    v_cvt_pk_bf16_f32 v113, v90, v91
    v_mfma_f32_32x32x16_bf16 a[32:47], v[64:67], v[104:107], a[32:47]
    v_exp_f32 v96, v96
    v_exp_f32 v97, v97
    v_exp_f32 v98, v98
    v_exp_f32 v99, v99
    v_cvt_pk_bf16_f32 v114, v92, v93
    v_cvt_pk_bf16_f32 v115, v94, v95
    v_mfma_f32_32x32x16_bf16 a[32:47], v[68:71], v[108:111], a[32:47]
    s_add_u32 m0, s80, 23552
    s_mov_b64 exec, s[74:75]
    buffer_load_dwordx4 v6, s[24:27], s52 offen sc1 lds
    s_mov_b64 exec, -1
    buffer_load_dwordx4 a[196:199], v121, s[24:27], s61 offen offset:0 sc1
    v_exp_f32 v100, v100
    v_exp_f32 v101, v101
    v_exp_f32 v102, v102
    v_exp_f32 v103, v103
    v_cvt_pk_bf16_f32 v116, v96, v97
    v_cvt_pk_bf16_f32 v117, v98, v99
    v_cvt_pk_bf16_f32 v118, v100, v101
    v_cvt_pk_bf16_f32 v119, v102, v103
    v_mfma_f32_32x32x16_bf16 v[88:103], v[44:47], v[26:29], 0
    ds_read_b128 v[50:53], v2 offset:1024
    v_exp_f32 v72, v72
    v_exp_f32 v73, v73
    v_exp_f32 v74, v74
    v_exp_f32 v75, v75
    v_mfma_f32_32x32x8_bf16 v[88:103], v[48:49], v[30:31], v[88:103]
    ds_read_b64 v[54:55], v3 offset:512
    v_exp_f32 v76, v76
    v_exp_f32 v77, v77
    v_exp_f32 v78, v78
    v_exp_f32 v79, v79
    v_cvt_pk_bf16_f32 v104, v72, v73
    v_cvt_pk_bf16_f32 v105, v74, v75
    v_mfma_f32_32x32x16_bf16 a[48:63], v[64:67], v[112:115], a[48:63]
    v_exp_f32 v80, v80
    v_exp_f32 v81, v81
    v_exp_f32 v82, v82
    v_exp_f32 v83, v83
    v_cvt_pk_bf16_f32 v106, v76, v77
    v_cvt_pk_bf16_f32 v107, v78, v79
    v_mfma_f32_32x32x16_bf16 a[48:63], v[68:71], v[116:119], a[48:63]
    s_add_u32 m0, s81, 23552
    s_mov_b64 exec, s[76:77]
    buffer_load_dwordx4 v7, s[24:27], s52 offen sc1 lds
    s_mov_b64 exec, -1
    buffer_load_dwordx4 a[200:203], v122, s[24:27], s61 offen offset:0 sc1
    v_exp_f32 v84, v84
    v_exp_f32 v85, v85
    v_exp_f32 v86, v86
    v_exp_f32 v87, v87
    v_cvt_pk_bf16_f32 v108, v80, v81
    v_cvt_pk_bf16_f32 v109, v82, v83
    v_cvt_pk_bf16_f32 v110, v84, v85
    v_cvt_pk_bf16_f32 v111, v86, v87
    v_mfma_f32_32x32x16_bf16 v[72:87], v[44:47], v[32:35], 0
    v_exp_f32 v88, v88
    v_exp_f32 v89, v89
    v_exp_f32 v90, v90
    v_exp_f32 v91, v91
    v_mfma_f32_32x32x8_bf16 v[72:87], v[48:49], v[36:37], v[72:87]
    v_exp_f32 v92, v92
    v_exp_f32 v93, v93
    v_exp_f32 v94, v94
    v_exp_f32 v95, v95
    v_cvt_pk_bf16_f32 v112, v88, v89
    v_cvt_pk_bf16_f32 v113, v90, v91
    s_waitcnt lgkmcnt(2)
    v_mfma_f32_32x32x16_bf16 a[0:15], v[56:59], v[104:107], a[0:15]
    ds_read_b128 v[64:67], v4 offset:1408
    v_exp_f32 v96, v96
    v_exp_f32 v97, v97
    v_exp_f32 v98, v98
    v_exp_f32 v99, v99
    v_cvt_pk_bf16_f32 v114, v92, v93
    v_cvt_pk_bf16_f32 v115, v94, v95
    v_mfma_f32_32x32x16_bf16 a[0:15], v[60:63], v[108:111], a[0:15]
    s_add_u32 m0, s82, 23552
    s_mov_b64 exec, s[78:79]
    buffer_load_dwordx4 v8, s[24:27], s52 offen sc1 lds
    s_mov_b64 exec, -1
    buffer_load_dwordx4 a[204:207], v123, s[24:27], s61 offen offset:0 sc1
    v_exp_f32 v100, v100
    v_exp_f32 v101, v101
    v_exp_f32 v102, v102
    v_exp_f32 v103, v103
    v_cvt_pk_bf16_f32 v116, v96, v97
    v_cvt_pk_bf16_f32 v117, v98, v99
    v_cvt_pk_bf16_f32 v118, v100, v101
    v_cvt_pk_bf16_f32 v119, v102, v103
    v_mfma_f32_32x32x16_bf16 v[88:103], v[44:47], v[38:41], 0
    v_exp_f32 v72, v72
    v_exp_f32 v73, v73
    v_exp_f32 v74, v74
    v_exp_f32 v75, v75
    v_mfma_f32_32x32x8_bf16 v[88:103], v[48:49], v[42:43], v[88:103]
    v_exp_f32 v76, v76
    v_exp_f32 v77, v77
    v_exp_f32 v78, v78
    v_exp_f32 v79, v79
    v_cvt_pk_bf16_f32 v104, v72, v73
    v_cvt_pk_bf16_f32 v105, v74, v75
    v_mfma_f32_32x32x16_bf16 a[16:31], v[56:59], v[112:115], a[16:31]
    ds_read_b128 v[68:71], v4 offset:2112
    v_exp_f32 v80, v80
    v_exp_f32 v81, v81
    v_exp_f32 v82, v82
    v_exp_f32 v83, v83
    v_cvt_pk_bf16_f32 v106, v76, v77
    v_cvt_pk_bf16_f32 v107, v78, v79
    v_mfma_f32_32x32x16_bf16 a[16:31], v[60:63], v[116:119], a[16:31]
    s_add_u32 s50, s50, 4096
    s_add_u32 s51, s51, 2048
    s_add_u32 s52, s52, 5120
    buffer_load_dwordx4 a[208:211], v120, s[24:27], s61 offen offset:1024 sc1
    v_exp_f32 v84, v84
    v_exp_f32 v85, v85
    v_exp_f32 v86, v86
    v_exp_f32 v87, v87
    v_cvt_pk_bf16_f32 v108, v80, v81
    v_cvt_pk_bf16_f32 v109, v82, v83
    v_cvt_pk_bf16_f32 v110, v84, v85
    v_cvt_pk_bf16_f32 v111, v86, v87
    s_waitcnt lgkmcnt(2)
    v_mfma_f32_32x32x16_bf16 v[72:87], v[50:53], v[20:23], 0
    v_exp_f32 v88, v88
    v_exp_f32 v89, v89
    v_exp_f32 v90, v90
    v_exp_f32 v91, v91
    v_mfma_f32_32x32x8_bf16 v[72:87], v[54:55], v[24:25], v[72:87]
    v_exp_f32 v92, v92
    v_exp_f32 v93, v93
    v_exp_f32 v94, v94
    v_exp_f32 v95, v95
    v_cvt_pk_bf16_f32 v112, v88, v89
    v_cvt_pk_bf16_f32 v113, v90, v91
    v_mfma_f32_32x32x16_bf16 a[32:47], v[56:59], v[104:107], a[32:47]
    v_exp_f32 v96, v96
    v_exp_f32 v97, v97
    v_exp_f32 v98, v98
    v_exp_f32 v99, v99
    v_cvt_pk_bf16_f32 v114, v92, v93
    v_cvt_pk_bf16_f32 v115, v94, v95
    v_mfma_f32_32x32x16_bf16 a[32:47], v[60:63], v[108:111], a[32:47]
    buffer_load_dwordx4 a[212:215], v121, s[24:27], s61 offen offset:1024 sc1
    v_exp_f32 v100, v100
    v_exp_f32 v101, v101
    v_exp_f32 v102, v102
    v_exp_f32 v103, v103
    v_cvt_pk_bf16_f32 v116, v96, v97
    v_cvt_pk_bf16_f32 v117, v98, v99
    v_cvt_pk_bf16_f32 v118, v100, v101
    v_cvt_pk_bf16_f32 v119, v102, v103
    v_mfma_f32_32x32x16_bf16 v[88:103], v[50:53], v[26:29], 0
    ds_read_b128 v[44:47], v2 offset:2048
    v_exp_f32 v72, v72
    v_exp_f32 v73, v73
    v_exp_f32 v74, v74
    v_exp_f32 v75, v75
    v_mfma_f32_32x32x8_bf16 v[88:103], v[54:55], v[30:31], v[88:103]
    ds_read_b64 v[48:49], v3 offset:1024
    v_exp_f32 v76, v76
    v_exp_f32 v77, v77
    v_exp_f32 v78, v78
    v_exp_f32 v79, v79
    v_cvt_pk_bf16_f32 v104, v72, v73
    v_cvt_pk_bf16_f32 v105, v74, v75
    v_mfma_f32_32x32x16_bf16 a[48:63], v[56:59], v[112:115], a[48:63]
    v_exp_f32 v80, v80
    v_exp_f32 v81, v81
    v_exp_f32 v82, v82
    v_exp_f32 v83, v83
    v_cvt_pk_bf16_f32 v106, v76, v77
    v_cvt_pk_bf16_f32 v107, v78, v79
    v_mfma_f32_32x32x16_bf16 a[48:63], v[60:63], v[116:119], a[48:63]
    buffer_load_dwordx4 a[216:219], v122, s[24:27], s61 offen offset:1024 sc1
    v_exp_f32 v84, v84
    v_exp_f32 v85, v85
    v_exp_f32 v86, v86
    v_exp_f32 v87, v87
    v_cvt_pk_bf16_f32 v108, v80, v81
    v_cvt_pk_bf16_f32 v109, v82, v83
    v_cvt_pk_bf16_f32 v110, v84, v85
    v_cvt_pk_bf16_f32 v111, v86, v87
    v_mfma_f32_32x32x16_bf16 v[72:87], v[50:53], v[32:35], 0
    v_exp_f32 v88, v88
    v_exp_f32 v89, v89
    v_exp_f32 v90, v90
    v_exp_f32 v91, v91
    v_mfma_f32_32x32x8_bf16 v[72:87], v[54:55], v[36:37], v[72:87]
    v_exp_f32 v92, v92
    v_exp_f32 v93, v93
    v_exp_f32 v94, v94
    v_exp_f32 v95, v95
    v_cvt_pk_bf16_f32 v112, v88, v89
    v_cvt_pk_bf16_f32 v113, v90, v91
    s_waitcnt lgkmcnt(2)
    v_mfma_f32_32x32x16_bf16 a[0:15], v[64:67], v[104:107], a[0:15]
    ds_read_b128 v[56:59], v4 offset:2816
    v_exp_f32 v96, v96
    v_exp_f32 v97, v97
    v_exp_f32 v98, v98
    v_exp_f32 v99, v99
    v_cvt_pk_bf16_f32 v114, v92, v93
    v_cvt_pk_bf16_f32 v115, v94, v95
    v_mfma_f32_32x32x16_bf16 a[0:15], v[68:71], v[108:111], a[0:15]
    buffer_load_dwordx4 a[220:223], v123, s[24:27], s61 offen offset:1024 sc1
    v_exp_f32 v100, v100
    v_exp_f32 v101, v101
    v_exp_f32 v102, v102
    v_exp_f32 v103, v103
    v_cvt_pk_bf16_f32 v116, v96, v97
    v_cvt_pk_bf16_f32 v117, v98, v99
    v_cvt_pk_bf16_f32 v118, v100, v101
    v_cvt_pk_bf16_f32 v119, v102, v103
    v_mfma_f32_32x32x16_bf16 v[88:103], v[50:53], v[38:41], 0
    v_exp_f32 v72, v72
    v_exp_f32 v73, v73
    v_exp_f32 v74, v74
    v_exp_f32 v75, v75
    v_mfma_f32_32x32x8_bf16 v[88:103], v[54:55], v[42:43], v[88:103]
    v_exp_f32 v76, v76
    v_exp_f32 v77, v77
    v_exp_f32 v78, v78
    v_exp_f32 v79, v79
    v_cvt_pk_bf16_f32 v104, v72, v73
    v_cvt_pk_bf16_f32 v105, v74, v75
    v_mfma_f32_32x32x16_bf16 a[16:31], v[64:67], v[112:115], a[16:31]
    ds_read_b128 v[60:63], v4 offset:3520
    v_exp_f32 v80, v80
    v_exp_f32 v81, v81
    v_exp_f32 v82, v82
    v_exp_f32 v83, v83
    v_cvt_pk_bf16_f32 v106, v76, v77
    v_cvt_pk_bf16_f32 v107, v78, v79
    v_mfma_f32_32x32x16_bf16 a[16:31], v[68:71], v[116:119], a[16:31]
    buffer_load_dwordx4 a[224:227], v120, s[24:27], s61 offen offset:2048 sc1
    v_exp_f32 v84, v84
    v_exp_f32 v85, v85
    v_exp_f32 v86, v86
    v_exp_f32 v87, v87
    v_cvt_pk_bf16_f32 v108, v80, v81
    v_cvt_pk_bf16_f32 v109, v82, v83
    v_cvt_pk_bf16_f32 v110, v84, v85
    v_cvt_pk_bf16_f32 v111, v86, v87
    s_waitcnt lgkmcnt(2)
    v_mfma_f32_32x32x16_bf16 v[72:87], v[44:47], v[20:23], 0
    v_exp_f32 v88, v88
    v_exp_f32 v89, v89
    v_exp_f32 v90, v90
    v_exp_f32 v91, v91
    v_mfma_f32_32x32x8_bf16 v[72:87], v[48:49], v[24:25], v[72:87]
    v_exp_f32 v92, v92
    v_exp_f32 v93, v93
    v_exp_f32 v94, v94
    v_exp_f32 v95, v95
    v_cvt_pk_bf16_f32 v112, v88, v89
    v_cvt_pk_bf16_f32 v113, v90, v91
    v_mfma_f32_32x32x16_bf16 a[32:47], v[64:67], v[104:107], a[32:47]
    v_exp_f32 v96, v96
    v_exp_f32 v97, v97
    v_exp_f32 v98, v98
    v_exp_f32 v99, v99
    v_cvt_pk_bf16_f32 v114, v92, v93
    v_cvt_pk_bf16_f32 v115, v94, v95
    v_mfma_f32_32x32x16_bf16 a[32:47], v[68:71], v[108:111], a[32:47]
    buffer_load_dwordx4 a[228:231], v121, s[24:27], s61 offen offset:2048 sc1
    v_exp_f32 v100, v100
    v_exp_f32 v101, v101
    v_exp_f32 v102, v102
    v_exp_f32 v103, v103
    v_cvt_pk_bf16_f32 v116, v96, v97
    v_cvt_pk_bf16_f32 v117, v98, v99
    v_cvt_pk_bf16_f32 v118, v100, v101
    v_cvt_pk_bf16_f32 v119, v102, v103
    v_mfma_f32_32x32x16_bf16 v[88:103], v[44:47], v[26:29], 0
    ds_read_b128 v[50:53], v2 offset:3072
    v_exp_f32 v72, v72
    v_exp_f32 v73, v73
    v_exp_f32 v74, v74
    v_exp_f32 v75, v75
    v_mfma_f32_32x32x8_bf16 v[88:103], v[48:49], v[30:31], v[88:103]
    ds_read_b64 v[54:55], v3 offset:1536
    v_exp_f32 v76, v76
    v_exp_f32 v77, v77
    v_exp_f32 v78, v78
    v_exp_f32 v79, v79
    v_cvt_pk_bf16_f32 v104, v72, v73
    v_cvt_pk_bf16_f32 v105, v74, v75
    v_mfma_f32_32x32x16_bf16 a[48:63], v[64:67], v[112:115], a[48:63]
    v_exp_f32 v80, v80
    v_exp_f32 v81, v81
    v_exp_f32 v82, v82
    v_exp_f32 v83, v83
    v_cvt_pk_bf16_f32 v106, v76, v77
    v_cvt_pk_bf16_f32 v107, v78, v79
    v_mfma_f32_32x32x16_bf16 a[48:63], v[68:71], v[116:119], a[48:63]
    buffer_load_dwordx4 a[232:235], v122, s[24:27], s61 offen offset:2048 sc1
    v_exp_f32 v84, v84
    v_exp_f32 v85, v85
    v_exp_f32 v86, v86
    v_exp_f32 v87, v87
    v_cvt_pk_bf16_f32 v108, v80, v81
    v_cvt_pk_bf16_f32 v109, v82, v83
    v_cvt_pk_bf16_f32 v110, v84, v85
    v_cvt_pk_bf16_f32 v111, v86, v87
    v_mfma_f32_32x32x16_bf16 v[72:87], v[44:47], v[32:35], 0
    v_exp_f32 v88, v88
    v_exp_f32 v89, v89
    v_exp_f32 v90, v90
    v_exp_f32 v91, v91
    v_mfma_f32_32x32x8_bf16 v[72:87], v[48:49], v[36:37], v[72:87]
    v_exp_f32 v92, v92
    v_exp_f32 v93, v93
    v_exp_f32 v94, v94
    v_exp_f32 v95, v95
    v_cvt_pk_bf16_f32 v112, v88, v89
    v_cvt_pk_bf16_f32 v113, v90, v91
    s_waitcnt lgkmcnt(2)
    v_mfma_f32_32x32x16_bf16 a[0:15], v[56:59], v[104:107], a[0:15]
    ds_read_b128 v[64:67], v4 offset:4224
    v_exp_f32 v96, v96
    v_exp_f32 v97, v97
    v_exp_f32 v98, v98
    v_exp_f32 v99, v99
    v_cvt_pk_bf16_f32 v114, v92, v93
    v_cvt_pk_bf16_f32 v115, v94, v95
    v_mfma_f32_32x32x16_bf16 a[0:15], v[60:63], v[108:111], a[0:15]
    buffer_load_dwordx4 a[236:239], v123, s[24:27], s61 offen offset:2048 sc1
    v_exp_f32 v100, v100
    v_exp_f32 v101, v101
    v_exp_f32 v102, v102
    v_exp_f32 v103, v103
    v_cvt_pk_bf16_f32 v116, v96, v97
    v_cvt_pk_bf16_f32 v117, v98, v99
    v_cvt_pk_bf16_f32 v118, v100, v101
    v_cvt_pk_bf16_f32 v119, v102, v103
    v_mfma_f32_32x32x16_bf16 v[88:103], v[44:47], v[38:41], 0
    v_exp_f32 v72, v72
    v_exp_f32 v73, v73
    v_exp_f32 v74, v74
    v_exp_f32 v75, v75
    v_mfma_f32_32x32x8_bf16 v[88:103], v[48:49], v[42:43], v[88:103]
    v_exp_f32 v76, v76
    v_exp_f32 v77, v77
    v_exp_f32 v78, v78
    v_exp_f32 v79, v79
    v_cvt_pk_bf16_f32 v104, v72, v73
    v_cvt_pk_bf16_f32 v105, v74, v75
    v_mfma_f32_32x32x16_bf16 a[16:31], v[56:59], v[112:115], a[16:31]
    ds_read_b128 v[68:71], v4 offset:4928
    v_exp_f32 v80, v80
    v_exp_f32 v81, v81
    v_exp_f32 v82, v82
    v_exp_f32 v83, v83
    v_cvt_pk_bf16_f32 v106, v76, v77
    v_cvt_pk_bf16_f32 v107, v78, v79
    v_mfma_f32_32x32x16_bf16 a[16:31], v[60:63], v[116:119], a[16:31]
    buffer_load_dwordx4 a[240:243], v120, s[24:27], s61 offen offset:3072 sc1
    v_exp_f32 v84, v84
    v_exp_f32 v85, v85
    v_exp_f32 v86, v86
    v_exp_f32 v87, v87
    v_cvt_pk_bf16_f32 v108, v80, v81
    v_cvt_pk_bf16_f32 v109, v82, v83
    v_cvt_pk_bf16_f32 v110, v84, v85
    v_cvt_pk_bf16_f32 v111, v86, v87
    s_waitcnt lgkmcnt(2)
    v_mfma_f32_32x32x16_bf16 v[72:87], v[50:53], v[20:23], 0
    v_exp_f32 v88, v88
    v_exp_f32 v89, v89
    v_exp_f32 v90, v90
    v_exp_f32 v91, v91
    v_mfma_f32_32x32x8_bf16 v[72:87], v[54:55], v[24:25], v[72:87]
    v_exp_f32 v92, v92
    v_exp_f32 v93, v93
    v_exp_f32 v94, v94
    v_exp_f32 v95, v95
    v_cvt_pk_bf16_f32 v112, v88, v89
    v_cvt_pk_bf16_f32 v113, v90, v91
    v_mfma_f32_32x32x16_bf16 a[32:47], v[56:59], v[104:107], a[32:47]
    v_exp_f32 v96, v96
    v_exp_f32 v97, v97
    v_exp_f32 v98, v98
    v_exp_f32 v99, v99
    v_cvt_pk_bf16_f32 v114, v92, v93
    v_cvt_pk_bf16_f32 v115, v94, v95
    v_mfma_f32_32x32x16_bf16 a[32:47], v[60:63], v[108:111], a[32:47]
    buffer_load_dwordx4 a[244:247], v121, s[24:27], s61 offen offset:3072 sc1
    v_exp_f32 v100, v100
    v_exp_f32 v101, v101
    v_exp_f32 v102, v102
    v_exp_f32 v103, v103
    v_cvt_pk_bf16_f32 v116, v96, v97
    v_cvt_pk_bf16_f32 v117, v98, v99
    v_cvt_pk_bf16_f32 v118, v100, v101
    v_cvt_pk_bf16_f32 v119, v102, v103
    s_waitcnt vmcnt(11)
    s_waitcnt lgkmcnt(0)
    s_barrier
    v_mfma_f32_32x32x16_bf16 v[88:103], v[50:53], v[26:29], 0
    ds_read_b128 v[44:47], v2 offset:23552
    v_exp_f32 v72, v72
    v_exp_f32 v73, v73
    v_exp_f32 v74, v74
    v_exp_f32 v75, v75
    v_mfma_f32_32x32x8_bf16 v[88:103], v[54:55], v[30:31], v[88:103]
    ds_read_b64 v[48:49], v3 offset:23552
    v_exp_f32 v76, v76
    v_exp_f32 v77, v77
    v_exp_f32 v78, v78
    v_exp_f32 v79, v79
    v_cvt_pk_bf16_f32 v104, v72, v73
    v_cvt_pk_bf16_f32 v105, v74, v75
    v_mfma_f32_32x32x16_bf16 a[48:63], v[56:59], v[112:115], a[48:63]
    v_exp_f32 v80, v80
    v_exp_f32 v81, v81
    v_exp_f32 v82, v82
    v_exp_f32 v83, v83
    v_cvt_pk_bf16_f32 v106, v76, v77
    v_cvt_pk_bf16_f32 v107, v78, v79
    v_mfma_f32_32x32x16_bf16 a[48:63], v[60:63], v[116:119], a[48:63]
    s_add_u32 m0, s67, 0
    s_nop 0
    buffer_load_dwordx4 v5, s[24:27], s50 offen sc1 lds
    buffer_load_dwordx4 a[248:251], v122, s[24:27], s61 offen offset:3072 sc1
    v_exp_f32 v84, v84
    v_exp_f32 v85, v85
    v_exp_f32 v86, v86
    v_exp_f32 v87, v87
    v_cvt_pk_bf16_f32 v108, v80, v81
    v_cvt_pk_bf16_f32 v109, v82, v83
    v_cvt_pk_bf16_f32 v110, v84, v85
    v_cvt_pk_bf16_f32 v111, v86, v87
    v_mfma_f32_32x32x16_bf16 v[72:87], v[50:53], v[32:35], 0
    v_exp_f32 v88, v88
    v_exp_f32 v89, v89
    v_exp_f32 v90, v90
    v_exp_f32 v91, v91
    v_mfma_f32_32x32x8_bf16 v[72:87], v[54:55], v[36:37], v[72:87]
    v_exp_f32 v92, v92
    v_exp_f32 v93, v93
    v_exp_f32 v94, v94
    v_exp_f32 v95, v95
    v_cvt_pk_bf16_f32 v112, v88, v89
    v_cvt_pk_bf16_f32 v113, v90, v91
    v_mfma_f32_32x32x16_bf16 a[0:15], v[64:67], v[104:107], a[0:15]
    ds_read_b128 v[56:59], v4 offset:23552
    v_exp_f32 v96, v96
    v_exp_f32 v97, v97
    v_exp_f32 v98, v98
    v_exp_f32 v99, v99
    v_cvt_pk_bf16_f32 v114, v92, v93
    v_cvt_pk_bf16_f32 v115, v94, v95
    v_mfma_f32_32x32x16_bf16 a[0:15], v[68:71], v[108:111], a[0:15]
    s_add_u32 m0, s67, 0
    s_nop 0
    buffer_load_dwordx4 v5, s[24:27], s50 offen offset:1024 sc1 lds
    buffer_load_dwordx4 a[252:255], v123, s[24:27], s61 offen offset:3072 sc1
    v_exp_f32 v100, v100
    v_exp_f32 v101, v101
    v_exp_f32 v102, v102
    v_exp_f32 v103, v103
    v_cvt_pk_bf16_f32 v116, v96, v97
    v_cvt_pk_bf16_f32 v117, v98, v99
    v_cvt_pk_bf16_f32 v118, v100, v101
    v_cvt_pk_bf16_f32 v119, v102, v103
    v_mfma_f32_32x32x16_bf16 v[88:103], v[50:53], v[38:41], 0
    v_exp_f32 v72, v72
    v_exp_f32 v73, v73
    v_exp_f32 v74, v74
    v_exp_f32 v75, v75
    v_mfma_f32_32x32x8_bf16 v[88:103], v[54:55], v[42:43], v[88:103]
    v_exp_f32 v76, v76
    v_exp_f32 v77, v77
    v_exp_f32 v78, v78
    v_exp_f32 v79, v79
    v_cvt_pk_bf16_f32 v104, v72, v73
    v_cvt_pk_bf16_f32 v105, v74, v75
    v_mfma_f32_32x32x16_bf16 a[16:31], v[64:67], v[112:115], a[16:31]
    ds_read_b128 v[60:63], v4 offset:24256
    v_exp_f32 v80, v80
    v_exp_f32 v81, v81
    v_exp_f32 v82, v82
    v_exp_f32 v83, v83
    v_cvt_pk_bf16_f32 v106, v76, v77
    v_cvt_pk_bf16_f32 v107, v78, v79
    v_mfma_f32_32x32x16_bf16 a[16:31], v[68:71], v[116:119], a[16:31]
    s_add_u32 m0, s71, 0
    s_nop 0
    buffer_load_dwordx4 v5, s[24:27], s51 offen sc1 lds
    s_add_u32 s85, s68, 0
    s_add_u32 m0, s70, 0
    s_nop 0
    buffer_load_dwordx4 v126, s[24:27], s85 offen offset:0 sc1 lds
    v_exp_f32 v84, v84
    v_exp_f32 v85, v85
    v_exp_f32 v86, v86
    v_exp_f32 v87, v87
    v_cvt_pk_bf16_f32 v108, v80, v81
    v_cvt_pk_bf16_f32 v109, v82, v83
    v_cvt_pk_bf16_f32 v110, v84, v85
    v_cvt_pk_bf16_f32 v111, v86, v87
    s_waitcnt lgkmcnt(2)
    v_mfma_f32_32x32x16_bf16 v[72:87], v[44:47], v[20:23], 0
    v_exp_f32 v88, v88
    v_exp_f32 v89, v89
    v_exp_f32 v90, v90
    v_exp_f32 v91, v91
    v_mfma_f32_32x32x8_bf16 v[72:87], v[48:49], v[24:25], v[72:87]
    v_exp_f32 v92, v92
    v_exp_f32 v93, v93
    v_exp_f32 v94, v94
    v_exp_f32 v95, v95
    v_cvt_pk_bf16_f32 v112, v88, v89
    v_cvt_pk_bf16_f32 v113, v90, v91
    v_mfma_f32_32x32x16_bf16 a[32:47], v[64:67], v[104:107], a[32:47]
    v_exp_f32 v96, v96
    v_exp_f32 v97, v97
    v_exp_f32 v98, v98
    v_exp_f32 v99, v99
    v_cvt_pk_bf16_f32 v114, v92, v93
    v_cvt_pk_bf16_f32 v115, v94, v95
    v_mfma_f32_32x32x16_bf16 a[32:47], v[68:71], v[108:111], a[32:47]
    s_add_u32 m0, s80, 0
    s_mov_b64 exec, s[74:75]
    buffer_load_dwordx4 v6, s[24:27], s52 offen sc1 lds
    s_mov_b64 exec, -1
    s_add_u32 m0, s70, 0
    s_nop 0
    buffer_load_dwordx4 v126, s[24:27], s85 offen offset:1024 sc1 lds
    v_exp_f32 v100, v100
    v_exp_f32 v101, v101
    v_exp_f32 v102, v102
    v_exp_f32 v103, v103
    v_cvt_pk_bf16_f32 v116, v96, v97
    v_cvt_pk_bf16_f32 v117, v98, v99
    v_cvt_pk_bf16_f32 v118, v100, v101
    v_cvt_pk_bf16_f32 v119, v102, v103
    v_mfma_f32_32x32x16_bf16 v[88:103], v[44:47], v[26:29], 0
    ds_read_b128 v[50:53], v2 offset:24576
    v_exp_f32 v72, v72
    v_exp_f32 v73, v73
    v_exp_f32 v74, v74
    v_exp_f32 v75, v75
    v_mfma_f32_32x32x8_bf16 v[88:103], v[48:49], v[30:31], v[88:103]
    ds_read_b64 v[54:55], v3 offset:24064
    v_exp_f32 v76, v76
    v_exp_f32 v77, v77
    v_exp_f32 v78, v78
    v_exp_f32 v79, v79
    v_cvt_pk_bf16_f32 v104, v72, v73
    v_cvt_pk_bf16_f32 v105, v74, v75
    v_mfma_f32_32x32x16_bf16 a[48:63], v[64:67], v[112:115], a[48:63]
    v_exp_f32 v80, v80
    v_exp_f32 v81, v81
    v_exp_f32 v82, v82
    v_exp_f32 v83, v83
    v_cvt_pk_bf16_f32 v106, v76, v77
    v_cvt_pk_bf16_f32 v107, v78, v79
    v_mfma_f32_32x32x16_bf16 a[48:63], v[68:71], v[116:119], a[48:63]
    s_add_u32 m0, s81, 0
    s_mov_b64 exec, s[76:77]
    buffer_load_dwordx4 v7, s[24:27], s52 offen sc1 lds
    s_mov_b64 exec, -1
    s_add_u32 m0, s70, 0
    s_nop 0
    buffer_load_dwordx4 v126, s[24:27], s85 offen offset:2048 sc1 lds
    v_exp_f32 v84, v84
    v_exp_f32 v85, v85
    v_exp_f32 v86, v86
    v_exp_f32 v87, v87
    v_cvt_pk_bf16_f32 v108, v80, v81
    v_cvt_pk_bf16_f32 v109, v82, v83
    v_cvt_pk_bf16_f32 v110, v84, v85
    v_cvt_pk_bf16_f32 v111, v86, v87
    v_mfma_f32_32x32x16_bf16 v[72:87], v[44:47], v[32:35], 0
    v_exp_f32 v88, v88
    v_exp_f32 v89, v89
    v_exp_f32 v90, v90
    v_exp_f32 v91, v91
    v_mfma_f32_32x32x8_bf16 v[72:87], v[48:49], v[36:37], v[72:87]
    v_exp_f32 v92, v92
    v_exp_f32 v93, v93
    v_exp_f32 v94, v94
    v_exp_f32 v95, v95
    v_cvt_pk_bf16_f32 v112, v88, v89
    v_cvt_pk_bf16_f32 v113, v90, v91
    s_waitcnt lgkmcnt(2)
    v_mfma_f32_32x32x16_bf16 a[0:15], v[56:59], v[104:107], a[0:15]
    ds_read_b128 v[64:67], v4 offset:24960
    v_exp_f32 v96, v96
    v_exp_f32 v97, v97
    v_exp_f32 v98, v98
    v_exp_f32 v99, v99
    v_cvt_pk_bf16_f32 v114, v92, v93
    v_cvt_pk_bf16_f32 v115, v94, v95
    v_mfma_f32_32x32x16_bf16 a[0:15], v[60:63], v[108:111], a[0:15]
    s_add_u32 m0, s82, 0
    s_mov_b64 exec, s[78:79]
    buffer_load_dwordx4 v8, s[24:27], s52 offen sc1 lds
    s_mov_b64 exec, -1
    s_add_u32 m0, s70, 0
    s_nop 0
    buffer_load_dwordx4 v126, s[24:27], s85 offen offset:3072 sc1 lds
    v_exp_f32 v100, v100
    v_exp_f32 v101, v101
    v_exp_f32 v102, v102
    v_exp_f32 v103, v103
    v_cvt_pk_bf16_f32 v116, v96, v97
    v_cvt_pk_bf16_f32 v117, v98, v99
    v_cvt_pk_bf16_f32 v118, v100, v101
    v_cvt_pk_bf16_f32 v119, v102, v103
    v_mfma_f32_32x32x16_bf16 v[88:103], v[44:47], v[38:41], 0
    v_exp_f32 v72, v72
    v_exp_f32 v73, v73
    v_exp_f32 v74, v74
    v_exp_f32 v75, v75
    v_mfma_f32_32x32x8_bf16 v[88:103], v[48:49], v[42:43], v[88:103]
    v_exp_f32 v76, v76
    v_exp_f32 v77, v77
    v_exp_f32 v78, v78
    v_exp_f32 v79, v79
    v_cvt_pk_bf16_f32 v104, v72, v73
    v_cvt_pk_bf16_f32 v105, v74, v75
    v_mfma_f32_32x32x16_bf16 a[16:31], v[56:59], v[112:115], a[16:31]
    ds_read_b128 v[68:71], v4 offset:25664
    v_exp_f32 v80, v80
    v_exp_f32 v81, v81
    v_exp_f32 v82, v82
    v_exp_f32 v83, v83
    v_cvt_pk_bf16_f32 v106, v76, v77
    v_cvt_pk_bf16_f32 v107, v78, v79
    v_mfma_f32_32x32x16_bf16 a[16:31], v[60:63], v[116:119], a[16:31]
    s_add_u32 s50, s50, 4096
    s_add_u32 s51, s51, 2048
    s_add_u32 s52, s52, 5120
    s_add_u32 s85, s85, 4096
    s_add_u32 m0, s70, 4096
    s_nop 0
    buffer_load_dwordx4 v126, s[24:27], s85 offen offset:0 sc1 lds
    v_exp_f32 v84, v84
    v_exp_f32 v85, v85
    v_exp_f32 v86, v86
    v_exp_f32 v87, v87
    v_cvt_pk_bf16_f32 v108, v80, v81
    v_cvt_pk_bf16_f32 v109, v82, v83
    v_cvt_pk_bf16_f32 v110, v84, v85
    v_cvt_pk_bf16_f32 v111, v86, v87
    s_waitcnt lgkmcnt(2)
    v_mfma_f32_32x32x16_bf16 v[72:87], v[50:53], v[20:23], 0
    v_exp_f32 v88, v88
    v_exp_f32 v89, v89
    v_exp_f32 v90, v90
    v_exp_f32 v91, v91
    v_mfma_f32_32x32x8_bf16 v[72:87], v[54:55], v[24:25], v[72:87]
    v_exp_f32 v92, v92
    v_exp_f32 v93, v93
    v_exp_f32 v94, v94
    v_exp_f32 v95, v95
    v_cvt_pk_bf16_f32 v112, v88, v89
    v_cvt_pk_bf16_f32 v113, v90, v91
    v_mfma_f32_32x32x16_bf16 a[32:47], v[56:59], v[104:107], a[32:47]
    v_exp_f32 v96, v96
    v_exp_f32 v97, v97
    v_exp_f32 v98, v98
    v_exp_f32 v99, v99
    v_cvt_pk_bf16_f32 v114, v92, v93
    v_cvt_pk_bf16_f32 v115, v94, v95
    v_mfma_f32_32x32x16_bf16 a[32:47], v[60:63], v[108:111], a[32:47]
    s_add_u32 s85, s68, 5120
    s_add_u32 m0, s70, 5120
    s_nop 0
    buffer_load_dwordx4 v126, s[24:27], s85 offen offset:0 sc1 lds
    v_exp_f32 v100, v100
    v_exp_f32 v101, v101
    v_exp_f32 v102, v102
    v_exp_f32 v103, v103
    v_cvt_pk_bf16_f32 v116, v96, v97
    v_cvt_pk_bf16_f32 v117, v98, v99
    v_cvt_pk_bf16_f32 v118, v100, v101
    v_cvt_pk_bf16_f32 v119, v102, v103
    v_mfma_f32_32x32x16_bf16 v[88:103], v[50:53], v[26:29], 0
    ds_read_b128 v[44:47], v2 offset:25600
    v_exp_f32 v72, v72
    v_exp_f32 v73, v73
    v_exp_f32 v74, v74
    v_exp_f32 v75, v75
    v_mfma_f32_32x32x8_bf16 v[88:103], v[54:55], v[30:31], v[88:103]
    ds_read_b64 v[48:49], v3 offset:24576
    v_exp_f32 v76, v76
    v_exp_f32 v77, v77
    v_exp_f32 v78, v78
    v_exp_f32 v79, v79
    v_cvt_pk_bf16_f32 v104, v72, v73
    v_cvt_pk_bf16_f32 v105, v74, v75
    v_mfma_f32_32x32x16_bf16 a[48:63], v[56:59], v[112:115], a[48:63]
    v_exp_f32 v80, v80
    v_exp_f32 v81, v81
    v_exp_f32 v82, v82
    v_exp_f32 v83, v83
    v_cvt_pk_bf16_f32 v106, v76, v77
    v_cvt_pk_bf16_f32 v107, v78, v79
    v_mfma_f32_32x32x16_bf16 a[48:63], v[60:63], v[116:119], a[48:63]
    s_add_u32 m0, s70, 5120
    s_nop 0
    buffer_load_dwordx4 v126, s[24:27], s85 offen offset:1024 sc1 lds
    v_exp_f32 v84, v84
    v_exp_f32 v85, v85
    v_exp_f32 v86, v86
    v_exp_f32 v87, v87
    v_cvt_pk_bf16_f32 v108, v80, v81
    v_cvt_pk_bf16_f32 v109, v82, v83
    v_cvt_pk_bf16_f32 v110, v84, v85
    v_cvt_pk_bf16_f32 v111, v86, v87
    v_mfma_f32_32x32x16_bf16 v[72:87], v[50:53], v[32:35], 0
    v_exp_f32 v88, v88
    v_exp_f32 v89, v89
    v_exp_f32 v90, v90
    v_exp_f32 v91, v91
    v_mfma_f32_32x32x8_bf16 v[72:87], v[54:55], v[36:37], v[72:87]
    v_exp_f32 v92, v92
    v_exp_f32 v93, v93
    v_exp_f32 v94, v94
    v_exp_f32 v95, v95
    v_cvt_pk_bf16_f32 v112, v88, v89
    v_cvt_pk_bf16_f32 v113, v90, v91
    s_waitcnt lgkmcnt(2)
    v_mfma_f32_32x32x16_bf16 a[0:15], v[64:67], v[104:107], a[0:15]
    ds_read_b128 v[56:59], v4 offset:26368
    v_exp_f32 v96, v96
    v_exp_f32 v97, v97
    v_exp_f32 v98, v98
    v_exp_f32 v99, v99
    v_cvt_pk_bf16_f32 v114, v92, v93
    v_cvt_pk_bf16_f32 v115, v94, v95
    v_mfma_f32_32x32x16_bf16 a[0:15], v[68:71], v[108:111], a[0:15]
    s_add_u32 m0, s70, 5120
    s_nop 0
    buffer_load_dwordx4 v126, s[24:27], s85 offen offset:2048 sc1 lds
    v_exp_f32 v100, v100
    v_exp_f32 v101, v101
    v_exp_f32 v102, v102
    v_exp_f32 v103, v103
    v_cvt_pk_bf16_f32 v116, v96, v97
    v_cvt_pk_bf16_f32 v117, v98, v99
    v_cvt_pk_bf16_f32 v118, v100, v101
    v_cvt_pk_bf16_f32 v119, v102, v103
    v_mfma_f32_32x32x16_bf16 v[88:103], v[50:53], v[38:41], 0
    v_exp_f32 v72, v72
    v_exp_f32 v73, v73
    v_exp_f32 v74, v74
    v_exp_f32 v75, v75
    v_mfma_f32_32x32x8_bf16 v[88:103], v[54:55], v[42:43], v[88:103]
    v_exp_f32 v76, v76
    v_exp_f32 v77, v77
    v_exp_f32 v78, v78
    v_exp_f32 v79, v79
    v_cvt_pk_bf16_f32 v104, v72, v73
    v_cvt_pk_bf16_f32 v105, v74, v75
    v_mfma_f32_32x32x16_bf16 a[16:31], v[64:67], v[112:115], a[16:31]
    ds_read_b128 v[60:63], v4 offset:27072
    v_exp_f32 v80, v80
    v_exp_f32 v81, v81
    v_exp_f32 v82, v82
    v_exp_f32 v83, v83
    v_cvt_pk_bf16_f32 v106, v76, v77
    v_cvt_pk_bf16_f32 v107, v78, v79
    v_mfma_f32_32x32x16_bf16 a[16:31], v[68:71], v[116:119], a[16:31]
    s_add_u32 m0, s70, 5120
    s_nop 0
    buffer_load_dwordx4 v126, s[24:27], s85 offen offset:3072 sc1 lds
    v_exp_f32 v84, v84
    v_exp_f32 v85, v85
    v_exp_f32 v86, v86
    v_exp_f32 v87, v87
    v_cvt_pk_bf16_f32 v108, v80, v81
    v_cvt_pk_bf16_f32 v109, v82, v83
    v_cvt_pk_bf16_f32 v110, v84, v85
    v_cvt_pk_bf16_f32 v111, v86, v87
    s_waitcnt lgkmcnt(2)
    v_mfma_f32_32x32x16_bf16 v[72:87], v[44:47], v[20:23], 0
    v_exp_f32 v88, v88
    v_exp_f32 v89, v89
    v_exp_f32 v90, v90
    v_exp_f32 v91, v91
    v_mfma_f32_32x32x8_bf16 v[72:87], v[48:49], v[24:25], v[72:87]
    v_exp_f32 v92, v92
    v_exp_f32 v93, v93
    v_exp_f32 v94, v94
    v_exp_f32 v95, v95
    v_cvt_pk_bf16_f32 v112, v88, v89
    v_cvt_pk_bf16_f32 v113, v90, v91
    v_mfma_f32_32x32x16_bf16 a[32:47], v[64:67], v[104:107], a[32:47]
    v_exp_f32 v96, v96
    v_exp_f32 v97, v97
    v_exp_f32 v98, v98
    v_exp_f32 v99, v99
    v_cvt_pk_bf16_f32 v114, v92, v93
    v_cvt_pk_bf16_f32 v115, v94, v95
    v_mfma_f32_32x32x16_bf16 a[32:47], v[68:71], v[108:111], a[32:47]
    s_add_u32 s85, s85, 4096
    s_add_u32 m0, s70, 9216
    s_nop 0
    buffer_load_dwordx4 v126, s[24:27], s85 offen offset:0 sc1 lds
    v_exp_f32 v100, v100
    v_exp_f32 v101, v101
    v_exp_f32 v102, v102
    v_exp_f32 v103, v103
    v_cvt_pk_bf16_f32 v116, v96, v97
    v_cvt_pk_bf16_f32 v117, v98, v99
    v_cvt_pk_bf16_f32 v118, v100, v101
    v_cvt_pk_bf16_f32 v119, v102, v103
    v_mfma_f32_32x32x16_bf16 v[88:103], v[44:47], v[26:29], 0
    ds_read_b128 v[50:53], v2 offset:26624
    v_exp_f32 v72, v72
    v_exp_f32 v73, v73
    v_exp_f32 v74, v74
    v_exp_f32 v75, v75
    v_mfma_f32_32x32x8_bf16 v[88:103], v[48:49], v[30:31], v[88:103]
    ds_read_b64 v[54:55], v3 offset:25088
    v_exp_f32 v76, v76
    v_exp_f32 v77, v77
    v_exp_f32 v78, v78
    v_exp_f32 v79, v79
    v_cvt_pk_bf16_f32 v104, v72, v73
    v_cvt_pk_bf16_f32 v105, v74, v75
    v_mfma_f32_32x32x16_bf16 a[48:63], v[64:67], v[112:115], a[48:63]
    v_exp_f32 v80, v80
    v_exp_f32 v81, v81
    v_exp_f32 v82, v82
    v_exp_f32 v83, v83
    v_cvt_pk_bf16_f32 v106, v76, v77
    v_cvt_pk_bf16_f32 v107, v78, v79
    v_mfma_f32_32x32x16_bf16 a[48:63], v[68:71], v[116:119], a[48:63]
    s_add_u32 s85, s68, 10240
    s_add_u32 m0, s70, 10240
    s_nop 0
    buffer_load_dwordx4 v126, s[24:27], s85 offen offset:0 sc1 lds
    v_exp_f32 v84, v84
    v_exp_f32 v85, v85
    v_exp_f32 v86, v86
    v_exp_f32 v87, v87
    v_cvt_pk_bf16_f32 v108, v80, v81
    v_cvt_pk_bf16_f32 v109, v82, v83
    v_cvt_pk_bf16_f32 v110, v84, v85
    v_cvt_pk_bf16_f32 v111, v86, v87
    v_mfma_f32_32x32x16_bf16 v[72:87], v[44:47], v[32:35], 0
    v_exp_f32 v88, v88
    v_exp_f32 v89, v89
    v_exp_f32 v90, v90
    v_exp_f32 v91, v91
    v_mfma_f32_32x32x8_bf16 v[72:87], v[48:49], v[36:37], v[72:87]
    v_exp_f32 v92, v92
    v_exp_f32 v93, v93
    v_exp_f32 v94, v94
    v_exp_f32 v95, v95
    v_cvt_pk_bf16_f32 v112, v88, v89
    v_cvt_pk_bf16_f32 v113, v90, v91
    s_waitcnt lgkmcnt(2)
    v_mfma_f32_32x32x16_bf16 a[0:15], v[56:59], v[104:107], a[0:15]
    ds_read_b128 v[64:67], v4 offset:27776
    v_exp_f32 v96, v96
    v_exp_f32 v97, v97
    v_exp_f32 v98, v98
    v_exp_f32 v99, v99
    v_cvt_pk_bf16_f32 v114, v92, v93
    v_cvt_pk_bf16_f32 v115, v94, v95
    v_mfma_f32_32x32x16_bf16 a[0:15], v[60:63], v[108:111], a[0:15]
    s_add_u32 m0, s70, 10240
    s_nop 0
    buffer_load_dwordx4 v126, s[24:27], s85 offen offset:1024 sc1 lds
    v_exp_f32 v100, v100
    v_exp_f32 v101, v101
    v_exp_f32 v102, v102
    v_exp_f32 v103, v103
    v_cvt_pk_bf16_f32 v116, v96, v97
    v_cvt_pk_bf16_f32 v117, v98, v99
    v_cvt_pk_bf16_f32 v118, v100, v101
    v_cvt_pk_bf16_f32 v119, v102, v103
    v_mfma_f32_32x32x16_bf16 v[88:103], v[44:47], v[38:41], 0
    v_exp_f32 v72, v72
    v_exp_f32 v73, v73
    v_exp_f32 v74, v74
    v_exp_f32 v75, v75
    v_mfma_f32_32x32x8_bf16 v[88:103], v[48:49], v[42:43], v[88:103]
    v_exp_f32 v76, v76
    v_exp_f32 v77, v77
    v_exp_f32 v78, v78
    v_exp_f32 v79, v79
    v_cvt_pk_bf16_f32 v104, v72, v73
    v_cvt_pk_bf16_f32 v105, v74, v75
    v_mfma_f32_32x32x16_bf16 a[16:31], v[56:59], v[112:115], a[16:31]
    ds_read_b128 v[68:71], v4 offset:28480
    v_exp_f32 v80, v80
    v_exp_f32 v81, v81
    v_exp_f32 v82, v82
    v_exp_f32 v83, v83
    v_cvt_pk_bf16_f32 v106, v76, v77
    v_cvt_pk_bf16_f32 v107, v78, v79
    v_mfma_f32_32x32x16_bf16 a[16:31], v[60:63], v[116:119], a[16:31]
    s_add_u32 m0, s70, 10240
    s_nop 0
    buffer_load_dwordx4 v126, s[24:27], s85 offen offset:2048 sc1 lds
    v_exp_f32 v84, v84
    v_exp_f32 v85, v85
    v_exp_f32 v86, v86
    v_exp_f32 v87, v87
    v_cvt_pk_bf16_f32 v108, v80, v81
    v_cvt_pk_bf16_f32 v109, v82, v83
    v_cvt_pk_bf16_f32 v110, v84, v85
    v_cvt_pk_bf16_f32 v111, v86, v87
    s_waitcnt lgkmcnt(2)
    v_mfma_f32_32x32x16_bf16 v[72:87], v[50:53], v[20:23], 0
    v_exp_f32 v88, v88
    v_exp_f32 v89, v89
    v_exp_f32 v90, v90
    v_exp_f32 v91, v91
    v_mfma_f32_32x32x8_bf16 v[72:87], v[54:55], v[24:25], v[72:87]
    v_exp_f32 v92, v92
    v_exp_f32 v93, v93
    v_exp_f32 v94, v94
    v_exp_f32 v95, v95
    v_cvt_pk_bf16_f32 v112, v88, v89
    v_cvt_pk_bf16_f32 v113, v90, v91
    v_mfma_f32_32x32x16_bf16 a[32:47], v[56:59], v[104:107], a[32:47]
    v_exp_f32 v96, v96
    v_exp_f32 v97, v97
    v_exp_f32 v98, v98
    v_exp_f32 v99, v99
    v_cvt_pk_bf16_f32 v114, v92, v93
    v_cvt_pk_bf16_f32 v115, v94, v95
    v_mfma_f32_32x32x16_bf16 a[32:47], v[60:63], v[108:111], a[32:47]
    s_add_u32 m0, s70, 10240
    s_nop 0
    buffer_load_dwordx4 v126, s[24:27], s85 offen offset:3072 sc1 lds
    v_exp_f32 v100, v100
    v_exp_f32 v101, v101
    v_exp_f32 v102, v102
    v_exp_f32 v103, v103
    v_cvt_pk_bf16_f32 v116, v96, v97
    v_cvt_pk_bf16_f32 v117, v98, v99
    v_cvt_pk_bf16_f32 v118, v100, v101
    v_cvt_pk_bf16_f32 v119, v102, v103
    s_waitcnt vmcnt(11)
    s_waitcnt lgkmcnt(0)
    s_barrier
    v_mfma_f32_32x32x16_bf16 v[88:103], v[50:53], v[26:29], 0
    ds_read_b128 v[44:47], v2 offset:0
    v_exp_f32 v72, v72
    v_exp_f32 v73, v73
    v_exp_f32 v74, v74
    v_exp_f32 v75, v75
    v_mfma_f32_32x32x8_bf16 v[88:103], v[54:55], v[30:31], v[88:103]
    ds_read_b64 v[48:49], v3 offset:0
    v_exp_f32 v76, v76
    v_exp_f32 v77, v77
    v_exp_f32 v78, v78
    v_exp_f32 v79, v79
    v_cvt_pk_bf16_f32 v104, v72, v73
    v_cvt_pk_bf16_f32 v105, v74, v75
    v_mfma_f32_32x32x16_bf16 a[48:63], v[56:59], v[112:115], a[48:63]
    v_exp_f32 v80, v80
    v_exp_f32 v81, v81
    v_exp_f32 v82, v82
    v_exp_f32 v83, v83
    v_cvt_pk_bf16_f32 v106, v76, v77
    v_cvt_pk_bf16_f32 v107, v78, v79
    v_mfma_f32_32x32x16_bf16 a[48:63], v[60:63], v[116:119], a[48:63]
    s_add_u32 m0, s67, 23552
    s_nop 0
    buffer_load_dwordx4 v5, s[24:27], s50 offen sc1 lds
    s_add_u32 s85, s85, 4096
    s_add_u32 m0, s70, 14336
    s_nop 0
    buffer_load_dwordx4 v126, s[24:27], s85 offen offset:0 sc1 lds
    v_exp_f32 v84, v84
    v_exp_f32 v85, v85
    v_exp_f32 v86, v86
    v_exp_f32 v87, v87
    v_cvt_pk_bf16_f32 v108, v80, v81
    v_cvt_pk_bf16_f32 v109, v82, v83
    v_cvt_pk_bf16_f32 v110, v84, v85
    v_cvt_pk_bf16_f32 v111, v86, v87
    v_mfma_f32_32x32x16_bf16 v[72:87], v[50:53], v[32:35], 0
    v_exp_f32 v88, v88
    v_exp_f32 v89, v89
    v_exp_f32 v90, v90
    v_exp_f32 v91, v91
    v_mfma_f32_32x32x8_bf16 v[72:87], v[54:55], v[36:37], v[72:87]
    v_exp_f32 v92, v92
    v_exp_f32 v93, v93
    v_exp_f32 v94, v94
    v_exp_f32 v95, v95
    v_cvt_pk_bf16_f32 v112, v88, v89
    v_cvt_pk_bf16_f32 v113, v90, v91
    v_mfma_f32_32x32x16_bf16 a[0:15], v[64:67], v[104:107], a[0:15]
    ds_read_b128 v[56:59], v4 offset:0
    v_exp_f32 v96, v96
    v_exp_f32 v97, v97
    v_exp_f32 v98, v98
    v_exp_f32 v99, v99
    v_cvt_pk_bf16_f32 v114, v92, v93
    v_cvt_pk_bf16_f32 v115, v94, v95
    v_mfma_f32_32x32x16_bf16 a[0:15], v[68:71], v[108:111], a[0:15]
    s_add_u32 m0, s67, 23552
    s_nop 0
    buffer_load_dwordx4 v5, s[24:27], s50 offen offset:1024 sc1 lds
    s_add_u32 s85, s68, 15360
    s_add_u32 m0, s70, 15360
    s_nop 0
    buffer_load_dwordx4 v126, s[24:27], s85 offen offset:0 sc1 lds
    v_exp_f32 v100, v100
    v_exp_f32 v101, v101
    v_exp_f32 v102, v102
    v_exp_f32 v103, v103
    v_cvt_pk_bf16_f32 v116, v96, v97
    v_cvt_pk_bf16_f32 v117, v98, v99
    v_cvt_pk_bf16_f32 v118, v100, v101
    v_cvt_pk_bf16_f32 v119, v102, v103
    v_mfma_f32_32x32x16_bf16 v[88:103], v[50:53], v[38:41], 0
    v_exp_f32 v72, v72
    v_exp_f32 v73, v73
    v_exp_f32 v74, v74
    v_exp_f32 v75, v75
    v_mfma_f32_32x32x8_bf16 v[88:103], v[54:55], v[42:43], v[88:103]
    v_exp_f32 v76, v76
    v_exp_f32 v77, v77
    v_exp_f32 v78, v78
    v_exp_f32 v79, v79
    v_cvt_pk_bf16_f32 v104, v72, v73
    v_cvt_pk_bf16_f32 v105, v74, v75
    v_mfma_f32_32x32x16_bf16 a[16:31], v[64:67], v[112:115], a[16:31]
    ds_read_b128 v[60:63], v4 offset:704
    v_exp_f32 v80, v80
    v_exp_f32 v81, v81
    v_exp_f32 v82, v82
    v_exp_f32 v83, v83
    v_cvt_pk_bf16_f32 v106, v76, v77
    v_cvt_pk_bf16_f32 v107, v78, v79
    v_mfma_f32_32x32x16_bf16 a[16:31], v[68:71], v[116:119], a[16:31]
    s_add_u32 m0, s71, 23552
    s_nop 0
    buffer_load_dwordx4 v5, s[24:27], s51 offen sc1 lds
    s_add_u32 m0, s70, 15360
    s_nop 0
    buffer_load_dwordx4 v126, s[24:27], s85 offen offset:1024 sc1 lds
    v_exp_f32 v84, v84
    v_exp_f32 v85, v85
    v_exp_f32 v86, v86
    v_exp_f32 v87, v87
    v_cvt_pk_bf16_f32 v108, v80, v81
    v_cvt_pk_bf16_f32 v109, v82, v83
    v_cvt_pk_bf16_f32 v110, v84, v85
    v_cvt_pk_bf16_f32 v111, v86, v87
    s_waitcnt lgkmcnt(2)
    v_mfma_f32_32x32x16_bf16 v[72:87], v[44:47], v[20:23], 0
    v_exp_f32 v88, v88
    v_exp_f32 v89, v89
    v_exp_f32 v90, v90
    v_exp_f32 v91, v91
    v_mfma_f32_32x32x8_bf16 v[72:87], v[48:49], v[24:25], v[72:87]
    v_exp_f32 v92, v92
    v_exp_f32 v93, v93
    v_exp_f32 v94, v94
    v_exp_f32 v95, v95
    v_cvt_pk_bf16_f32 v112, v88, v89
    v_cvt_pk_bf16_f32 v113, v90, v91
    v_mfma_f32_32x32x16_bf16 a[32:47], v[64:67], v[104:107], a[32:47]
    v_exp_f32 v96, v96
    v_exp_f32 v97, v97
    v_exp_f32 v98, v98
    v_exp_f32 v99, v99
    v_cvt_pk_bf16_f32 v114, v92, v93
    v_cvt_pk_bf16_f32 v115, v94, v95
    v_mfma_f32_32x32x16_bf16 a[32:47], v[68:71], v[108:111], a[32:47]
    s_add_u32 m0, s80, 23552
    s_mov_b64 exec, s[74:75]
    buffer_load_dwordx4 v6, s[24:27], s52 offen sc1 lds
    s_mov_b64 exec, -1
    s_add_u32 m0, s70, 15360
    s_nop 0
    buffer_load_dwordx4 v126, s[24:27], s85 offen offset:2048 sc1 lds
    v_exp_f32 v100, v100
    v_exp_f32 v101, v101
    v_exp_f32 v102, v102
    v_exp_f32 v103, v103
    v_cvt_pk_bf16_f32 v116, v96, v97
    v_cvt_pk_bf16_f32 v117, v98, v99
    v_cvt_pk_bf16_f32 v118, v100, v101
    v_cvt_pk_bf16_f32 v119, v102, v103
    v_mfma_f32_32x32x16_bf16 v[88:103], v[44:47], v[26:29], 0
    ds_read_b128 v[50:53], v2 offset:1024
    v_exp_f32 v72, v72
    v_exp_f32 v73, v73
    v_exp_f32 v74, v74
    v_exp_f32 v75, v75
    v_mfma_f32_32x32x8_bf16 v[88:103], v[48:49], v[30:31], v[88:103]
    ds_read_b64 v[54:55], v3 offset:512
    v_exp_f32 v76, v76
    v_exp_f32 v77, v77
    v_exp_f32 v78, v78
    v_exp_f32 v79, v79
    v_cvt_pk_bf16_f32 v104, v72, v73
    v_cvt_pk_bf16_f32 v105, v74, v75
    v_mfma_f32_32x32x16_bf16 a[48:63], v[64:67], v[112:115], a[48:63]
    v_exp_f32 v80, v80
    v_exp_f32 v81, v81
    v_exp_f32 v82, v82
    v_exp_f32 v83, v83
    v_cvt_pk_bf16_f32 v106, v76, v77
    v_cvt_pk_bf16_f32 v107, v78, v79
    v_mfma_f32_32x32x16_bf16 a[48:63], v[68:71], v[116:119], a[48:63]
    s_add_u32 m0, s81, 23552
    s_mov_b64 exec, s[76:77]
    buffer_load_dwordx4 v7, s[24:27], s52 offen sc1 lds
    s_mov_b64 exec, -1
    s_add_u32 m0, s70, 15360
    s_nop 0
    buffer_load_dwordx4 v126, s[24:27], s85 offen offset:3072 sc1 lds
    v_exp_f32 v84, v84
    v_exp_f32 v85, v85
    v_exp_f32 v86, v86
    v_exp_f32 v87, v87
    v_cvt_pk_bf16_f32 v108, v80, v81
    v_cvt_pk_bf16_f32 v109, v82, v83
    v_cvt_pk_bf16_f32 v110, v84, v85
    v_cvt_pk_bf16_f32 v111, v86, v87
    v_mfma_f32_32x32x16_bf16 v[72:87], v[44:47], v[32:35], 0
    v_exp_f32 v88, v88
    v_exp_f32 v89, v89
    v_exp_f32 v90, v90
    v_exp_f32 v91, v91
    v_mfma_f32_32x32x8_bf16 v[72:87], v[48:49], v[36:37], v[72:87]
    v_exp_f32 v92, v92
    v_exp_f32 v93, v93
    v_exp_f32 v94, v94
    v_exp_f32 v95, v95
    v_cvt_pk_bf16_f32 v112, v88, v89
    v_cvt_pk_bf16_f32 v113, v90, v91
    s_waitcnt lgkmcnt(2)
    v_mfma_f32_32x32x16_bf16 a[0:15], v[56:59], v[104:107], a[0:15]
    ds_read_b128 v[64:67], v4 offset:1408
    v_exp_f32 v96, v96
    v_exp_f32 v97, v97
    v_exp_f32 v98, v98
    v_exp_f32 v99, v99
    v_cvt_pk_bf16_f32 v114, v92, v93
    v_cvt_pk_bf16_f32 v115, v94, v95
    v_mfma_f32_32x32x16_bf16 a[0:15], v[60:63], v[108:111], a[0:15]
    s_add_u32 m0, s82, 23552
    s_mov_b64 exec, s[78:79]
    buffer_load_dwordx4 v8, s[24:27], s52 offen sc1 lds
    s_mov_b64 exec, -1
    s_add_u32 s85, s85, 4096
    s_add_u32 m0, s70, 19456
    s_nop 0
    buffer_load_dwordx4 v126, s[24:27], s85 offen offset:0 sc1 lds
    v_exp_f32 v100, v100
    v_exp_f32 v101, v101
    v_exp_f32 v102, v102
    v_exp_f32 v103, v103
    v_cvt_pk_bf16_f32 v116, v96, v97
    v_cvt_pk_bf16_f32 v117, v98, v99
    v_cvt_pk_bf16_f32 v118, v100, v101
    v_cvt_pk_bf16_f32 v119, v102, v103
    v_mfma_f32_32x32x16_bf16 v[88:103], v[44:47], v[38:41], 0
    v_exp_f32 v72, v72
    v_exp_f32 v73, v73
    v_exp_f32 v74, v74
    v_exp_f32 v75, v75
    v_mfma_f32_32x32x8_bf16 v[88:103], v[48:49], v[42:43], v[88:103]
    v_exp_f32 v76, v76
    v_exp_f32 v77, v77
    v_exp_f32 v78, v78
    v_exp_f32 v79, v79
    v_cvt_pk_bf16_f32 v104, v72, v73
    v_cvt_pk_bf16_f32 v105, v74, v75
    v_mfma_f32_32x32x16_bf16 a[16:31], v[56:59], v[112:115], a[16:31]
    ds_read_b128 v[68:71], v4 offset:2112
    v_exp_f32 v80, v80
    v_exp_f32 v81, v81
    v_exp_f32 v82, v82
    v_exp_f32 v83, v83
    v_cvt_pk_bf16_f32 v106, v76, v77
    v_cvt_pk_bf16_f32 v107, v78, v79
    v_mfma_f32_32x32x16_bf16 a[16:31], v[60:63], v[116:119], a[16:31]
    s_add_u32 s50, s50, 4096
    s_add_u32 s51, s51, 2048
    s_add_u32 s52, s52, 5120
    s_add_u32 s85, s68, 20480
    s_add_u32 m0, s70, 20480
    s_nop 0
    buffer_load_dwordx4 v126, s[24:27], s85 offen offset:0 sc1 lds
    v_exp_f32 v84, v84
    v_exp_f32 v85, v85
    v_exp_f32 v86, v86
    v_exp_f32 v87, v87
    v_cvt_pk_bf16_f32 v108, v80, v81
    v_cvt_pk_bf16_f32 v109, v82, v83
    v_cvt_pk_bf16_f32 v110, v84, v85
    v_cvt_pk_bf16_f32 v111, v86, v87
    s_waitcnt lgkmcnt(2)
    v_mfma_f32_32x32x16_bf16 v[72:87], v[50:53], v[20:23], 0
    v_exp_f32 v88, v88
    v_exp_f32 v89, v89
    v_exp_f32 v90, v90
    v_exp_f32 v91, v91
    v_mfma_f32_32x32x8_bf16 v[72:87], v[54:55], v[24:25], v[72:87]
    v_exp_f32 v92, v92
    v_exp_f32 v93, v93
    v_exp_f32 v94, v94
    v_exp_f32 v95, v95
    v_cvt_pk_bf16_f32 v112, v88, v89
    v_cvt_pk_bf16_f32 v113, v90, v91
    v_mfma_f32_32x32x16_bf16 a[32:47], v[56:59], v[104:107], a[32:47]
    v_exp_f32 v96, v96
    v_exp_f32 v97, v97
    v_exp_f32 v98, v98
    v_exp_f32 v99, v99
    v_cvt_pk_bf16_f32 v114, v92, v93
    v_cvt_pk_bf16_f32 v115, v94, v95
    v_mfma_f32_32x32x16_bf16 a[32:47], v[60:63], v[108:111], a[32:47]
    s_add_u32 m0, s70, 20480
    s_nop 0
    buffer_load_dwordx4 v126, s[24:27], s85 offen offset:1024 sc1 lds
    v_exp_f32 v100, v100
    v_exp_f32 v101, v101
    v_exp_f32 v102, v102
    v_exp_f32 v103, v103
    v_cvt_pk_bf16_f32 v116, v96, v97
    v_cvt_pk_bf16_f32 v117, v98, v99
    v_cvt_pk_bf16_f32 v118, v100, v101
    v_cvt_pk_bf16_f32 v119, v102, v103
    v_mfma_f32_32x32x16_bf16 v[88:103], v[50:53], v[26:29], 0
    ds_read_b128 v[44:47], v2 offset:2048
    v_exp_f32 v72, v72
    v_exp_f32 v73, v73
    v_exp_f32 v74, v74
    v_exp_f32 v75, v75
    v_mfma_f32_32x32x8_bf16 v[88:103], v[54:55], v[30:31], v[88:103]
    ds_read_b64 v[48:49], v3 offset:1024
    v_exp_f32 v76, v76
    v_exp_f32 v77, v77
    v_exp_f32 v78, v78
    v_exp_f32 v79, v79
    v_cvt_pk_bf16_f32 v104, v72, v73
    v_cvt_pk_bf16_f32 v105, v74, v75
    v_mfma_f32_32x32x16_bf16 a[48:63], v[56:59], v[112:115], a[48:63]
    v_exp_f32 v80, v80
    v_exp_f32 v81, v81
    v_exp_f32 v82, v82
    v_exp_f32 v83, v83
    v_cvt_pk_bf16_f32 v106, v76, v77
    v_cvt_pk_bf16_f32 v107, v78, v79
    v_mfma_f32_32x32x16_bf16 a[48:63], v[60:63], v[116:119], a[48:63]
    s_add_u32 m0, s70, 20480
    s_nop 0
    buffer_load_dwordx4 v126, s[24:27], s85 offen offset:2048 sc1 lds
    v_exp_f32 v84, v84
    v_exp_f32 v85, v85
    v_exp_f32 v86, v86
    v_exp_f32 v87, v87
    v_cvt_pk_bf16_f32 v108, v80, v81
    v_cvt_pk_bf16_f32 v109, v82, v83
    v_cvt_pk_bf16_f32 v110, v84, v85
    v_cvt_pk_bf16_f32 v111, v86, v87
    v_mfma_f32_32x32x16_bf16 v[72:87], v[50:53], v[32:35], 0
    v_exp_f32 v88, v88
    v_exp_f32 v89, v89
    v_exp_f32 v90, v90
    v_exp_f32 v91, v91
    v_mfma_f32_32x32x8_bf16 v[72:87], v[54:55], v[36:37], v[72:87]
    v_exp_f32 v92, v92
    v_exp_f32 v93, v93
    v_exp_f32 v94, v94
    v_exp_f32 v95, v95
    v_cvt_pk_bf16_f32 v112, v88, v89
    v_cvt_pk_bf16_f32 v113, v90, v91
    s_waitcnt lgkmcnt(2)
    v_mfma_f32_32x32x16_bf16 a[0:15], v[64:67], v[104:107], a[0:15]
    ds_read_b128 v[56:59], v4 offset:2816
    v_exp_f32 v96, v96
    v_exp_f32 v97, v97
    v_exp_f32 v98, v98
    v_exp_f32 v99, v99
    v_cvt_pk_bf16_f32 v114, v92, v93
    v_cvt_pk_bf16_f32 v115, v94, v95
    v_mfma_f32_32x32x16_bf16 a[0:15], v[68:71], v[108:111], a[0:15]
    s_add_u32 m0, s70, 20480
    s_nop 0
    buffer_load_dwordx4 v126, s[24:27], s85 offen offset:3072 sc1 lds
    v_exp_f32 v100, v100
    v_exp_f32 v101, v101
    v_exp_f32 v102, v102
    v_exp_f32 v103, v103
    v_cvt_pk_bf16_f32 v116, v96, v97
    v_cvt_pk_bf16_f32 v117, v98, v99
    v_cvt_pk_bf16_f32 v118, v100, v101
    v_cvt_pk_bf16_f32 v119, v102, v103
    v_mfma_f32_32x32x16_bf16 v[88:103], v[50:53], v[38:41], 0
    v_exp_f32 v72, v72
    v_exp_f32 v73, v73
    v_exp_f32 v74, v74
    v_exp_f32 v75, v75
    v_mfma_f32_32x32x8_bf16 v[88:103], v[54:55], v[42:43], v[88:103]
    v_exp_f32 v76, v76
    v_exp_f32 v77, v77
    v_exp_f32 v78, v78
    v_exp_f32 v79, v79
    v_cvt_pk_bf16_f32 v104, v72, v73
    v_cvt_pk_bf16_f32 v105, v74, v75
    v_mfma_f32_32x32x16_bf16 a[16:31], v[64:67], v[112:115], a[16:31]
    ds_read_b128 v[60:63], v4 offset:3520
    v_exp_f32 v80, v80
    v_exp_f32 v81, v81
    v_exp_f32 v82, v82
    v_exp_f32 v83, v83
    v_cvt_pk_bf16_f32 v106, v76, v77
    v_cvt_pk_bf16_f32 v107, v78, v79
    v_mfma_f32_32x32x16_bf16 a[16:31], v[68:71], v[116:119], a[16:31]
    s_add_u32 s85, s85, 4096
    s_add_u32 m0, s70, 24576
    s_nop 0
    buffer_load_dwordx4 v126, s[24:27], s85 offen offset:0 sc1 lds
    v_exp_f32 v84, v84
    v_exp_f32 v85, v85
    v_exp_f32 v86, v86
    v_exp_f32 v87, v87
    v_cvt_pk_bf16_f32 v108, v80, v81
    v_cvt_pk_bf16_f32 v109, v82, v83
    v_cvt_pk_bf16_f32 v110, v84, v85
    v_cvt_pk_bf16_f32 v111, v86, v87
    s_waitcnt lgkmcnt(2)
    v_mfma_f32_32x32x16_bf16 v[72:87], v[44:47], v[20:23], 0
    v_exp_f32 v88, v88
    v_exp_f32 v89, v89
    v_exp_f32 v90, v90
    v_exp_f32 v91, v91
    v_mfma_f32_32x32x8_bf16 v[72:87], v[48:49], v[24:25], v[72:87]
    v_exp_f32 v92, v92
    v_exp_f32 v93, v93
    v_exp_f32 v94, v94
    v_exp_f32 v95, v95
    v_cvt_pk_bf16_f32 v112, v88, v89
    v_cvt_pk_bf16_f32 v113, v90, v91
    v_mfma_f32_32x32x16_bf16 a[32:47], v[64:67], v[104:107], a[32:47]
    v_exp_f32 v96, v96
    v_exp_f32 v97, v97
    v_exp_f32 v98, v98
    v_exp_f32 v99, v99
    v_cvt_pk_bf16_f32 v114, v92, v93
    v_cvt_pk_bf16_f32 v115, v94, v95
    v_mfma_f32_32x32x16_bf16 a[32:47], v[68:71], v[108:111], a[32:47]
    s_lshr_b32 s85, s41, 3
    s_and_b32 s85, s85, 7
    s_mul_i32 s85, s85, 340
    s_mul_i32 s101, s40, 85
    s_add_u32 s85, s85, s101
    s_add_u32 s85, s85, 0
    s_lshl_b32 s85, s85, 7
    s_mul_i32 s101, s43, 348160
    s_add_u32 s85, s85, s101
    s_add_u32 s85, s85, 20971520
    v_lshrrev_b32 v246, 4, v126
    v_lshlrev_b32 v246, 7, v246
    buffer_load_dword v127, v246, s[24:27], s85 offen sc1
    v_exp_f32 v100, v100
    v_exp_f32 v101, v101
    v_exp_f32 v102, v102
    v_exp_f32 v103, v103
    v_cvt_pk_bf16_f32 v116, v96, v97
    v_cvt_pk_bf16_f32 v117, v98, v99
    v_cvt_pk_bf16_f32 v118, v100, v101
    v_cvt_pk_bf16_f32 v119, v102, v103
    v_mfma_f32_32x32x16_bf16 v[88:103], v[44:47], v[26:29], 0
    ds_read_b128 v[50:53], v2 offset:3072
    v_exp_f32 v72, v72
    v_exp_f32 v73, v73
    v_exp_f32 v74, v74
    v_exp_f32 v75, v75
    v_mfma_f32_32x32x8_bf16 v[88:103], v[48:49], v[30:31], v[88:103]
    ds_read_b64 v[54:55], v3 offset:1536
    v_exp_f32 v76, v76
    v_exp_f32 v77, v77
    v_exp_f32 v78, v78
    v_exp_f32 v79, v79
    v_cvt_pk_bf16_f32 v104, v72, v73
    v_cvt_pk_bf16_f32 v105, v74, v75
    v_mfma_f32_32x32x16_bf16 a[48:63], v[64:67], v[112:115], a[48:63]
    v_exp_f32 v80, v80
    v_exp_f32 v81, v81
    v_exp_f32 v82, v82
    v_exp_f32 v83, v83
    v_cvt_pk_bf16_f32 v106, v76, v77
    v_cvt_pk_bf16_f32 v107, v78, v79
    v_mfma_f32_32x32x16_bf16 a[48:63], v[68:71], v[116:119], a[48:63]
    s_lshr_b32 s85, s41, 3
    s_and_b32 s85, s85, 7
    s_mul_i32 s85, s85, 340
    s_mul_i32 s101, s40, 85
    s_add_u32 s85, s85, s101
    s_add_u32 s85, s85, 64
    s_lshl_b32 s85, s85, 7
    s_mul_i32 s101, s43, 348160
    s_add_u32 s85, s85, s101
    s_add_u32 s85, s85, 20971520
    v_lshrrev_b32 v246, 4, v126
    v_min_u32 v246, 20, v246
    v_lshlrev_b32 v246, 7, v246
    buffer_load_dword v127, v246, s[24:27], s85 offen sc1
    v_exp_f32 v84, v84
    v_exp_f32 v85, v85
    v_exp_f32 v86, v86
    v_exp_f32 v87, v87
    v_cvt_pk_bf16_f32 v108, v80, v81
    v_cvt_pk_bf16_f32 v109, v82, v83
    v_cvt_pk_bf16_f32 v110, v84, v85
    v_cvt_pk_bf16_f32 v111, v86, v87
    v_mfma_f32_32x32x16_bf16 v[72:87], v[44:47], v[32:35], 0
    v_exp_f32 v88, v88
    v_exp_f32 v89, v89
    v_exp_f32 v90, v90
    v_exp_f32 v91, v91
    v_mfma_f32_32x32x8_bf16 v[72:87], v[48:49], v[36:37], v[72:87]
    v_exp_f32 v92, v92
    v_exp_f32 v93, v93
    v_exp_f32 v94, v94
    v_exp_f32 v95, v95
    v_cvt_pk_bf16_f32 v112, v88, v89
    v_cvt_pk_bf16_f32 v113, v90, v91
    s_waitcnt lgkmcnt(2)
    v_mfma_f32_32x32x16_bf16 a[0:15], v[56:59], v[104:107], a[0:15]
    ds_read_b128 v[64:67], v4 offset:4224
    v_exp_f32 v96, v96
    v_exp_f32 v97, v97
    v_exp_f32 v98, v98
    v_exp_f32 v99, v99
    v_cvt_pk_bf16_f32 v114, v92, v93
    v_cvt_pk_bf16_f32 v115, v94, v95
    v_mfma_f32_32x32x16_bf16 a[0:15], v[60:63], v[108:111], a[0:15]
    v_exp_f32 v100, v100
    v_exp_f32 v101, v101
    v_exp_f32 v102, v102
    v_exp_f32 v103, v103
    v_cvt_pk_bf16_f32 v116, v96, v97
    v_cvt_pk_bf16_f32 v117, v98, v99
    v_cvt_pk_bf16_f32 v118, v100, v101
    v_cvt_pk_bf16_f32 v119, v102, v103
    v_mfma_f32_32x32x16_bf16 v[88:103], v[44:47], v[38:41], 0
    v_exp_f32 v72, v72
    v_exp_f32 v73, v73
    v_exp_f32 v74, v74
    v_exp_f32 v75, v75
    v_mfma_f32_32x32x8_bf16 v[88:103], v[48:49], v[42:43], v[88:103]
    v_exp_f32 v76, v76
    v_exp_f32 v77, v77
    v_exp_f32 v78, v78
    v_exp_f32 v79, v79
    v_cvt_pk_bf16_f32 v104, v72, v73
    v_cvt_pk_bf16_f32 v105, v74, v75
    v_mfma_f32_32x32x16_bf16 a[16:31], v[56:59], v[112:115], a[16:31]
    ds_read_b128 v[68:71], v4 offset:4928
    v_exp_f32 v80, v80
    v_exp_f32 v81, v81
    v_exp_f32 v82, v82
    v_exp_f32 v83, v83
    v_cvt_pk_bf16_f32 v106, v76, v77
    v_cvt_pk_bf16_f32 v107, v78, v79
    v_mfma_f32_32x32x16_bf16 a[16:31], v[60:63], v[116:119], a[16:31]
    v_exp_f32 v84, v84
    v_exp_f32 v85, v85
    v_exp_f32 v86, v86
    v_exp_f32 v87, v87
    v_cvt_pk_bf16_f32 v108, v80, v81
    v_cvt_pk_bf16_f32 v109, v82, v83
    v_cvt_pk_bf16_f32 v110, v84, v85
    v_cvt_pk_bf16_f32 v111, v86, v87
    s_waitcnt lgkmcnt(2)
    v_mfma_f32_32x32x16_bf16 v[72:87], v[50:53], v[20:23], 0
    v_exp_f32 v88, v88
    v_exp_f32 v89, v89
    v_exp_f32 v90, v90
    v_exp_f32 v91, v91
    v_mfma_f32_32x32x8_bf16 v[72:87], v[54:55], v[24:25], v[72:87]
    v_exp_f32 v92, v92
    v_exp_f32 v93, v93
    v_exp_f32 v94, v94
    v_exp_f32 v95, v95
    v_cvt_pk_bf16_f32 v112, v88, v89
    v_cvt_pk_bf16_f32 v113, v90, v91
    v_mfma_f32_32x32x16_bf16 a[32:47], v[56:59], v[104:107], a[32:47]
    v_exp_f32 v96, v96
    v_exp_f32 v97, v97
    v_exp_f32 v98, v98
    v_exp_f32 v99, v99
    v_cvt_pk_bf16_f32 v114, v92, v93
    v_cvt_pk_bf16_f32 v115, v94, v95
    v_mfma_f32_32x32x16_bf16 a[32:47], v[60:63], v[108:111], a[32:47]
    v_exp_f32 v100, v100
    v_exp_f32 v101, v101
    v_exp_f32 v102, v102
    v_exp_f32 v103, v103
    v_cvt_pk_bf16_f32 v116, v96, v97
    v_cvt_pk_bf16_f32 v117, v98, v99
    v_cvt_pk_bf16_f32 v118, v100, v101
    v_cvt_pk_bf16_f32 v119, v102, v103
    s_waitcnt vmcnt(8)
    s_waitcnt lgkmcnt(0)
    s_barrier
    v_mfma_f32_32x32x16_bf16 v[88:103], v[50:53], v[26:29], 0
    ds_read_b128 v[44:47], v2 offset:23552
    v_exp_f32 v72, v72
    v_exp_f32 v73, v73
    v_exp_f32 v74, v74
    v_exp_f32 v75, v75
    v_mfma_f32_32x32x8_bf16 v[88:103], v[54:55], v[30:31], v[88:103]
    ds_read_b64 v[48:49], v3 offset:23552
    v_exp_f32 v76, v76
    v_exp_f32 v77, v77
    v_exp_f32 v78, v78
    v_exp_f32 v79, v79
    v_cvt_pk_bf16_f32 v104, v72, v73
    v_cvt_pk_bf16_f32 v105, v74, v75
    v_mfma_f32_32x32x16_bf16 a[48:63], v[56:59], v[112:115], a[48:63]
    v_exp_f32 v80, v80
    v_exp_f32 v81, v81
    v_exp_f32 v82, v82
    v_exp_f32 v83, v83
    v_cvt_pk_bf16_f32 v106, v76, v77
    v_cvt_pk_bf16_f32 v107, v78, v79
    v_mfma_f32_32x32x16_bf16 a[48:63], v[60:63], v[116:119], a[48:63]
    v_exp_f32 v84, v84
    v_exp_f32 v85, v85
    v_exp_f32 v86, v86
    v_exp_f32 v87, v87
    v_cvt_pk_bf16_f32 v108, v80, v81
    v_cvt_pk_bf16_f32 v109, v82, v83
    v_cvt_pk_bf16_f32 v110, v84, v85
    v_cvt_pk_bf16_f32 v111, v86, v87
    v_mfma_f32_32x32x16_bf16 v[72:87], v[50:53], v[32:35], 0
    v_exp_f32 v88, v88
    v_exp_f32 v89, v89
    v_exp_f32 v90, v90
    v_exp_f32 v91, v91
    v_mfma_f32_32x32x8_bf16 v[72:87], v[54:55], v[36:37], v[72:87]
    v_exp_f32 v92, v92
    v_exp_f32 v93, v93
    v_exp_f32 v94, v94
    v_exp_f32 v95, v95
    v_cvt_pk_bf16_f32 v112, v88, v89
    v_cvt_pk_bf16_f32 v113, v90, v91
    v_mfma_f32_32x32x16_bf16 a[0:15], v[64:67], v[104:107], a[0:15]
    ds_read_b128 v[56:59], v4 offset:23552
    v_exp_f32 v96, v96
    v_exp_f32 v97, v97
    v_exp_f32 v98, v98
    v_exp_f32 v99, v99
    v_cvt_pk_bf16_f32 v114, v92, v93
    v_cvt_pk_bf16_f32 v115, v94, v95
    v_mfma_f32_32x32x16_bf16 a[0:15], v[68:71], v[108:111], a[0:15]
    v_exp_f32 v100, v100
    v_exp_f32 v101, v101
    v_exp_f32 v102, v102
    v_exp_f32 v103, v103
    v_cvt_pk_bf16_f32 v116, v96, v97
    v_cvt_pk_bf16_f32 v117, v98, v99
    v_cvt_pk_bf16_f32 v118, v100, v101
    v_cvt_pk_bf16_f32 v119, v102, v103
    v_mfma_f32_32x32x16_bf16 v[88:103], v[50:53], v[38:41], 0
    v_exp_f32 v72, v72
    v_exp_f32 v73, v73
    v_exp_f32 v74, v74
    v_exp_f32 v75, v75
    v_mfma_f32_32x32x8_bf16 v[88:103], v[54:55], v[42:43], v[88:103]
    v_exp_f32 v76, v76
    v_exp_f32 v77, v77
    v_exp_f32 v78, v78
    v_exp_f32 v79, v79
    v_cvt_pk_bf16_f32 v104, v72, v73
    v_cvt_pk_bf16_f32 v105, v74, v75
    v_mfma_f32_32x32x16_bf16 a[16:31], v[64:67], v[112:115], a[16:31]
    ds_read_b128 v[60:63], v4 offset:24256
    v_exp_f32 v80, v80
    v_exp_f32 v81, v81
    v_exp_f32 v82, v82
    v_exp_f32 v83, v83
    v_cvt_pk_bf16_f32 v106, v76, v77
    v_cvt_pk_bf16_f32 v107, v78, v79
    v_mfma_f32_32x32x16_bf16 a[16:31], v[68:71], v[116:119], a[16:31]
    v_exp_f32 v84, v84
    v_exp_f32 v85, v85
    v_exp_f32 v86, v86
    v_exp_f32 v87, v87
    v_cvt_pk_bf16_f32 v108, v80, v81
    v_cvt_pk_bf16_f32 v109, v82, v83
    v_cvt_pk_bf16_f32 v110, v84, v85
    v_cvt_pk_bf16_f32 v111, v86, v87
    s_waitcnt lgkmcnt(2)
    v_mfma_f32_32x32x16_bf16 v[72:87], v[44:47], v[20:23], 0
    v_exp_f32 v88, v88
    v_exp_f32 v89, v89
    v_exp_f32 v90, v90
    v_exp_f32 v91, v91
    v_mfma_f32_32x32x8_bf16 v[72:87], v[48:49], v[24:25], v[72:87]
    v_exp_f32 v92, v92
    v_exp_f32 v93, v93
    v_exp_f32 v94, v94
    v_exp_f32 v95, v95
    v_cvt_pk_bf16_f32 v112, v88, v89
    v_cvt_pk_bf16_f32 v113, v90, v91
    v_mfma_f32_32x32x16_bf16 a[32:47], v[64:67], v[104:107], a[32:47]
    v_exp_f32 v96, v96
    v_exp_f32 v97, v97
    v_exp_f32 v98, v98
    v_exp_f32 v99, v99
    v_cvt_pk_bf16_f32 v114, v92, v93
    v_cvt_pk_bf16_f32 v115, v94, v95
    v_mfma_f32_32x32x16_bf16 a[32:47], v[68:71], v[108:111], a[32:47]
    v_exp_f32 v100, v100
    v_exp_f32 v101, v101
    v_exp_f32 v102, v102
    v_exp_f32 v103, v103
    v_cvt_pk_bf16_f32 v116, v96, v97
    v_cvt_pk_bf16_f32 v117, v98, v99
    v_cvt_pk_bf16_f32 v118, v100, v101
    v_cvt_pk_bf16_f32 v119, v102, v103
    v_mfma_f32_32x32x16_bf16 v[88:103], v[44:47], v[26:29], 0
    ds_read_b128 v[50:53], v2 offset:24576
    v_exp_f32 v72, v72
    v_exp_f32 v73, v73
    v_exp_f32 v74, v74
    v_exp_f32 v75, v75
    v_mfma_f32_32x32x8_bf16 v[88:103], v[48:49], v[30:31], v[88:103]
    ds_read_b64 v[54:55], v3 offset:24064
    v_exp_f32 v76, v76
    v_exp_f32 v77, v77
    v_exp_f32 v78, v78
    v_exp_f32 v79, v79
    v_cvt_pk_bf16_f32 v104, v72, v73
    v_cvt_pk_bf16_f32 v105, v74, v75
    v_mfma_f32_32x32x16_bf16 a[48:63], v[64:67], v[112:115], a[48:63]
    v_exp_f32 v80, v80
    v_exp_f32 v81, v81
    v_exp_f32 v82, v82
    v_exp_f32 v83, v83
    v_cvt_pk_bf16_f32 v106, v76, v77
    v_cvt_pk_bf16_f32 v107, v78, v79
    v_mfma_f32_32x32x16_bf16 a[48:63], v[68:71], v[116:119], a[48:63]
    v_exp_f32 v84, v84
    v_exp_f32 v85, v85
    v_exp_f32 v86, v86
    v_exp_f32 v87, v87
    v_cvt_pk_bf16_f32 v108, v80, v81
    v_cvt_pk_bf16_f32 v109, v82, v83
    v_cvt_pk_bf16_f32 v110, v84, v85
    v_cvt_pk_bf16_f32 v111, v86, v87
    v_mfma_f32_32x32x16_bf16 v[72:87], v[44:47], v[32:35], 0
    v_exp_f32 v88, v88
    v_exp_f32 v89, v89
    v_exp_f32 v90, v90
    v_exp_f32 v91, v91
    v_mfma_f32_32x32x8_bf16 v[72:87], v[48:49], v[36:37], v[72:87]
    v_exp_f32 v92, v92
    v_exp_f32 v93, v93
    v_exp_f32 v94, v94
    v_exp_f32 v95, v95
    v_cvt_pk_bf16_f32 v112, v88, v89
    v_cvt_pk_bf16_f32 v113, v90, v91
    s_waitcnt lgkmcnt(2)
    v_mfma_f32_32x32x16_bf16 a[0:15], v[56:59], v[104:107], a[0:15]
    ds_read_b128 v[64:67], v4 offset:24960
    v_exp_f32 v96, v96
    v_exp_f32 v97, v97
    v_exp_f32 v98, v98
    v_exp_f32 v99, v99
    v_cvt_pk_bf16_f32 v114, v92, v93
    v_cvt_pk_bf16_f32 v115, v94, v95
    v_mfma_f32_32x32x16_bf16 a[0:15], v[60:63], v[108:111], a[0:15]
    v_exp_f32 v100, v100
    v_exp_f32 v101, v101
    v_exp_f32 v102, v102
    v_exp_f32 v103, v103
    v_cvt_pk_bf16_f32 v116, v96, v97
    v_cvt_pk_bf16_f32 v117, v98, v99
    v_cvt_pk_bf16_f32 v118, v100, v101
    v_cvt_pk_bf16_f32 v119, v102, v103
    v_mfma_f32_32x32x16_bf16 v[88:103], v[44:47], v[38:41], 0
    v_exp_f32 v72, v72
    v_exp_f32 v73, v73
    v_exp_f32 v74, v74
    v_exp_f32 v75, v75
    v_mfma_f32_32x32x8_bf16 v[88:103], v[48:49], v[42:43], v[88:103]
    v_exp_f32 v76, v76
    v_exp_f32 v77, v77
    v_exp_f32 v78, v78
    v_exp_f32 v79, v79
    v_cvt_pk_bf16_f32 v104, v72, v73
    v_cvt_pk_bf16_f32 v105, v74, v75
    v_mfma_f32_32x32x16_bf16 a[16:31], v[56:59], v[112:115], a[16:31]
    ds_read_b128 v[68:71], v4 offset:25664
    v_exp_f32 v80, v80
    v_exp_f32 v81, v81
    v_exp_f32 v82, v82
    v_exp_f32 v83, v83
    v_cvt_pk_bf16_f32 v106, v76, v77
    v_cvt_pk_bf16_f32 v107, v78, v79
    v_mfma_f32_32x32x16_bf16 a[16:31], v[60:63], v[116:119], a[16:31]
    v_exp_f32 v84, v84
    v_exp_f32 v85, v85
    v_exp_f32 v86, v86
    v_exp_f32 v87, v87
    v_cvt_pk_bf16_f32 v108, v80, v81
    v_cvt_pk_bf16_f32 v109, v82, v83
    v_cvt_pk_bf16_f32 v110, v84, v85
    v_cvt_pk_bf16_f32 v111, v86, v87
    s_waitcnt lgkmcnt(2)
    v_mfma_f32_32x32x16_bf16 v[72:87], v[50:53], v[20:23], 0
    v_exp_f32 v88, v88
    v_exp_f32 v89, v89
    v_exp_f32 v90, v90
    v_exp_f32 v91, v91
    v_mfma_f32_32x32x8_bf16 v[72:87], v[54:55], v[24:25], v[72:87]
    v_exp_f32 v92, v92
    v_exp_f32 v93, v93
    v_exp_f32 v94, v94
    v_exp_f32 v95, v95
    v_cvt_pk_bf16_f32 v112, v88, v89
    v_cvt_pk_bf16_f32 v113, v90, v91
    v_mfma_f32_32x32x16_bf16 a[32:47], v[56:59], v[104:107], a[32:47]
    v_exp_f32 v96, v96
    v_exp_f32 v97, v97
    v_exp_f32 v98, v98
    v_exp_f32 v99, v99
    v_cvt_pk_bf16_f32 v114, v92, v93
    v_cvt_pk_bf16_f32 v115, v94, v95
    v_mfma_f32_32x32x16_bf16 a[32:47], v[60:63], v[108:111], a[32:47]
    v_exp_f32 v100, v100
    v_exp_f32 v101, v101
    v_exp_f32 v102, v102
    v_exp_f32 v103, v103
    v_cvt_pk_bf16_f32 v116, v96, v97
    v_cvt_pk_bf16_f32 v117, v98, v99
    v_cvt_pk_bf16_f32 v118, v100, v101
    v_cvt_pk_bf16_f32 v119, v102, v103
    v_mfma_f32_32x32x16_bf16 v[88:103], v[50:53], v[26:29], 0
    ds_read_b128 v[44:47], v2 offset:25600
    v_exp_f32 v72, v72
    v_exp_f32 v73, v73
    v_exp_f32 v74, v74
    v_exp_f32 v75, v75
    v_mfma_f32_32x32x8_bf16 v[88:103], v[54:55], v[30:31], v[88:103]
    ds_read_b64 v[48:49], v3 offset:24576
    v_exp_f32 v76, v76
    v_exp_f32 v77, v77
    v_exp_f32 v78, v78
    v_exp_f32 v79, v79
    v_cvt_pk_bf16_f32 v104, v72, v73
    v_cvt_pk_bf16_f32 v105, v74, v75
    v_mfma_f32_32x32x16_bf16 a[48:63], v[56:59], v[112:115], a[48:63]
    v_exp_f32 v80, v80
    v_exp_f32 v81, v81
    v_exp_f32 v82, v82
    v_exp_f32 v83, v83
    v_cvt_pk_bf16_f32 v106, v76, v77
    v_cvt_pk_bf16_f32 v107, v78, v79
    v_mfma_f32_32x32x16_bf16 a[48:63], v[60:63], v[116:119], a[48:63]
    v_exp_f32 v84, v84
    v_exp_f32 v85, v85
    v_exp_f32 v86, v86
    v_exp_f32 v87, v87
    v_cvt_pk_bf16_f32 v108, v80, v81
    v_cvt_pk_bf16_f32 v109, v82, v83
    v_cvt_pk_bf16_f32 v110, v84, v85
    v_cvt_pk_bf16_f32 v111, v86, v87
    v_mfma_f32_32x32x16_bf16 v[72:87], v[50:53], v[32:35], 0
    v_exp_f32 v88, v88
    v_exp_f32 v89, v89
    v_exp_f32 v90, v90
    v_exp_f32 v91, v91
    v_mfma_f32_32x32x8_bf16 v[72:87], v[54:55], v[36:37], v[72:87]
    v_exp_f32 v92, v92
    v_exp_f32 v93, v93
    v_exp_f32 v94, v94
    v_exp_f32 v95, v95
    v_cvt_pk_bf16_f32 v112, v88, v89
    v_cvt_pk_bf16_f32 v113, v90, v91
    s_waitcnt lgkmcnt(2)
    v_mfma_f32_32x32x16_bf16 a[0:15], v[64:67], v[104:107], a[0:15]
    ds_read_b128 v[56:59], v4 offset:26368
    v_exp_f32 v96, v96
    v_exp_f32 v97, v97
    v_exp_f32 v98, v98
    v_exp_f32 v99, v99
    v_cvt_pk_bf16_f32 v114, v92, v93
    v_cvt_pk_bf16_f32 v115, v94, v95
    v_mfma_f32_32x32x16_bf16 a[0:15], v[68:71], v[108:111], a[0:15]
    v_exp_f32 v100, v100
    v_exp_f32 v101, v101
    v_exp_f32 v102, v102
    v_exp_f32 v103, v103
    v_cvt_pk_bf16_f32 v116, v96, v97
    v_cvt_pk_bf16_f32 v117, v98, v99
    v_cvt_pk_bf16_f32 v118, v100, v101
    v_cvt_pk_bf16_f32 v119, v102, v103
    v_mfma_f32_32x32x16_bf16 v[88:103], v[50:53], v[38:41], 0
    v_exp_f32 v72, v72
    v_exp_f32 v73, v73
    v_exp_f32 v74, v74
    v_exp_f32 v75, v75
    v_mfma_f32_32x32x8_bf16 v[88:103], v[54:55], v[42:43], v[88:103]
    v_exp_f32 v76, v76
    v_exp_f32 v77, v77
    v_exp_f32 v78, v78
    v_exp_f32 v79, v79
    v_cvt_pk_bf16_f32 v104, v72, v73
    v_cvt_pk_bf16_f32 v105, v74, v75
    v_mfma_f32_32x32x16_bf16 a[16:31], v[64:67], v[112:115], a[16:31]
    ds_read_b128 v[60:63], v4 offset:27072
    v_exp_f32 v80, v80
    v_exp_f32 v81, v81
    v_exp_f32 v82, v82
    v_exp_f32 v83, v83
    v_cvt_pk_bf16_f32 v106, v76, v77
    v_cvt_pk_bf16_f32 v107, v78, v79
    v_mfma_f32_32x32x16_bf16 a[16:31], v[68:71], v[116:119], a[16:31]
    v_exp_f32 v84, v84
    v_exp_f32 v85, v85
    v_exp_f32 v86, v86
    v_exp_f32 v87, v87
    v_cvt_pk_bf16_f32 v108, v80, v81
    v_cvt_pk_bf16_f32 v109, v82, v83
    v_cvt_pk_bf16_f32 v110, v84, v85
    v_cvt_pk_bf16_f32 v111, v86, v87
    s_waitcnt lgkmcnt(2)
    v_mfma_f32_32x32x16_bf16 v[72:87], v[44:47], v[20:23], 0
    v_exp_f32 v88, v88
    v_exp_f32 v89, v89
    v_exp_f32 v90, v90
    v_exp_f32 v91, v91
    v_mfma_f32_32x32x8_bf16 v[72:87], v[48:49], v[24:25], v[72:87]
    v_exp_f32 v92, v92
    v_exp_f32 v93, v93
    v_exp_f32 v94, v94
    v_exp_f32 v95, v95
    v_cvt_pk_bf16_f32 v112, v88, v89
    v_cvt_pk_bf16_f32 v113, v90, v91
    v_mfma_f32_32x32x16_bf16 a[32:47], v[64:67], v[104:107], a[32:47]
    v_exp_f32 v96, v96
    v_exp_f32 v97, v97
    v_exp_f32 v98, v98
    v_exp_f32 v99, v99
    v_cvt_pk_bf16_f32 v114, v92, v93
    v_cvt_pk_bf16_f32 v115, v94, v95
    v_mfma_f32_32x32x16_bf16 a[32:47], v[68:71], v[108:111], a[32:47]
    v_exp_f32 v100, v100
    v_exp_f32 v101, v101
    v_exp_f32 v102, v102
    v_exp_f32 v103, v103
    v_cvt_pk_bf16_f32 v116, v96, v97
    v_cvt_pk_bf16_f32 v117, v98, v99
    v_cvt_pk_bf16_f32 v118, v100, v101
    v_cvt_pk_bf16_f32 v119, v102, v103
    v_mfma_f32_32x32x16_bf16 v[88:103], v[44:47], v[26:29], 0
    ds_read_b128 v[50:53], v2 offset:26624
    v_exp_f32 v72, v72
    v_exp_f32 v73, v73
    v_exp_f32 v74, v74
    v_exp_f32 v75, v75
    v_mfma_f32_32x32x8_bf16 v[88:103], v[48:49], v[30:31], v[88:103]
    ds_read_b64 v[54:55], v3 offset:25088
    v_exp_f32 v76, v76
    v_exp_f32 v77, v77
    v_exp_f32 v78, v78
    v_exp_f32 v79, v79
    v_cvt_pk_bf16_f32 v104, v72, v73
    v_cvt_pk_bf16_f32 v105, v74, v75
    v_mfma_f32_32x32x16_bf16 a[48:63], v[64:67], v[112:115], a[48:63]
    v_exp_f32 v80, v80
    v_exp_f32 v81, v81
    v_exp_f32 v82, v82
    v_exp_f32 v83, v83
    v_cvt_pk_bf16_f32 v106, v76, v77
    v_cvt_pk_bf16_f32 v107, v78, v79
    v_mfma_f32_32x32x16_bf16 a[48:63], v[68:71], v[116:119], a[48:63]
    v_exp_f32 v84, v84
    v_exp_f32 v85, v85
    v_exp_f32 v86, v86
    v_exp_f32 v87, v87
    v_cvt_pk_bf16_f32 v108, v80, v81
    v_cvt_pk_bf16_f32 v109, v82, v83
    v_cvt_pk_bf16_f32 v110, v84, v85
    v_cvt_pk_bf16_f32 v111, v86, v87
    v_mfma_f32_32x32x16_bf16 v[72:87], v[44:47], v[32:35], 0
    v_exp_f32 v88, v88
    v_exp_f32 v89, v89
    v_exp_f32 v90, v90
    v_exp_f32 v91, v91
    v_mfma_f32_32x32x8_bf16 v[72:87], v[48:49], v[36:37], v[72:87]
    v_exp_f32 v92, v92
    v_exp_f32 v93, v93
    v_exp_f32 v94, v94
    v_exp_f32 v95, v95
    v_cvt_pk_bf16_f32 v112, v88, v89
    v_cvt_pk_bf16_f32 v113, v90, v91
    s_waitcnt lgkmcnt(2)
    v_mfma_f32_32x32x16_bf16 a[0:15], v[56:59], v[104:107], a[0:15]
    ds_read_b128 v[64:67], v4 offset:27776
    v_exp_f32 v96, v96
    v_exp_f32 v97, v97
    v_exp_f32 v98, v98
    v_exp_f32 v99, v99
    v_cvt_pk_bf16_f32 v114, v92, v93
    v_cvt_pk_bf16_f32 v115, v94, v95
    v_mfma_f32_32x32x16_bf16 a[0:15], v[60:63], v[108:111], a[0:15]
    v_exp_f32 v100, v100
    v_exp_f32 v101, v101
    v_exp_f32 v102, v102
    v_exp_f32 v103, v103
    v_cvt_pk_bf16_f32 v116, v96, v97
    v_cvt_pk_bf16_f32 v117, v98, v99
    v_cvt_pk_bf16_f32 v118, v100, v101
    v_cvt_pk_bf16_f32 v119, v102, v103
    v_mfma_f32_32x32x16_bf16 v[88:103], v[44:47], v[38:41], 0
    v_exp_f32 v72, v72
    v_exp_f32 v73, v73
    v_exp_f32 v74, v74
    v_exp_f32 v75, v75
    v_mfma_f32_32x32x8_bf16 v[88:103], v[48:49], v[42:43], v[88:103]
    v_exp_f32 v76, v76
    v_exp_f32 v77, v77
    v_exp_f32 v78, v78
    v_exp_f32 v79, v79
    v_cvt_pk_bf16_f32 v104, v72, v73
    v_cvt_pk_bf16_f32 v105, v74, v75
    v_mfma_f32_32x32x16_bf16 a[16:31], v[56:59], v[112:115], a[16:31]
    ds_read_b128 v[68:71], v4 offset:28480
    v_exp_f32 v80, v80
    v_exp_f32 v81, v81
    v_exp_f32 v82, v82
    v_exp_f32 v83, v83
    v_cvt_pk_bf16_f32 v106, v76, v77
    v_cvt_pk_bf16_f32 v107, v78, v79
    v_mfma_f32_32x32x16_bf16 a[16:31], v[60:63], v[116:119], a[16:31]
    v_exp_f32 v84, v84
    v_exp_f32 v85, v85
    v_exp_f32 v86, v86
    v_exp_f32 v87, v87
    v_cvt_pk_bf16_f32 v108, v80, v81
    v_cvt_pk_bf16_f32 v109, v82, v83
    v_cvt_pk_bf16_f32 v110, v84, v85
    v_cvt_pk_bf16_f32 v111, v86, v87
    s_waitcnt lgkmcnt(2)
    v_mfma_f32_32x32x16_bf16 v[72:87], v[50:53], v[20:23], 0
    v_exp_f32 v88, v88
    v_exp_f32 v89, v89
    v_exp_f32 v90, v90
    v_exp_f32 v91, v91
    v_mfma_f32_32x32x8_bf16 v[72:87], v[54:55], v[24:25], v[72:87]
    v_exp_f32 v92, v92
    v_exp_f32 v93, v93
    v_exp_f32 v94, v94
    v_exp_f32 v95, v95
    v_cvt_pk_bf16_f32 v112, v88, v89
    v_cvt_pk_bf16_f32 v113, v90, v91
    v_mfma_f32_32x32x16_bf16 a[32:47], v[56:59], v[104:107], a[32:47]
    v_exp_f32 v96, v96
    v_exp_f32 v97, v97
    v_exp_f32 v98, v98
    v_exp_f32 v99, v99
    v_cvt_pk_bf16_f32 v114, v92, v93
    v_cvt_pk_bf16_f32 v115, v94, v95
    v_mfma_f32_32x32x16_bf16 a[32:47], v[60:63], v[108:111], a[32:47]
    v_exp_f32 v100, v100
    v_exp_f32 v101, v101
    v_exp_f32 v102, v102
    v_exp_f32 v103, v103
    v_cvt_pk_bf16_f32 v116, v96, v97
    v_cvt_pk_bf16_f32 v117, v98, v99
    v_cvt_pk_bf16_f32 v118, v100, v101
    v_cvt_pk_bf16_f32 v119, v102, v103
    v_mfma_f32_32x32x16_bf16 v[88:103], v[50:53], v[26:29], 0
    v_exp_f32 v72, v72
    v_exp_f32 v73, v73
    v_exp_f32 v74, v74
    v_exp_f32 v75, v75
    v_mfma_f32_32x32x8_bf16 v[88:103], v[54:55], v[30:31], v[88:103]
    v_exp_f32 v76, v76
    v_exp_f32 v77, v77
    v_exp_f32 v78, v78
    v_exp_f32 v79, v79
    v_cvt_pk_bf16_f32 v104, v72, v73
    v_cvt_pk_bf16_f32 v105, v74, v75
    v_mfma_f32_32x32x16_bf16 a[48:63], v[56:59], v[112:115], a[48:63]
    v_exp_f32 v80, v80
    v_exp_f32 v81, v81
    v_exp_f32 v82, v82
    v_exp_f32 v83, v83
    v_cvt_pk_bf16_f32 v106, v76, v77
    v_cvt_pk_bf16_f32 v107, v78, v79
    v_mfma_f32_32x32x16_bf16 a[48:63], v[60:63], v[116:119], a[48:63]
    v_exp_f32 v84, v84
    v_exp_f32 v85, v85
    v_exp_f32 v86, v86
    v_exp_f32 v87, v87
    v_cvt_pk_bf16_f32 v108, v80, v81
    v_cvt_pk_bf16_f32 v109, v82, v83
    v_cvt_pk_bf16_f32 v110, v84, v85
    v_cvt_pk_bf16_f32 v111, v86, v87
    v_mfma_f32_32x32x16_bf16 v[72:87], v[50:53], v[32:35], 0
    v_exp_f32 v88, v88
    v_exp_f32 v89, v89
    v_exp_f32 v90, v90
    v_exp_f32 v91, v91
    v_mfma_f32_32x32x8_bf16 v[72:87], v[54:55], v[36:37], v[72:87]
    v_exp_f32 v92, v92
    v_exp_f32 v93, v93
    v_exp_f32 v94, v94
    v_exp_f32 v95, v95
    v_cvt_pk_bf16_f32 v112, v88, v89
    v_cvt_pk_bf16_f32 v113, v90, v91
    s_waitcnt lgkmcnt(0)
    v_mfma_f32_32x32x16_bf16 a[0:15], v[64:67], v[104:107], a[0:15]
    v_exp_f32 v96, v96
    v_exp_f32 v97, v97
    v_exp_f32 v98, v98
    v_exp_f32 v99, v99
    v_cvt_pk_bf16_f32 v114, v92, v93
    v_cvt_pk_bf16_f32 v115, v94, v95
    v_mfma_f32_32x32x16_bf16 a[0:15], v[68:71], v[108:111], a[0:15]
    v_exp_f32 v100, v100
    v_exp_f32 v101, v101
    v_exp_f32 v102, v102
    v_exp_f32 v103, v103
    v_cvt_pk_bf16_f32 v116, v96, v97
    v_cvt_pk_bf16_f32 v117, v98, v99
    v_cvt_pk_bf16_f32 v118, v100, v101
    v_cvt_pk_bf16_f32 v119, v102, v103
    v_mfma_f32_32x32x16_bf16 v[88:103], v[50:53], v[38:41], 0
    v_exp_f32 v72, v72
    v_exp_f32 v73, v73
    v_exp_f32 v74, v74
    v_exp_f32 v75, v75
    v_mfma_f32_32x32x8_bf16 v[88:103], v[54:55], v[42:43], v[88:103]
    v_exp_f32 v76, v76
    v_exp_f32 v77, v77
    v_exp_f32 v78, v78
    v_exp_f32 v79, v79
    v_cvt_pk_bf16_f32 v104, v72, v73
    v_cvt_pk_bf16_f32 v105, v74, v75
    v_mfma_f32_32x32x16_bf16 a[16:31], v[64:67], v[112:115], a[16:31]
    v_exp_f32 v80, v80
    v_exp_f32 v81, v81
    v_exp_f32 v82, v82
    v_exp_f32 v83, v83
    v_cvt_pk_bf16_f32 v106, v76, v77
    v_cvt_pk_bf16_f32 v107, v78, v79
    v_mfma_f32_32x32x16_bf16 a[16:31], v[68:71], v[116:119], a[16:31]
    v_exp_f32 v84, v84
    v_exp_f32 v85, v85
    v_exp_f32 v86, v86
    v_exp_f32 v87, v87
    v_cvt_pk_bf16_f32 v108, v80, v81
    v_cvt_pk_bf16_f32 v109, v82, v83
    v_cvt_pk_bf16_f32 v110, v84, v85
    v_cvt_pk_bf16_f32 v111, v86, v87
    v_exp_f32 v88, v88
    v_exp_f32 v89, v89
    v_exp_f32 v90, v90
    v_exp_f32 v91, v91
    v_exp_f32 v92, v92
    v_exp_f32 v93, v93
    v_exp_f32 v94, v94
    v_exp_f32 v95, v95
    v_cvt_pk_bf16_f32 v112, v88, v89
    v_cvt_pk_bf16_f32 v113, v90, v91
    v_mfma_f32_32x32x16_bf16 a[32:47], v[64:67], v[104:107], a[32:47]
    v_exp_f32 v96, v96
    v_exp_f32 v97, v97
    v_exp_f32 v98, v98
    v_exp_f32 v99, v99
    v_cvt_pk_bf16_f32 v114, v92, v93
    v_cvt_pk_bf16_f32 v115, v94, v95
    v_mfma_f32_32x32x16_bf16 a[32:47], v[68:71], v[108:111], a[32:47]
    v_exp_f32 v100, v100
    v_exp_f32 v101, v101
    v_exp_f32 v102, v102
    v_exp_f32 v103, v103
    v_cvt_pk_bf16_f32 v116, v96, v97
    v_cvt_pk_bf16_f32 v117, v98, v99
    v_cvt_pk_bf16_f32 v118, v100, v101
    v_cvt_pk_bf16_f32 v119, v102, v103
    s_nop 1
    v_mfma_f32_32x32x16_bf16 a[48:63], v[64:67], v[112:115], a[48:63]
    v_mfma_f32_32x32x16_bf16 a[48:63], v[68:71], v[116:119], a[48:63]
    s_nop 7
    s_nop 3
    s_cmp_eq_u32 s49, 1
    s_cbranch_scc1 L_kh1_77
    ds_write_b128 v131, a[32:35] offset:0
    ds_write_b128 v131, a[36:39] offset:1024
    ds_write_b128 v131, a[40:43] offset:2048
    ds_write_b128 v131, a[48:51] offset:3072
    ds_write_b128 v131, a[52:55] offset:4096
    ds_write_b128 v131, a[56:59] offset:5120
    v_accvgpr_read_b32 v72, a0
    v_accvgpr_read_b32 v73, a1
    v_accvgpr_read_b32 v74, a2
    v_accvgpr_read_b32 v75, a3
    v_accvgpr_read_b32 v76, a4
    v_accvgpr_read_b32 v77, a5
    v_accvgpr_read_b32 v78, a6
    v_accvgpr_read_b32 v79, a7
    v_accvgpr_read_b32 v80, a8
    v_accvgpr_read_b32 v81, a9
    v_accvgpr_read_b32 v82, a10
    v_accvgpr_read_b32 v83, a11
    v_accvgpr_read_b32 v84, a16
    v_accvgpr_read_b32 v85, a17
    v_accvgpr_read_b32 v86, a18
    v_accvgpr_read_b32 v87, a19
    v_accvgpr_read_b32 v88, a20
    v_accvgpr_read_b32 v89, a21
    v_accvgpr_read_b32 v90, a22
    v_accvgpr_read_b32 v91, a23
    v_accvgpr_read_b32 v92, a24
    v_accvgpr_read_b32 v93, a25
    v_accvgpr_read_b32 v94, a26
    v_accvgpr_read_b32 v95, a27
    s_branch L_khj_78
L_kh1_77:
    ds_write_b128 v131, a[0:3] offset:0
    ds_write_b128 v131, a[4:7] offset:1024
    ds_write_b128 v131, a[8:11] offset:2048
    ds_write_b128 v131, a[16:19] offset:3072
    ds_write_b128 v131, a[20:23] offset:4096
    ds_write_b128 v131, a[24:27] offset:5120
    v_accvgpr_read_b32 v72, a32
    v_accvgpr_read_b32 v73, a33
    v_accvgpr_read_b32 v74, a34
    v_accvgpr_read_b32 v75, a35
    v_accvgpr_read_b32 v76, a36
    v_accvgpr_read_b32 v77, a37
    v_accvgpr_read_b32 v78, a38
    v_accvgpr_read_b32 v79, a39
    v_accvgpr_read_b32 v80, a40
    v_accvgpr_read_b32 v81, a41
    v_accvgpr_read_b32 v82, a42
    v_accvgpr_read_b32 v83, a43
    v_accvgpr_read_b32 v84, a48
    v_accvgpr_read_b32 v85, a49
    v_accvgpr_read_b32 v86, a50
    v_accvgpr_read_b32 v87, a51
    v_accvgpr_read_b32 v88, a52
    v_accvgpr_read_b32 v89, a53
    v_accvgpr_read_b32 v90, a54
    v_accvgpr_read_b32 v91, a55
    v_accvgpr_read_b32 v92, a56
    v_accvgpr_read_b32 v93, a57
    v_accvgpr_read_b32 v94, a58
    v_accvgpr_read_b32 v95, a59
L_khj_78:
    s_waitcnt lgkmcnt(0)
    s_barrier
    ds_read_b128 v[144:147], v132 offset:0
    ds_read_b128 v[148:151], v132 offset:1024
    ds_read_b128 v[152:155], v132 offset:2048
    ds_read_b128 v[156:159], v132 offset:3072
    ds_read_b128 v[160:163], v132 offset:4096
    ds_read_b128 v[164:167], v132 offset:5120
    s_waitcnt lgkmcnt(0)
    v_pk_add_f32 v[72:73], v[72:73], v[144:145]
    v_pk_add_f32 v[74:75], v[74:75], v[146:147]
    v_pk_add_f32 v[76:77], v[76:77], v[148:149]
    v_pk_add_f32 v[78:79], v[78:79], v[150:151]
    v_pk_add_f32 v[80:81], v[80:81], v[152:153]
    v_pk_add_f32 v[82:83], v[82:83], v[154:155]
    v_pk_add_f32 v[84:85], v[84:85], v[156:157]
    v_pk_add_f32 v[86:87], v[86:87], v[158:159]
    v_pk_add_f32 v[88:89], v[88:89], v[160:161]
    v_pk_add_f32 v[90:91], v[90:91], v[162:163]
    v_pk_add_f32 v[92:93], v[92:93], v[164:165]
    v_pk_add_f32 v[94:95], v[94:95], v[166:167]
    v_mov_b32 v214, v80
    v_mov_b32 v212, v80
    v_mov_b32 v215, v92
    v_mov_b32 v213, v92
    s_nop 0
    v_permlane32_swap_b32 v214, v212
    v_permlane32_swap_b32 v215, v213
    v_mov_b32 v216, 0
    v_mov_b32 v217, 0
    v_mov_b32 v218, 0
    v_mov_b32 v219, 0
    v_pk_fma_f32 v[216:217], v[72:73], v[218:219], v[216:217]
    v_pk_fma_f32 v[216:217], v[74:75], v[218:219], v[216:217]
    v_pk_fma_f32 v[216:217], v[76:77], v[218:219], v[216:217]
    v_pk_fma_f32 v[216:217], v[78:79], v[218:219], v[216:217]
    v_pk_fma_f32 v[216:217], v[80:81], v[218:219], v[216:217]
    v_pk_fma_f32 v[216:217], v[82:83], v[218:219], v[216:217]
    v_pk_fma_f32 v[216:217], v[84:85], v[218:219], v[216:217]
    v_pk_fma_f32 v[216:217], v[86:87], v[218:219], v[216:217]
    v_pk_fma_f32 v[216:217], v[88:89], v[218:219], v[216:217]
    v_pk_fma_f32 v[216:217], v[90:91], v[218:219], v[216:217]
    v_pk_fma_f32 v[216:217], v[92:93], v[218:219], v[216:217]
    v_pk_fma_f32 v[216:217], v[94:95], v[218:219], v[216:217]
    v_mov_b32 v218, 0x1f800000
    v_mov_b32 v219, 0x5f800000
    v_cmp_u_f32 s[58:59], v216, v217
    v_cmp_nge_f32 vcc, v212, v218
    s_or_b64 s[58:59], s[58:59], vcc
    v_cmp_nle_f32 vcc, v212, v219
    s_or_b64 s[58:59], s[58:59], vcc
    v_cmp_nge_f32 vcc, v213, v218
    s_or_b64 s[58:59], s[58:59], vcc
    v_cmp_nle_f32 vcc, v213, v219
    s_or_b64 s[58:59], s[58:59], vcc
    s_cmp_eq_u64 s[58:59], 0
    s_cbranch_scc1 L_novote_79
    v_mov_b32 v216, 149504
    v_mov_b32 v217, 1
    ds_write_b32 v216, v217
L_novote_79:
    v_rcp_f32 v212, v212
    v_rcp_f32 v213, v213
    s_nop 0
    v_mul_f32 v212, v212, v9
    v_mul_f32 v213, v213, v10
    v_pk_mul_f32 v[72:73], v[72:73], v[212:213] op_sel_hi:[1,0]
    v_pk_mul_f32 v[74:75], v[74:75], v[212:213] op_sel_hi:[1,0]
    v_cvt_pk_bf16_f32 v224, v72, v73
    v_cvt_pk_bf16_f32 v225, v74, v75
    v_pk_mul_f32 v[76:77], v[76:77], v[212:213] op_sel_hi:[1,0]
    v_pk_mul_f32 v[78:79], v[78:79], v[212:213] op_sel_hi:[1,0]
    v_cvt_pk_bf16_f32 v226, v76, v77
    v_cvt_pk_bf16_f32 v227, v78, v79
    v_pk_mul_f32 v[80:81], v[80:81], v[212:213] op_sel_hi:[1,0]
    v_pk_mul_f32 v[82:83], v[82:83], v[212:213] op_sel_hi:[1,0]
    v_cvt_pk_bf16_f32 v228, v80, v81
    v_cvt_pk_bf16_f32 v229, v82, v83
    v_pk_mul_f32 v[84:85], v[84:85], v[212:213] op_sel:[0,1] op_sel_hi:[1,1]
    v_pk_mul_f32 v[86:87], v[86:87], v[212:213] op_sel:[0,1] op_sel_hi:[1,1]
    v_cvt_pk_bf16_f32 v230, v84, v85
    v_cvt_pk_bf16_f32 v231, v86, v87
    v_pk_mul_f32 v[88:89], v[88:89], v[212:213] op_sel:[0,1] op_sel_hi:[1,1]
    v_pk_mul_f32 v[90:91], v[90:91], v[212:213] op_sel:[0,1] op_sel_hi:[1,1]
    v_cvt_pk_bf16_f32 v232, v88, v89
    v_cvt_pk_bf16_f32 v233, v90, v91
    v_pk_mul_f32 v[92:93], v[92:93], v[212:213] op_sel:[0,1] op_sel_hi:[1,1]
    v_pk_mul_f32 v[94:95], v[94:95], v[212:213] op_sel:[0,1] op_sel_hi:[1,1]
    v_cvt_pk_bf16_f32 v234, v92, v93
    v_cvt_pk_bf16_f32 v235, v94, v95
    s_waitcnt lgkmcnt(0)
    s_barrier
    v_mov_b32 v216, 149504
    ds_read_b32 v217, v216
    s_waitcnt lgkmcnt(0)
    v_readfirstlane_b32 s58, v217
    s_cmp_lg_u32 s58, 0
    s_cbranch_scc1 L_redo_75
L_ostore_76:
    s_add_u32 s57, s62, 40960
    buffer_store_dwordx2 v[224:225], v128, s[24:27], s62 offen sc1
    buffer_store_dwordx2 v[226:227], v129, s[24:27], s62 offen sc1
    s_mov_b64 exec, s[72:73]
    buffer_store_dwordx2 v[228:229], v130, s[24:27], s62 offen sc1
    s_mov_b64 exec, -1
    buffer_store_dwordx2 v[230:231], v128, s[24:27], s57 offen sc1
    buffer_store_dwordx2 v[232:233], v129, s[24:27], s57 offen sc1
    s_mov_b64 exec, s[72:73]
    buffer_store_dwordx2 v[234:235], v130, s[24:27], s57 offen sc1
    s_mov_b64 exec, -1
    s_branch L_attdone_80
L_redo_75:
    s_waitcnt vmcnt(0) lgkmcnt(0)
    s_barrier
    v_lshrrev_b32 v208, 5, v1
    v_mul_u32_u24 v208, 23552, v208
    v_mul_u32_u24 v209, 352, v13
    v_add_u32 v208, v208, v209
    v_add_u32 v208, 115008, v208
    v_mov_b32 v212, 0x3f803f80
    v_mov_b32 v216, 0
    v_mov_b32 v213, 0x3f803f80
    v_mov_b32 v217, 0
    v_mov_b32 v214, 0x3f803f80
    v_mov_b32 v218, 0
    v_mov_b32 v215, 0x3f803f80
    v_mov_b32 v219, 0
    ds_write_b128 v208, v[212:215]
    ds_write_b128 v208, v[216:219] offset:16
    s_mov_b32 s50, s64
    s_mov_b32 s51, s65
    s_mov_b32 s52, s66
    s_add_u32 m0, s67, 0
    s_nop 0
    buffer_load_dwordx4 v5, s[24:27], s50 offen sc1 lds
    s_add_u32 m0, s67, 0
    s_nop 0
    buffer_load_dwordx4 v5, s[24:27], s50 offen offset:1024 sc1 lds
    s_add_u32 m0, s71, 0
    s_nop 0
    buffer_load_dwordx4 v5, s[24:27], s51 offen sc1 lds
    s_add_u32 m0, s80, 0
    s_mov_b64 exec, s[74:75]
    buffer_load_dwordx4 v6, s[24:27], s52 offen sc1 lds
    s_mov_b64 exec, -1
    s_add_u32 m0, s81, 0
    s_mov_b64 exec, s[76:77]
    buffer_load_dwordx4 v7, s[24:27], s52 offen sc1 lds
    s_mov_b64 exec, -1
    s_add_u32 m0, s82, 0
    s_mov_b64 exec, s[78:79]
    buffer_load_dwordx4 v8, s[24:27], s52 offen sc1 lds
    s_mov_b64 exec, -1
    s_add_u32 s50, s50, 4096
    s_add_u32 s51, s51, 2048
    s_add_u32 s52, s52, 5120
    v_mov_b32 v144, 0xff800000
    v_mov_b32 v160, 0xff800000
    v_mov_b32 v176, 0xff800000
    v_mov_b32 v192, 0xff800000
    s_waitcnt vmcnt(0)
    s_waitcnt lgkmcnt(0)
    s_barrier
    s_add_u32 m0, s67, 23552
    s_nop 0
    buffer_load_dwordx4 v5, s[24:27], s50 offen sc1 lds
    s_add_u32 m0, s67, 23552
    s_nop 0
    buffer_load_dwordx4 v5, s[24:27], s50 offen offset:1024 sc1 lds
    s_add_u32 m0, s71, 23552
    s_nop 0
    buffer_load_dwordx4 v5, s[24:27], s51 offen sc1 lds
    s_add_u32 m0, s80, 23552
    s_mov_b64 exec, s[74:75]
    buffer_load_dwordx4 v6, s[24:27], s52 offen sc1 lds
    s_mov_b64 exec, -1
    s_add_u32 m0, s81, 23552
    s_mov_b64 exec, s[76:77]
    buffer_load_dwordx4 v7, s[24:27], s52 offen sc1 lds
    s_mov_b64 exec, -1
    s_add_u32 m0, s82, 23552
    s_mov_b64 exec, s[78:79]
    buffer_load_dwordx4 v8, s[24:27], s52 offen sc1 lds
    s_mov_b64 exec, -1
    s_add_u32 s50, s50, 4096
    s_add_u32 s51, s51, 2048
    s_add_u32 s52, s52, 5120
    ds_read_b128 v[44:47], v2 offset:0
    ds_read_b64 v[48:49], v3 offset:0
    s_waitcnt lgkmcnt(0)
    v_mfma_f32_32x32x16_bf16 v[72:87], v[44:47], v[20:23], 0
    v_mfma_f32_32x32x8_bf16 v[72:87], v[48:49], v[24:25], v[72:87]
    s_nop 11
    s_mov_b32 s53, 0
.p2align 6
L_att_max_81:
    v_mfma_f32_32x32x16_bf16 v[88:103], v[44:47], v[26:29], 0
    ds_read_b128 v[50:53], v2 offset:1024
    s_nop 9
    v_max3_f32 v144, v72, v73, v144
    v_max3_f32 v144, v74, v75, v144
    v_mfma_f32_32x32x8_bf16 v[88:103], v[48:49], v[30:31], v[88:103]
    ds_read_b64 v[54:55], v3 offset:512
    v_max3_f32 v144, v76, v77, v144
    v_max3_f32 v144, v78, v79, v144
    v_max3_f32 v144, v80, v81, v144
    v_max3_f32 v144, v82, v83, v144
    v_max3_f32 v144, v84, v85, v144
    v_max3_f32 v144, v86, v87, v144
    v_mfma_f32_32x32x16_bf16 v[72:87], v[44:47], v[32:35], 0
    s_nop 9
    v_max3_f32 v160, v88, v89, v160
    v_max3_f32 v160, v90, v91, v160
    v_mfma_f32_32x32x8_bf16 v[72:87], v[48:49], v[36:37], v[72:87]
    v_max3_f32 v160, v92, v93, v160
    v_max3_f32 v160, v94, v95, v160
    v_max3_f32 v160, v96, v97, v160
    v_max3_f32 v160, v98, v99, v160
    v_max3_f32 v160, v100, v101, v160
    v_max3_f32 v160, v102, v103, v160
    v_mfma_f32_32x32x16_bf16 v[88:103], v[44:47], v[38:41], 0
    s_nop 9
    v_max3_f32 v176, v72, v73, v176
    v_max3_f32 v176, v74, v75, v176
    v_mfma_f32_32x32x8_bf16 v[88:103], v[48:49], v[42:43], v[88:103]
    v_max3_f32 v176, v76, v77, v176
    v_max3_f32 v176, v78, v79, v176
    v_max3_f32 v176, v80, v81, v176
    v_max3_f32 v176, v82, v83, v176
    v_max3_f32 v176, v84, v85, v176
    v_max3_f32 v176, v86, v87, v176
    s_waitcnt lgkmcnt(0)
    v_mfma_f32_32x32x16_bf16 v[72:87], v[50:53], v[20:23], 0
    s_nop 9
    v_max3_f32 v192, v88, v89, v192
    v_max3_f32 v192, v90, v91, v192
    v_mfma_f32_32x32x8_bf16 v[72:87], v[54:55], v[24:25], v[72:87]
    v_max3_f32 v192, v92, v93, v192
    v_max3_f32 v192, v94, v95, v192
    v_max3_f32 v192, v96, v97, v192
    v_max3_f32 v192, v98, v99, v192
    v_max3_f32 v192, v100, v101, v192
    v_max3_f32 v192, v102, v103, v192
    v_mfma_f32_32x32x16_bf16 v[88:103], v[50:53], v[26:29], 0
    ds_read_b128 v[44:47], v2 offset:2048
    s_nop 9
    v_max3_f32 v144, v72, v73, v144
    v_max3_f32 v144, v74, v75, v144
    v_mfma_f32_32x32x8_bf16 v[88:103], v[54:55], v[30:31], v[88:103]
    ds_read_b64 v[48:49], v3 offset:1024
    v_max3_f32 v144, v76, v77, v144
    v_max3_f32 v144, v78, v79, v144
    v_max3_f32 v144, v80, v81, v144
    v_max3_f32 v144, v82, v83, v144
    v_max3_f32 v144, v84, v85, v144
    v_max3_f32 v144, v86, v87, v144
    v_mfma_f32_32x32x16_bf16 v[72:87], v[50:53], v[32:35], 0
    s_nop 9
    v_max3_f32 v160, v88, v89, v160
    v_max3_f32 v160, v90, v91, v160
    v_mfma_f32_32x32x8_bf16 v[72:87], v[54:55], v[36:37], v[72:87]
    v_max3_f32 v160, v92, v93, v160
    v_max3_f32 v160, v94, v95, v160
    v_max3_f32 v160, v96, v97, v160
    v_max3_f32 v160, v98, v99, v160
    v_max3_f32 v160, v100, v101, v160
    v_max3_f32 v160, v102, v103, v160
    v_mfma_f32_32x32x16_bf16 v[88:103], v[50:53], v[38:41], 0
    s_nop 9
    v_max3_f32 v176, v72, v73, v176
    v_max3_f32 v176, v74, v75, v176
    v_mfma_f32_32x32x8_bf16 v[88:103], v[54:55], v[42:43], v[88:103]
    v_max3_f32 v176, v76, v77, v176
    v_max3_f32 v176, v78, v79, v176
    v_max3_f32 v176, v80, v81, v176
    v_max3_f32 v176, v82, v83, v176
    v_max3_f32 v176, v84, v85, v176
    v_max3_f32 v176, v86, v87, v176
    s_waitcnt lgkmcnt(0)
    v_mfma_f32_32x32x16_bf16 v[72:87], v[44:47], v[20:23], 0
    s_nop 9
    v_max3_f32 v192, v88, v89, v192
    v_max3_f32 v192, v90, v91, v192
    v_mfma_f32_32x32x8_bf16 v[72:87], v[48:49], v[24:25], v[72:87]
    v_max3_f32 v192, v92, v93, v192
    v_max3_f32 v192, v94, v95, v192
    v_max3_f32 v192, v96, v97, v192
    v_max3_f32 v192, v98, v99, v192
    v_max3_f32 v192, v100, v101, v192
    v_max3_f32 v192, v102, v103, v192
    v_mfma_f32_32x32x16_bf16 v[88:103], v[44:47], v[26:29], 0
    ds_read_b128 v[50:53], v2 offset:3072
    s_nop 9
    v_max3_f32 v144, v72, v73, v144
    v_max3_f32 v144, v74, v75, v144
    v_mfma_f32_32x32x8_bf16 v[88:103], v[48:49], v[30:31], v[88:103]
    ds_read_b64 v[54:55], v3 offset:1536
    v_max3_f32 v144, v76, v77, v144
    v_max3_f32 v144, v78, v79, v144
    v_max3_f32 v144, v80, v81, v144
    v_max3_f32 v144, v82, v83, v144
    v_max3_f32 v144, v84, v85, v144
    v_max3_f32 v144, v86, v87, v144
    v_mfma_f32_32x32x16_bf16 v[72:87], v[44:47], v[32:35], 0
    s_nop 9
    v_max3_f32 v160, v88, v89, v160
    v_max3_f32 v160, v90, v91, v160
    v_mfma_f32_32x32x8_bf16 v[72:87], v[48:49], v[36:37], v[72:87]
    v_max3_f32 v160, v92, v93, v160
    v_max3_f32 v160, v94, v95, v160
    v_max3_f32 v160, v96, v97, v160
    v_max3_f32 v160, v98, v99, v160
    v_max3_f32 v160, v100, v101, v160
    v_max3_f32 v160, v102, v103, v160
    v_mfma_f32_32x32x16_bf16 v[88:103], v[44:47], v[38:41], 0
    s_nop 9
    v_max3_f32 v176, v72, v73, v176
    v_max3_f32 v176, v74, v75, v176
    v_mfma_f32_32x32x8_bf16 v[88:103], v[48:49], v[42:43], v[88:103]
    v_max3_f32 v176, v76, v77, v176
    v_max3_f32 v176, v78, v79, v176
    v_max3_f32 v176, v80, v81, v176
    v_max3_f32 v176, v82, v83, v176
    v_max3_f32 v176, v84, v85, v176
    v_max3_f32 v176, v86, v87, v176
    s_waitcnt lgkmcnt(0)
    v_mfma_f32_32x32x16_bf16 v[72:87], v[50:53], v[20:23], 0
    s_nop 9
    v_max3_f32 v192, v88, v89, v192
    v_max3_f32 v192, v90, v91, v192
    v_mfma_f32_32x32x8_bf16 v[72:87], v[54:55], v[24:25], v[72:87]
    v_max3_f32 v192, v92, v93, v192
    v_max3_f32 v192, v94, v95, v192
    v_max3_f32 v192, v96, v97, v192
    v_max3_f32 v192, v98, v99, v192
    v_max3_f32 v192, v100, v101, v192
    v_max3_f32 v192, v102, v103, v192
    s_waitcnt vmcnt(0)
    s_waitcnt lgkmcnt(0)
    s_barrier
    v_mfma_f32_32x32x16_bf16 v[88:103], v[50:53], v[26:29], 0
    ds_read_b128 v[44:47], v2 offset:23552
    s_nop 9
    v_max3_f32 v144, v72, v73, v144
    v_max3_f32 v144, v74, v75, v144
    v_mfma_f32_32x32x8_bf16 v[88:103], v[54:55], v[30:31], v[88:103]
    ds_read_b64 v[48:49], v3 offset:23552
    v_max3_f32 v144, v76, v77, v144
    v_max3_f32 v144, v78, v79, v144
    v_max3_f32 v144, v80, v81, v144
    v_max3_f32 v144, v82, v83, v144
    v_max3_f32 v144, v84, v85, v144
    v_max3_f32 v144, v86, v87, v144
    s_cmp_ge_u32 s53, 3
    s_cbranch_scc1 L_noload_82
    s_add_u32 m0, s67, 0
    s_nop 0
    buffer_load_dwordx4 v5, s[24:27], s50 offen sc1 lds
    s_add_u32 m0, s67, 0
    s_nop 0
    buffer_load_dwordx4 v5, s[24:27], s50 offen offset:1024 sc1 lds
    s_add_u32 m0, s71, 0
    s_nop 0
    buffer_load_dwordx4 v5, s[24:27], s51 offen sc1 lds
    s_add_u32 m0, s80, 0
    s_mov_b64 exec, s[74:75]
    buffer_load_dwordx4 v6, s[24:27], s52 offen sc1 lds
    s_mov_b64 exec, -1
    s_add_u32 m0, s81, 0
    s_mov_b64 exec, s[76:77]
    buffer_load_dwordx4 v7, s[24:27], s52 offen sc1 lds
    s_mov_b64 exec, -1
    s_add_u32 m0, s82, 0
    s_mov_b64 exec, s[78:79]
    buffer_load_dwordx4 v8, s[24:27], s52 offen sc1 lds
    s_mov_b64 exec, -1
    s_add_u32 s50, s50, 4096
    s_add_u32 s51, s51, 2048
    s_add_u32 s52, s52, 5120
L_noload_82:
    v_mfma_f32_32x32x16_bf16 v[72:87], v[50:53], v[32:35], 0
    s_nop 9
    v_max3_f32 v160, v88, v89, v160
    v_max3_f32 v160, v90, v91, v160
    v_mfma_f32_32x32x8_bf16 v[72:87], v[54:55], v[36:37], v[72:87]
    v_max3_f32 v160, v92, v93, v160
    v_max3_f32 v160, v94, v95, v160
    v_max3_f32 v160, v96, v97, v160
    v_max3_f32 v160, v98, v99, v160
    v_max3_f32 v160, v100, v101, v160
    v_max3_f32 v160, v102, v103, v160
    v_mfma_f32_32x32x16_bf16 v[88:103], v[50:53], v[38:41], 0
    s_nop 9
    v_max3_f32 v176, v72, v73, v176
    v_max3_f32 v176, v74, v75, v176
    v_mfma_f32_32x32x8_bf16 v[88:103], v[54:55], v[42:43], v[88:103]
    v_max3_f32 v176, v76, v77, v176
    v_max3_f32 v176, v78, v79, v176
    v_max3_f32 v176, v80, v81, v176
    v_max3_f32 v176, v82, v83, v176
    v_max3_f32 v176, v84, v85, v176
    v_max3_f32 v176, v86, v87, v176
    s_waitcnt lgkmcnt(0)
    v_mfma_f32_32x32x16_bf16 v[72:87], v[44:47], v[20:23], 0
    s_nop 9
    v_max3_f32 v192, v88, v89, v192
    v_max3_f32 v192, v90, v91, v192
    v_mfma_f32_32x32x8_bf16 v[72:87], v[48:49], v[24:25], v[72:87]
    v_max3_f32 v192, v92, v93, v192
    v_max3_f32 v192, v94, v95, v192
    v_max3_f32 v192, v96, v97, v192
    v_max3_f32 v192, v98, v99, v192
    v_max3_f32 v192, v100, v101, v192
    v_max3_f32 v192, v102, v103, v192
    v_mfma_f32_32x32x16_bf16 v[88:103], v[44:47], v[26:29], 0
    ds_read_b128 v[50:53], v2 offset:24576
    s_nop 9
    v_max3_f32 v144, v72, v73, v144
    v_max3_f32 v144, v74, v75, v144
    v_mfma_f32_32x32x8_bf16 v[88:103], v[48:49], v[30:31], v[88:103]
    ds_read_b64 v[54:55], v3 offset:24064
    v_max3_f32 v144, v76, v77, v144
    v_max3_f32 v144, v78, v79, v144
    v_max3_f32 v144, v80, v81, v144
    v_max3_f32 v144, v82, v83, v144
    v_max3_f32 v144, v84, v85, v144
    v_max3_f32 v144, v86, v87, v144
    v_mfma_f32_32x32x16_bf16 v[72:87], v[44:47], v[32:35], 0
    s_nop 9
    v_max3_f32 v160, v88, v89, v160
    v_max3_f32 v160, v90, v91, v160
    v_mfma_f32_32x32x8_bf16 v[72:87], v[48:49], v[36:37], v[72:87]
    v_max3_f32 v160, v92, v93, v160
    v_max3_f32 v160, v94, v95, v160
    v_max3_f32 v160, v96, v97, v160
    v_max3_f32 v160, v98, v99, v160
    v_max3_f32 v160, v100, v101, v160
    v_max3_f32 v160, v102, v103, v160
    v_mfma_f32_32x32x16_bf16 v[88:103], v[44:47], v[38:41], 0
    s_nop 9
    v_max3_f32 v176, v72, v73, v176
    v_max3_f32 v176, v74, v75, v176
    v_mfma_f32_32x32x8_bf16 v[88:103], v[48:49], v[42:43], v[88:103]
    v_max3_f32 v176, v76, v77, v176
    v_max3_f32 v176, v78, v79, v176
    v_max3_f32 v176, v80, v81, v176
    v_max3_f32 v176, v82, v83, v176
    v_max3_f32 v176, v84, v85, v176
    v_max3_f32 v176, v86, v87, v176
    s_waitcnt lgkmcnt(0)
    v_mfma_f32_32x32x16_bf16 v[72:87], v[50:53], v[20:23], 0
    s_nop 9
    v_max3_f32 v192, v88, v89, v192
    v_max3_f32 v192, v90, v91, v192
    v_mfma_f32_32x32x8_bf16 v[72:87], v[54:55], v[24:25], v[72:87]
    v_max3_f32 v192, v92, v93, v192
    v_max3_f32 v192, v94, v95, v192
    v_max3_f32 v192, v96, v97, v192
    v_max3_f32 v192, v98, v99, v192
    v_max3_f32 v192, v100, v101, v192
    v_max3_f32 v192, v102, v103, v192
    v_mfma_f32_32x32x16_bf16 v[88:103], v[50:53], v[26:29], 0
    ds_read_b128 v[44:47], v2 offset:25600
    s_nop 9
    v_max3_f32 v144, v72, v73, v144
    v_max3_f32 v144, v74, v75, v144
    v_mfma_f32_32x32x8_bf16 v[88:103], v[54:55], v[30:31], v[88:103]
    ds_read_b64 v[48:49], v3 offset:24576
    v_max3_f32 v144, v76, v77, v144
    v_max3_f32 v144, v78, v79, v144
    v_max3_f32 v144, v80, v81, v144
    v_max3_f32 v144, v82, v83, v144
    v_max3_f32 v144, v84, v85, v144
    v_max3_f32 v144, v86, v87, v144
    v_mfma_f32_32x32x16_bf16 v[72:87], v[50:53], v[32:35], 0
    s_nop 9
    v_max3_f32 v160, v88, v89, v160
    v_max3_f32 v160, v90, v91, v160
    v_mfma_f32_32x32x8_bf16 v[72:87], v[54:55], v[36:37], v[72:87]
    v_max3_f32 v160, v92, v93, v160
    v_max3_f32 v160, v94, v95, v160
    v_max3_f32 v160, v96, v97, v160
    v_max3_f32 v160, v98, v99, v160
    v_max3_f32 v160, v100, v101, v160
    v_max3_f32 v160, v102, v103, v160
    v_mfma_f32_32x32x16_bf16 v[88:103], v[50:53], v[38:41], 0
    s_nop 9
    v_max3_f32 v176, v72, v73, v176
    v_max3_f32 v176, v74, v75, v176
    v_mfma_f32_32x32x8_bf16 v[88:103], v[54:55], v[42:43], v[88:103]
    v_max3_f32 v176, v76, v77, v176
    v_max3_f32 v176, v78, v79, v176
    v_max3_f32 v176, v80, v81, v176
    v_max3_f32 v176, v82, v83, v176
    v_max3_f32 v176, v84, v85, v176
    v_max3_f32 v176, v86, v87, v176
    s_waitcnt lgkmcnt(0)
    v_mfma_f32_32x32x16_bf16 v[72:87], v[44:47], v[20:23], 0
    s_nop 9
    v_max3_f32 v192, v88, v89, v192
    v_max3_f32 v192, v90, v91, v192
    v_mfma_f32_32x32x8_bf16 v[72:87], v[48:49], v[24:25], v[72:87]
    v_max3_f32 v192, v92, v93, v192
    v_max3_f32 v192, v94, v95, v192
    v_max3_f32 v192, v96, v97, v192
    v_max3_f32 v192, v98, v99, v192
    v_max3_f32 v192, v100, v101, v192
    v_max3_f32 v192, v102, v103, v192
    v_mfma_f32_32x32x16_bf16 v[88:103], v[44:47], v[26:29], 0
    ds_read_b128 v[50:53], v2 offset:26624
    s_nop 9
    v_max3_f32 v144, v72, v73, v144
    v_max3_f32 v144, v74, v75, v144
    v_mfma_f32_32x32x8_bf16 v[88:103], v[48:49], v[30:31], v[88:103]
    ds_read_b64 v[54:55], v3 offset:25088
    v_max3_f32 v144, v76, v77, v144
    v_max3_f32 v144, v78, v79, v144
    v_max3_f32 v144, v80, v81, v144
    v_max3_f32 v144, v82, v83, v144
    v_max3_f32 v144, v84, v85, v144
    v_max3_f32 v144, v86, v87, v144
    v_mfma_f32_32x32x16_bf16 v[72:87], v[44:47], v[32:35], 0
    s_nop 9
    v_max3_f32 v160, v88, v89, v160
    v_max3_f32 v160, v90, v91, v160
    v_mfma_f32_32x32x8_bf16 v[72:87], v[48:49], v[36:37], v[72:87]
    v_max3_f32 v160, v92, v93, v160
    v_max3_f32 v160, v94, v95, v160
    v_max3_f32 v160, v96, v97, v160
    v_max3_f32 v160, v98, v99, v160
    v_max3_f32 v160, v100, v101, v160
    v_max3_f32 v160, v102, v103, v160
    v_mfma_f32_32x32x16_bf16 v[88:103], v[44:47], v[38:41], 0
    s_nop 9
    v_max3_f32 v176, v72, v73, v176
    v_max3_f32 v176, v74, v75, v176
    v_mfma_f32_32x32x8_bf16 v[88:103], v[48:49], v[42:43], v[88:103]
    v_max3_f32 v176, v76, v77, v176
    v_max3_f32 v176, v78, v79, v176
    v_max3_f32 v176, v80, v81, v176
    v_max3_f32 v176, v82, v83, v176
    v_max3_f32 v176, v84, v85, v176
    v_max3_f32 v176, v86, v87, v176
    s_waitcnt lgkmcnt(0)
    v_mfma_f32_32x32x16_bf16 v[72:87], v[50:53], v[20:23], 0
    s_nop 9
    v_max3_f32 v192, v88, v89, v192
    v_max3_f32 v192, v90, v91, v192
    v_mfma_f32_32x32x8_bf16 v[72:87], v[54:55], v[24:25], v[72:87]
    v_max3_f32 v192, v92, v93, v192
    v_max3_f32 v192, v94, v95, v192
    v_max3_f32 v192, v96, v97, v192
    v_max3_f32 v192, v98, v99, v192
    v_max3_f32 v192, v100, v101, v192
    v_max3_f32 v192, v102, v103, v192
    s_waitcnt vmcnt(0)
    s_waitcnt lgkmcnt(0)
    s_barrier
    v_mfma_f32_32x32x16_bf16 v[88:103], v[50:53], v[26:29], 0
    ds_read_b128 v[44:47], v2 offset:0
    s_nop 9
    v_max3_f32 v144, v72, v73, v144
    v_max3_f32 v144, v74, v75, v144
    v_mfma_f32_32x32x8_bf16 v[88:103], v[54:55], v[30:31], v[88:103]
    ds_read_b64 v[48:49], v3 offset:0
    v_max3_f32 v144, v76, v77, v144
    v_max3_f32 v144, v78, v79, v144
    v_max3_f32 v144, v80, v81, v144
    v_max3_f32 v144, v82, v83, v144
    v_max3_f32 v144, v84, v85, v144
    v_max3_f32 v144, v86, v87, v144
    s_cmp_ge_u32 s53, 3
    s_cbranch_scc1 L_noload_83
    s_add_u32 m0, s67, 23552
    s_nop 0
    buffer_load_dwordx4 v5, s[24:27], s50 offen sc1 lds
    s_add_u32 m0, s67, 23552
    s_nop 0
    buffer_load_dwordx4 v5, s[24:27], s50 offen offset:1024 sc1 lds
    s_add_u32 m0, s71, 23552
    s_nop 0
    buffer_load_dwordx4 v5, s[24:27], s51 offen sc1 lds
    s_add_u32 m0, s80, 23552
    s_mov_b64 exec, s[74:75]
    buffer_load_dwordx4 v6, s[24:27], s52 offen sc1 lds
    s_mov_b64 exec, -1
    s_add_u32 m0, s81, 23552
    s_mov_b64 exec, s[76:77]
    buffer_load_dwordx4 v7, s[24:27], s52 offen sc1 lds
    s_mov_b64 exec, -1
    s_add_u32 m0, s82, 23552
    s_mov_b64 exec, s[78:79]
    buffer_load_dwordx4 v8, s[24:27], s52 offen sc1 lds
    s_mov_b64 exec, -1
    s_add_u32 s50, s50, 4096
    s_add_u32 s51, s51, 2048
    s_add_u32 s52, s52, 5120
L_noload_83:
    v_mfma_f32_32x32x16_bf16 v[72:87], v[50:53], v[32:35], 0
    s_nop 9
    v_max3_f32 v160, v88, v89, v160
    v_max3_f32 v160, v90, v91, v160
    v_mfma_f32_32x32x8_bf16 v[72:87], v[54:55], v[36:37], v[72:87]
    v_max3_f32 v160, v92, v93, v160
    v_max3_f32 v160, v94, v95, v160
    v_max3_f32 v160, v96, v97, v160
    v_max3_f32 v160, v98, v99, v160
    v_max3_f32 v160, v100, v101, v160
    v_max3_f32 v160, v102, v103, v160
    v_mfma_f32_32x32x16_bf16 v[88:103], v[50:53], v[38:41], 0
    s_nop 9
    v_max3_f32 v176, v72, v73, v176
    v_max3_f32 v176, v74, v75, v176
    v_mfma_f32_32x32x8_bf16 v[88:103], v[54:55], v[42:43], v[88:103]
    v_max3_f32 v176, v76, v77, v176
    v_max3_f32 v176, v78, v79, v176
    v_max3_f32 v176, v80, v81, v176
    v_max3_f32 v176, v82, v83, v176
    v_max3_f32 v176, v84, v85, v176
    v_max3_f32 v176, v86, v87, v176
    s_waitcnt lgkmcnt(0)
    v_mfma_f32_32x32x16_bf16 v[72:87], v[44:47], v[20:23], 0
    s_nop 9
    v_max3_f32 v192, v88, v89, v192
    v_max3_f32 v192, v90, v91, v192
    v_mfma_f32_32x32x8_bf16 v[72:87], v[48:49], v[24:25], v[72:87]
    v_max3_f32 v192, v92, v93, v192
    v_max3_f32 v192, v94, v95, v192
    v_max3_f32 v192, v96, v97, v192
    v_max3_f32 v192, v98, v99, v192
    v_max3_f32 v192, v100, v101, v192
    v_max3_f32 v192, v102, v103, v192
    s_add_u32 s53, s53, 1
    s_cmp_lt_u32 s53, 4
    s_cbranch_scc1 L_att_max_81
    s_nop 1
    v_mov_b32 v208, v144
    s_nop 1
    v_permlane32_swap_b32 v208, v144
    v_max_f32 v144, v144, v208
    v_mov_b32 v208, v160
    s_nop 1
    v_permlane32_swap_b32 v208, v160
    v_max_f32 v160, v160, v208
    v_mov_b32 v208, v176
    s_nop 1
    v_permlane32_swap_b32 v208, v176
    v_max_f32 v176, v176, v208
    v_mov_b32 v208, v192
    s_nop 1
    v_permlane32_swap_b32 v208, v192
    v_max_f32 v192, v192, v208
    s_barrier
    s_lshl_b32 s54, s40, 10
    s_add_u32 s54, s54, 102400
    v_lshl_add_u32 v209, v1, 2, s54
    ds_write_b32 v209, v144 offset:0
    ds_write_b32 v209, v160 offset:256
    ds_write_b32 v209, v176 offset:512
    ds_write_b32 v209, v192 offset:768
    s_xor_b32 s54, s40, 2
    s_lshl_b32 s54, s54, 10
    s_add_u32 s54, s54, 102400
    v_lshl_add_u32 v209, v1, 2, s54
    s_waitcnt lgkmcnt(0)
    s_barrier
    ds_read_b32 v210, v209 offset:0
    ds_read_b32 v211, v209 offset:256
    ds_read_b32 v212, v209 offset:512
    ds_read_b32 v213, v209 offset:768
    s_waitcnt lgkmcnt(0)
    v_max_f32 v144, v144, v210
    v_sub_f32 v144, 0, v144
    v_mov_b32 v145, v144
    v_mov_b32 v146, v144
    v_mov_b32 v147, v144
    v_mov_b32 v148, v144
    v_mov_b32 v149, v144
    v_mov_b32 v150, v144
    v_mov_b32 v151, v144
    v_mov_b32 v152, v144
    v_mov_b32 v153, v144
    v_mov_b32 v154, v144
    v_mov_b32 v155, v144
    v_mov_b32 v156, v144
    v_mov_b32 v157, v144
    v_mov_b32 v158, v144
    v_mov_b32 v159, v144
    v_max_f32 v160, v160, v211
    v_sub_f32 v160, 0, v160
    v_mov_b32 v161, v160
    v_mov_b32 v162, v160
    v_mov_b32 v163, v160
    v_mov_b32 v164, v160
    v_mov_b32 v165, v160
    v_mov_b32 v166, v160
    v_mov_b32 v167, v160
    v_mov_b32 v168, v160
    v_mov_b32 v169, v160
    v_mov_b32 v170, v160
    v_mov_b32 v171, v160
    v_mov_b32 v172, v160
    v_mov_b32 v173, v160
    v_mov_b32 v174, v160
    v_mov_b32 v175, v160
    v_max_f32 v176, v176, v212
    v_sub_f32 v176, 0, v176
    v_mov_b32 v177, v176
    v_mov_b32 v178, v176
    v_mov_b32 v179, v176
    v_mov_b32 v180, v176
    v_mov_b32 v181, v176
    v_mov_b32 v182, v176
    v_mov_b32 v183, v176
    v_mov_b32 v184, v176
    v_mov_b32 v185, v176
    v_mov_b32 v186, v176
    v_mov_b32 v187, v176
    v_mov_b32 v188, v176
    v_mov_b32 v189, v176
    v_mov_b32 v190, v176
    v_mov_b32 v191, v176
    v_max_f32 v192, v192, v213
    v_sub_f32 v192, 0, v192
    v_mov_b32 v193, v192
    v_mov_b32 v194, v192
    v_mov_b32 v195, v192
    v_mov_b32 v196, v192
    v_mov_b32 v197, v192
    v_mov_b32 v198, v192
    v_mov_b32 v199, v192
    v_mov_b32 v200, v192
    v_mov_b32 v201, v192
    v_mov_b32 v202, v192
    v_mov_b32 v203, v192
    v_mov_b32 v204, v192
    v_mov_b32 v205, v192
    v_mov_b32 v206, v192
    v_mov_b32 v207, v192
    s_barrier
    s_mov_b32 s50, s64
    s_mov_b32 s51, s65
    s_mov_b32 s52, s66
    s_add_u32 m0, s67, 0
    s_nop 0
    buffer_load_dwordx4 v5, s[24:27], s50 offen sc1 lds
    s_add_u32 m0, s67, 0
    s_nop 0
    buffer_load_dwordx4 v5, s[24:27], s50 offen offset:1024 sc1 lds
    s_add_u32 m0, s71, 0
    s_nop 0
    buffer_load_dwordx4 v5, s[24:27], s51 offen sc1 lds
    s_add_u32 m0, s80, 0
    s_mov_b64 exec, s[74:75]
    buffer_load_dwordx4 v6, s[24:27], s52 offen sc1 lds
    s_mov_b64 exec, -1
    s_add_u32 m0, s81, 0
    s_mov_b64 exec, s[76:77]
    buffer_load_dwordx4 v7, s[24:27], s52 offen sc1 lds
    s_mov_b64 exec, -1
    s_add_u32 m0, s82, 0
    s_mov_b64 exec, s[78:79]
    buffer_load_dwordx4 v8, s[24:27], s52 offen sc1 lds
    s_mov_b64 exec, -1
    s_add_u32 s50, s50, 4096
    s_add_u32 s51, s51, 2048
    s_add_u32 s52, s52, 5120
    v_accvgpr_write_b32 a0, 0
    v_accvgpr_write_b32 a1, 0
    v_accvgpr_write_b32 a2, 0
    v_accvgpr_write_b32 a3, 0
    v_accvgpr_write_b32 a4, 0
    v_accvgpr_write_b32 a5, 0
    v_accvgpr_write_b32 a6, 0
    v_accvgpr_write_b32 a7, 0
    v_accvgpr_write_b32 a8, 0
    v_accvgpr_write_b32 a9, 0
    v_accvgpr_write_b32 a10, 0
    v_accvgpr_write_b32 a11, 0
    v_accvgpr_write_b32 a12, 0
    v_accvgpr_write_b32 a13, 0
    v_accvgpr_write_b32 a14, 0
    v_accvgpr_write_b32 a15, 0
    v_accvgpr_write_b32 a16, 0
    v_accvgpr_write_b32 a17, 0
    v_accvgpr_write_b32 a18, 0
    v_accvgpr_write_b32 a19, 0
    v_accvgpr_write_b32 a20, 0
    v_accvgpr_write_b32 a21, 0
    v_accvgpr_write_b32 a22, 0
    v_accvgpr_write_b32 a23, 0
    v_accvgpr_write_b32 a24, 0
    v_accvgpr_write_b32 a25, 0
    v_accvgpr_write_b32 a26, 0
    v_accvgpr_write_b32 a27, 0
    v_accvgpr_write_b32 a28, 0
    v_accvgpr_write_b32 a29, 0
    v_accvgpr_write_b32 a30, 0
    v_accvgpr_write_b32 a31, 0
    v_accvgpr_write_b32 a32, 0
    v_accvgpr_write_b32 a33, 0
    v_accvgpr_write_b32 a34, 0
    v_accvgpr_write_b32 a35, 0
    v_accvgpr_write_b32 a36, 0
    v_accvgpr_write_b32 a37, 0
    v_accvgpr_write_b32 a38, 0
    v_accvgpr_write_b32 a39, 0
    v_accvgpr_write_b32 a40, 0
    v_accvgpr_write_b32 a41, 0
    v_accvgpr_write_b32 a42, 0
    v_accvgpr_write_b32 a43, 0
    v_accvgpr_write_b32 a44, 0
    v_accvgpr_write_b32 a45, 0
    v_accvgpr_write_b32 a46, 0
    v_accvgpr_write_b32 a47, 0
    v_accvgpr_write_b32 a48, 0
    v_accvgpr_write_b32 a49, 0
    v_accvgpr_write_b32 a50, 0
    v_accvgpr_write_b32 a51, 0
    v_accvgpr_write_b32 a52, 0
    v_accvgpr_write_b32 a53, 0
    v_accvgpr_write_b32 a54, 0
    v_accvgpr_write_b32 a55, 0
    v_accvgpr_write_b32 a56, 0
    v_accvgpr_write_b32 a57, 0
    v_accvgpr_write_b32 a58, 0
    v_accvgpr_write_b32 a59, 0
    v_accvgpr_write_b32 a60, 0
    v_accvgpr_write_b32 a61, 0
    v_accvgpr_write_b32 a62, 0
    v_accvgpr_write_b32 a63, 0
    v_mov_b32 v112, 0
    v_mov_b32 v64, 0
    v_mov_b32 v113, 0
    v_mov_b32 v65, 0
    v_mov_b32 v114, 0
    v_mov_b32 v66, 0
    v_mov_b32 v115, 0
    v_mov_b32 v67, 0
    v_mov_b32 v116, 0
    v_mov_b32 v68, 0
    v_mov_b32 v117, 0
    v_mov_b32 v69, 0
    v_mov_b32 v118, 0
    v_mov_b32 v70, 0
    v_mov_b32 v119, 0
    v_mov_b32 v71, 0
    s_waitcnt vmcnt(0)
    s_barrier
    s_add_u32 m0, s67, 23552
    s_nop 0
    buffer_load_dwordx4 v5, s[24:27], s50 offen sc1 lds
    s_add_u32 m0, s67, 23552
    s_nop 0
    buffer_load_dwordx4 v5, s[24:27], s50 offen offset:1024 sc1 lds
    s_add_u32 m0, s71, 23552
    s_nop 0
    buffer_load_dwordx4 v5, s[24:27], s51 offen sc1 lds
    s_add_u32 m0, s80, 23552
    s_mov_b64 exec, s[74:75]
    buffer_load_dwordx4 v6, s[24:27], s52 offen sc1 lds
    s_mov_b64 exec, -1
    s_add_u32 m0, s81, 23552
    s_mov_b64 exec, s[76:77]
    buffer_load_dwordx4 v7, s[24:27], s52 offen sc1 lds
    s_mov_b64 exec, -1
    s_add_u32 m0, s82, 23552
    s_mov_b64 exec, s[78:79]
    buffer_load_dwordx4 v8, s[24:27], s52 offen sc1 lds
    s_mov_b64 exec, -1
    s_add_u32 s50, s50, 4096
    s_add_u32 s51, s51, 2048
    s_add_u32 s52, s52, 5120
    ds_read_b128 v[44:47], v2 offset:0
    ds_read_b64 v[48:49], v3 offset:0
    s_waitcnt lgkmcnt(0)
    v_mfma_f32_32x32x16_bf16 v[72:87], v[44:47], v[20:23], v[144:159]
    v_mfma_f32_32x32x8_bf16 v[72:87], v[48:49], v[24:25], v[72:87]
    ds_read_b128 v[56:59], v4 offset:0
    ds_read_b128 v[60:63], v4 offset:704
    s_nop 11
    s_mov_b32 s53, 0
.p2align 6
L_att_safe_84:
    v_mfma_f32_32x32x16_bf16 v[88:103], v[44:47], v[26:29], v[160:175]
    ds_read_b128 v[50:53], v2 offset:1024
    v_exp_f32 v72, v72
    v_exp_f32 v73, v73
    v_exp_f32 v74, v74
    v_exp_f32 v75, v75
    v_mfma_f32_32x32x8_bf16 v[88:103], v[48:49], v[30:31], v[88:103]
    ds_read_b64 v[54:55], v3 offset:512
    v_exp_f32 v76, v76
    v_exp_f32 v77, v77
    v_exp_f32 v78, v78
    v_exp_f32 v79, v79
    v_cvt_pk_bf16_f32 v104, v72, v73
    v_cvt_pk_bf16_f32 v105, v74, v75
    v_mfma_f32_32x32x16_bf16 a[48:63], v[64:67], v[112:115], a[48:63]
    v_exp_f32 v80, v80
    v_exp_f32 v81, v81
    v_exp_f32 v82, v82
    v_exp_f32 v83, v83
    v_cvt_pk_bf16_f32 v106, v76, v77
    v_cvt_pk_bf16_f32 v107, v78, v79
    v_mfma_f32_32x32x16_bf16 a[48:63], v[68:71], v[116:119], a[48:63]
    v_exp_f32 v84, v84
    v_exp_f32 v85, v85
    v_exp_f32 v86, v86
    v_exp_f32 v87, v87
    v_cvt_pk_bf16_f32 v108, v80, v81
    v_cvt_pk_bf16_f32 v109, v82, v83
    v_cvt_pk_bf16_f32 v110, v84, v85
    v_cvt_pk_bf16_f32 v111, v86, v87
    v_mfma_f32_32x32x16_bf16 v[72:87], v[44:47], v[32:35], v[176:191]
    v_exp_f32 v88, v88
    v_exp_f32 v89, v89
    v_exp_f32 v90, v90
    v_exp_f32 v91, v91
    v_mfma_f32_32x32x8_bf16 v[72:87], v[48:49], v[36:37], v[72:87]
    v_exp_f32 v92, v92
    v_exp_f32 v93, v93
    v_exp_f32 v94, v94
    v_exp_f32 v95, v95
    v_cvt_pk_bf16_f32 v112, v88, v89
    v_cvt_pk_bf16_f32 v113, v90, v91
    s_waitcnt lgkmcnt(2)
    v_mfma_f32_32x32x16_bf16 a[0:15], v[56:59], v[104:107], a[0:15]
    ds_read_b128 v[64:67], v4 offset:1408
    v_exp_f32 v96, v96
    v_exp_f32 v97, v97
    v_exp_f32 v98, v98
    v_exp_f32 v99, v99
    v_cvt_pk_bf16_f32 v114, v92, v93
    v_cvt_pk_bf16_f32 v115, v94, v95
    v_mfma_f32_32x32x16_bf16 a[0:15], v[60:63], v[108:111], a[0:15]
    v_exp_f32 v100, v100
    v_exp_f32 v101, v101
    v_exp_f32 v102, v102
    v_exp_f32 v103, v103
    v_cvt_pk_bf16_f32 v116, v96, v97
    v_cvt_pk_bf16_f32 v117, v98, v99
    v_cvt_pk_bf16_f32 v118, v100, v101
    v_cvt_pk_bf16_f32 v119, v102, v103
    v_mfma_f32_32x32x16_bf16 v[88:103], v[44:47], v[38:41], v[192:207]
    v_exp_f32 v72, v72
    v_exp_f32 v73, v73
    v_exp_f32 v74, v74
    v_exp_f32 v75, v75
    v_mfma_f32_32x32x8_bf16 v[88:103], v[48:49], v[42:43], v[88:103]
    v_exp_f32 v76, v76
    v_exp_f32 v77, v77
    v_exp_f32 v78, v78
    v_exp_f32 v79, v79
    v_cvt_pk_bf16_f32 v104, v72, v73
    v_cvt_pk_bf16_f32 v105, v74, v75
    v_mfma_f32_32x32x16_bf16 a[16:31], v[56:59], v[112:115], a[16:31]
    ds_read_b128 v[68:71], v4 offset:2112
    v_exp_f32 v80, v80
    v_exp_f32 v81, v81
    v_exp_f32 v82, v82
    v_exp_f32 v83, v83
    v_cvt_pk_bf16_f32 v106, v76, v77
    v_cvt_pk_bf16_f32 v107, v78, v79
    v_mfma_f32_32x32x16_bf16 a[16:31], v[60:63], v[116:119], a[16:31]
    v_exp_f32 v84, v84
    v_exp_f32 v85, v85
    v_exp_f32 v86, v86
    v_exp_f32 v87, v87
    v_cvt_pk_bf16_f32 v108, v80, v81
    v_cvt_pk_bf16_f32 v109, v82, v83
    v_cvt_pk_bf16_f32 v110, v84, v85
    v_cvt_pk_bf16_f32 v111, v86, v87
    s_waitcnt lgkmcnt(2)
    v_mfma_f32_32x32x16_bf16 v[72:87], v[50:53], v[20:23], v[144:159]
    v_exp_f32 v88, v88
    v_exp_f32 v89, v89
    v_exp_f32 v90, v90
    v_exp_f32 v91, v91
    v_mfma_f32_32x32x8_bf16 v[72:87], v[54:55], v[24:25], v[72:87]
    v_exp_f32 v92, v92
    v_exp_f32 v93, v93
    v_exp_f32 v94, v94
    v_exp_f32 v95, v95
    v_cvt_pk_bf16_f32 v112, v88, v89
    v_cvt_pk_bf16_f32 v113, v90, v91
    v_mfma_f32_32x32x16_bf16 a[32:47], v[56:59], v[104:107], a[32:47]
    v_exp_f32 v96, v96
    v_exp_f32 v97, v97
    v_exp_f32 v98, v98
    v_exp_f32 v99, v99
    v_cvt_pk_bf16_f32 v114, v92, v93
    v_cvt_pk_bf16_f32 v115, v94, v95
    v_mfma_f32_32x32x16_bf16 a[32:47], v[60:63], v[108:111], a[32:47]
    v_exp_f32 v100, v100
    v_exp_f32 v101, v101
    v_exp_f32 v102, v102
    v_exp_f32 v103, v103
    v_cvt_pk_bf16_f32 v116, v96, v97
    v_cvt_pk_bf16_f32 v117, v98, v99
    v_cvt_pk_bf16_f32 v118, v100, v101
    v_cvt_pk_bf16_f32 v119, v102, v103
    v_mfma_f32_32x32x16_bf16 v[88:103], v[50:53], v[26:29], v[160:175]
    ds_read_b128 v[44:47], v2 offset:2048
    v_exp_f32 v72, v72
    v_exp_f32 v73, v73
    v_exp_f32 v74, v74
    v_exp_f32 v75, v75
    v_mfma_f32_32x32x8_bf16 v[88:103], v[54:55], v[30:31], v[88:103]
    ds_read_b64 v[48:49], v3 offset:1024
    v_exp_f32 v76, v76
    v_exp_f32 v77, v77
    v_exp_f32 v78, v78
    v_exp_f32 v79, v79
    v_cvt_pk_bf16_f32 v104, v72, v73
    v_cvt_pk_bf16_f32 v105, v74, v75
    v_mfma_f32_32x32x16_bf16 a[48:63], v[56:59], v[112:115], a[48:63]
    v_exp_f32 v80, v80
    v_exp_f32 v81, v81
    v_exp_f32 v82, v82
    v_exp_f32 v83, v83
    v_cvt_pk_bf16_f32 v106, v76, v77
    v_cvt_pk_bf16_f32 v107, v78, v79
    v_mfma_f32_32x32x16_bf16 a[48:63], v[60:63], v[116:119], a[48:63]
    v_exp_f32 v84, v84
    v_exp_f32 v85, v85
    v_exp_f32 v86, v86
    v_exp_f32 v87, v87
    v_cvt_pk_bf16_f32 v108, v80, v81
    v_cvt_pk_bf16_f32 v109, v82, v83
    v_cvt_pk_bf16_f32 v110, v84, v85
    v_cvt_pk_bf16_f32 v111, v86, v87
    v_mfma_f32_32x32x16_bf16 v[72:87], v[50:53], v[32:35], v[176:191]
    v_exp_f32 v88, v88
    v_exp_f32 v89, v89
    v_exp_f32 v90, v90
    v_exp_f32 v91, v91
    v_mfma_f32_32x32x8_bf16 v[72:87], v[54:55], v[36:37], v[72:87]
    v_exp_f32 v92, v92
    v_exp_f32 v93, v93
    v_exp_f32 v94, v94
    v_exp_f32 v95, v95
    v_cvt_pk_bf16_f32 v112, v88, v89
    v_cvt_pk_bf16_f32 v113, v90, v91
    s_waitcnt lgkmcnt(2)
    v_mfma_f32_32x32x16_bf16 a[0:15], v[64:67], v[104:107], a[0:15]
    ds_read_b128 v[56:59], v4 offset:2816
    v_exp_f32 v96, v96
    v_exp_f32 v97, v97
    v_exp_f32 v98, v98
    v_exp_f32 v99, v99
    v_cvt_pk_bf16_f32 v114, v92, v93
    v_cvt_pk_bf16_f32 v115, v94, v95
    v_mfma_f32_32x32x16_bf16 a[0:15], v[68:71], v[108:111], a[0:15]
    v_exp_f32 v100, v100
    v_exp_f32 v101, v101
    v_exp_f32 v102, v102
    v_exp_f32 v103, v103
    v_cvt_pk_bf16_f32 v116, v96, v97
    v_cvt_pk_bf16_f32 v117, v98, v99
    v_cvt_pk_bf16_f32 v118, v100, v101
    v_cvt_pk_bf16_f32 v119, v102, v103
    v_mfma_f32_32x32x16_bf16 v[88:103], v[50:53], v[38:41], v[192:207]
    v_exp_f32 v72, v72
    v_exp_f32 v73, v73
    v_exp_f32 v74, v74
    v_exp_f32 v75, v75
    v_mfma_f32_32x32x8_bf16 v[88:103], v[54:55], v[42:43], v[88:103]
    v_exp_f32 v76, v76
    v_exp_f32 v77, v77
    v_exp_f32 v78, v78
    v_exp_f32 v79, v79
    v_cvt_pk_bf16_f32 v104, v72, v73
    v_cvt_pk_bf16_f32 v105, v74, v75
    v_mfma_f32_32x32x16_bf16 a[16:31], v[64:67], v[112:115], a[16:31]
    ds_read_b128 v[60:63], v4 offset:3520
    v_exp_f32 v80, v80
    v_exp_f32 v81, v81
    v_exp_f32 v82, v82
    v_exp_f32 v83, v83
    v_cvt_pk_bf16_f32 v106, v76, v77
    v_cvt_pk_bf16_f32 v107, v78, v79
    v_mfma_f32_32x32x16_bf16 a[16:31], v[68:71], v[116:119], a[16:31]
    v_exp_f32 v84, v84
    v_exp_f32 v85, v85
    v_exp_f32 v86, v86
    v_exp_f32 v87, v87
    v_cvt_pk_bf16_f32 v108, v80, v81
    v_cvt_pk_bf16_f32 v109, v82, v83
    v_cvt_pk_bf16_f32 v110, v84, v85
    v_cvt_pk_bf16_f32 v111, v86, v87
    s_waitcnt lgkmcnt(2)
    v_mfma_f32_32x32x16_bf16 v[72:87], v[44:47], v[20:23], v[144:159]
    v_exp_f32 v88, v88
    v_exp_f32 v89, v89
    v_exp_f32 v90, v90
    v_exp_f32 v91, v91
    v_mfma_f32_32x32x8_bf16 v[72:87], v[48:49], v[24:25], v[72:87]
    v_exp_f32 v92, v92
    v_exp_f32 v93, v93
    v_exp_f32 v94, v94
    v_exp_f32 v95, v95
    v_cvt_pk_bf16_f32 v112, v88, v89
    v_cvt_pk_bf16_f32 v113, v90, v91
    v_mfma_f32_32x32x16_bf16 a[32:47], v[64:67], v[104:107], a[32:47]
    v_exp_f32 v96, v96
    v_exp_f32 v97, v97
    v_exp_f32 v98, v98
    v_exp_f32 v99, v99
    v_cvt_pk_bf16_f32 v114, v92, v93
    v_cvt_pk_bf16_f32 v115, v94, v95
    v_mfma_f32_32x32x16_bf16 a[32:47], v[68:71], v[108:111], a[32:47]
    v_exp_f32 v100, v100
    v_exp_f32 v101, v101
    v_exp_f32 v102, v102
    v_exp_f32 v103, v103
    v_cvt_pk_bf16_f32 v116, v96, v97
    v_cvt_pk_bf16_f32 v117, v98, v99
    v_cvt_pk_bf16_f32 v118, v100, v101
    v_cvt_pk_bf16_f32 v119, v102, v103
    v_mfma_f32_32x32x16_bf16 v[88:103], v[44:47], v[26:29], v[160:175]
    ds_read_b128 v[50:53], v2 offset:3072
    v_exp_f32 v72, v72
    v_exp_f32 v73, v73
    v_exp_f32 v74, v74
    v_exp_f32 v75, v75
    v_mfma_f32_32x32x8_bf16 v[88:103], v[48:49], v[30:31], v[88:103]
    ds_read_b64 v[54:55], v3 offset:1536
    v_exp_f32 v76, v76
    v_exp_f32 v77, v77
    v_exp_f32 v78, v78
    v_exp_f32 v79, v79
    v_cvt_pk_bf16_f32 v104, v72, v73
    v_cvt_pk_bf16_f32 v105, v74, v75
    v_mfma_f32_32x32x16_bf16 a[48:63], v[64:67], v[112:115], a[48:63]
    v_exp_f32 v80, v80
    v_exp_f32 v81, v81
    v_exp_f32 v82, v82
    v_exp_f32 v83, v83
    v_cvt_pk_bf16_f32 v106, v76, v77
    v_cvt_pk_bf16_f32 v107, v78, v79
    v_mfma_f32_32x32x16_bf16 a[48:63], v[68:71], v[116:119], a[48:63]
    v_exp_f32 v84, v84
    v_exp_f32 v85, v85
    v_exp_f32 v86, v86
    v_exp_f32 v87, v87
    v_cvt_pk_bf16_f32 v108, v80, v81
    v_cvt_pk_bf16_f32 v109, v82, v83
    v_cvt_pk_bf16_f32 v110, v84, v85
    v_cvt_pk_bf16_f32 v111, v86, v87
    v_mfma_f32_32x32x16_bf16 v[72:87], v[44:47], v[32:35], v[176:191]
    v_exp_f32 v88, v88
    v_exp_f32 v89, v89
    v_exp_f32 v90, v90
    v_exp_f32 v91, v91
    v_mfma_f32_32x32x8_bf16 v[72:87], v[48:49], v[36:37], v[72:87]
    v_exp_f32 v92, v92
    v_exp_f32 v93, v93
    v_exp_f32 v94, v94
    v_exp_f32 v95, v95
    v_cvt_pk_bf16_f32 v112, v88, v89
    v_cvt_pk_bf16_f32 v113, v90, v91
    s_waitcnt lgkmcnt(2)
    v_mfma_f32_32x32x16_bf16 a[0:15], v[56:59], v[104:107], a[0:15]
    ds_read_b128 v[64:67], v4 offset:4224
    v_exp_f32 v96, v96
    v_exp_f32 v97, v97
    v_exp_f32 v98, v98
    v_exp_f32 v99, v99
    v_cvt_pk_bf16_f32 v114, v92, v93
    v_cvt_pk_bf16_f32 v115, v94, v95
    v_mfma_f32_32x32x16_bf16 a[0:15], v[60:63], v[108:111], a[0:15]
    v_exp_f32 v100, v100
    v_exp_f32 v101, v101
    v_exp_f32 v102, v102
    v_exp_f32 v103, v103
    v_cvt_pk_bf16_f32 v116, v96, v97
    v_cvt_pk_bf16_f32 v117, v98, v99
    v_cvt_pk_bf16_f32 v118, v100, v101
    v_cvt_pk_bf16_f32 v119, v102, v103
    v_mfma_f32_32x32x16_bf16 v[88:103], v[44:47], v[38:41], v[192:207]
    v_exp_f32 v72, v72
    v_exp_f32 v73, v73
    v_exp_f32 v74, v74
    v_exp_f32 v75, v75
    v_mfma_f32_32x32x8_bf16 v[88:103], v[48:49], v[42:43], v[88:103]
    v_exp_f32 v76, v76
    v_exp_f32 v77, v77
    v_exp_f32 v78, v78
    v_exp_f32 v79, v79
    v_cvt_pk_bf16_f32 v104, v72, v73
    v_cvt_pk_bf16_f32 v105, v74, v75
    v_mfma_f32_32x32x16_bf16 a[16:31], v[56:59], v[112:115], a[16:31]
    ds_read_b128 v[68:71], v4 offset:4928
    v_exp_f32 v80, v80
    v_exp_f32 v81, v81
    v_exp_f32 v82, v82
    v_exp_f32 v83, v83
    v_cvt_pk_bf16_f32 v106, v76, v77
    v_cvt_pk_bf16_f32 v107, v78, v79
    v_mfma_f32_32x32x16_bf16 a[16:31], v[60:63], v[116:119], a[16:31]
    v_exp_f32 v84, v84
    v_exp_f32 v85, v85
    v_exp_f32 v86, v86
    v_exp_f32 v87, v87
    v_cvt_pk_bf16_f32 v108, v80, v81
    v_cvt_pk_bf16_f32 v109, v82, v83
    v_cvt_pk_bf16_f32 v110, v84, v85
    v_cvt_pk_bf16_f32 v111, v86, v87
    s_waitcnt lgkmcnt(2)
    v_mfma_f32_32x32x16_bf16 v[72:87], v[50:53], v[20:23], v[144:159]
    v_exp_f32 v88, v88
    v_exp_f32 v89, v89
    v_exp_f32 v90, v90
    v_exp_f32 v91, v91
    v_mfma_f32_32x32x8_bf16 v[72:87], v[54:55], v[24:25], v[72:87]
    v_exp_f32 v92, v92
    v_exp_f32 v93, v93
    v_exp_f32 v94, v94
    v_exp_f32 v95, v95
    v_cvt_pk_bf16_f32 v112, v88, v89
    v_cvt_pk_bf16_f32 v113, v90, v91
    v_mfma_f32_32x32x16_bf16 a[32:47], v[56:59], v[104:107], a[32:47]
    v_exp_f32 v96, v96
    v_exp_f32 v97, v97
    v_exp_f32 v98, v98
    v_exp_f32 v99, v99
    v_cvt_pk_bf16_f32 v114, v92, v93
    v_cvt_pk_bf16_f32 v115, v94, v95
    v_mfma_f32_32x32x16_bf16 a[32:47], v[60:63], v[108:111], a[32:47]
    v_exp_f32 v100, v100
    v_exp_f32 v101, v101
    v_exp_f32 v102, v102
    v_exp_f32 v103, v103
    v_cvt_pk_bf16_f32 v116, v96, v97
    v_cvt_pk_bf16_f32 v117, v98, v99
    v_cvt_pk_bf16_f32 v118, v100, v101
    v_cvt_pk_bf16_f32 v119, v102, v103
    s_waitcnt vmcnt(0)
    s_waitcnt lgkmcnt(0)
    s_barrier
    v_mfma_f32_32x32x16_bf16 v[88:103], v[50:53], v[26:29], v[160:175]
    ds_read_b128 v[44:47], v2 offset:23552
    v_exp_f32 v72, v72
    v_exp_f32 v73, v73
    v_exp_f32 v74, v74
    v_exp_f32 v75, v75
    v_mfma_f32_32x32x8_bf16 v[88:103], v[54:55], v[30:31], v[88:103]
    ds_read_b64 v[48:49], v3 offset:23552
    v_exp_f32 v76, v76
    v_exp_f32 v77, v77
    v_exp_f32 v78, v78
    v_exp_f32 v79, v79
    v_cvt_pk_bf16_f32 v104, v72, v73
    v_cvt_pk_bf16_f32 v105, v74, v75
    v_mfma_f32_32x32x16_bf16 a[48:63], v[56:59], v[112:115], a[48:63]
    v_exp_f32 v80, v80
    v_exp_f32 v81, v81
    v_exp_f32 v82, v82
    v_exp_f32 v83, v83
    v_cvt_pk_bf16_f32 v106, v76, v77
    v_cvt_pk_bf16_f32 v107, v78, v79
    v_mfma_f32_32x32x16_bf16 a[48:63], v[60:63], v[116:119], a[48:63]
    v_exp_f32 v84, v84
    v_exp_f32 v85, v85
    v_exp_f32 v86, v86
    v_exp_f32 v87, v87
    v_cvt_pk_bf16_f32 v108, v80, v81
    v_cvt_pk_bf16_f32 v109, v82, v83
    v_cvt_pk_bf16_f32 v110, v84, v85
    v_cvt_pk_bf16_f32 v111, v86, v87
    s_cmp_ge_u32 s53, 3
    s_cbranch_scc1 L_noload_85
    s_add_u32 m0, s67, 0
    s_nop 0
    buffer_load_dwordx4 v5, s[24:27], s50 offen sc1 lds
    s_add_u32 m0, s67, 0
    s_nop 0
    buffer_load_dwordx4 v5, s[24:27], s50 offen offset:1024 sc1 lds
    s_add_u32 m0, s71, 0
    s_nop 0
    buffer_load_dwordx4 v5, s[24:27], s51 offen sc1 lds
    s_add_u32 m0, s80, 0
    s_mov_b64 exec, s[74:75]
    buffer_load_dwordx4 v6, s[24:27], s52 offen sc1 lds
    s_mov_b64 exec, -1
    s_add_u32 m0, s81, 0
    s_mov_b64 exec, s[76:77]
    buffer_load_dwordx4 v7, s[24:27], s52 offen sc1 lds
    s_mov_b64 exec, -1
    s_add_u32 m0, s82, 0
    s_mov_b64 exec, s[78:79]
    buffer_load_dwordx4 v8, s[24:27], s52 offen sc1 lds
    s_mov_b64 exec, -1
    s_add_u32 s50, s50, 4096
    s_add_u32 s51, s51, 2048
    s_add_u32 s52, s52, 5120
L_noload_85:
    v_mfma_f32_32x32x16_bf16 v[72:87], v[50:53], v[32:35], v[176:191]
    v_exp_f32 v88, v88
    v_exp_f32 v89, v89
    v_exp_f32 v90, v90
    v_exp_f32 v91, v91
    v_mfma_f32_32x32x8_bf16 v[72:87], v[54:55], v[36:37], v[72:87]
    v_exp_f32 v92, v92
    v_exp_f32 v93, v93
    v_exp_f32 v94, v94
    v_exp_f32 v95, v95
    v_cvt_pk_bf16_f32 v112, v88, v89
    v_cvt_pk_bf16_f32 v113, v90, v91
    v_mfma_f32_32x32x16_bf16 a[0:15], v[64:67], v[104:107], a[0:15]
    ds_read_b128 v[56:59], v4 offset:23552
    v_exp_f32 v96, v96
    v_exp_f32 v97, v97
    v_exp_f32 v98, v98
    v_exp_f32 v99, v99
    v_cvt_pk_bf16_f32 v114, v92, v93
    v_cvt_pk_bf16_f32 v115, v94, v95
    v_mfma_f32_32x32x16_bf16 a[0:15], v[68:71], v[108:111], a[0:15]
    v_exp_f32 v100, v100
    v_exp_f32 v101, v101
    v_exp_f32 v102, v102
    v_exp_f32 v103, v103
    v_cvt_pk_bf16_f32 v116, v96, v97
    v_cvt_pk_bf16_f32 v117, v98, v99
    v_cvt_pk_bf16_f32 v118, v100, v101
    v_cvt_pk_bf16_f32 v119, v102, v103
    v_mfma_f32_32x32x16_bf16 v[88:103], v[50:53], v[38:41], v[192:207]
    v_exp_f32 v72, v72
    v_exp_f32 v73, v73
    v_exp_f32 v74, v74
    v_exp_f32 v75, v75
    v_mfma_f32_32x32x8_bf16 v[88:103], v[54:55], v[42:43], v[88:103]
    v_exp_f32 v76, v76
    v_exp_f32 v77, v77
    v_exp_f32 v78, v78
    v_exp_f32 v79, v79
    v_cvt_pk_bf16_f32 v104, v72, v73
    v_cvt_pk_bf16_f32 v105, v74, v75
    v_mfma_f32_32x32x16_bf16 a[16:31], v[64:67], v[112:115], a[16:31]
    ds_read_b128 v[60:63], v4 offset:24256
    v_exp_f32 v80, v80
    v_exp_f32 v81, v81
    v_exp_f32 v82, v82
    v_exp_f32 v83, v83
    v_cvt_pk_bf16_f32 v106, v76, v77
    v_cvt_pk_bf16_f32 v107, v78, v79
    v_mfma_f32_32x32x16_bf16 a[16:31], v[68:71], v[116:119], a[16:31]
    v_exp_f32 v84, v84
    v_exp_f32 v85, v85
    v_exp_f32 v86, v86
    v_exp_f32 v87, v87
    v_cvt_pk_bf16_f32 v108, v80, v81
    v_cvt_pk_bf16_f32 v109, v82, v83
    v_cvt_pk_bf16_f32 v110, v84, v85
    v_cvt_pk_bf16_f32 v111, v86, v87
    s_waitcnt lgkmcnt(2)
    v_mfma_f32_32x32x16_bf16 v[72:87], v[44:47], v[20:23], v[144:159]
    v_exp_f32 v88, v88
    v_exp_f32 v89, v89
    v_exp_f32 v90, v90
    v_exp_f32 v91, v91
    v_mfma_f32_32x32x8_bf16 v[72:87], v[48:49], v[24:25], v[72:87]
    v_exp_f32 v92, v92
    v_exp_f32 v93, v93
    v_exp_f32 v94, v94
    v_exp_f32 v95, v95
    v_cvt_pk_bf16_f32 v112, v88, v89
    v_cvt_pk_bf16_f32 v113, v90, v91
    v_mfma_f32_32x32x16_bf16 a[32:47], v[64:67], v[104:107], a[32:47]
    v_exp_f32 v96, v96
    v_exp_f32 v97, v97
    v_exp_f32 v98, v98
    v_exp_f32 v99, v99
    v_cvt_pk_bf16_f32 v114, v92, v93
    v_cvt_pk_bf16_f32 v115, v94, v95
    v_mfma_f32_32x32x16_bf16 a[32:47], v[68:71], v[108:111], a[32:47]
    v_exp_f32 v100, v100
    v_exp_f32 v101, v101
    v_exp_f32 v102, v102
    v_exp_f32 v103, v103
    v_cvt_pk_bf16_f32 v116, v96, v97
    v_cvt_pk_bf16_f32 v117, v98, v99
    v_cvt_pk_bf16_f32 v118, v100, v101
    v_cvt_pk_bf16_f32 v119, v102, v103
    v_mfma_f32_32x32x16_bf16 v[88:103], v[44:47], v[26:29], v[160:175]
    ds_read_b128 v[50:53], v2 offset:24576
    v_exp_f32 v72, v72
    v_exp_f32 v73, v73
    v_exp_f32 v74, v74
    v_exp_f32 v75, v75
    v_mfma_f32_32x32x8_bf16 v[88:103], v[48:49], v[30:31], v[88:103]
    ds_read_b64 v[54:55], v3 offset:24064
    v_exp_f32 v76, v76
    v_exp_f32 v77, v77
    v_exp_f32 v78, v78
    v_exp_f32 v79, v79
    v_cvt_pk_bf16_f32 v104, v72, v73
    v_cvt_pk_bf16_f32 v105, v74, v75
    v_mfma_f32_32x32x16_bf16 a[48:63], v[64:67], v[112:115], a[48:63]
    v_exp_f32 v80, v80
    v_exp_f32 v81, v81
    v_exp_f32 v82, v82
    v_exp_f32 v83, v83
    v_cvt_pk_bf16_f32 v106, v76, v77
    v_cvt_pk_bf16_f32 v107, v78, v79
    v_mfma_f32_32x32x16_bf16 a[48:63], v[68:71], v[116:119], a[48:63]
    v_exp_f32 v84, v84
    v_exp_f32 v85, v85
    v_exp_f32 v86, v86
    v_exp_f32 v87, v87
    v_cvt_pk_bf16_f32 v108, v80, v81
    v_cvt_pk_bf16_f32 v109, v82, v83
    v_cvt_pk_bf16_f32 v110, v84, v85
    v_cvt_pk_bf16_f32 v111, v86, v87
    v_mfma_f32_32x32x16_bf16 v[72:87], v[44:47], v[32:35], v[176:191]
    v_exp_f32 v88, v88
    v_exp_f32 v89, v89
    v_exp_f32 v90, v90
    v_exp_f32 v91, v91
    v_mfma_f32_32x32x8_bf16 v[72:87], v[48:49], v[36:37], v[72:87]
    v_exp_f32 v92, v92
    v_exp_f32 v93, v93
    v_exp_f32 v94, v94
    v_exp_f32 v95, v95
    v_cvt_pk_bf16_f32 v112, v88, v89
    v_cvt_pk_bf16_f32 v113, v90, v91
    s_waitcnt lgkmcnt(2)
    v_mfma_f32_32x32x16_bf16 a[0:15], v[56:59], v[104:107], a[0:15]
    ds_read_b128 v[64:67], v4 offset:24960
    v_exp_f32 v96, v96
    v_exp_f32 v97, v97
    v_exp_f32 v98, v98
    v_exp_f32 v99, v99
    v_cvt_pk_bf16_f32 v114, v92, v93
    v_cvt_pk_bf16_f32 v115, v94, v95
    v_mfma_f32_32x32x16_bf16 a[0:15], v[60:63], v[108:111], a[0:15]
    v_exp_f32 v100, v100
    v_exp_f32 v101, v101
    v_exp_f32 v102, v102
    v_exp_f32 v103, v103
    v_cvt_pk_bf16_f32 v116, v96, v97
    v_cvt_pk_bf16_f32 v117, v98, v99
    v_cvt_pk_bf16_f32 v118, v100, v101
    v_cvt_pk_bf16_f32 v119, v102, v103
    v_mfma_f32_32x32x16_bf16 v[88:103], v[44:47], v[38:41], v[192:207]
    v_exp_f32 v72, v72
    v_exp_f32 v73, v73
    v_exp_f32 v74, v74
    v_exp_f32 v75, v75
    v_mfma_f32_32x32x8_bf16 v[88:103], v[48:49], v[42:43], v[88:103]
    v_exp_f32 v76, v76
    v_exp_f32 v77, v77
    v_exp_f32 v78, v78
    v_exp_f32 v79, v79
    v_cvt_pk_bf16_f32 v104, v72, v73
    v_cvt_pk_bf16_f32 v105, v74, v75
    v_mfma_f32_32x32x16_bf16 a[16:31], v[56:59], v[112:115], a[16:31]
    ds_read_b128 v[68:71], v4 offset:25664
    v_exp_f32 v80, v80
    v_exp_f32 v81, v81
    v_exp_f32 v82, v82
    v_exp_f32 v83, v83
    v_cvt_pk_bf16_f32 v106, v76, v77
    v_cvt_pk_bf16_f32 v107, v78, v79
    v_mfma_f32_32x32x16_bf16 a[16:31], v[60:63], v[116:119], a[16:31]
    v_exp_f32 v84, v84
    v_exp_f32 v85, v85
    v_exp_f32 v86, v86
    v_exp_f32 v87, v87
    v_cvt_pk_bf16_f32 v108, v80, v81
    v_cvt_pk_bf16_f32 v109, v82, v83
    v_cvt_pk_bf16_f32 v110, v84, v85
    v_cvt_pk_bf16_f32 v111, v86, v87
    s_waitcnt lgkmcnt(2)
    v_mfma_f32_32x32x16_bf16 v[72:87], v[50:53], v[20:23], v[144:159]
    v_exp_f32 v88, v88
    v_exp_f32 v89, v89
    v_exp_f32 v90, v90
    v_exp_f32 v91, v91
    v_mfma_f32_32x32x8_bf16 v[72:87], v[54:55], v[24:25], v[72:87]
    v_exp_f32 v92, v92
    v_exp_f32 v93, v93
    v_exp_f32 v94, v94
    v_exp_f32 v95, v95
    v_cvt_pk_bf16_f32 v112, v88, v89
    v_cvt_pk_bf16_f32 v113, v90, v91
    v_mfma_f32_32x32x16_bf16 a[32:47], v[56:59], v[104:107], a[32:47]
    v_exp_f32 v96, v96
    v_exp_f32 v97, v97
    v_exp_f32 v98, v98
    v_exp_f32 v99, v99
    v_cvt_pk_bf16_f32 v114, v92, v93
    v_cvt_pk_bf16_f32 v115, v94, v95
    v_mfma_f32_32x32x16_bf16 a[32:47], v[60:63], v[108:111], a[32:47]
    v_exp_f32 v100, v100
    v_exp_f32 v101, v101
    v_exp_f32 v102, v102
    v_exp_f32 v103, v103
    v_cvt_pk_bf16_f32 v116, v96, v97
    v_cvt_pk_bf16_f32 v117, v98, v99
    v_cvt_pk_bf16_f32 v118, v100, v101
    v_cvt_pk_bf16_f32 v119, v102, v103
    v_mfma_f32_32x32x16_bf16 v[88:103], v[50:53], v[26:29], v[160:175]
    ds_read_b128 v[44:47], v2 offset:25600
    v_exp_f32 v72, v72
    v_exp_f32 v73, v73
    v_exp_f32 v74, v74
    v_exp_f32 v75, v75
    v_mfma_f32_32x32x8_bf16 v[88:103], v[54:55], v[30:31], v[88:103]
    ds_read_b64 v[48:49], v3 offset:24576
    v_exp_f32 v76, v76
    v_exp_f32 v77, v77
    v_exp_f32 v78, v78
    v_exp_f32 v79, v79
    v_cvt_pk_bf16_f32 v104, v72, v73
    v_cvt_pk_bf16_f32 v105, v74, v75
    v_mfma_f32_32x32x16_bf16 a[48:63], v[56:59], v[112:115], a[48:63]
    v_exp_f32 v80, v80
    v_exp_f32 v81, v81
    v_exp_f32 v82, v82
    v_exp_f32 v83, v83
    v_cvt_pk_bf16_f32 v106, v76, v77
    v_cvt_pk_bf16_f32 v107, v78, v79
    v_mfma_f32_32x32x16_bf16 a[48:63], v[60:63], v[116:119], a[48:63]
    v_exp_f32 v84, v84
    v_exp_f32 v85, v85
    v_exp_f32 v86, v86
    v_exp_f32 v87, v87
    v_cvt_pk_bf16_f32 v108, v80, v81
    v_cvt_pk_bf16_f32 v109, v82, v83
    v_cvt_pk_bf16_f32 v110, v84, v85
    v_cvt_pk_bf16_f32 v111, v86, v87
    v_mfma_f32_32x32x16_bf16 v[72:87], v[50:53], v[32:35], v[176:191]
    v_exp_f32 v88, v88
    v_exp_f32 v89, v89
    v_exp_f32 v90, v90
    v_exp_f32 v91, v91
    v_mfma_f32_32x32x8_bf16 v[72:87], v[54:55], v[36:37], v[72:87]
    v_exp_f32 v92, v92
    v_exp_f32 v93, v93
    v_exp_f32 v94, v94
    v_exp_f32 v95, v95
    v_cvt_pk_bf16_f32 v112, v88, v89
    v_cvt_pk_bf16_f32 v113, v90, v91
    s_waitcnt lgkmcnt(2)
    v_mfma_f32_32x32x16_bf16 a[0:15], v[64:67], v[104:107], a[0:15]
    ds_read_b128 v[56:59], v4 offset:26368
    v_exp_f32 v96, v96
    v_exp_f32 v97, v97
    v_exp_f32 v98, v98
    v_exp_f32 v99, v99
    v_cvt_pk_bf16_f32 v114, v92, v93
    v_cvt_pk_bf16_f32 v115, v94, v95
    v_mfma_f32_32x32x16_bf16 a[0:15], v[68:71], v[108:111], a[0:15]
    v_exp_f32 v100, v100
    v_exp_f32 v101, v101
    v_exp_f32 v102, v102
    v_exp_f32 v103, v103
    v_cvt_pk_bf16_f32 v116, v96, v97
    v_cvt_pk_bf16_f32 v117, v98, v99
    v_cvt_pk_bf16_f32 v118, v100, v101
    v_cvt_pk_bf16_f32 v119, v102, v103
    v_mfma_f32_32x32x16_bf16 v[88:103], v[50:53], v[38:41], v[192:207]
    v_exp_f32 v72, v72
    v_exp_f32 v73, v73
    v_exp_f32 v74, v74
    v_exp_f32 v75, v75
    v_mfma_f32_32x32x8_bf16 v[88:103], v[54:55], v[42:43], v[88:103]
    v_exp_f32 v76, v76
    v_exp_f32 v77, v77
    v_exp_f32 v78, v78
    v_exp_f32 v79, v79
    v_cvt_pk_bf16_f32 v104, v72, v73
    v_cvt_pk_bf16_f32 v105, v74, v75
    v_mfma_f32_32x32x16_bf16 a[16:31], v[64:67], v[112:115], a[16:31]
    ds_read_b128 v[60:63], v4 offset:27072
    v_exp_f32 v80, v80
    v_exp_f32 v81, v81
    v_exp_f32 v82, v82
    v_exp_f32 v83, v83
    v_cvt_pk_bf16_f32 v106, v76, v77
    v_cvt_pk_bf16_f32 v107, v78, v79
    v_mfma_f32_32x32x16_bf16 a[16:31], v[68:71], v[116:119], a[16:31]
    v_exp_f32 v84, v84
    v_exp_f32 v85, v85
    v_exp_f32 v86, v86
    v_exp_f32 v87, v87
    v_cvt_pk_bf16_f32 v108, v80, v81
    v_cvt_pk_bf16_f32 v109, v82, v83
    v_cvt_pk_bf16_f32 v110, v84, v85
    v_cvt_pk_bf16_f32 v111, v86, v87
    s_waitcnt lgkmcnt(2)
    v_mfma_f32_32x32x16_bf16 v[72:87], v[44:47], v[20:23], v[144:159]
    v_exp_f32 v88, v88
    v_exp_f32 v89, v89
    v_exp_f32 v90, v90
    v_exp_f32 v91, v91
    v_mfma_f32_32x32x8_bf16 v[72:87], v[48:49], v[24:25], v[72:87]
    v_exp_f32 v92, v92
    v_exp_f32 v93, v93
    v_exp_f32 v94, v94
    v_exp_f32 v95, v95
    v_cvt_pk_bf16_f32 v112, v88, v89
    v_cvt_pk_bf16_f32 v113, v90, v91
    v_mfma_f32_32x32x16_bf16 a[32:47], v[64:67], v[104:107], a[32:47]
    v_exp_f32 v96, v96
    v_exp_f32 v97, v97
    v_exp_f32 v98, v98
    v_exp_f32 v99, v99
    v_cvt_pk_bf16_f32 v114, v92, v93
    v_cvt_pk_bf16_f32 v115, v94, v95
    v_mfma_f32_32x32x16_bf16 a[32:47], v[68:71], v[108:111], a[32:47]
    v_exp_f32 v100, v100
    v_exp_f32 v101, v101
    v_exp_f32 v102, v102
    v_exp_f32 v103, v103
    v_cvt_pk_bf16_f32 v116, v96, v97
    v_cvt_pk_bf16_f32 v117, v98, v99
    v_cvt_pk_bf16_f32 v118, v100, v101
    v_cvt_pk_bf16_f32 v119, v102, v103
    v_mfma_f32_32x32x16_bf16 v[88:103], v[44:47], v[26:29], v[160:175]
    ds_read_b128 v[50:53], v2 offset:26624
    v_exp_f32 v72, v72
    v_exp_f32 v73, v73
    v_exp_f32 v74, v74
    v_exp_f32 v75, v75
    v_mfma_f32_32x32x8_bf16 v[88:103], v[48:49], v[30:31], v[88:103]
    ds_read_b64 v[54:55], v3 offset:25088
    v_exp_f32 v76, v76
    v_exp_f32 v77, v77
    v_exp_f32 v78, v78
    v_exp_f32 v79, v79
    v_cvt_pk_bf16_f32 v104, v72, v73
    v_cvt_pk_bf16_f32 v105, v74, v75
    v_mfma_f32_32x32x16_bf16 a[48:63], v[64:67], v[112:115], a[48:63]
    v_exp_f32 v80, v80
    v_exp_f32 v81, v81
    v_exp_f32 v82, v82
    v_exp_f32 v83, v83
    v_cvt_pk_bf16_f32 v106, v76, v77
    v_cvt_pk_bf16_f32 v107, v78, v79
    v_mfma_f32_32x32x16_bf16 a[48:63], v[68:71], v[116:119], a[48:63]
    v_exp_f32 v84, v84
    v_exp_f32 v85, v85
    v_exp_f32 v86, v86
    v_exp_f32 v87, v87
    v_cvt_pk_bf16_f32 v108, v80, v81
    v_cvt_pk_bf16_f32 v109, v82, v83
    v_cvt_pk_bf16_f32 v110, v84, v85
    v_cvt_pk_bf16_f32 v111, v86, v87
    v_mfma_f32_32x32x16_bf16 v[72:87], v[44:47], v[32:35], v[176:191]
    v_exp_f32 v88, v88
    v_exp_f32 v89, v89
    v_exp_f32 v90, v90
    v_exp_f32 v91, v91
    v_mfma_f32_32x32x8_bf16 v[72:87], v[48:49], v[36:37], v[72:87]
    v_exp_f32 v92, v92
    v_exp_f32 v93, v93
    v_exp_f32 v94, v94
    v_exp_f32 v95, v95
    v_cvt_pk_bf16_f32 v112, v88, v89
    v_cvt_pk_bf16_f32 v113, v90, v91
    s_waitcnt lgkmcnt(2)
    v_mfma_f32_32x32x16_bf16 a[0:15], v[56:59], v[104:107], a[0:15]
    ds_read_b128 v[64:67], v4 offset:27776
    v_exp_f32 v96, v96
    v_exp_f32 v97, v97
    v_exp_f32 v98, v98
    v_exp_f32 v99, v99
    v_cvt_pk_bf16_f32 v114, v92, v93
    v_cvt_pk_bf16_f32 v115, v94, v95
    v_mfma_f32_32x32x16_bf16 a[0:15], v[60:63], v[108:111], a[0:15]
    v_exp_f32 v100, v100
    v_exp_f32 v101, v101
    v_exp_f32 v102, v102
    v_exp_f32 v103, v103
    v_cvt_pk_bf16_f32 v116, v96, v97
    v_cvt_pk_bf16_f32 v117, v98, v99
    v_cvt_pk_bf16_f32 v118, v100, v101
    v_cvt_pk_bf16_f32 v119, v102, v103
    v_mfma_f32_32x32x16_bf16 v[88:103], v[44:47], v[38:41], v[192:207]
    v_exp_f32 v72, v72
    v_exp_f32 v73, v73
    v_exp_f32 v74, v74
    v_exp_f32 v75, v75
    v_mfma_f32_32x32x8_bf16 v[88:103], v[48:49], v[42:43], v[88:103]
    v_exp_f32 v76, v76
    v_exp_f32 v77, v77
    v_exp_f32 v78, v78
    v_exp_f32 v79, v79
    v_cvt_pk_bf16_f32 v104, v72, v73
    v_cvt_pk_bf16_f32 v105, v74, v75
    v_mfma_f32_32x32x16_bf16 a[16:31], v[56:59], v[112:115], a[16:31]
    ds_read_b128 v[68:71], v4 offset:28480
    v_exp_f32 v80, v80
    v_exp_f32 v81, v81
    v_exp_f32 v82, v82
    v_exp_f32 v83, v83
    v_cvt_pk_bf16_f32 v106, v76, v77
    v_cvt_pk_bf16_f32 v107, v78, v79
    v_mfma_f32_32x32x16_bf16 a[16:31], v[60:63], v[116:119], a[16:31]
    v_exp_f32 v84, v84
    v_exp_f32 v85, v85
    v_exp_f32 v86, v86
    v_exp_f32 v87, v87
    v_cvt_pk_bf16_f32 v108, v80, v81
    v_cvt_pk_bf16_f32 v109, v82, v83
    v_cvt_pk_bf16_f32 v110, v84, v85
    v_cvt_pk_bf16_f32 v111, v86, v87
    s_waitcnt lgkmcnt(2)
    v_mfma_f32_32x32x16_bf16 v[72:87], v[50:53], v[20:23], v[144:159]
    v_exp_f32 v88, v88
    v_exp_f32 v89, v89
    v_exp_f32 v90, v90
    v_exp_f32 v91, v91
    v_mfma_f32_32x32x8_bf16 v[72:87], v[54:55], v[24:25], v[72:87]
    v_exp_f32 v92, v92
    v_exp_f32 v93, v93
    v_exp_f32 v94, v94
    v_exp_f32 v95, v95
    v_cvt_pk_bf16_f32 v112, v88, v89
    v_cvt_pk_bf16_f32 v113, v90, v91
    v_mfma_f32_32x32x16_bf16 a[32:47], v[56:59], v[104:107], a[32:47]
    v_exp_f32 v96, v96
    v_exp_f32 v97, v97
    v_exp_f32 v98, v98
    v_exp_f32 v99, v99
    v_cvt_pk_bf16_f32 v114, v92, v93
    v_cvt_pk_bf16_f32 v115, v94, v95
    v_mfma_f32_32x32x16_bf16 a[32:47], v[60:63], v[108:111], a[32:47]
    v_exp_f32 v100, v100
    v_exp_f32 v101, v101
    v_exp_f32 v102, v102
    v_exp_f32 v103, v103
    v_cvt_pk_bf16_f32 v116, v96, v97
    v_cvt_pk_bf16_f32 v117, v98, v99
    v_cvt_pk_bf16_f32 v118, v100, v101
    v_cvt_pk_bf16_f32 v119, v102, v103
    s_waitcnt vmcnt(0)
    s_waitcnt lgkmcnt(0)
    s_barrier
    v_mfma_f32_32x32x16_bf16 v[88:103], v[50:53], v[26:29], v[160:175]
    ds_read_b128 v[44:47], v2 offset:0
    v_exp_f32 v72, v72
    v_exp_f32 v73, v73
    v_exp_f32 v74, v74
    v_exp_f32 v75, v75
    v_mfma_f32_32x32x8_bf16 v[88:103], v[54:55], v[30:31], v[88:103]
    ds_read_b64 v[48:49], v3 offset:0
    v_exp_f32 v76, v76
    v_exp_f32 v77, v77
    v_exp_f32 v78, v78
    v_exp_f32 v79, v79
    v_cvt_pk_bf16_f32 v104, v72, v73
    v_cvt_pk_bf16_f32 v105, v74, v75
    v_mfma_f32_32x32x16_bf16 a[48:63], v[56:59], v[112:115], a[48:63]
    v_exp_f32 v80, v80
    v_exp_f32 v81, v81
    v_exp_f32 v82, v82
    v_exp_f32 v83, v83
    v_cvt_pk_bf16_f32 v106, v76, v77
    v_cvt_pk_bf16_f32 v107, v78, v79
    v_mfma_f32_32x32x16_bf16 a[48:63], v[60:63], v[116:119], a[48:63]
    v_exp_f32 v84, v84
    v_exp_f32 v85, v85
    v_exp_f32 v86, v86
    v_exp_f32 v87, v87
    v_cvt_pk_bf16_f32 v108, v80, v81
    v_cvt_pk_bf16_f32 v109, v82, v83
    v_cvt_pk_bf16_f32 v110, v84, v85
    v_cvt_pk_bf16_f32 v111, v86, v87
    s_cmp_ge_u32 s53, 3
    s_cbranch_scc1 L_noload_86
    s_add_u32 m0, s67, 23552
    s_nop 0
    buffer_load_dwordx4 v5, s[24:27], s50 offen sc1 lds
    s_add_u32 m0, s67, 23552
    s_nop 0
    buffer_load_dwordx4 v5, s[24:27], s50 offen offset:1024 sc1 lds
    s_add_u32 m0, s71, 23552
    s_nop 0
    buffer_load_dwordx4 v5, s[24:27], s51 offen sc1 lds
    s_add_u32 m0, s80, 23552
    s_mov_b64 exec, s[74:75]
    buffer_load_dwordx4 v6, s[24:27], s52 offen sc1 lds
    s_mov_b64 exec, -1
    s_add_u32 m0, s81, 23552
    s_mov_b64 exec, s[76:77]
    buffer_load_dwordx4 v7, s[24:27], s52 offen sc1 lds
    s_mov_b64 exec, -1
    s_add_u32 m0, s82, 23552
    s_mov_b64 exec, s[78:79]
    buffer_load_dwordx4 v8, s[24:27], s52 offen sc1 lds
    s_mov_b64 exec, -1
    s_add_u32 s50, s50, 4096
    s_add_u32 s51, s51, 2048
    s_add_u32 s52, s52, 5120
L_noload_86:
    v_mfma_f32_32x32x16_bf16 v[72:87], v[50:53], v[32:35], v[176:191]
    v_exp_f32 v88, v88
    v_exp_f32 v89, v89
    v_exp_f32 v90, v90
    v_exp_f32 v91, v91
    v_mfma_f32_32x32x8_bf16 v[72:87], v[54:55], v[36:37], v[72:87]
    v_exp_f32 v92, v92
    v_exp_f32 v93, v93
    v_exp_f32 v94, v94
    v_exp_f32 v95, v95
    v_cvt_pk_bf16_f32 v112, v88, v89
    v_cvt_pk_bf16_f32 v113, v90, v91
    v_mfma_f32_32x32x16_bf16 a[0:15], v[64:67], v[104:107], a[0:15]
    ds_read_b128 v[56:59], v4 offset:0
    v_exp_f32 v96, v96
    v_exp_f32 v97, v97
    v_exp_f32 v98, v98
    v_exp_f32 v99, v99
    v_cvt_pk_bf16_f32 v114, v92, v93
    v_cvt_pk_bf16_f32 v115, v94, v95
    v_mfma_f32_32x32x16_bf16 a[0:15], v[68:71], v[108:111], a[0:15]
    v_exp_f32 v100, v100
    v_exp_f32 v101, v101
    v_exp_f32 v102, v102
    v_exp_f32 v103, v103
    v_cvt_pk_bf16_f32 v116, v96, v97
    v_cvt_pk_bf16_f32 v117, v98, v99
    v_cvt_pk_bf16_f32 v118, v100, v101
    v_cvt_pk_bf16_f32 v119, v102, v103
    v_mfma_f32_32x32x16_bf16 v[88:103], v[50:53], v[38:41], v[192:207]
    v_exp_f32 v72, v72
    v_exp_f32 v73, v73
    v_exp_f32 v74, v74
    v_exp_f32 v75, v75
    v_mfma_f32_32x32x8_bf16 v[88:103], v[54:55], v[42:43], v[88:103]
    v_exp_f32 v76, v76
    v_exp_f32 v77, v77
    v_exp_f32 v78, v78
    v_exp_f32 v79, v79
    v_cvt_pk_bf16_f32 v104, v72, v73
    v_cvt_pk_bf16_f32 v105, v74, v75
    v_mfma_f32_32x32x16_bf16 a[16:31], v[64:67], v[112:115], a[16:31]
    ds_read_b128 v[60:63], v4 offset:704
    v_exp_f32 v80, v80
    v_exp_f32 v81, v81
    v_exp_f32 v82, v82
    v_exp_f32 v83, v83
    v_cvt_pk_bf16_f32 v106, v76, v77
    v_cvt_pk_bf16_f32 v107, v78, v79
    v_mfma_f32_32x32x16_bf16 a[16:31], v[68:71], v[116:119], a[16:31]
    v_exp_f32 v84, v84
    v_exp_f32 v85, v85
    v_exp_f32 v86, v86
    v_exp_f32 v87, v87
    v_cvt_pk_bf16_f32 v108, v80, v81
    v_cvt_pk_bf16_f32 v109, v82, v83
    v_cvt_pk_bf16_f32 v110, v84, v85
    v_cvt_pk_bf16_f32 v111, v86, v87
    s_waitcnt lgkmcnt(2)
    v_mfma_f32_32x32x16_bf16 v[72:87], v[44:47], v[20:23], v[144:159]
    v_exp_f32 v88, v88
    v_exp_f32 v89, v89
    v_exp_f32 v90, v90
    v_exp_f32 v91, v91
    v_mfma_f32_32x32x8_bf16 v[72:87], v[48:49], v[24:25], v[72:87]
    v_exp_f32 v92, v92
    v_exp_f32 v93, v93
    v_exp_f32 v94, v94
    v_exp_f32 v95, v95
    v_cvt_pk_bf16_f32 v112, v88, v89
    v_cvt_pk_bf16_f32 v113, v90, v91
    v_mfma_f32_32x32x16_bf16 a[32:47], v[64:67], v[104:107], a[32:47]
    v_exp_f32 v96, v96
    v_exp_f32 v97, v97
    v_exp_f32 v98, v98
    v_exp_f32 v99, v99
    v_cvt_pk_bf16_f32 v114, v92, v93
    v_cvt_pk_bf16_f32 v115, v94, v95
    v_mfma_f32_32x32x16_bf16 a[32:47], v[68:71], v[108:111], a[32:47]
    v_exp_f32 v100, v100
    v_exp_f32 v101, v101
    v_exp_f32 v102, v102
    v_exp_f32 v103, v103
    v_cvt_pk_bf16_f32 v116, v96, v97
    v_cvt_pk_bf16_f32 v117, v98, v99
    v_cvt_pk_bf16_f32 v118, v100, v101
    v_cvt_pk_bf16_f32 v119, v102, v103
    s_add_u32 s53, s53, 1
    s_cmp_lt_u32 s53, 4
    s_cbranch_scc1 L_att_safe_84
    s_waitcnt lgkmcnt(0)
    s_nop 1
    v_mfma_f32_32x32x16_bf16 a[48:63], v[64:67], v[112:115], a[48:63]
    v_mfma_f32_32x32x16_bf16 a[48:63], v[68:71], v[116:119], a[48:63]
    s_barrier
    s_nop 7
    s_nop 3
    s_cmp_eq_u32 s49, 1
    s_cbranch_scc1 L_kh1_87
    ds_write_b128 v131, a[32:35] offset:0
    ds_write_b128 v131, a[36:39] offset:1024
    ds_write_b128 v131, a[40:43] offset:2048
    ds_write_b128 v131, a[48:51] offset:3072
    ds_write_b128 v131, a[52:55] offset:4096
    ds_write_b128 v131, a[56:59] offset:5120
    v_accvgpr_read_b32 v72, a0
    v_accvgpr_read_b32 v73, a1
    v_accvgpr_read_b32 v74, a2
    v_accvgpr_read_b32 v75, a3
    v_accvgpr_read_b32 v76, a4
    v_accvgpr_read_b32 v77, a5
    v_accvgpr_read_b32 v78, a6
    v_accvgpr_read_b32 v79, a7
    v_accvgpr_read_b32 v80, a8
    v_accvgpr_read_b32 v81, a9
    v_accvgpr_read_b32 v82, a10
    v_accvgpr_read_b32 v83, a11
    v_accvgpr_read_b32 v84, a16
    v_accvgpr_read_b32 v85, a17
    v_accvgpr_read_b32 v86, a18
    v_accvgpr_read_b32 v87, a19
    v_accvgpr_read_b32 v88, a20
    v_accvgpr_read_b32 v89, a21
    v_accvgpr_read_b32 v90, a22
    v_accvgpr_read_b32 v91, a23
    v_accvgpr_read_b32 v92, a24
    v_accvgpr_read_b32 v93, a25
    v_accvgpr_read_b32 v94, a26
    v_accvgpr_read_b32 v95, a27
    s_branch L_khj_88
L_kh1_87:
    ds_write_b128 v131, a[0:3] offset:0
    ds_write_b128 v131, a[4:7] offset:1024
    ds_write_b128 v131, a[8:11] offset:2048
    ds_write_b128 v131, a[16:19] offset:3072
    ds_write_b128 v131, a[20:23] offset:4096
    ds_write_b128 v131, a[24:27] offset:5120
    v_accvgpr_read_b32 v72, a32
    v_accvgpr_read_b32 v73, a33
    v_accvgpr_read_b32 v74, a34
    v_accvgpr_read_b32 v75, a35
    v_accvgpr_read_b32 v76, a36
    v_accvgpr_read_b32 v77, a37
    v_accvgpr_read_b32 v78, a38
    v_accvgpr_read_b32 v79, a39
    v_accvgpr_read_b32 v80, a40
    v_accvgpr_read_b32 v81, a41
    v_accvgpr_read_b32 v82, a42
    v_accvgpr_read_b32 v83, a43
    v_accvgpr_read_b32 v84, a48
    v_accvgpr_read_b32 v85, a49
    v_accvgpr_read_b32 v86, a50
    v_accvgpr_read_b32 v87, a51
    v_accvgpr_read_b32 v88, a52
    v_accvgpr_read_b32 v89, a53
    v_accvgpr_read_b32 v90, a54
    v_accvgpr_read_b32 v91, a55
    v_accvgpr_read_b32 v92, a56
    v_accvgpr_read_b32 v93, a57
    v_accvgpr_read_b32 v94, a58
    v_accvgpr_read_b32 v95, a59
L_khj_88:
    s_waitcnt lgkmcnt(0)
    s_barrier
    ds_read_b128 v[144:147], v132 offset:0
    ds_read_b128 v[148:151], v132 offset:1024
    ds_read_b128 v[152:155], v132 offset:2048
    ds_read_b128 v[156:159], v132 offset:3072
    ds_read_b128 v[160:163], v132 offset:4096
    ds_read_b128 v[164:167], v132 offset:5120
    s_waitcnt lgkmcnt(0)
    v_pk_add_f32 v[72:73], v[72:73], v[144:145]
    v_pk_add_f32 v[74:75], v[74:75], v[146:147]
    v_pk_add_f32 v[76:77], v[76:77], v[148:149]
    v_pk_add_f32 v[78:79], v[78:79], v[150:151]
    v_pk_add_f32 v[80:81], v[80:81], v[152:153]
    v_pk_add_f32 v[82:83], v[82:83], v[154:155]
    v_pk_add_f32 v[84:85], v[84:85], v[156:157]
    v_pk_add_f32 v[86:87], v[86:87], v[158:159]
    v_pk_add_f32 v[88:89], v[88:89], v[160:161]
    v_pk_add_f32 v[90:91], v[90:91], v[162:163]
    v_pk_add_f32 v[92:93], v[92:93], v[164:165]
    v_pk_add_f32 v[94:95], v[94:95], v[166:167]
    v_mov_b32 v214, v80
    v_mov_b32 v212, v80
    v_mov_b32 v215, v92
    v_mov_b32 v213, v92
    s_nop 0
    v_permlane32_swap_b32 v214, v212
    v_permlane32_swap_b32 v215, v213
    v_rcp_f32 v212, v212
    v_rcp_f32 v213, v213
    s_nop 0
    v_mul_f32 v212, v212, v9
    v_mul_f32 v213, v213, v10
    v_pk_mul_f32 v[72:73], v[72:73], v[212:213] op_sel_hi:[1,0]
    v_pk_mul_f32 v[74:75], v[74:75], v[212:213] op_sel_hi:[1,0]
    v_cvt_pk_bf16_f32 v224, v72, v73
    v_cvt_pk_bf16_f32 v225, v74, v75
    v_pk_mul_f32 v[76:77], v[76:77], v[212:213] op_sel_hi:[1,0]
    v_pk_mul_f32 v[78:79], v[78:79], v[212:213] op_sel_hi:[1,0]
    v_cvt_pk_bf16_f32 v226, v76, v77
    v_cvt_pk_bf16_f32 v227, v78, v79
    v_pk_mul_f32 v[80:81], v[80:81], v[212:213] op_sel_hi:[1,0]
    v_pk_mul_f32 v[82:83], v[82:83], v[212:213] op_sel_hi:[1,0]
    v_cvt_pk_bf16_f32 v228, v80, v81
    v_cvt_pk_bf16_f32 v229, v82, v83
    v_pk_mul_f32 v[84:85], v[84:85], v[212:213] op_sel:[0,1] op_sel_hi:[1,1]
    v_pk_mul_f32 v[86:87], v[86:87], v[212:213] op_sel:[0,1] op_sel_hi:[1,1]
    v_cvt_pk_bf16_f32 v230, v84, v85
    v_cvt_pk_bf16_f32 v231, v86, v87
    v_pk_mul_f32 v[88:89], v[88:89], v[212:213] op_sel:[0,1] op_sel_hi:[1,1]
    v_pk_mul_f32 v[90:91], v[90:91], v[212:213] op_sel:[0,1] op_sel_hi:[1,1]
    v_cvt_pk_bf16_f32 v232, v88, v89
    v_cvt_pk_bf16_f32 v233, v90, v91
    v_pk_mul_f32 v[92:93], v[92:93], v[212:213] op_sel:[0,1] op_sel_hi:[1,1]
    v_pk_mul_f32 v[94:95], v[94:95], v[212:213] op_sel:[0,1] op_sel_hi:[1,1]
    v_cvt_pk_bf16_f32 v234, v92, v93
    v_cvt_pk_bf16_f32 v235, v94, v95
    s_waitcnt vmcnt(0)
    s_branch L_ostore_76
L_attdone_80:
    s_waitcnt vmcnt(6)
    ds_read_b128 v[128:131], v124 offset:0
    ds_read_b128 v[132:135], v124 offset:1024
    ds_read_b128 v[136:139], v124 offset:2048
    ds_read_b128 v[140:143], v124 offset:3072
    ds_read_b128 v[144:147], v124 offset:4096
    s_waitcnt lgkmcnt(0)
    v_mfma_f32_16x16x32_bf16 v[32:35], v[128:131], a[64:67], 0
    ds_read_b128 v[148:151], v124 offset:5120
    v_mfma_f32_16x16x32_bf16 v[36:39], v[128:131], a[68:71], 0
    ds_read_b128 v[152:155], v124 offset:6144
    s_add_u32 s85, s68, 25600
    v_mfma_f32_16x16x32_bf16 v[40:43], v[128:131], a[72:75], 0
    ds_read_b128 v[156:159], v124 offset:7168
    s_add_u32 m0, s70, 0
    v_mfma_f32_16x16x32_bf16 v[44:47], v[128:131], a[76:79], 0
    ds_read_b128 v[160:163], v124 offset:8192
    s_nop 0
    v_mfma_f32_16x16x32_bf16 v[48:51], v[132:135], a[64:67], 0
    ds_read_b128 v[164:167], v124 offset:9216
    buffer_load_dwordx4 v126, s[24:27], s85 offen offset:0 sc1 lds
    v_mfma_f32_16x16x32_bf16 v[52:55], v[132:135], a[68:71], 0
    v_mfma_f32_16x16x32_bf16 v[56:59], v[132:135], a[72:75], 0
    buffer_load_dwordx4 v126, s[24:27], s85 offen offset:1024 sc1 lds
    v_mfma_f32_16x16x32_bf16 v[60:63], v[132:135], a[76:79], 0
    v_mfma_f32_16x16x32_bf16 v[64:67], v[136:139], a[64:67], 0
    v_mfma_f32_16x16x32_bf16 v[68:71], v[136:139], a[68:71], 0
    v_mfma_f32_16x16x32_bf16 v[72:75], v[136:139], a[72:75], 0
    buffer_load_dwordx4 v126, s[24:27], s85 offen offset:2048 sc1 lds
    v_mfma_f32_16x16x32_bf16 v[76:79], v[136:139], a[76:79], 0
    v_mfma_f32_16x16x32_bf16 v[80:83], v[140:143], a[64:67], 0
    v_mfma_f32_16x16x32_bf16 v[84:87], v[140:143], a[68:71], 0
    v_mfma_f32_16x16x32_bf16 v[88:91], v[140:143], a[72:75], 0
    buffer_load_dwordx4 v126, s[24:27], s85 offen offset:3072 sc1 lds
    v_mfma_f32_16x16x32_bf16 v[92:95], v[140:143], a[76:79], 0
    v_mfma_f32_16x16x32_bf16 v[96:99], v[144:147], a[64:67], 0
    v_mfma_f32_16x16x32_bf16 v[100:103], v[144:147], a[68:71], 0
    s_add_u32 s85, s85, 4096
    s_add_u32 m0, s70, 4096
    v_mfma_f32_16x16x32_bf16 v[104:107], v[144:147], a[72:75], 0
    s_nop 0
    buffer_load_dwordx4 v126, s[24:27], s85 offen offset:0 sc1 lds
    v_mfma_f32_16x16x32_bf16 v[108:111], v[144:147], a[76:79], 0
    s_waitcnt lgkmcnt(0)
    v_mfma_f32_16x16x32_bf16 v[32:35], v[148:151], a[80:83], v[32:35]
    ds_read_b128 v[128:131], v124 offset:10240
    v_mfma_f32_16x16x32_bf16 v[36:39], v[148:151], a[84:87], v[36:39]
    ds_read_b128 v[132:135], v124 offset:11264
    s_add_u32 s85, s68, 30720
    v_mfma_f32_16x16x32_bf16 v[40:43], v[148:151], a[88:91], v[40:43]
    ds_read_b128 v[136:139], v124 offset:12288
    s_add_u32 m0, s70, 5120
    v_mfma_f32_16x16x32_bf16 v[44:47], v[148:151], a[92:95], v[44:47]
    ds_read_b128 v[140:143], v124 offset:13312
    s_nop 0
    v_mfma_f32_16x16x32_bf16 v[48:51], v[152:155], a[80:83], v[48:51]
    ds_read_b128 v[144:147], v124 offset:14336
    buffer_load_dwordx4 v126, s[24:27], s85 offen offset:0 sc1 lds
    v_mfma_f32_16x16x32_bf16 v[52:55], v[152:155], a[84:87], v[52:55]
    v_mfma_f32_16x16x32_bf16 v[56:59], v[152:155], a[88:91], v[56:59]
    buffer_load_dwordx4 v126, s[24:27], s85 offen offset:1024 sc1 lds
    v_mfma_f32_16x16x32_bf16 v[60:63], v[152:155], a[92:95], v[60:63]
    v_mfma_f32_16x16x32_bf16 v[64:67], v[156:159], a[80:83], v[64:67]
    v_mfma_f32_16x16x32_bf16 v[68:71], v[156:159], a[84:87], v[68:71]
    v_mfma_f32_16x16x32_bf16 v[72:75], v[156:159], a[88:91], v[72:75]
    buffer_load_dwordx4 v126, s[24:27], s85 offen offset:2048 sc1 lds
    v_mfma_f32_16x16x32_bf16 v[76:79], v[156:159], a[92:95], v[76:79]
    v_mfma_f32_16x16x32_bf16 v[80:83], v[160:163], a[80:83], v[80:83]
    v_mfma_f32_16x16x32_bf16 v[84:87], v[160:163], a[84:87], v[84:87]
    v_mfma_f32_16x16x32_bf16 v[88:91], v[160:163], a[88:91], v[88:91]
    buffer_load_dwordx4 v126, s[24:27], s85 offen offset:3072 sc1 lds
    v_mfma_f32_16x16x32_bf16 v[92:95], v[160:163], a[92:95], v[92:95]
    v_mfma_f32_16x16x32_bf16 v[96:99], v[164:167], a[80:83], v[96:99]
    v_mfma_f32_16x16x32_bf16 v[100:103], v[164:167], a[84:87], v[100:103]
    s_add_u32 s85, s85, 4096
    s_add_u32 m0, s70, 9216
    v_mfma_f32_16x16x32_bf16 v[104:107], v[164:167], a[88:91], v[104:107]
    s_nop 0
    buffer_load_dwordx4 v126, s[24:27], s85 offen offset:0 sc1 lds
    v_mfma_f32_16x16x32_bf16 v[108:111], v[164:167], a[92:95], v[108:111]
    s_waitcnt lgkmcnt(0)
    v_mfma_f32_16x16x32_bf16 v[32:35], v[128:131], a[96:99], v[32:35]
    ds_read_b128 v[148:151], v124 offset:15360
    v_mfma_f32_16x16x32_bf16 v[36:39], v[128:131], a[100:103], v[36:39]
    ds_read_b128 v[152:155], v124 offset:16384
    s_add_u32 s85, s68, 35840
    v_mfma_f32_16x16x32_bf16 v[40:43], v[128:131], a[104:107], v[40:43]
    ds_read_b128 v[156:159], v124 offset:17408
    s_add_u32 m0, s70, 10240
    v_mfma_f32_16x16x32_bf16 v[44:47], v[128:131], a[108:111], v[44:47]
    ds_read_b128 v[160:163], v124 offset:18432
    s_nop 0
    v_mfma_f32_16x16x32_bf16 v[48:51], v[132:135], a[96:99], v[48:51]
    ds_read_b128 v[164:167], v124 offset:19456
    buffer_load_dwordx4 v126, s[24:27], s85 offen offset:0 sc1 lds
    v_mfma_f32_16x16x32_bf16 v[52:55], v[132:135], a[100:103], v[52:55]
    v_mfma_f32_16x16x32_bf16 v[56:59], v[132:135], a[104:107], v[56:59]
    buffer_load_dwordx4 v126, s[24:27], s85 offen offset:1024 sc1 lds
    v_mfma_f32_16x16x32_bf16 v[60:63], v[132:135], a[108:111], v[60:63]
    v_mfma_f32_16x16x32_bf16 v[64:67], v[136:139], a[96:99], v[64:67]
    v_mfma_f32_16x16x32_bf16 v[68:71], v[136:139], a[100:103], v[68:71]
    v_mfma_f32_16x16x32_bf16 v[72:75], v[136:139], a[104:107], v[72:75]
    buffer_load_dwordx4 v126, s[24:27], s85 offen offset:2048 sc1 lds
    v_mfma_f32_16x16x32_bf16 v[76:79], v[136:139], a[108:111], v[76:79]
    v_mfma_f32_16x16x32_bf16 v[80:83], v[140:143], a[96:99], v[80:83]
    v_mfma_f32_16x16x32_bf16 v[84:87], v[140:143], a[100:103], v[84:87]
    v_mfma_f32_16x16x32_bf16 v[88:91], v[140:143], a[104:107], v[88:91]
    buffer_load_dwordx4 v126, s[24:27], s85 offen offset:3072 sc1 lds
    v_mfma_f32_16x16x32_bf16 v[92:95], v[140:143], a[108:111], v[92:95]
    v_mfma_f32_16x16x32_bf16 v[96:99], v[144:147], a[96:99], v[96:99]
    v_mfma_f32_16x16x32_bf16 v[100:103], v[144:147], a[100:103], v[100:103]
    s_add_u32 s85, s85, 4096
    s_add_u32 m0, s70, 14336
    v_mfma_f32_16x16x32_bf16 v[104:107], v[144:147], a[104:107], v[104:107]
    s_nop 0
    buffer_load_dwordx4 v126, s[24:27], s85 offen offset:0 sc1 lds
    v_mfma_f32_16x16x32_bf16 v[108:111], v[144:147], a[108:111], v[108:111]
    s_waitcnt lgkmcnt(0)
    s_waitcnt vmcnt(15)
    s_barrier
    s_cmp_lg_u32 s40, 0
    s_cbranch_scc1 L_noflag_89
    s_mov_b64 exec, 1
    v_mov_b32 v240, s2
    v_mov_b32 v241, s3
    v_mov_b32 v242, 0
    buffer_store_dwordx2 v[240:241], v242, s[24:27], s100 offen sc1
    s_mov_b64 exec, -1
L_noflag_89:
    v_mfma_f32_16x16x32_bf16 v[32:35], v[148:151], a[112:115], v[32:35]
    ds_read_b128 v[128:131], v124 offset:20480
    v_mfma_f32_16x16x32_bf16 v[36:39], v[148:151], a[116:119], v[36:39]
    ds_read_b128 v[132:135], v124 offset:21504
    s_add_u32 s85, s68, 40960
    v_mfma_f32_16x16x32_bf16 v[40:43], v[148:151], a[120:123], v[40:43]
    ds_read_b128 v[136:139], v124 offset:22528
    s_add_u32 m0, s70, 15360
    v_mfma_f32_16x16x32_bf16 v[44:47], v[148:151], a[124:127], v[44:47]
    ds_read_b128 v[140:143], v124 offset:23552
    s_nop 0
    v_mfma_f32_16x16x32_bf16 v[48:51], v[152:155], a[112:115], v[48:51]
    ds_read_b128 v[144:147], v124 offset:24576
    buffer_load_dwordx4 v126, s[24:27], s85 offen offset:0 sc1 lds
    v_mfma_f32_16x16x32_bf16 v[52:55], v[152:155], a[116:119], v[52:55]
    v_mfma_f32_16x16x32_bf16 v[56:59], v[152:155], a[120:123], v[56:59]
    buffer_load_dwordx4 v126, s[24:27], s85 offen offset:1024 sc1 lds
    v_mfma_f32_16x16x32_bf16 v[60:63], v[152:155], a[124:127], v[60:63]
    v_mfma_f32_16x16x32_bf16 v[64:67], v[156:159], a[112:115], v[64:67]
    v_mfma_f32_16x16x32_bf16 v[68:71], v[156:159], a[116:119], v[68:71]
    v_mfma_f32_16x16x32_bf16 v[72:75], v[156:159], a[120:123], v[72:75]
    buffer_load_dwordx4 v126, s[24:27], s85 offen offset:2048 sc1 lds
    v_mfma_f32_16x16x32_bf16 v[76:79], v[156:159], a[124:127], v[76:79]
    v_mfma_f32_16x16x32_bf16 v[80:83], v[160:163], a[112:115], v[80:83]
    v_mfma_f32_16x16x32_bf16 v[84:87], v[160:163], a[116:119], v[84:87]
    v_mfma_f32_16x16x32_bf16 v[88:91], v[160:163], a[120:123], v[88:91]
    buffer_load_dwordx4 v126, s[24:27], s85 offen offset:3072 sc1 lds
    v_mfma_f32_16x16x32_bf16 v[92:95], v[160:163], a[124:127], v[92:95]
    v_mfma_f32_16x16x32_bf16 v[96:99], v[164:167], a[112:115], v[96:99]
    v_mfma_f32_16x16x32_bf16 v[100:103], v[164:167], a[116:119], v[100:103]
    s_add_u32 s85, s85, 4096
    s_add_u32 m0, s70, 19456
    v_mfma_f32_16x16x32_bf16 v[104:107], v[164:167], a[120:123], v[104:107]
    s_nop 0
    buffer_load_dwordx4 v126, s[24:27], s85 offen offset:0 sc1 lds
    v_mfma_f32_16x16x32_bf16 v[108:111], v[164:167], a[124:127], v[108:111]
    s_waitcnt lgkmcnt(0)
    s_waitcnt vmcnt(15)
    v_mfma_f32_16x16x32_bf16 v[32:35], v[128:131], a[128:131], v[32:35]
    ds_read_b128 v[148:151], v124 offset:0
    v_mfma_f32_16x16x32_bf16 v[36:39], v[128:131], a[132:135], v[36:39]
    ds_read_b128 v[152:155], v124 offset:1024
    s_add_u32 s85, s68, 46080
    v_mfma_f32_16x16x32_bf16 v[40:43], v[128:131], a[136:139], v[40:43]
    ds_read_b128 v[156:159], v124 offset:2048
    s_add_u32 m0, s70, 20480
    v_mfma_f32_16x16x32_bf16 v[44:47], v[128:131], a[140:143], v[44:47]
    ds_read_b128 v[160:163], v124 offset:3072
    s_nop 0
    v_mfma_f32_16x16x32_bf16 v[48:51], v[132:135], a[128:131], v[48:51]
    ds_read_b128 v[164:167], v124 offset:4096
    buffer_load_dwordx4 v126, s[24:27], s85 offen offset:0 sc1 lds
    v_mfma_f32_16x16x32_bf16 v[52:55], v[132:135], a[132:135], v[52:55]
    v_mfma_f32_16x16x32_bf16 v[56:59], v[132:135], a[136:139], v[56:59]
    buffer_load_dwordx4 v126, s[24:27], s85 offen offset:1024 sc1 lds
    v_mfma_f32_16x16x32_bf16 v[60:63], v[132:135], a[140:143], v[60:63]
    v_mfma_f32_16x16x32_bf16 v[64:67], v[136:139], a[128:131], v[64:67]
    v_mfma_f32_16x16x32_bf16 v[68:71], v[136:139], a[132:135], v[68:71]
    v_mfma_f32_16x16x32_bf16 v[72:75], v[136:139], a[136:139], v[72:75]
    buffer_load_dwordx4 v126, s[24:27], s85 offen offset:2048 sc1 lds
    v_and_b32 v1, 63, v0
    v_mfma_f32_16x16x32_bf16 v[76:79], v[136:139], a[140:143], v[76:79]
    v_and_b32 v2, 15, v0
    v_mfma_f32_16x16x32_bf16 v[80:83], v[140:143], a[128:131], v[80:83]
    v_lshrrev_b32 v3, 4, v1
    v_mfma_f32_16x16x32_bf16 v[84:87], v[140:143], a[132:135], v[84:87]
    s_lshl_b32 s54, s42, 6
    v_mfma_f32_16x16x32_bf16 v[88:91], v[140:143], a[136:139], v[88:91]
    buffer_load_dwordx4 v126, s[24:27], s85 offen offset:3072 sc1 lds
    s_lshl_b32 s55, s40, 4
    v_mfma_f32_16x16x32_bf16 v[92:95], v[140:143], a[140:143], v[92:95]
    s_add_u32 s54, s54, s55
    v_mfma_f32_16x16x32_bf16 v[96:99], v[144:147], a[128:131], v[96:99]
    v_add_u32 v21, s54, v2
    v_mfma_f32_16x16x32_bf16 v[100:103], v[144:147], a[132:135], v[100:103]
    s_add_u32 s85, s85, 4096
    v_lshlrev_b32 v22, 4, v21
    v_mfma_f32_16x16x32_bf16 v[104:107], v[144:147], a[136:139], v[104:107]
    s_add_u32 m0, s70, 24576
    buffer_load_dword v4, v22, s[24:27], 0 offen offset:12 sc1
    v_mfma_f32_16x16x32_bf16 v[108:111], v[144:147], a[140:143], v[108:111]
    s_nop 0
    s_mul_i32 s56, s43, 160
    s_waitcnt lgkmcnt(0)
    s_waitcnt vmcnt(15)
    v_mfma_f32_16x16x32_bf16 v[32:35], v[148:151], a[144:147], v[32:35]
    ds_read_b128 v[128:131], v124 offset:5120
    buffer_load_dwordx4 v126, s[24:27], s85 offen offset:0 sc1 lds
    v_mfma_f32_16x16x32_bf16 v[36:39], v[148:151], a[148:151], v[36:39]
    ds_read_b128 v[132:135], v124 offset:6144
    s_add_u32 s85, s68, 51200
    v_mfma_f32_16x16x32_bf16 v[40:43], v[148:151], a[152:155], v[40:43]
    ds_read_b128 v[136:139], v124 offset:7168
    s_add_u32 m0, s70, 0
    v_mfma_f32_16x16x32_bf16 v[44:47], v[148:151], a[156:159], v[44:47]
    ds_read_b128 v[140:143], v124 offset:8192
    s_nop 0
    v_mfma_f32_16x16x32_bf16 v[48:51], v[152:155], a[144:147], v[48:51]
    ds_read_b128 v[144:147], v124 offset:9216
    buffer_load_dwordx4 v126, s[24:27], s85 offen offset:0 sc1 lds
    v_mfma_f32_16x16x32_bf16 v[52:55], v[152:155], a[148:151], v[52:55]
    v_lshlrev_b32 v23, 3, v3
    v_add_u32 v23, s56, v23
    v_mfma_f32_16x16x32_bf16 v[56:59], v[152:155], a[152:155], v[56:59]
    buffer_load_dwordx4 v126, s[24:27], s85 offen offset:1024 sc1 lds
    global_load_dwordx2 v[6:7], v23, s[34:35] offset:0
    v_mfma_f32_16x16x32_bf16 v[60:63], v[152:155], a[156:159], v[60:63]
    global_load_dwordx2 v[8:9], v23, s[34:35] offset:32
    global_load_dwordx2 v[10:11], v23, s[34:35] offset:64
    v_mfma_f32_16x16x32_bf16 v[64:67], v[156:159], a[144:147], v[64:67]
    global_load_dwordx2 v[12:13], v23, s[34:35] offset:96
    global_load_dwordx2 v[14:15], v23, s[34:35] offset:128
    v_mfma_f32_16x16x32_bf16 v[68:71], v[156:159], a[148:151], v[68:71]
    s_mul_i32 s57, s40, 20480
    v_add_u32 v16, s57, v126
    v_mfma_f32_16x16x32_bf16 v[72:75], v[156:159], a[152:155], v[72:75]
    buffer_load_dwordx4 v126, s[24:27], s85 offen offset:2048 sc1 lds
    s_mul_i32 s57, s40, 5120
    v_mfma_f32_16x16x32_bf16 v[76:79], v[156:159], a[156:159], v[76:79]
    v_add_u32 v17, s57, v126
    v_mul_u32_u24 v21, 1280, v21
    v_mfma_f32_16x16x32_bf16 v[80:83], v[160:163], a[144:147], v[80:83]
    v_add_u32 v21, s56, v21
    v_mfma_f32_16x16x32_bf16 v[84:87], v[160:163], a[148:151], v[84:87]
    v_and_b32 v22, 1, v3
    v_mfma_f32_16x16x32_bf16 v[88:91], v[160:163], a[152:155], v[88:91]
    buffer_load_dwordx4 v126, s[24:27], s85 offen offset:3072 sc1 lds
    v_lshlrev_b32 v22, 5, v22
    v_mfma_f32_16x16x32_bf16 v[92:95], v[160:163], a[156:159], v[92:95]
    v_lshrrev_b32 v24, 1, v3
    v_mfma_f32_16x16x32_bf16 v[96:99], v[164:167], a[144:147], v[96:99]
    v_lshl_add_u32 v22, v24, 4, v22
    v_mfma_f32_16x16x32_bf16 v[100:103], v[164:167], a[148:151], v[100:103]
    s_add_u32 s85, s85, 4096
    v_add_u32 v18, v21, v22
    v_mfma_f32_16x16x32_bf16 v[104:107], v[164:167], a[152:155], v[104:107]
    s_add_u32 m0, s70, 4096
    v_lshlrev_b32 v22, 3, v3
    v_mfma_f32_16x16x32_bf16 v[108:111], v[164:167], a[156:159], v[108:111]
    s_nop 0
    v_add_u32 v19, v21, v22
    s_waitcnt lgkmcnt(0)
    s_waitcnt vmcnt(20)
    v_mfma_f32_16x16x32_bf16 v[32:35], v[128:131], a[160:163], v[32:35]
    ds_read_b128 v[148:151], v124 offset:10240
    buffer_load_dwordx4 v126, s[24:27], s85 offen offset:0 sc1 lds
    v_mfma_f32_16x16x32_bf16 v[36:39], v[128:131], a[164:167], v[36:39]
    ds_read_b128 v[152:155], v124 offset:11264
    s_add_u32 s85, s68, 56320
    v_mfma_f32_16x16x32_bf16 v[40:43], v[128:131], a[168:171], v[40:43]
    ds_read_b128 v[156:159], v124 offset:12288
    s_add_u32 m0, s70, 5120
    v_mfma_f32_16x16x32_bf16 v[44:47], v[128:131], a[172:175], v[44:47]
    ds_read_b128 v[160:163], v124 offset:13312
    s_nop 0
    v_mfma_f32_16x16x32_bf16 v[48:51], v[132:135], a[160:163], v[48:51]
    ds_read_b128 v[164:167], v124 offset:14336
    buffer_load_dwordx4 v126, s[24:27], s85 offen offset:0 sc1 lds
    v_mfma_f32_16x16x32_bf16 v[52:55], v[132:135], a[164:167], v[52:55]
    v_mfma_f32_16x16x32_bf16 v[56:59], v[132:135], a[168:171], v[56:59]
    buffer_load_dwordx4 v126, s[24:27], s85 offen offset:1024 sc1 lds
    v_mfma_f32_16x16x32_bf16 v[60:63], v[132:135], a[172:175], v[60:63]
    v_mfma_f32_16x16x32_bf16 v[64:67], v[136:139], a[160:163], v[64:67]
    v_mfma_f32_16x16x32_bf16 v[68:71], v[136:139], a[164:167], v[68:71]
    v_mfma_f32_16x16x32_bf16 v[72:75], v[136:139], a[168:171], v[72:75]
    buffer_load_dwordx4 v126, s[24:27], s85 offen offset:2048 sc1 lds
    v_mfma_f32_16x16x32_bf16 v[76:79], v[136:139], a[172:175], v[76:79]
    v_mfma_f32_16x16x32_bf16 v[80:83], v[140:143], a[160:163], v[80:83]
    v_mfma_f32_16x16x32_bf16 v[84:87], v[140:143], a[164:167], v[84:87]
    v_mfma_f32_16x16x32_bf16 v[88:91], v[140:143], a[168:171], v[88:91]
    buffer_load_dwordx4 v126, s[24:27], s85 offen offset:3072 sc1 lds
    v_mfma_f32_16x16x32_bf16 v[92:95], v[140:143], a[172:175], v[92:95]
    v_mfma_f32_16x16x32_bf16 v[96:99], v[144:147], a[160:163], v[96:99]
    v_mfma_f32_16x16x32_bf16 v[100:103], v[144:147], a[164:167], v[100:103]
    s_add_u32 s85, s85, 4096
    s_add_u32 m0, s70, 9216
    v_mfma_f32_16x16x32_bf16 v[104:107], v[144:147], a[168:171], v[104:107]
    s_nop 0
    buffer_load_dwordx4 v126, s[24:27], s85 offen offset:0 sc1 lds
    v_mfma_f32_16x16x32_bf16 v[108:111], v[144:147], a[172:175], v[108:111]
    s_waitcnt lgkmcnt(0)
    s_waitcnt vmcnt(21)
    v_mfma_f32_16x16x32_bf16 v[32:35], v[148:151], a[176:179], v[32:35]
    ds_read_b128 v[128:131], v124 offset:15360
    v_mfma_f32_16x16x32_bf16 v[36:39], v[148:151], a[180:183], v[36:39]
    ds_read_b128 v[132:135], v124 offset:16384
    s_add_u32 s85, s69, 0
    v_mfma_f32_16x16x32_bf16 v[40:43], v[148:151], a[184:187], v[40:43]
    ds_read_b128 v[136:139], v124 offset:17408
    s_add_u32 m0, s70, 10240
    v_mfma_f32_16x16x32_bf16 v[44:47], v[148:151], a[188:191], v[44:47]
    ds_read_b128 v[140:143], v124 offset:18432
    s_nop 0
    v_mfma_f32_16x16x32_bf16 v[48:51], v[152:155], a[176:179], v[48:51]
    ds_read_b128 v[144:147], v124 offset:19456
    buffer_load_dwordx4 v126, s[24:27], s85 offen offset:0 sc1 lds
    v_mfma_f32_16x16x32_bf16 v[52:55], v[152:155], a[180:183], v[52:55]
    v_mfma_f32_16x16x32_bf16 v[56:59], v[152:155], a[184:187], v[56:59]
    buffer_load_dwordx4 v126, s[24:27], s85 offen offset:1024 sc1 lds
    v_mfma_f32_16x16x32_bf16 v[60:63], v[152:155], a[188:191], v[60:63]
    v_mfma_f32_16x16x32_bf16 v[64:67], v[156:159], a[176:179], v[64:67]
    v_mfma_f32_16x16x32_bf16 v[68:71], v[156:159], a[180:183], v[68:71]
    v_mfma_f32_16x16x32_bf16 v[72:75], v[156:159], a[184:187], v[72:75]
    buffer_load_dwordx4 v126, s[24:27], s85 offen offset:2048 sc1 lds
    v_mfma_f32_16x16x32_bf16 v[76:79], v[156:159], a[188:191], v[76:79]
    v_mfma_f32_16x16x32_bf16 v[80:83], v[160:163], a[176:179], v[80:83]
    v_mfma_f32_16x16x32_bf16 v[84:87], v[160:163], a[180:183], v[84:87]
    v_mfma_f32_16x16x32_bf16 v[88:91], v[160:163], a[184:187], v[88:91]
    buffer_load_dwordx4 v126, s[24:27], s85 offen offset:3072 sc1 lds
    v_mfma_f32_16x16x32_bf16 v[92:95], v[160:163], a[188:191], v[92:95]
    v_mfma_f32_16x16x32_bf16 v[96:99], v[164:167], a[176:179], v[96:99]
    v_mfma_f32_16x16x32_bf16 v[100:103], v[164:167], a[180:183], v[100:103]
    s_add_u32 s85, s85, 4096
    s_add_u32 m0, s70, 14336
    v_mfma_f32_16x16x32_bf16 v[104:107], v[164:167], a[184:187], v[104:107]
    s_nop 0
    buffer_load_dwordx4 v126, s[24:27], s85 offen offset:0 sc1 lds
    v_mfma_f32_16x16x32_bf16 v[108:111], v[164:167], a[188:191], v[108:111]
    s_waitcnt lgkmcnt(0)
    s_waitcnt vmcnt(20)
    v_mfma_f32_16x16x32_bf16 v[32:35], v[128:131], a[192:195], v[32:35]
    ds_read_b128 v[148:151], v124 offset:20480
    v_mfma_f32_16x16x32_bf16 v[36:39], v[128:131], a[196:199], v[36:39]
    ds_read_b128 v[152:155], v124 offset:21504
    s_add_u32 s85, s69, 5120
    v_mfma_f32_16x16x32_bf16 v[40:43], v[128:131], a[200:203], v[40:43]
    ds_read_b128 v[156:159], v124 offset:22528
    s_add_u32 m0, s70, 15360
    v_mfma_f32_16x16x32_bf16 v[44:47], v[128:131], a[204:207], v[44:47]
    ds_read_b128 v[160:163], v124 offset:23552
    s_nop 0
    v_mfma_f32_16x16x32_bf16 v[48:51], v[132:135], a[192:195], v[48:51]
    ds_read_b128 v[164:167], v124 offset:24576
    buffer_load_dwordx4 v126, s[24:27], s85 offen offset:0 sc1 lds
    v_mfma_f32_16x16x32_bf16 v[52:55], v[132:135], a[196:199], v[52:55]
    v_mfma_f32_16x16x32_bf16 v[56:59], v[132:135], a[200:203], v[56:59]
    buffer_load_dwordx4 v126, s[24:27], s85 offen offset:1024 sc1 lds
    v_mfma_f32_16x16x32_bf16 v[60:63], v[132:135], a[204:207], v[60:63]
    v_mfma_f32_16x16x32_bf16 v[64:67], v[136:139], a[192:195], v[64:67]
    v_mfma_f32_16x16x32_bf16 v[68:71], v[136:139], a[196:199], v[68:71]
    v_mfma_f32_16x16x32_bf16 v[72:75], v[136:139], a[200:203], v[72:75]
    buffer_load_dwordx4 v126, s[24:27], s85 offen offset:2048 sc1 lds
    v_mfma_f32_16x16x32_bf16 v[76:79], v[136:139], a[204:207], v[76:79]
    v_mfma_f32_16x16x32_bf16 v[80:83], v[140:143], a[192:195], v[80:83]
    v_mfma_f32_16x16x32_bf16 v[84:87], v[140:143], a[196:199], v[84:87]
    v_mfma_f32_16x16x32_bf16 v[88:91], v[140:143], a[200:203], v[88:91]
    buffer_load_dwordx4 v126, s[24:27], s85 offen offset:3072 sc1 lds
    v_mfma_f32_16x16x32_bf16 v[92:95], v[140:143], a[204:207], v[92:95]
    v_mfma_f32_16x16x32_bf16 v[96:99], v[144:147], a[192:195], v[96:99]
    v_mfma_f32_16x16x32_bf16 v[100:103], v[144:147], a[196:199], v[100:103]
    s_add_u32 s85, s85, 4096
    s_add_u32 m0, s70, 19456
    v_mfma_f32_16x16x32_bf16 v[104:107], v[144:147], a[200:203], v[104:107]
    s_nop 0
    buffer_load_dwordx4 v126, s[24:27], s85 offen offset:0 sc1 lds
    v_mfma_f32_16x16x32_bf16 v[108:111], v[144:147], a[204:207], v[108:111]
    s_waitcnt lgkmcnt(0)
    s_waitcnt vmcnt(15)
    v_mfma_f32_16x16x32_bf16 v[32:35], v[148:151], a[208:211], v[32:35]
    ds_read_b128 v[128:131], v124 offset:0
    v_mfma_f32_16x16x32_bf16 v[36:39], v[148:151], a[212:215], v[36:39]
    ds_read_b128 v[132:135], v124 offset:1024
    s_add_u32 s85, s69, 10240
    v_mfma_f32_16x16x32_bf16 v[40:43], v[148:151], a[216:219], v[40:43]
    ds_read_b128 v[136:139], v124 offset:2048
    s_add_u32 m0, s70, 20480
    v_mfma_f32_16x16x32_bf16 v[44:47], v[148:151], a[220:223], v[44:47]
    ds_read_b128 v[140:143], v124 offset:3072
    s_nop 0
    v_mfma_f32_16x16x32_bf16 v[48:51], v[152:155], a[208:211], v[48:51]
    ds_read_b128 v[144:147], v124 offset:4096
    buffer_load_dwordx4 v126, s[24:27], s85 offen offset:0 sc1 lds
    v_mfma_f32_16x16x32_bf16 v[52:55], v[152:155], a[212:215], v[52:55]
    v_mfma_f32_16x16x32_bf16 v[56:59], v[152:155], a[216:219], v[56:59]
    buffer_load_dwordx4 v126, s[24:27], s85 offen offset:1024 sc1 lds
    v_mfma_f32_16x16x32_bf16 v[60:63], v[152:155], a[220:223], v[60:63]
    v_mfma_f32_16x16x32_bf16 v[64:67], v[156:159], a[208:211], v[64:67]
    v_mfma_f32_16x16x32_bf16 v[68:71], v[156:159], a[212:215], v[68:71]
    v_mfma_f32_16x16x32_bf16 v[72:75], v[156:159], a[216:219], v[72:75]
    buffer_load_dwordx4 v126, s[24:27], s85 offen offset:2048 sc1 lds
    v_mfma_f32_16x16x32_bf16 v[76:79], v[156:159], a[220:223], v[76:79]
    v_mfma_f32_16x16x32_bf16 v[80:83], v[160:163], a[208:211], v[80:83]
    v_mfma_f32_16x16x32_bf16 v[84:87], v[160:163], a[212:215], v[84:87]
    v_mfma_f32_16x16x32_bf16 v[88:91], v[160:163], a[216:219], v[88:91]
    buffer_load_dwordx4 v126, s[24:27], s85 offen offset:3072 sc1 lds
    v_mfma_f32_16x16x32_bf16 v[92:95], v[160:163], a[220:223], v[92:95]
    v_mfma_f32_16x16x32_bf16 v[96:99], v[164:167], a[208:211], v[96:99]
    v_mfma_f32_16x16x32_bf16 v[100:103], v[164:167], a[212:215], v[100:103]
    s_add_u32 s85, s85, 4096
    s_add_u32 m0, s70, 24576
    v_mfma_f32_16x16x32_bf16 v[104:107], v[164:167], a[216:219], v[104:107]
    s_nop 0
    buffer_load_dwordx4 v126, s[24:27], s85 offen offset:0 sc1 lds
    v_mfma_f32_16x16x32_bf16 v[108:111], v[164:167], a[220:223], v[108:111]
    s_waitcnt lgkmcnt(0)
    s_waitcnt vmcnt(15)
    v_mfma_f32_16x16x32_bf16 v[32:35], v[128:131], a[224:227], v[32:35]
    ds_read_b128 v[148:151], v124 offset:5120
    v_mfma_f32_16x16x32_bf16 v[36:39], v[128:131], a[228:231], v[36:39]
    ds_read_b128 v[152:155], v124 offset:6144
    s_add_u32 s85, s69, 15360
    v_mfma_f32_16x16x32_bf16 v[40:43], v[128:131], a[232:235], v[40:43]
    ds_read_b128 v[156:159], v124 offset:7168
    s_add_u32 m0, s70, 0
    v_mfma_f32_16x16x32_bf16 v[44:47], v[128:131], a[236:239], v[44:47]
    ds_read_b128 v[160:163], v124 offset:8192
    s_nop 0
    v_mfma_f32_16x16x32_bf16 v[48:51], v[132:135], a[224:227], v[48:51]
    ds_read_b128 v[164:167], v124 offset:9216
    buffer_load_dwordx4 v126, s[24:27], s85 offen offset:0 sc1 lds
    v_mfma_f32_16x16x32_bf16 v[52:55], v[132:135], a[228:231], v[52:55]
    v_mfma_f32_16x16x32_bf16 v[56:59], v[132:135], a[232:235], v[56:59]
    buffer_load_dwordx4 v126, s[24:27], s85 offen offset:1024 sc1 lds
    v_mfma_f32_16x16x32_bf16 v[60:63], v[132:135], a[236:239], v[60:63]
    v_mfma_f32_16x16x32_bf16 v[64:67], v[136:139], a[224:227], v[64:67]
    v_mfma_f32_16x16x32_bf16 v[68:71], v[136:139], a[228:231], v[68:71]
    v_mfma_f32_16x16x32_bf16 v[72:75], v[136:139], a[232:235], v[72:75]
    buffer_load_dwordx4 v126, s[24:27], s85 offen offset:2048 sc1 lds
    v_mfma_f32_16x16x32_bf16 v[76:79], v[136:139], a[236:239], v[76:79]
    v_mfma_f32_16x16x32_bf16 v[80:83], v[140:143], a[224:227], v[80:83]
    v_mfma_f32_16x16x32_bf16 v[84:87], v[140:143], a[228:231], v[84:87]
    v_mfma_f32_16x16x32_bf16 v[88:91], v[140:143], a[232:235], v[88:91]
    buffer_load_dwordx4 v126, s[24:27], s85 offen offset:3072 sc1 lds
    v_mfma_f32_16x16x32_bf16 v[92:95], v[140:143], a[236:239], v[92:95]
    v_mfma_f32_16x16x32_bf16 v[96:99], v[144:147], a[224:227], v[96:99]
    v_mfma_f32_16x16x32_bf16 v[100:103], v[144:147], a[228:231], v[100:103]
    s_add_u32 s85, s85, 4096
    s_add_u32 m0, s70, 4096
    v_mfma_f32_16x16x32_bf16 v[104:107], v[144:147], a[232:235], v[104:107]
    s_nop 0
    buffer_load_dwordx4 v126, s[24:27], s85 offen offset:0 sc1 lds
    v_mfma_f32_16x16x32_bf16 v[108:111], v[144:147], a[236:239], v[108:111]
    s_waitcnt lgkmcnt(0)
    s_lshr_b32 s88, s42, 2
    s_lshl_b32 s88, s88, 12
    s_add_u32 s88, s88, 131072
    v_and_b32 v242, 31, v0
    v_lshlrev_b32 v242, 7, v242
    v_add_u32 v242, s88, v242
    s_mov_b32 exec_lo, 0xffffffff
    s_mov_b32 exec_hi, 0x0
    s_mov_b32 s84, 1048576
L_poll_90:
    buffer_load_dwordx2 v[240:241], v242, s[24:27], 0 offen sc1
    s_waitcnt vmcnt(0)
    v_xor_b32 v240, s2, v240
    v_xor_b32 v241, s3, v241
    v_or_b32 v240, v240, v241
    v_cmp_ne_u32 vcc, 0, v240
    s_cmp_eq_u64 vcc, 0
    s_cbranch_scc1 L_polled_91
    s_sub_u32 s84, s84, 1
    s_cmp_eq_u32 s84, 0
    s_cbranch_scc1 L_polltmo_92
    s_sleep 2
    s_branch L_poll_90
L_polltmo_92:
    v_mov_b32 v240, 228
    v_mov_b32 v241, 252
    global_store_dword v241, v240, s[38:39]
L_polled_91:
    s_mov_b64 exec, -1
    s_add_u32 s89, s45, 0
    buffer_load_dwordx4 v[168:171], v126, s[24:27], s89 offen sc1
    s_add_u32 s89, s45, 20480
    buffer_load_dwordx4 v[172:175], v126, s[24:27], s89 offen sc1
    s_add_u32 s89, s45, 40960
    buffer_load_dwordx4 v[176:179], v126, s[24:27], s89 offen sc1
    s_add_u32 s89, s45, 61440
    buffer_load_dwordx4 v[180:183], v126, s[24:27], s89 offen sc1
    s_add_u32 s89, s45, 1024
    buffer_load_dwordx4 v[184:187], v126, s[24:27], s89 offen sc1
    s_add_u32 s89, s45, 21504
    buffer_load_dwordx4 v[188:191], v126, s[24:27], s89 offen sc1
    s_add_u32 s89, s45, 41984
    buffer_load_dwordx4 v[192:195], v126, s[24:27], s89 offen sc1
    s_add_u32 s89, s45, 62464
    buffer_load_dwordx4 v[196:199], v126, s[24:27], s89 offen sc1
    s_add_u32 s89, s45, 2048
    buffer_load_dwordx4 v[200:203], v126, s[24:27], s89 offen sc1
    s_add_u32 s89, s45, 22528
    buffer_load_dwordx4 v[204:207], v126, s[24:27], s89 offen sc1
    s_add_u32 s89, s45, 43008
    buffer_load_dwordx4 v[208:211], v126, s[24:27], s89 offen sc1
    s_add_u32 s89, s45, 63488
    buffer_load_dwordx4 v[212:215], v126, s[24:27], s89 offen sc1
    s_add_u32 s89, s45, 3072
    buffer_load_dwordx4 v[216:219], v126, s[24:27], s89 offen sc1
    s_add_u32 s89, s45, 23552
    buffer_load_dwordx4 v[220:223], v126, s[24:27], s89 offen sc1
    s_add_u32 s89, s45, 44032
    buffer_load_dwordx4 v[224:227], v126, s[24:27], s89 offen sc1
    s_add_u32 s89, s45, 64512
    buffer_load_dwordx4 v[228:231], v126, s[24:27], s89 offen sc1
    s_add_u32 s89, s45, 4096
    buffer_load_dwordx4 v[232:235], v126, s[24:27], s89 offen sc1
    s_add_u32 s89, s45, 24576
    buffer_load_dwordx4 v[236:239], v126, s[24:27], s89 offen sc1
    s_add_u32 s89, s45, 45056
    buffer_load_dwordx4 v[240:243], v126, s[24:27], s89 offen sc1
    s_add_u32 s89, s45, 65536
    buffer_load_dwordx4 v[244:247], v126, s[24:27], s89 offen sc1
    v_mfma_f32_16x16x32_bf16 v[32:35], v[148:151], a[240:243], v[32:35]
    ds_read_b128 v[128:131], v124 offset:10240
    v_mfma_f32_16x16x32_bf16 v[36:39], v[148:151], a[244:247], v[36:39]
    ds_read_b128 v[132:135], v124 offset:11264
    s_add_u32 s85, s69, 20480
    v_mfma_f32_16x16x32_bf16 v[40:43], v[148:151], a[248:251], v[40:43]
    ds_read_b128 v[136:139], v124 offset:12288
    s_add_u32 m0, s70, 5120
    v_mfma_f32_16x16x32_bf16 v[44:47], v[148:151], a[252:255], v[44:47]
    ds_read_b128 v[140:143], v124 offset:13312
    s_nop 0
    v_mfma_f32_16x16x32_bf16 v[48:51], v[152:155], a[240:243], v[48:51]
    ds_read_b128 v[144:147], v124 offset:14336
    buffer_load_dwordx4 v126, s[24:27], s85 offen offset:0 sc1 lds
    v_mfma_f32_16x16x32_bf16 v[52:55], v[152:155], a[244:247], v[52:55]
    v_mfma_f32_16x16x32_bf16 v[56:59], v[152:155], a[248:251], v[56:59]
    buffer_load_dwordx4 v126, s[24:27], s85 offen offset:1024 sc1 lds
    v_mfma_f32_16x16x32_bf16 v[60:63], v[152:155], a[252:255], v[60:63]
    v_mfma_f32_16x16x32_bf16 v[64:67], v[156:159], a[240:243], v[64:67]
    v_mfma_f32_16x16x32_bf16 v[68:71], v[156:159], a[244:247], v[68:71]
    v_mfma_f32_16x16x32_bf16 v[72:75], v[156:159], a[248:251], v[72:75]
    buffer_load_dwordx4 v126, s[24:27], s85 offen offset:2048 sc1 lds
    v_mfma_f32_16x16x32_bf16 v[76:79], v[156:159], a[252:255], v[76:79]
    v_mfma_f32_16x16x32_bf16 v[80:83], v[160:163], a[240:243], v[80:83]
    v_mfma_f32_16x16x32_bf16 v[84:87], v[160:163], a[244:247], v[84:87]
    v_mfma_f32_16x16x32_bf16 v[88:91], v[160:163], a[248:251], v[88:91]
    buffer_load_dwordx4 v126, s[24:27], s85 offen offset:3072 sc1 lds
    v_mfma_f32_16x16x32_bf16 v[92:95], v[160:163], a[252:255], v[92:95]
    v_mfma_f32_16x16x32_bf16 v[96:99], v[164:167], a[240:243], v[96:99]
    v_mfma_f32_16x16x32_bf16 v[100:103], v[164:167], a[244:247], v[100:103]
    s_add_u32 s85, s85, 4096
    s_add_u32 m0, s70, 9216
    v_mfma_f32_16x16x32_bf16 v[104:107], v[164:167], a[248:251], v[104:107]
    s_nop 0
    buffer_load_dwordx4 v126, s[24:27], s85 offen offset:0 sc1 lds
    v_mfma_f32_16x16x32_bf16 v[108:111], v[164:167], a[252:255], v[108:111]
    s_waitcnt lgkmcnt(0)
    s_waitcnt vmcnt(21)
    v_mfma_f32_16x16x32_bf16 v[32:35], v[128:131], v[168:171], v[32:35]
    ds_read_b128 v[148:151], v124 offset:15360
    v_mfma_f32_16x16x32_bf16 v[36:39], v[128:131], v[172:175], v[36:39]
    ds_read_b128 v[152:155], v124 offset:16384
    v_mfma_f32_16x16x32_bf16 v[40:43], v[128:131], v[176:179], v[40:43]
    ds_read_b128 v[156:159], v124 offset:17408
    v_mfma_f32_16x16x32_bf16 v[44:47], v[128:131], v[180:183], v[44:47]
    ds_read_b128 v[160:163], v124 offset:18432
    v_mfma_f32_16x16x32_bf16 v[48:51], v[132:135], v[168:171], v[48:51]
    ds_read_b128 v[164:167], v124 offset:19456
    v_mfma_f32_16x16x32_bf16 v[52:55], v[132:135], v[172:175], v[52:55]
    v_mfma_f32_16x16x32_bf16 v[56:59], v[132:135], v[176:179], v[56:59]
    v_mfma_f32_16x16x32_bf16 v[60:63], v[132:135], v[180:183], v[60:63]
    v_mfma_f32_16x16x32_bf16 v[64:67], v[136:139], v[168:171], v[64:67]
    v_mfma_f32_16x16x32_bf16 v[68:71], v[136:139], v[172:175], v[68:71]
    v_mfma_f32_16x16x32_bf16 v[72:75], v[136:139], v[176:179], v[72:75]
    v_mfma_f32_16x16x32_bf16 v[76:79], v[136:139], v[180:183], v[76:79]
    v_mfma_f32_16x16x32_bf16 v[80:83], v[140:143], v[168:171], v[80:83]
    v_mfma_f32_16x16x32_bf16 v[84:87], v[140:143], v[172:175], v[84:87]
    v_mfma_f32_16x16x32_bf16 v[88:91], v[140:143], v[176:179], v[88:91]
    v_mfma_f32_16x16x32_bf16 v[92:95], v[140:143], v[180:183], v[92:95]
    v_mfma_f32_16x16x32_bf16 v[96:99], v[144:147], v[168:171], v[96:99]
    v_mfma_f32_16x16x32_bf16 v[100:103], v[144:147], v[172:175], v[100:103]
    v_mfma_f32_16x16x32_bf16 v[104:107], v[144:147], v[176:179], v[104:107]
    v_mfma_f32_16x16x32_bf16 v[108:111], v[144:147], v[180:183], v[108:111]
    s_waitcnt lgkmcnt(0)
    s_waitcnt vmcnt(17)
    v_mfma_f32_16x16x32_bf16 v[32:35], v[148:151], v[184:187], v[32:35]
    ds_read_b128 v[128:131], v124 offset:20480
    v_mfma_f32_16x16x32_bf16 v[36:39], v[148:151], v[188:191], v[36:39]
    ds_read_b128 v[132:135], v124 offset:21504
    v_mfma_f32_16x16x32_bf16 v[40:43], v[148:151], v[192:195], v[40:43]
    ds_read_b128 v[136:139], v124 offset:22528
    v_mfma_f32_16x16x32_bf16 v[44:47], v[148:151], v[196:199], v[44:47]
    ds_read_b128 v[140:143], v124 offset:23552
    v_mfma_f32_16x16x32_bf16 v[48:51], v[152:155], v[184:187], v[48:51]
    ds_read_b128 v[144:147], v124 offset:24576
    v_mfma_f32_16x16x32_bf16 v[52:55], v[152:155], v[188:191], v[52:55]
    v_mfma_f32_16x16x32_bf16 v[56:59], v[152:155], v[192:195], v[56:59]
    v_mfma_f32_16x16x32_bf16 v[60:63], v[152:155], v[196:199], v[60:63]
    v_mfma_f32_16x16x32_bf16 v[64:67], v[156:159], v[184:187], v[64:67]
    v_mfma_f32_16x16x32_bf16 v[68:71], v[156:159], v[188:191], v[68:71]
    v_mfma_f32_16x16x32_bf16 v[72:75], v[156:159], v[192:195], v[72:75]
    v_mfma_f32_16x16x32_bf16 v[76:79], v[156:159], v[196:199], v[76:79]
    v_mfma_f32_16x16x32_bf16 v[80:83], v[160:163], v[184:187], v[80:83]
    v_mfma_f32_16x16x32_bf16 v[84:87], v[160:163], v[188:191], v[84:87]
    v_mfma_f32_16x16x32_bf16 v[88:91], v[160:163], v[192:195], v[88:91]
    v_mfma_f32_16x16x32_bf16 v[92:95], v[160:163], v[196:199], v[92:95]
    v_mfma_f32_16x16x32_bf16 v[96:99], v[164:167], v[184:187], v[96:99]
    v_mfma_f32_16x16x32_bf16 v[100:103], v[164:167], v[188:191], v[100:103]
    v_mfma_f32_16x16x32_bf16 v[104:107], v[164:167], v[192:195], v[104:107]
    v_mfma_f32_16x16x32_bf16 v[108:111], v[164:167], v[196:199], v[108:111]
    s_waitcnt lgkmcnt(0)
    s_waitcnt vmcnt(13)
    v_mfma_f32_16x16x32_bf16 v[32:35], v[128:131], v[200:203], v[32:35]
    ds_read_b128 v[148:151], v124 offset:0
    v_mfma_f32_16x16x32_bf16 v[36:39], v[128:131], v[204:207], v[36:39]
    ds_read_b128 v[152:155], v124 offset:1024
    v_mfma_f32_16x16x32_bf16 v[40:43], v[128:131], v[208:211], v[40:43]
    ds_read_b128 v[156:159], v124 offset:2048
    v_mfma_f32_16x16x32_bf16 v[44:47], v[128:131], v[212:215], v[44:47]
    ds_read_b128 v[160:163], v124 offset:3072
    v_mfma_f32_16x16x32_bf16 v[48:51], v[132:135], v[200:203], v[48:51]
    ds_read_b128 v[164:167], v124 offset:4096
    v_mfma_f32_16x16x32_bf16 v[52:55], v[132:135], v[204:207], v[52:55]
    v_mfma_f32_16x16x32_bf16 v[56:59], v[132:135], v[208:211], v[56:59]
    v_mfma_f32_16x16x32_bf16 v[60:63], v[132:135], v[212:215], v[60:63]
    v_mfma_f32_16x16x32_bf16 v[64:67], v[136:139], v[200:203], v[64:67]
    v_mfma_f32_16x16x32_bf16 v[68:71], v[136:139], v[204:207], v[68:71]
    v_mfma_f32_16x16x32_bf16 v[72:75], v[136:139], v[208:211], v[72:75]
    v_mfma_f32_16x16x32_bf16 v[76:79], v[136:139], v[212:215], v[76:79]
    v_mfma_f32_16x16x32_bf16 v[80:83], v[140:143], v[200:203], v[80:83]
    v_mfma_f32_16x16x32_bf16 v[84:87], v[140:143], v[204:207], v[84:87]
    v_mfma_f32_16x16x32_bf16 v[88:91], v[140:143], v[208:211], v[88:91]
    v_mfma_f32_16x16x32_bf16 v[92:95], v[140:143], v[212:215], v[92:95]
    v_mfma_f32_16x16x32_bf16 v[96:99], v[144:147], v[200:203], v[96:99]
    v_mfma_f32_16x16x32_bf16 v[100:103], v[144:147], v[204:207], v[100:103]
    v_mfma_f32_16x16x32_bf16 v[104:107], v[144:147], v[208:211], v[104:107]
    v_mfma_f32_16x16x32_bf16 v[108:111], v[144:147], v[212:215], v[108:111]
    s_waitcnt lgkmcnt(0)
    s_waitcnt vmcnt(0)
    v_mfma_f32_16x16x32_bf16 v[32:35], v[148:151], v[216:219], v[32:35]
    ds_read_b128 v[128:131], v124 offset:5120
    v_mfma_f32_16x16x32_bf16 v[36:39], v[148:151], v[220:223], v[36:39]
    ds_read_b128 v[132:135], v124 offset:6144
    v_mfma_f32_16x16x32_bf16 v[40:43], v[148:151], v[224:227], v[40:43]
    ds_read_b128 v[136:139], v124 offset:7168
    v_mfma_f32_16x16x32_bf16 v[44:47], v[148:151], v[228:231], v[44:47]
    ds_read_b128 v[140:143], v124 offset:8192
    v_mfma_f32_16x16x32_bf16 v[48:51], v[152:155], v[216:219], v[48:51]
    ds_read_b128 v[144:147], v124 offset:9216
    v_mfma_f32_16x16x32_bf16 v[52:55], v[152:155], v[220:223], v[52:55]
    v_mfma_f32_16x16x32_bf16 v[56:59], v[152:155], v[224:227], v[56:59]
    v_mfma_f32_16x16x32_bf16 v[60:63], v[152:155], v[228:231], v[60:63]
    v_mfma_f32_16x16x32_bf16 v[64:67], v[156:159], v[216:219], v[64:67]
    v_mfma_f32_16x16x32_bf16 v[68:71], v[156:159], v[220:223], v[68:71]
    v_mfma_f32_16x16x32_bf16 v[72:75], v[156:159], v[224:227], v[72:75]
    v_mfma_f32_16x16x32_bf16 v[76:79], v[156:159], v[228:231], v[76:79]
    v_mfma_f32_16x16x32_bf16 v[80:83], v[160:163], v[216:219], v[80:83]
    v_mfma_f32_16x16x32_bf16 v[84:87], v[160:163], v[220:223], v[84:87]
    v_mfma_f32_16x16x32_bf16 v[88:91], v[160:163], v[224:227], v[88:91]
    v_mfma_f32_16x16x32_bf16 v[92:95], v[160:163], v[228:231], v[92:95]
    v_mfma_f32_16x16x32_bf16 v[96:99], v[164:167], v[216:219], v[96:99]
    v_mfma_f32_16x16x32_bf16 v[100:103], v[164:167], v[220:223], v[100:103]
    v_mfma_f32_16x16x32_bf16 v[104:107], v[164:167], v[224:227], v[104:107]
    v_mfma_f32_16x16x32_bf16 v[108:111], v[164:167], v[228:231], v[108:111]
    s_waitcnt lgkmcnt(0)
    v_mfma_f32_16x16x32_bf16 v[32:35], v[128:131], v[232:235], v[32:35]
    v_mfma_f32_16x16x32_bf16 v[36:39], v[128:131], v[236:239], v[36:39]
    v_mfma_f32_16x16x32_bf16 v[40:43], v[128:131], v[240:243], v[40:43]
    v_mfma_f32_16x16x32_bf16 v[44:47], v[128:131], v[244:247], v[44:47]
    v_mfma_f32_16x16x32_bf16 v[48:51], v[132:135], v[232:235], v[48:51]
    v_mfma_f32_16x16x32_bf16 v[52:55], v[132:135], v[236:239], v[52:55]
    v_mfma_f32_16x16x32_bf16 v[56:59], v[132:135], v[240:243], v[56:59]
    v_mfma_f32_16x16x32_bf16 v[60:63], v[132:135], v[244:247], v[60:63]
    v_mfma_f32_16x16x32_bf16 v[64:67], v[136:139], v[232:235], v[64:67]
    v_mfma_f32_16x16x32_bf16 v[68:71], v[136:139], v[236:239], v[68:71]
    v_mfma_f32_16x16x32_bf16 v[72:75], v[136:139], v[240:243], v[72:75]
    v_mfma_f32_16x16x32_bf16 v[76:79], v[136:139], v[244:247], v[76:79]
    v_mfma_f32_16x16x32_bf16 v[80:83], v[140:143], v[232:235], v[80:83]
    v_mfma_f32_16x16x32_bf16 v[84:87], v[140:143], v[236:239], v[84:87]
    v_mfma_f32_16x16x32_bf16 v[88:91], v[140:143], v[240:243], v[88:91]
    v_mfma_f32_16x16x32_bf16 v[92:95], v[140:143], v[244:247], v[92:95]
    v_mfma_f32_16x16x32_bf16 v[96:99], v[144:147], v[232:235], v[96:99]
    v_mfma_f32_16x16x32_bf16 v[100:103], v[144:147], v[236:239], v[100:103]
    v_mfma_f32_16x16x32_bf16 v[104:107], v[144:147], v[240:243], v[104:107]
    v_mfma_f32_16x16x32_bf16 v[108:111], v[144:147], v[244:247], v[108:111]
    s_mov_b32 s56, 1.0
    s_mov_b32 s57, 1.0
    s_nop 7
    s_waitcnt lgkmcnt(0)
    s_barrier
    s_cmp_lg_u32 s40, 0
    s_cbranch_scc1 L_pw1_94
    ds_write_b128 v16, v[36:39] offset:5120
    ds_write_b128 v16, v[52:55] offset:6144
    ds_write_b128 v16, v[68:71] offset:7168
    ds_write_b128 v16, v[84:87] offset:8192
    ds_write_b128 v16, v[100:103] offset:9216
    ds_write_b128 v16, v[40:43] offset:10240
    ds_write_b128 v16, v[56:59] offset:11264
    ds_write_b128 v16, v[72:75] offset:12288
    ds_write_b128 v16, v[88:91] offset:13312
    ds_write_b128 v16, v[104:107] offset:14336
    ds_write_b128 v16, v[44:47] offset:15360
    ds_write_b128 v16, v[60:63] offset:16384
    ds_write_b128 v16, v[76:79] offset:17408
    ds_write_b128 v16, v[92:95] offset:18432
    ds_write_b128 v16, v[108:111] offset:19456
    s_branch L_pwj_97
L_pw1_94:
    s_cmp_lg_u32 s40, 1
    s_cbranch_scc1 L_pw2_95
    ds_write_b128 v16, v[32:35] offset:0
    ds_write_b128 v16, v[48:51] offset:1024
    ds_write_b128 v16, v[64:67] offset:2048
    ds_write_b128 v16, v[80:83] offset:3072
    ds_write_b128 v16, v[96:99] offset:4096
    ds_write_b128 v16, v[40:43] offset:10240
    ds_write_b128 v16, v[56:59] offset:11264
    ds_write_b128 v16, v[72:75] offset:12288
    ds_write_b128 v16, v[88:91] offset:13312
    ds_write_b128 v16, v[104:107] offset:14336
    ds_write_b128 v16, v[44:47] offset:15360
    ds_write_b128 v16, v[60:63] offset:16384
    ds_write_b128 v16, v[76:79] offset:17408
    ds_write_b128 v16, v[92:95] offset:18432
    ds_write_b128 v16, v[108:111] offset:19456
    v_pk_mul_f32 v[32:33], v[36:37], s[56:57]
    v_pk_mul_f32 v[34:35], v[38:39], s[56:57]
    v_pk_mul_f32 v[48:49], v[52:53], s[56:57]
    v_pk_mul_f32 v[50:51], v[54:55], s[56:57]
    v_pk_mul_f32 v[64:65], v[68:69], s[56:57]
    v_pk_mul_f32 v[66:67], v[70:71], s[56:57]
    v_pk_mul_f32 v[80:81], v[84:85], s[56:57]
    v_pk_mul_f32 v[82:83], v[86:87], s[56:57]
    v_pk_mul_f32 v[96:97], v[100:101], s[56:57]
    v_pk_mul_f32 v[98:99], v[102:103], s[56:57]
    s_branch L_pwj_97
L_pw2_95:
    s_cmp_lg_u32 s40, 2
    s_cbranch_scc1 L_pw3_96
    ds_write_b128 v16, v[32:35] offset:0
    ds_write_b128 v16, v[48:51] offset:1024
    ds_write_b128 v16, v[64:67] offset:2048
    ds_write_b128 v16, v[80:83] offset:3072
    ds_write_b128 v16, v[96:99] offset:4096
    ds_write_b128 v16, v[36:39] offset:5120
    ds_write_b128 v16, v[52:55] offset:6144
    ds_write_b128 v16, v[68:71] offset:7168
    ds_write_b128 v16, v[84:87] offset:8192
    ds_write_b128 v16, v[100:103] offset:9216
    ds_write_b128 v16, v[44:47] offset:15360
    ds_write_b128 v16, v[60:63] offset:16384
    ds_write_b128 v16, v[76:79] offset:17408
    ds_write_b128 v16, v[92:95] offset:18432
    ds_write_b128 v16, v[108:111] offset:19456
    v_pk_mul_f32 v[32:33], v[40:41], s[56:57]
    v_pk_mul_f32 v[34:35], v[42:43], s[56:57]
    v_pk_mul_f32 v[48:49], v[56:57], s[56:57]
    v_pk_mul_f32 v[50:51], v[58:59], s[56:57]
    v_pk_mul_f32 v[64:65], v[72:73], s[56:57]
    v_pk_mul_f32 v[66:67], v[74:75], s[56:57]
    v_pk_mul_f32 v[80:81], v[88:89], s[56:57]
    v_pk_mul_f32 v[82:83], v[90:91], s[56:57]
    v_pk_mul_f32 v[96:97], v[104:105], s[56:57]
    v_pk_mul_f32 v[98:99], v[106:107], s[56:57]
    s_branch L_pwj_97
L_pw3_96:
    ds_write_b128 v16, v[32:35] offset:0
    ds_write_b128 v16, v[48:51] offset:1024
    ds_write_b128 v16, v[64:67] offset:2048
    ds_write_b128 v16, v[80:83] offset:3072
    ds_write_b128 v16, v[96:99] offset:4096
    ds_write_b128 v16, v[36:39] offset:5120
    ds_write_b128 v16, v[52:55] offset:6144
    ds_write_b128 v16, v[68:71] offset:7168
    ds_write_b128 v16, v[84:87] offset:8192
    ds_write_b128 v16, v[100:103] offset:9216
    ds_write_b128 v16, v[40:43] offset:10240
    ds_write_b128 v16, v[56:59] offset:11264
    ds_write_b128 v16, v[72:75] offset:12288
    ds_write_b128 v16, v[88:91] offset:13312
    ds_write_b128 v16, v[104:107] offset:14336
    v_pk_mul_f32 v[32:33], v[44:45], s[56:57]
    v_pk_mul_f32 v[34:35], v[46:47], s[56:57]
    v_pk_mul_f32 v[48:49], v[60:61], s[56:57]
    v_pk_mul_f32 v[50:51], v[62:63], s[56:57]
    v_pk_mul_f32 v[64:65], v[76:77], s[56:57]
    v_pk_mul_f32 v[66:67], v[78:79], s[56:57]
    v_pk_mul_f32 v[80:81], v[92:93], s[56:57]
    v_pk_mul_f32 v[82:83], v[94:95], s[56:57]
    v_pk_mul_f32 v[96:97], v[108:109], s[56:57]
    v_pk_mul_f32 v[98:99], v[110:111], s[56:57]
L_pwj_97:
    s_waitcnt lgkmcnt(0)
    s_barrier
    s_add_u32 s57, s40, 1
    s_and_b32 s57, s57, 3
    s_mul_i32 s57, s57, 20480
    v_add_u32 v21, s57, v17
    s_add_u32 s57, s40, 2
    s_and_b32 s57, s57, 3
    s_mul_i32 s57, s57, 20480
    v_add_u32 v22, s57, v17
    s_add_u32 s57, s40, 3
    s_and_b32 s57, s57, 3
    s_mul_i32 s57, s57, 20480
    v_add_u32 v23, s57, v17
    ds_read_b128 v[128:131], v21 offset:0
    ds_read_b128 v[132:135], v21 offset:1024
    ds_read_b128 v[136:139], v21 offset:2048
    ds_read_b128 v[140:143], v21 offset:3072
    ds_read_b128 v[144:147], v21 offset:4096
    ds_read_b128 v[148:151], v22 offset:0
    ds_read_b128 v[152:155], v22 offset:1024
    ds_read_b128 v[156:159], v22 offset:2048
    ds_read_b128 v[160:163], v22 offset:3072
    ds_read_b128 v[164:167], v22 offset:4096
    ds_read_b128 v[168:171], v23 offset:0
    ds_read_b128 v[172:175], v23 offset:1024
    ds_read_b128 v[176:179], v23 offset:2048
    ds_read_b128 v[180:183], v23 offset:3072
    ds_read_b128 v[184:187], v23 offset:4096
    v_lshlrev_b32 v24, 16, v6
    v_and_b32 v25, 0xffff0000, v6
    v_lshlrev_b32 v26, 16, v7
    v_and_b32 v27, 0xffff0000, v7
    v_pk_fma_f32 v[32:33], v[24:25], v[4:5], v[32:33] op_sel_hi:[1,0,1]
    v_pk_fma_f32 v[34:35], v[26:27], v[4:5], v[34:35] op_sel_hi:[1,0,1]
    v_lshlrev_b32 v24, 16, v8
    v_and_b32 v25, 0xffff0000, v8
    v_lshlrev_b32 v26, 16, v9
    v_and_b32 v27, 0xffff0000, v9
    v_pk_fma_f32 v[48:49], v[24:25], v[4:5], v[48:49] op_sel_hi:[1,0,1]
    v_pk_fma_f32 v[50:51], v[26:27], v[4:5], v[50:51] op_sel_hi:[1,0,1]
    v_lshlrev_b32 v24, 16, v10
    v_and_b32 v25, 0xffff0000, v10
    v_lshlrev_b32 v26, 16, v11
    v_and_b32 v27, 0xffff0000, v11
    v_pk_fma_f32 v[64:65], v[24:25], v[4:5], v[64:65] op_sel_hi:[1,0,1]
    v_pk_fma_f32 v[66:67], v[26:27], v[4:5], v[66:67] op_sel_hi:[1,0,1]
    v_lshlrev_b32 v24, 16, v12
    v_and_b32 v25, 0xffff0000, v12
    v_lshlrev_b32 v26, 16, v13
    v_and_b32 v27, 0xffff0000, v13
    v_pk_fma_f32 v[80:81], v[24:25], v[4:5], v[80:81] op_sel_hi:[1,0,1]
    v_pk_fma_f32 v[82:83], v[26:27], v[4:5], v[82:83] op_sel_hi:[1,0,1]
    v_lshlrev_b32 v24, 16, v14
    v_and_b32 v25, 0xffff0000, v14
    v_lshlrev_b32 v26, 16, v15
    v_and_b32 v27, 0xffff0000, v15
    v_pk_fma_f32 v[96:97], v[24:25], v[4:5], v[96:97] op_sel_hi:[1,0,1]
    v_pk_fma_f32 v[98:99], v[26:27], v[4:5], v[98:99] op_sel_hi:[1,0,1]
    s_waitcnt lgkmcnt(0)
    v_pk_add_f32 v[32:33], v[32:33], v[128:129]
    v_pk_add_f32 v[34:35], v[34:35], v[130:131]
    v_pk_add_f32 v[32:33], v[32:33], v[148:149]
    v_pk_add_f32 v[34:35], v[34:35], v[150:151]
    v_pk_add_f32 v[32:33], v[32:33], v[168:169]
    v_pk_add_f32 v[34:35], v[34:35], v[170:171]
    v_cvt_pk_bf16_f32 v190, v32, v33
    v_cvt_pk_bf16_f32 v191, v34, v35
    v_pk_add_f32 v[48:49], v[48:49], v[132:133]
    v_pk_add_f32 v[50:51], v[50:51], v[134:135]
    v_pk_add_f32 v[48:49], v[48:49], v[152:153]
    v_pk_add_f32 v[50:51], v[50:51], v[154:155]
    v_pk_add_f32 v[48:49], v[48:49], v[172:173]
    v_pk_add_f32 v[50:51], v[50:51], v[174:175]
    v_cvt_pk_bf16_f32 v192, v48, v49
    v_cvt_pk_bf16_f32 v193, v50, v51
    v_pk_add_f32 v[64:65], v[64:65], v[136:137]
    v_pk_add_f32 v[66:67], v[66:67], v[138:139]
    v_pk_add_f32 v[64:65], v[64:65], v[156:157]
    v_pk_add_f32 v[66:67], v[66:67], v[158:159]
    v_pk_add_f32 v[64:65], v[64:65], v[176:177]
    v_pk_add_f32 v[66:67], v[66:67], v[178:179]
    v_cvt_pk_bf16_f32 v194, v64, v65
    v_cvt_pk_bf16_f32 v195, v66, v67
    v_pk_add_f32 v[80:81], v[80:81], v[140:141]
    v_pk_add_f32 v[82:83], v[82:83], v[142:143]
    v_pk_add_f32 v[80:81], v[80:81], v[160:161]
    v_pk_add_f32 v[82:83], v[82:83], v[162:163]
    v_pk_add_f32 v[80:81], v[80:81], v[180:181]
    v_pk_add_f32 v[82:83], v[82:83], v[182:183]
    v_cvt_pk_bf16_f32 v196, v80, v81
    v_cvt_pk_bf16_f32 v197, v82, v83
    v_pk_add_f32 v[96:97], v[96:97], v[144:145]
    v_pk_add_f32 v[98:99], v[98:99], v[146:147]
    v_pk_add_f32 v[96:97], v[96:97], v[164:165]
    v_pk_add_f32 v[98:99], v[98:99], v[166:167]
    v_pk_add_f32 v[96:97], v[96:97], v[184:185]
    v_pk_add_f32 v[98:99], v[98:99], v[186:187]
    v_cvt_pk_bf16_f32 v198, v96, v97
    v_cvt_pk_bf16_f32 v199, v98, v99
    s_nop 1
    v_permlane16_swap_b32 v190, v192
    v_permlane16_swap_b32 v191, v193
    buffer_store_dwordx4 v[190:193], v18, s[28:31], 0 offen offset:0
    v_permlane16_swap_b32 v194, v196
    v_permlane16_swap_b32 v195, v197
    buffer_store_dwordx4 v[194:197], v18, s[28:31], 0 offen offset:64
    buffer_store_dwordx2 v[198:199], v19, s[28:31], 0 offen offset:128
    s_waitcnt vmcnt(0)
    s_waitcnt vmcnt(0)
L_exit_gated_mix__softmax_full_mha__mixer_channel_mlp__prompt_kernel:
    s_endpgm
L_code_end:
.section .rodata,"a"
.p2align 6
.amdhsa_kernel gated_mix__softmax_full_mha__mixer_channel_mlp__prompt_kernel
  .amdhsa_next_free_vgpr 512
  .amdhsa_next_free_sgpr 102
  .amdhsa_accum_offset 256
  .amdhsa_group_segment_fixed_size 0
  .amdhsa_kernarg_size 96
  .amdhsa_user_sgpr_count 2
  .amdhsa_user_sgpr_kernarg_segment_ptr 1
  .amdhsa_system_sgpr_workgroup_id_x 1
  .amdhsa_float_denorm_mode_32 3
  .amdhsa_float_denorm_mode_16_64 3
.end_amdhsa_kernel
```
